```python
import torch

def _softmax(x, axis=-1):
    return torch.softmax(x, dim=axis)
def _gelu(x):
    return torch.nn.functional.gelu(x, approximate="tanh")
def _silu(x):
    return torch.nn.functional.silu(x)
def _sigmoid(x):
    return torch.sigmoid(x)
def _layernorm(x, axis=-1, eps=1e-5):
    m = x.mean(dim=axis, keepdim=True)
    v = x.var(dim=axis, keepdim=True, unbiased=False)
    return (x - m) / torch.sqrt(v + eps)
def _scatter_add(tgt, idx, src, axis=0):
    return tgt.clone().index_add_(axis, idx, src)
def _segment_sum(src, seg, n):
    out = torch.zeros((n,) + src.shape[1:], dtype=src.dtype)
    return out.index_add_(0, seg, src)
def _pad(x, pw):
    flat = tuple(v for pair in reversed(pw) for v in pair)
    return torch.nn.functional.pad(x, flat)

kernel_name = 'standalone__sliding_block_cached__sampling'

def setup_inputs():

    _w = (lambda a: (lambda t: t.to(torch.bfloat16) if t.is_floating_point() else t)(torch.as_tensor(a)))
    B, Sq, D = 8, 4, 640
    Hq, Hkv, Sk, Dh = 32, 32, 4096, 192
    assert Hq % Hkv == 0, (Hq, Hkv)
    return {
        "x": _w((lambda *s: torch.randn(*s, dtype=torch.bfloat16) * 0.8)(B, Sq, D)),
        "k_cache": _w((lambda *s: torch.randn(*s, dtype=torch.bfloat16) * 0.8)(B, Hkv, Sk, Dh)),
        "v_cache": _w((lambda *s: torch.randn(*s, dtype=torch.bfloat16) * 0.05)(B, Hkv, Sk, Dh)),
        "wq": _w((lambda *s: torch.randn(*s, dtype=torch.bfloat16) * 0.8)(D, Hq * Dh) * (D ** -0.5)),
        "wo": _w((lambda *s: torch.randn(*s, dtype=torch.bfloat16) * 0.05)(Hq * Dh, D) * ((Hq * Dh) ** -0.5)),
    }

def reference(x, k_cache, v_cache, wq, wo):
    B, Sq, D = x.shape
    Hq, Dh = 32, 192
    Hkv, Sk = k_cache.shape[1], k_cache.shape[2]
    W = min(4096, max(256, Sk // 4))
    rep = Hq // Hkv
    q = (lambda x, *d: x.permute(*d))((x @ wq).reshape(B, Sq, Hq, Dh), 0, 2, 1, 3)
    k = (lambda x, n, axis: torch.repeat_interleave(x, n, dim=axis))(k_cache[:, :, Sk - W:, :], rep, axis=1)
    v = (lambda x, n, axis: torch.repeat_interleave(x, n, dim=axis))(v_cache[:, :, Sk - W:, :], rep, axis=1)
    scores = torch.einsum("bhqd,bhkd->bhqk", q, k) * (Dh ** -0.5)
    p = _softmax(scores, axis=-1)
    o = torch.einsum("bhqk,bhkd->bhqd", p, v)
    return (lambda x, *d: x.permute(*d))(o, 0, 2, 1, 3).reshape(B, Sq, Hq * Dh) @ wo
```

```asm
; @launch grid=(256,1,1) block=(256,1,1) lds=162112
.amdgcn_target "amdgcn-amd-amdhsa--gfx950"
.text
.globl standalone__sliding_block_cached__sampling_kernel
.p2align 12
.p2align 8
.type standalone__sliding_block_cached__sampling_kernel,@function
standalone__sliding_block_cached__sampling_kernel:
    s_cmp_ge_u32 s2, 256
    s_cbranch_scc1 L_end
    s_memrealtime s[76:77]
    s_load_dwordx16 s[4:19], s[0:1], 0
    v_lshrrev_b32 v34, 6, v0
    v_and_b32 v1, 63, v0
    v_readfirstlane_b32 s3, v34
    s_and_b32 s53, s2, 7
    s_lshl_b32 s53, s53, 2
    s_bfe_u32 s56, s2, 0x20003
    s_add_u32 s53, s53, s56
    s_lshr_b32 s52, s2, 5
    s_mul_i32 s54, s3, 36864
    s_mul_i32 s59, s3, 1966080
    s_mul_i32 s58, s52, 56
    s_and_b32 s57, s2, 7
    s_mul_i32 s57, s57, 0
    s_mul_i32 s56, s56, 16
    s_add_u32 s58, s58, s57
    s_add_u32 s58, s58, s56
    s_mul_i32 s56, s3, 1
    s_add_u32 s58, s58, s56
    s_lshl_b32 s57, s52, 2
    s_lshr_b32 s75, 0x32103210, s57
    s_and_b32 s75, s75, 15
    s_lshr_b32 s60, 0x98754320, s57
    s_and_b32 s60, s60, 15
    s_lshr_b32 s73, 0x44524452, s57
    s_and_b32 s73, s73, 15
    s_mul_i32 s73, s73, 6144
    s_add_u32 s73, s73, s54
    s_add_u32 s61, s60, 1
    s_cmp_eq_u32 s61, 10
    s_cselect_b32 s61, 0, s61
    s_add_u32 s62, s61, 1
    s_cmp_eq_u32 s62, 10
    s_cselect_b32 s62, 0, s62
    s_add_u32 s63, s62, 1
    s_cmp_eq_u32 s63, 10
    s_cselect_b32 s63, 0, s63
    s_add_u32 s64, s63, 1
    s_cmp_eq_u32 s64, 10
    s_cselect_b32 s64, 0, s64
    s_add_u32 s65, s64, 1
    s_cmp_eq_u32 s65, 10
    s_cselect_b32 s65, 0, s65
    s_add_u32 s66, s65, 1
    s_cmp_eq_u32 s66, 10
    s_cselect_b32 s66, 0, s66
    s_add_u32 s67, s66, 1
    s_cmp_eq_u32 s67, 10
    s_cselect_b32 s67, 0, s67
    s_add_u32 s68, s67, 1
    s_cmp_eq_u32 s68, 10
    s_cselect_b32 s68, 0, s68
    s_add_u32 s69, s68, 1
    s_cmp_eq_u32 s69, 10
    s_cselect_b32 s69, 0, s69
    v_lshrrev_b32 v34, 3, v1
    v_and_b32 v35, 7, v1
    v_add_u32 v36, 0, v34
    v_mul_u32_u24 v37, 43, v36
    v_lshrrev_b32 v37, 7, v37
    v_and_b32 v38, 6, v37
    v_xor_b32 v38, v38, v35
    v_lshlrev_b32 v38, 4, v38
    v_lshl_add_u32 v2, v36, 7, v38
    v_mul_u32_u24 v37, 11904, v37
    v_add_u32 v8, v2, v37
    v_add_u32 v36, 8, v34
    v_mul_u32_u24 v37, 43, v36
    v_lshrrev_b32 v37, 7, v37
    v_and_b32 v38, 6, v37
    v_xor_b32 v38, v38, v35
    v_lshlrev_b32 v38, 4, v38
    v_lshl_add_u32 v3, v36, 7, v38
    v_mul_u32_u24 v37, 11904, v37
    v_add_u32 v9, v3, v37
    v_add_u32 v36, 16, v34
    v_mul_u32_u24 v37, 43, v36
    v_lshrrev_b32 v37, 7, v37
    v_and_b32 v38, 6, v37
    v_xor_b32 v38, v38, v35
    v_lshlrev_b32 v38, 4, v38
    v_lshl_add_u32 v4, v36, 7, v38
    v_mul_u32_u24 v37, 11904, v37
    v_add_u32 v10, v4, v37
    v_add_u32 v36, 24, v34
    v_mul_u32_u24 v37, 43, v36
    v_lshrrev_b32 v37, 7, v37
    v_and_b32 v38, 6, v37
    v_xor_b32 v38, v38, v35
    v_lshlrev_b32 v38, 4, v38
    v_lshl_add_u32 v5, v36, 7, v38
    v_mul_u32_u24 v37, 11904, v37
    v_add_u32 v11, v5, v37
    v_add_u32 v36, 32, v34
    v_mul_u32_u24 v37, 43, v36
    v_lshrrev_b32 v37, 7, v37
    v_and_b32 v38, 6, v37
    v_xor_b32 v38, v38, v35
    v_lshlrev_b32 v38, 4, v38
    v_lshl_add_u32 v6, v36, 7, v38
    v_mul_u32_u24 v37, 11904, v37
    v_add_u32 v12, v6, v37
    v_add_u32 v36, 40, v34
    v_mul_u32_u24 v37, 43, v36
    v_lshrrev_b32 v37, 7, v37
    v_and_b32 v38, 6, v37
    v_xor_b32 v38, v38, v35
    v_lshlrev_b32 v38, 4, v38
    v_lshl_add_u32 v7, v36, 7, v38
    v_mul_u32_u24 v37, 11904, v37
    v_add_u32 v13, v7, v37
    v_lshrrev_b32 v34, 4, v1
    v_and_b32 v35, 3, v1
    v_mul_u32_u24 v36, 205, v1
    v_lshrrev_b32 v36, 12, v36
    v_mul_u32_u24 v36, 960, v36
    v_lshl_add_u32 v36, v1, 4, v36
    s_mul_i32 s56, s3, 320
    v_add_u32 v255, s56, v36
    v_lshlrev_b32 v36, 4, v1
    v_add_u32 v36, 3904, v36
    v_add_u32 v252, s56, v36
    s_mul_i32 s74, s3, 3136
    s_add_u32 s74, s74, 147456
    s_mul_i32 s55, s60, 196608
    s_add_u32 s55, s55, s59
    s_waitcnt lgkmcnt(0)
    s_mul_i32 s56, s52, 5120
    s_add_u32 s36, s4, s56
    s_addc_u32 s37, s5, 0
    s_and_b32 s37, s37, 0xffff
    s_mov_b32 s38, 5120
    s_mov_b32 s39, 0x20000
    s_mov_b32 m0, s74
    s_nop 0
    buffer_load_dwordx4 v255, s[36:39], 0 offen lds
    s_add_u32 m0, s74, 1024
    s_mov_b64 exec, 0xffff
    buffer_load_dwordx4 v252, s[36:39], 0 offen lds
    s_mov_b64 exec, -1
    s_mul_i32 s56, s53, 384
    s_sub_u32 s57, 7864320, s56
    s_add_u32 s28, s10, s56
    s_addc_u32 s29, s11, 0
    s_and_b32 s29, s29, 0xffff
    s_mov_b32 s30, s57
    s_mov_b32 s31, 0x20000
    s_add_u32 m0, s73, 0
    s_nop 0
    buffer_load_dwordx4 v8, s[28:31], s55 offen  lds
    s_add_u32 m0, s73, 1024
    s_nop 0
    buffer_load_dwordx4 v9, s[28:31], s55 offen  lds
    s_add_u32 m0, s73, 2048
    s_nop 0
    buffer_load_dwordx4 v10, s[28:31], s55 offen  lds
    s_add_u32 m0, s73, 3072
    s_nop 0
    buffer_load_dwordx4 v11, s[28:31], s55 offen  lds
    s_add_u32 m0, s73, 4096
    s_nop 0
    buffer_load_dwordx4 v12, s[28:31], s55 offen  lds
    s_add_u32 m0, s73, 5120
    s_nop 0
    buffer_load_dwordx4 v13, s[28:31], s55 offen  lds
    s_lshl_b32 s56, s52, 5
    s_add_u32 s56, s56, s53
    s_mul_i32 s56, s56, 1572864
    s_add_u32 s56, s56, 1179648
    s_add_u32 s20, s6, s56
    s_addc_u32 s21, s7, 0
    s_and_b32 s21, s21, 0xffff
    s_mov_b32 s22, 393216
    s_mov_b32 s23, 0x20000
    s_add_u32 s24, s8, s56
    s_addc_u32 s25, s9, 0
    s_and_b32 s25, s25, 0xffff
    s_mov_b32 s26, 393216
    s_mov_b32 s27, 0x20000
    s_cmp_eq_u32 s75, 1
    s_cbranch_scc1 L_grp_1
    s_cmp_eq_u32 s75, 2
    s_cbranch_scc1 L_grp_2
    s_cmp_eq_u32 s75, 3
    s_cbranch_scc1 L_grp_3
    s_mul_i32 s55, s61, 196608
    s_add_u32 s55, s55, s59
    s_add_u32 m0, s54, 18432
    s_nop 0
    buffer_load_dwordx4 v8, s[28:31], s55 offen  lds
    s_add_u32 m0, s54, 19456
    s_nop 0
    buffer_load_dwordx4 v9, s[28:31], s55 offen  lds
    s_add_u32 m0, s54, 20480
    s_nop 0
    buffer_load_dwordx4 v10, s[28:31], s55 offen  lds
    s_add_u32 m0, s54, 21504
    s_nop 0
    buffer_load_dwordx4 v11, s[28:31], s55 offen  lds
    s_mov_b32 s70, 0x3d93cd3a
    s_mov_b32 s71, 0x3fb8aa3b
    s_mul_i32 s56, s53, 245760
    s_add_u32 s32, s12, s56
    s_addc_u32 s33, s13, 0
    s_and_b32 s33, s33, 0xffff
    s_mov_b32 s34, 245760
    s_mov_b32 s35, 0x20000
    s_mul_i32 s56, s3, 320
    v_add_u32 v36, 0, v1
    v_mul_u32_u24 v37, 205, v36
    v_lshrrev_b32 v37, 12, v37
    v_mul_u32_u24 v37, 960, v37
    v_lshl_add_u32 v37, v36, 4, v37
    v_add_u32 v14, s56, v37
    v_add_u32 v36, 64, v1
    v_mul_u32_u24 v37, 205, v36
    v_lshrrev_b32 v37, 12, v37
    v_mul_u32_u24 v37, 960, v37
    v_lshl_add_u32 v37, v36, 4, v37
    v_add_u32 v15, s56, v37
    v_add_u32 v36, 128, v1
    v_mul_u32_u24 v37, 205, v36
    v_lshrrev_b32 v37, 12, v37
    v_mul_u32_u24 v37, 960, v37
    v_lshl_add_u32 v37, v36, 4, v37
    v_add_u32 v16, s56, v37
    v_add_u32 v36, 192, v1
    v_mul_u32_u24 v37, 205, v36
    v_lshrrev_b32 v37, 12, v37
    v_mul_u32_u24 v37, 960, v37
    v_lshl_add_u32 v37, v36, 4, v37
    v_add_u32 v17, s56, v37
    v_add_u32 v36, 256, v1
    v_mul_u32_u24 v37, 205, v36
    v_lshrrev_b32 v37, 12, v37
    v_mul_u32_u24 v37, 960, v37
    v_lshl_add_u32 v37, v36, 4, v37
    v_add_u32 v18, s56, v37
    v_and_b32 v36, 15, v1
    v_and_b32 v37, 6, v36
    v_xor_b32 v37, v37, v34
    v_lshlrev_b32 v37, 4, v37
    v_mul_u32_u24 v36, 384, v36
    v_add3_u32 v19, v36, v37, s54
    v_xor_b32 v20, 64, v19
    v_lshrrev_b32 v36, 2, v1
    v_and_b32 v37, 6, v36
    v_lshlrev_b32 v37, 4, v37
    v_lshl_add_u32 v37, v35, 3, v37
    v_mul_u32_u24 v38, 384, v36
    v_add3_u32 v21, v38, v37, s54
    v_xor_b32 v22, 32, v21
    v_xor_b32 v23, 64, v21
    v_xor_b32 v24, 96, v21
    v_mul_u32_u24 v38, 320, v36
    v_lshl_add_u32 v38, v35, 3, v38
    v_add_u32 v25, s54, v38
    v_mul_u32_u24 v36, 784, v35
    v_lshl_add_u32 v36, v34, 4, v36
    v_add_u32 v26, s74, v36
    v_mul_u32_u24 v37, 1366, v0
    v_lshrrev_b32 v37, 16, v37
    v_lshlrev_b32 v37, 4, v37
    v_lshl_add_u32 v36, v0, 4, v37
    v_add_u32 v27, 147456, v36
    v_lshl_add_u32 v36, v0, 3, v37
    v_add_u32 v28, 160000, v36
    v_mul_u32_u24 v36, 400, v35
    v_add_u32 v36, 160000, v36
    v_lshl_add_u32 v29, v34, 4, v36
    v_lshlrev_b32 v36, 6, v35
    v_add_u32 v32, 161600, v36
    s_lshl_b32 s56, s3, 4
    v_lshl_add_u32 v36, v34, 2, v32
    v_add_u32 v31, s56, v36
    v_lshlrev_b32 v30, 4, v1
    s_lshr_b32 s79, s52, 2
    s_mul_i32 s79, s79, 122880
    s_mul_i32 s56, s3, 9216
    s_add_u32 s79, s79, s56
    s_add_u32 s79, s79, 0
    v_mul_u32_u24 v36, 320, v35
    v_lshl_add_u32 v36, v34, 3, v36
    v_add_u32 v36, s74, v36
    s_waitcnt vmcnt(10)
    v_lshl_add_u32 v37, s60, 5, v36
    ds_read_b64 v[232:233], v37
    v_lshl_add_u32 v37, s61, 5, v36
    ds_read_b64 v[234:235], v37
    v_lshl_add_u32 v37, s62, 5, v36
    ds_read_b64 v[236:237], v37
    v_lshl_add_u32 v37, s63, 5, v36
    ds_read_b64 v[238:239], v37
    v_lshl_add_u32 v37, s64, 5, v36
    ds_read_b64 v[240:241], v37
    v_lshl_add_u32 v37, s65, 5, v36
    ds_read_b64 v[242:243], v37
    v_lshl_add_u32 v37, s66, 5, v36
    ds_read_b64 v[244:245], v37
    v_lshl_add_u32 v37, s67, 5, v36
    ds_read_b64 v[246:247], v37
    v_lshl_add_u32 v37, s68, 5, v36
    ds_read_b64 v[248:249], v37
    v_lshl_add_u32 v37, s69, 5, v36
    ds_read_b64 v[250:251], v37
    s_add_u32 m0, s54, 22528
    s_nop 0
    buffer_load_dwordx4 v12, s[28:31], s55 offen  lds
    s_add_u32 m0, s54, 23552
    s_nop 0
    buffer_load_dwordx4 v13, s[28:31], s55 offen  lds
    s_waitcnt vmcnt(11)
    s_mul_i32 s55, s62, 196608
    s_add_u32 s55, s55, s59
    s_add_u32 m0, s54, 24576
    s_nop 0
    buffer_load_dwordx4 v8, s[28:31], s55 offen  lds
    s_waitcnt vmcnt(11)
    s_add_u32 m0, s54, 25600
    s_nop 0
    buffer_load_dwordx4 v9, s[28:31], s55 offen  lds
    s_waitcnt vmcnt(11)
    s_add_u32 m0, s54, 26624
    s_nop 0
    buffer_load_dwordx4 v10, s[28:31], s55 offen  lds
    s_waitcnt vmcnt(11)
    s_add_u32 m0, s54, 27648
    s_nop 0
    buffer_load_dwordx4 v11, s[28:31], s55 offen  lds
    s_waitcnt vmcnt(11)
    s_add_u32 m0, s54, 28672
    s_nop 0
    buffer_load_dwordx4 v12, s[28:31], s55 offen  lds
    s_waitcnt vmcnt(11)
    s_add_u32 m0, s54, 29696
    s_nop 0
    buffer_load_dwordx4 v13, s[28:31], s55 offen  lds
    ds_read_b64_tr_b16 v[40:41], v21 offset:12288
    ds_read_b64_tr_b16 v[42:43], v22 offset:12288
    ds_read_b64_tr_b16 v[44:45], v23 offset:12288
    ds_read_b64_tr_b16 v[46:47], v24 offset:12288
    ds_read_b64_tr_b16 v[48:49], v21 offset:12416
    ds_read_b64_tr_b16 v[50:51], v22 offset:12416
    ds_read_b64_tr_b16 v[52:53], v23 offset:12416
    ds_read_b64_tr_b16 v[54:55], v24 offset:12416
    ds_read_b64_tr_b16 v[56:57], v21 offset:12544
    ds_read_b64_tr_b16 v[58:59], v22 offset:12544
    ds_read_b64_tr_b16 v[60:61], v23 offset:12544
    ds_read_b64_tr_b16 v[62:63], v24 offset:12544
    s_waitcnt lgkmcnt(0)
    v_mfma_f32_16x16x16_bf16 v[64:67], v[40:41], v[232:233], 0
    v_mfma_f32_16x16x16_bf16 v[68:71], v[42:43], v[232:233], 0
    v_mfma_f32_16x16x16_bf16 v[72:75], v[44:45], v[232:233], 0
    v_mfma_f32_16x16x16_bf16 v[76:79], v[46:47], v[232:233], 0
    v_mfma_f32_16x16x16_bf16 v[80:83], v[48:49], v[232:233], 0
    v_mfma_f32_16x16x16_bf16 v[84:87], v[50:51], v[232:233], 0
    v_mfma_f32_16x16x16_bf16 v[88:91], v[52:53], v[232:233], 0
    v_mfma_f32_16x16x16_bf16 v[92:95], v[54:55], v[232:233], 0
    v_mfma_f32_16x16x16_bf16 v[96:99], v[56:57], v[232:233], 0
    v_mfma_f32_16x16x16_bf16 v[100:103], v[58:59], v[232:233], 0
    v_mfma_f32_16x16x16_bf16 v[104:107], v[60:61], v[232:233], 0
    v_mfma_f32_16x16x16_bf16 v[108:111], v[62:63], v[232:233], 0
    s_waitcnt vmcnt(11)
    s_mul_i32 s55, s63, 196608
    s_add_u32 s55, s55, s59
    s_add_u32 m0, s54, 30720
    s_nop 0
    buffer_load_dwordx4 v8, s[28:31], s55 offen  lds
    s_waitcnt vmcnt(11)
    s_add_u32 m0, s54, 31744
    s_nop 0
    buffer_load_dwordx4 v9, s[28:31], s55 offen  lds
    s_waitcnt vmcnt(11)
    s_add_u32 m0, s54, 32768
    s_nop 0
    buffer_load_dwordx4 v10, s[28:31], s55 offen  lds
    s_waitcnt vmcnt(11)
    s_add_u32 m0, s54, 33792
    s_nop 0
    buffer_load_dwordx4 v11, s[28:31], s55 offen  lds
    s_waitcnt vmcnt(11)
    s_add_u32 m0, s54, 34816
    s_nop 0
    buffer_load_dwordx4 v12, s[28:31], s55 offen  lds
    s_waitcnt vmcnt(11)
    s_add_u32 m0, s54, 35840
    s_nop 0
    buffer_load_dwordx4 v13, s[28:31], s55 offen  lds
    ds_read_b64_tr_b16 v[40:41], v21 offset:18432
    ds_read_b64_tr_b16 v[42:43], v22 offset:18432
    ds_read_b64_tr_b16 v[44:45], v23 offset:18432
    ds_read_b64_tr_b16 v[46:47], v24 offset:18432
    ds_read_b64_tr_b16 v[48:49], v21 offset:18560
    ds_read_b64_tr_b16 v[50:51], v22 offset:18560
    ds_read_b64_tr_b16 v[52:53], v23 offset:18560
    ds_read_b64_tr_b16 v[54:55], v24 offset:18560
    ds_read_b64_tr_b16 v[56:57], v21 offset:18688
    ds_read_b64_tr_b16 v[58:59], v22 offset:18688
    ds_read_b64_tr_b16 v[60:61], v23 offset:18688
    ds_read_b64_tr_b16 v[62:63], v24 offset:18688
    s_waitcnt lgkmcnt(0)
    v_mfma_f32_16x16x16_bf16 v[64:67], v[40:41], v[234:235], v[64:67]
    v_mfma_f32_16x16x16_bf16 v[68:71], v[42:43], v[234:235], v[68:71]
    v_mfma_f32_16x16x16_bf16 v[72:75], v[44:45], v[234:235], v[72:75]
    v_mfma_f32_16x16x16_bf16 v[76:79], v[46:47], v[234:235], v[76:79]
    v_mfma_f32_16x16x16_bf16 v[80:83], v[48:49], v[234:235], v[80:83]
    v_mfma_f32_16x16x16_bf16 v[84:87], v[50:51], v[234:235], v[84:87]
    v_mfma_f32_16x16x16_bf16 v[88:91], v[52:53], v[234:235], v[88:91]
    v_mfma_f32_16x16x16_bf16 v[92:95], v[54:55], v[234:235], v[92:95]
    v_mfma_f32_16x16x16_bf16 v[96:99], v[56:57], v[234:235], v[96:99]
    v_mfma_f32_16x16x16_bf16 v[100:103], v[58:59], v[234:235], v[100:103]
    v_mfma_f32_16x16x16_bf16 v[104:107], v[60:61], v[234:235], v[104:107]
    v_mfma_f32_16x16x16_bf16 v[108:111], v[62:63], v[234:235], v[108:111]
    s_waitcnt vmcnt(11)
    s_mul_i32 s55, s64, 196608
    s_add_u32 s55, s55, s59
    s_add_u32 m0, s54, 0
    s_nop 0
    buffer_load_dwordx4 v8, s[28:31], s55 offen  lds
    s_waitcnt vmcnt(11)
    s_add_u32 m0, s54, 1024
    s_nop 0
    buffer_load_dwordx4 v9, s[28:31], s55 offen  lds
    s_waitcnt vmcnt(11)
    s_add_u32 m0, s54, 2048
    s_nop 0
    buffer_load_dwordx4 v10, s[28:31], s55 offen  lds
    s_waitcnt vmcnt(11)
    s_add_u32 m0, s54, 3072
    s_nop 0
    buffer_load_dwordx4 v11, s[28:31], s55 offen  lds
    s_waitcnt vmcnt(11)
    s_add_u32 m0, s54, 4096
    s_nop 0
    buffer_load_dwordx4 v12, s[28:31], s55 offen  lds
    s_waitcnt vmcnt(11)
    s_add_u32 m0, s54, 5120
    s_nop 0
    buffer_load_dwordx4 v13, s[28:31], s55 offen  lds
    ds_read_b64_tr_b16 v[40:41], v21 offset:24576
    ds_read_b64_tr_b16 v[42:43], v22 offset:24576
    ds_read_b64_tr_b16 v[44:45], v23 offset:24576
    ds_read_b64_tr_b16 v[46:47], v24 offset:24576
    ds_read_b64_tr_b16 v[48:49], v21 offset:24704
    ds_read_b64_tr_b16 v[50:51], v22 offset:24704
    ds_read_b64_tr_b16 v[52:53], v23 offset:24704
    ds_read_b64_tr_b16 v[54:55], v24 offset:24704
    ds_read_b64_tr_b16 v[56:57], v21 offset:24832
    ds_read_b64_tr_b16 v[58:59], v22 offset:24832
    ds_read_b64_tr_b16 v[60:61], v23 offset:24832
    ds_read_b64_tr_b16 v[62:63], v24 offset:24832
    s_waitcnt lgkmcnt(0)
    v_mfma_f32_16x16x16_bf16 v[64:67], v[40:41], v[236:237], v[64:67]
    v_mfma_f32_16x16x16_bf16 v[68:71], v[42:43], v[236:237], v[68:71]
    v_mfma_f32_16x16x16_bf16 v[72:75], v[44:45], v[236:237], v[72:75]
    v_mfma_f32_16x16x16_bf16 v[76:79], v[46:47], v[236:237], v[76:79]
    v_mfma_f32_16x16x16_bf16 v[80:83], v[48:49], v[236:237], v[80:83]
    v_mfma_f32_16x16x16_bf16 v[84:87], v[50:51], v[236:237], v[84:87]
    v_mfma_f32_16x16x16_bf16 v[88:91], v[52:53], v[236:237], v[88:91]
    v_mfma_f32_16x16x16_bf16 v[92:95], v[54:55], v[236:237], v[92:95]
    v_mfma_f32_16x16x16_bf16 v[96:99], v[56:57], v[236:237], v[96:99]
    v_mfma_f32_16x16x16_bf16 v[100:103], v[58:59], v[236:237], v[100:103]
    v_mfma_f32_16x16x16_bf16 v[104:107], v[60:61], v[236:237], v[104:107]
    v_mfma_f32_16x16x16_bf16 v[108:111], v[62:63], v[236:237], v[108:111]
    s_waitcnt vmcnt(11)
    s_mul_i32 s55, s65, 196608
    s_add_u32 s55, s55, s59
    s_add_u32 m0, s54, 6144
    s_nop 0
    buffer_load_dwordx4 v8, s[28:31], s55 offen  lds
    s_waitcnt vmcnt(11)
    s_add_u32 m0, s54, 7168
    s_nop 0
    buffer_load_dwordx4 v9, s[28:31], s55 offen  lds
    s_waitcnt vmcnt(11)
    s_add_u32 m0, s54, 8192
    s_nop 0
    buffer_load_dwordx4 v10, s[28:31], s55 offen  lds
    s_waitcnt vmcnt(11)
    s_add_u32 m0, s54, 9216
    s_nop 0
    buffer_load_dwordx4 v11, s[28:31], s55 offen  lds
    s_waitcnt vmcnt(11)
    s_add_u32 m0, s54, 10240
    s_nop 0
    buffer_load_dwordx4 v12, s[28:31], s55 offen  lds
    s_waitcnt vmcnt(11)
    s_add_u32 m0, s54, 11264
    s_nop 0
    buffer_load_dwordx4 v13, s[28:31], s55 offen  lds
    ds_read_b64_tr_b16 v[40:41], v21 offset:30720
    ds_read_b64_tr_b16 v[42:43], v22 offset:30720
    ds_read_b64_tr_b16 v[44:45], v23 offset:30720
    ds_read_b64_tr_b16 v[46:47], v24 offset:30720
    ds_read_b64_tr_b16 v[48:49], v21 offset:30848
    ds_read_b64_tr_b16 v[50:51], v22 offset:30848
    ds_read_b64_tr_b16 v[52:53], v23 offset:30848
    ds_read_b64_tr_b16 v[54:55], v24 offset:30848
    ds_read_b64_tr_b16 v[56:57], v21 offset:30976
    ds_read_b64_tr_b16 v[58:59], v22 offset:30976
    ds_read_b64_tr_b16 v[60:61], v23 offset:30976
    ds_read_b64_tr_b16 v[62:63], v24 offset:30976
    s_waitcnt lgkmcnt(0)
    v_mfma_f32_16x16x16_bf16 v[64:67], v[40:41], v[238:239], v[64:67]
    v_mfma_f32_16x16x16_bf16 v[68:71], v[42:43], v[238:239], v[68:71]
    v_mfma_f32_16x16x16_bf16 v[72:75], v[44:45], v[238:239], v[72:75]
    v_mfma_f32_16x16x16_bf16 v[76:79], v[46:47], v[238:239], v[76:79]
    v_mfma_f32_16x16x16_bf16 v[80:83], v[48:49], v[238:239], v[80:83]
    v_mfma_f32_16x16x16_bf16 v[84:87], v[50:51], v[238:239], v[84:87]
    v_mfma_f32_16x16x16_bf16 v[88:91], v[52:53], v[238:239], v[88:91]
    v_mfma_f32_16x16x16_bf16 v[92:95], v[54:55], v[238:239], v[92:95]
    v_mfma_f32_16x16x16_bf16 v[96:99], v[56:57], v[238:239], v[96:99]
    v_mfma_f32_16x16x16_bf16 v[100:103], v[58:59], v[238:239], v[100:103]
    v_mfma_f32_16x16x16_bf16 v[104:107], v[60:61], v[238:239], v[104:107]
    v_mfma_f32_16x16x16_bf16 v[108:111], v[62:63], v[238:239], v[108:111]
    s_waitcnt vmcnt(11)
    s_mul_i32 s55, s66, 196608
    s_add_u32 s55, s55, s59
    s_add_u32 m0, s54, 12288
    s_nop 0
    buffer_load_dwordx4 v8, s[28:31], s55 offen  lds
    s_waitcnt vmcnt(11)
    s_add_u32 m0, s54, 13312
    s_nop 0
    buffer_load_dwordx4 v9, s[28:31], s55 offen  lds
    s_waitcnt vmcnt(11)
    s_add_u32 m0, s54, 14336
    s_nop 0
    buffer_load_dwordx4 v10, s[28:31], s55 offen  lds
    s_waitcnt vmcnt(11)
    s_add_u32 m0, s54, 15360
    s_nop 0
    buffer_load_dwordx4 v11, s[28:31], s55 offen  lds
    s_waitcnt vmcnt(11)
    s_add_u32 m0, s54, 16384
    s_nop 0
    buffer_load_dwordx4 v12, s[28:31], s55 offen  lds
    s_waitcnt vmcnt(11)
    s_add_u32 m0, s54, 17408
    s_nop 0
    buffer_load_dwordx4 v13, s[28:31], s55 offen  lds
    ds_read_b64_tr_b16 v[40:41], v21 offset:0
    ds_read_b64_tr_b16 v[42:43], v22 offset:0
    ds_read_b64_tr_b16 v[44:45], v23 offset:0
    ds_read_b64_tr_b16 v[46:47], v24 offset:0
    ds_read_b64_tr_b16 v[48:49], v21 offset:128
    ds_read_b64_tr_b16 v[50:51], v22 offset:128
    ds_read_b64_tr_b16 v[52:53], v23 offset:128
    ds_read_b64_tr_b16 v[54:55], v24 offset:128
    ds_read_b64_tr_b16 v[56:57], v21 offset:256
    ds_read_b64_tr_b16 v[58:59], v22 offset:256
    ds_read_b64_tr_b16 v[60:61], v23 offset:256
    ds_read_b64_tr_b16 v[62:63], v24 offset:256
    s_waitcnt lgkmcnt(0)
    v_mfma_f32_16x16x16_bf16 v[64:67], v[40:41], v[240:241], v[64:67]
    v_mfma_f32_16x16x16_bf16 v[68:71], v[42:43], v[240:241], v[68:71]
    v_mfma_f32_16x16x16_bf16 v[72:75], v[44:45], v[240:241], v[72:75]
    v_mfma_f32_16x16x16_bf16 v[76:79], v[46:47], v[240:241], v[76:79]
    v_mfma_f32_16x16x16_bf16 v[80:83], v[48:49], v[240:241], v[80:83]
    v_mfma_f32_16x16x16_bf16 v[84:87], v[50:51], v[240:241], v[84:87]
    v_mfma_f32_16x16x16_bf16 v[88:91], v[52:53], v[240:241], v[88:91]
    v_mfma_f32_16x16x16_bf16 v[92:95], v[54:55], v[240:241], v[92:95]
    v_mfma_f32_16x16x16_bf16 v[96:99], v[56:57], v[240:241], v[96:99]
    v_mfma_f32_16x16x16_bf16 v[100:103], v[58:59], v[240:241], v[100:103]
    v_mfma_f32_16x16x16_bf16 v[104:107], v[60:61], v[240:241], v[104:107]
    v_mfma_f32_16x16x16_bf16 v[108:111], v[62:63], v[240:241], v[108:111]
    s_waitcnt vmcnt(11)
    s_mul_i32 s55, s67, 196608
    s_add_u32 s55, s55, s59
    s_add_u32 m0, s54, 18432
    s_nop 0
    buffer_load_dwordx4 v8, s[28:31], s55 offen  lds
    s_waitcnt vmcnt(11)
    s_add_u32 m0, s54, 19456
    s_nop 0
    buffer_load_dwordx4 v9, s[28:31], s55 offen  lds
    s_waitcnt vmcnt(11)
    s_add_u32 m0, s54, 20480
    s_nop 0
    buffer_load_dwordx4 v10, s[28:31], s55 offen  lds
    s_waitcnt vmcnt(11)
    s_add_u32 m0, s54, 21504
    s_nop 0
    buffer_load_dwordx4 v11, s[28:31], s55 offen  lds
    s_waitcnt vmcnt(11)
    s_add_u32 m0, s54, 22528
    s_nop 0
    buffer_load_dwordx4 v12, s[28:31], s55 offen  lds
    s_waitcnt vmcnt(11)
    s_add_u32 m0, s54, 23552
    s_nop 0
    buffer_load_dwordx4 v13, s[28:31], s55 offen  lds
    ds_read_b64_tr_b16 v[40:41], v21 offset:6144
    ds_read_b64_tr_b16 v[42:43], v22 offset:6144
    ds_read_b64_tr_b16 v[44:45], v23 offset:6144
    ds_read_b64_tr_b16 v[46:47], v24 offset:6144
    ds_read_b64_tr_b16 v[48:49], v21 offset:6272
    ds_read_b64_tr_b16 v[50:51], v22 offset:6272
    ds_read_b64_tr_b16 v[52:53], v23 offset:6272
    ds_read_b64_tr_b16 v[54:55], v24 offset:6272
    ds_read_b64_tr_b16 v[56:57], v21 offset:6400
    ds_read_b64_tr_b16 v[58:59], v22 offset:6400
    ds_read_b64_tr_b16 v[60:61], v23 offset:6400
    ds_read_b64_tr_b16 v[62:63], v24 offset:6400
    s_waitcnt lgkmcnt(0)
    v_mfma_f32_16x16x16_bf16 v[64:67], v[40:41], v[242:243], v[64:67]
    v_mfma_f32_16x16x16_bf16 v[68:71], v[42:43], v[242:243], v[68:71]
    v_mfma_f32_16x16x16_bf16 v[72:75], v[44:45], v[242:243], v[72:75]
    v_mfma_f32_16x16x16_bf16 v[76:79], v[46:47], v[242:243], v[76:79]
    v_mfma_f32_16x16x16_bf16 v[80:83], v[48:49], v[242:243], v[80:83]
    v_mfma_f32_16x16x16_bf16 v[84:87], v[50:51], v[242:243], v[84:87]
    v_mfma_f32_16x16x16_bf16 v[88:91], v[52:53], v[242:243], v[88:91]
    v_mfma_f32_16x16x16_bf16 v[92:95], v[54:55], v[242:243], v[92:95]
    v_mfma_f32_16x16x16_bf16 v[96:99], v[56:57], v[242:243], v[96:99]
    v_mfma_f32_16x16x16_bf16 v[100:103], v[58:59], v[242:243], v[100:103]
    v_mfma_f32_16x16x16_bf16 v[104:107], v[60:61], v[242:243], v[104:107]
    v_mfma_f32_16x16x16_bf16 v[108:111], v[62:63], v[242:243], v[108:111]
    s_waitcnt vmcnt(11)
    s_mul_i32 s55, s68, 196608
    s_add_u32 s55, s55, s59
    s_add_u32 m0, s54, 24576
    s_nop 0
    buffer_load_dwordx4 v8, s[28:31], s55 offen  lds
    s_waitcnt vmcnt(11)
    s_add_u32 m0, s54, 25600
    s_nop 0
    buffer_load_dwordx4 v9, s[28:31], s55 offen  lds
    s_waitcnt vmcnt(11)
    s_add_u32 m0, s54, 26624
    s_nop 0
    buffer_load_dwordx4 v10, s[28:31], s55 offen  lds
    s_waitcnt vmcnt(11)
    s_add_u32 m0, s54, 27648
    s_nop 0
    buffer_load_dwordx4 v11, s[28:31], s55 offen  lds
    s_waitcnt vmcnt(11)
    s_add_u32 m0, s54, 28672
    s_nop 0
    buffer_load_dwordx4 v12, s[28:31], s55 offen  lds
    s_waitcnt vmcnt(11)
    s_add_u32 m0, s54, 29696
    s_nop 0
    buffer_load_dwordx4 v13, s[28:31], s55 offen  lds
    ds_read_b64_tr_b16 v[40:41], v21 offset:12288
    ds_read_b64_tr_b16 v[42:43], v22 offset:12288
    ds_read_b64_tr_b16 v[44:45], v23 offset:12288
    ds_read_b64_tr_b16 v[46:47], v24 offset:12288
    ds_read_b64_tr_b16 v[48:49], v21 offset:12416
    ds_read_b64_tr_b16 v[50:51], v22 offset:12416
    ds_read_b64_tr_b16 v[52:53], v23 offset:12416
    ds_read_b64_tr_b16 v[54:55], v24 offset:12416
    ds_read_b64_tr_b16 v[56:57], v21 offset:12544
    ds_read_b64_tr_b16 v[58:59], v22 offset:12544
    ds_read_b64_tr_b16 v[60:61], v23 offset:12544
    ds_read_b64_tr_b16 v[62:63], v24 offset:12544
    s_waitcnt lgkmcnt(0)
    v_mfma_f32_16x16x16_bf16 v[64:67], v[40:41], v[244:245], v[64:67]
    v_mfma_f32_16x16x16_bf16 v[68:71], v[42:43], v[244:245], v[68:71]
    v_mfma_f32_16x16x16_bf16 v[72:75], v[44:45], v[244:245], v[72:75]
    v_mfma_f32_16x16x16_bf16 v[76:79], v[46:47], v[244:245], v[76:79]
    v_mfma_f32_16x16x16_bf16 v[80:83], v[48:49], v[244:245], v[80:83]
    v_mfma_f32_16x16x16_bf16 v[84:87], v[50:51], v[244:245], v[84:87]
    v_mfma_f32_16x16x16_bf16 v[88:91], v[52:53], v[244:245], v[88:91]
    v_mfma_f32_16x16x16_bf16 v[92:95], v[54:55], v[244:245], v[92:95]
    v_mfma_f32_16x16x16_bf16 v[96:99], v[56:57], v[244:245], v[96:99]
    v_mfma_f32_16x16x16_bf16 v[100:103], v[58:59], v[244:245], v[100:103]
    v_mfma_f32_16x16x16_bf16 v[104:107], v[60:61], v[244:245], v[104:107]
    v_mfma_f32_16x16x16_bf16 v[108:111], v[62:63], v[244:245], v[108:111]
    s_waitcnt vmcnt(11)
    s_mul_i32 s55, s69, 196608
    s_add_u32 s55, s55, s59
    s_add_u32 m0, s54, 30720
    s_nop 0
    buffer_load_dwordx4 v8, s[28:31], s55 offen  lds
    s_waitcnt vmcnt(11)
    s_add_u32 m0, s54, 31744
    s_nop 0
    buffer_load_dwordx4 v9, s[28:31], s55 offen  lds
    s_waitcnt vmcnt(11)
    s_add_u32 m0, s54, 32768
    s_nop 0
    buffer_load_dwordx4 v10, s[28:31], s55 offen  lds
    s_waitcnt vmcnt(11)
    s_add_u32 m0, s54, 33792
    s_nop 0
    buffer_load_dwordx4 v11, s[28:31], s55 offen  lds
    s_waitcnt vmcnt(11)
    s_add_u32 m0, s54, 34816
    s_nop 0
    buffer_load_dwordx4 v12, s[28:31], s55 offen  lds
    s_waitcnt vmcnt(11)
    s_add_u32 m0, s54, 35840
    s_nop 0
    buffer_load_dwordx4 v13, s[28:31], s55 offen  lds
    ds_read_b64_tr_b16 v[40:41], v21 offset:18432
    ds_read_b64_tr_b16 v[42:43], v22 offset:18432
    ds_read_b64_tr_b16 v[44:45], v23 offset:18432
    ds_read_b64_tr_b16 v[46:47], v24 offset:18432
    ds_read_b64_tr_b16 v[48:49], v21 offset:18560
    ds_read_b64_tr_b16 v[50:51], v22 offset:18560
    ds_read_b64_tr_b16 v[52:53], v23 offset:18560
    ds_read_b64_tr_b16 v[54:55], v24 offset:18560
    ds_read_b64_tr_b16 v[56:57], v21 offset:18688
    ds_read_b64_tr_b16 v[58:59], v22 offset:18688
    ds_read_b64_tr_b16 v[60:61], v23 offset:18688
    ds_read_b64_tr_b16 v[62:63], v24 offset:18688
    s_waitcnt lgkmcnt(0)
    v_mfma_f32_16x16x16_bf16 v[64:67], v[40:41], v[246:247], v[64:67]
    v_mfma_f32_16x16x16_bf16 v[68:71], v[42:43], v[246:247], v[68:71]
    v_mfma_f32_16x16x16_bf16 v[72:75], v[44:45], v[246:247], v[72:75]
    v_mfma_f32_16x16x16_bf16 v[76:79], v[46:47], v[246:247], v[76:79]
    v_mfma_f32_16x16x16_bf16 v[80:83], v[48:49], v[246:247], v[80:83]
    v_mfma_f32_16x16x16_bf16 v[84:87], v[50:51], v[246:247], v[84:87]
    v_mfma_f32_16x16x16_bf16 v[88:91], v[52:53], v[246:247], v[88:91]
    v_mfma_f32_16x16x16_bf16 v[92:95], v[54:55], v[246:247], v[92:95]
    v_mfma_f32_16x16x16_bf16 v[96:99], v[56:57], v[246:247], v[96:99]
    v_mfma_f32_16x16x16_bf16 v[100:103], v[58:59], v[246:247], v[100:103]
    v_mfma_f32_16x16x16_bf16 v[104:107], v[60:61], v[246:247], v[104:107]
    v_mfma_f32_16x16x16_bf16 v[108:111], v[62:63], v[246:247], v[108:111]
    s_waitcnt vmcnt(11)
    s_add_u32 s55, s58, 0
    s_and_b32 s55, s55, 63
    s_mul_i32 s55, s55, 6144
    s_add_u32 m0, s54, 0
    s_nop 0
    buffer_load_dwordx4 v2, s[20:23], s55 offen nt lds
    s_waitcnt vmcnt(11)
    s_add_u32 m0, s54, 1024
    s_nop 0
    buffer_load_dwordx4 v3, s[20:23], s55 offen nt lds
    s_waitcnt vmcnt(11)
    s_add_u32 m0, s54, 2048
    s_nop 0
    buffer_load_dwordx4 v4, s[20:23], s55 offen nt lds
    s_waitcnt vmcnt(11)
    s_add_u32 m0, s54, 3072
    s_nop 0
    buffer_load_dwordx4 v5, s[20:23], s55 offen nt lds
    s_waitcnt vmcnt(11)
    s_add_u32 m0, s54, 4096
    s_nop 0
    buffer_load_dwordx4 v6, s[20:23], s55 offen nt lds
    s_waitcnt vmcnt(11)
    s_add_u32 m0, s54, 5120
    s_nop 0
    buffer_load_dwordx4 v7, s[20:23], s55 offen nt lds
    ds_read_b64_tr_b16 v[40:41], v21 offset:24576
    ds_read_b64_tr_b16 v[42:43], v22 offset:24576
    ds_read_b64_tr_b16 v[44:45], v23 offset:24576
    ds_read_b64_tr_b16 v[46:47], v24 offset:24576
    ds_read_b64_tr_b16 v[48:49], v21 offset:24704
    ds_read_b64_tr_b16 v[50:51], v22 offset:24704
    ds_read_b64_tr_b16 v[52:53], v23 offset:24704
    ds_read_b64_tr_b16 v[54:55], v24 offset:24704
    ds_read_b64_tr_b16 v[56:57], v21 offset:24832
    ds_read_b64_tr_b16 v[58:59], v22 offset:24832
    ds_read_b64_tr_b16 v[60:61], v23 offset:24832
    ds_read_b64_tr_b16 v[62:63], v24 offset:24832
    s_waitcnt lgkmcnt(0)
    v_mfma_f32_16x16x16_bf16 v[64:67], v[40:41], v[248:249], v[64:67]
    v_mfma_f32_16x16x16_bf16 v[68:71], v[42:43], v[248:249], v[68:71]
    v_mfma_f32_16x16x16_bf16 v[72:75], v[44:45], v[248:249], v[72:75]
    v_mfma_f32_16x16x16_bf16 v[76:79], v[46:47], v[248:249], v[76:79]
    v_mfma_f32_16x16x16_bf16 v[80:83], v[48:49], v[248:249], v[80:83]
    v_mfma_f32_16x16x16_bf16 v[84:87], v[50:51], v[248:249], v[84:87]
    v_mfma_f32_16x16x16_bf16 v[88:91], v[52:53], v[248:249], v[88:91]
    v_mfma_f32_16x16x16_bf16 v[92:95], v[54:55], v[248:249], v[92:95]
    v_mfma_f32_16x16x16_bf16 v[96:99], v[56:57], v[248:249], v[96:99]
    v_mfma_f32_16x16x16_bf16 v[100:103], v[58:59], v[248:249], v[100:103]
    v_mfma_f32_16x16x16_bf16 v[104:107], v[60:61], v[248:249], v[104:107]
    v_mfma_f32_16x16x16_bf16 v[108:111], v[62:63], v[248:249], v[108:111]
    s_waitcnt vmcnt(11)
    s_add_u32 s55, s58, 4
    s_and_b32 s55, s55, 63
    s_mul_i32 s55, s55, 6144
    s_add_u32 m0, s54, 6144
    s_nop 0
    buffer_load_dwordx4 v2, s[20:23], s55 offen nt lds
    s_waitcnt vmcnt(11)
    s_add_u32 m0, s54, 7168
    s_nop 0
    buffer_load_dwordx4 v3, s[20:23], s55 offen nt lds
    s_waitcnt vmcnt(11)
    s_add_u32 m0, s54, 8192
    s_nop 0
    buffer_load_dwordx4 v4, s[20:23], s55 offen nt lds
    s_waitcnt vmcnt(11)
    s_add_u32 m0, s54, 9216
    s_nop 0
    buffer_load_dwordx4 v5, s[20:23], s55 offen nt lds
    s_waitcnt vmcnt(11)
    s_add_u32 m0, s54, 10240
    s_nop 0
    buffer_load_dwordx4 v6, s[20:23], s55 offen nt lds
    s_waitcnt vmcnt(11)
    s_add_u32 m0, s54, 11264
    s_nop 0
    buffer_load_dwordx4 v7, s[20:23], s55 offen nt lds
    ds_read_b64_tr_b16 v[40:41], v21 offset:30720
    ds_read_b64_tr_b16 v[42:43], v22 offset:30720
    ds_read_b64_tr_b16 v[44:45], v23 offset:30720
    ds_read_b64_tr_b16 v[46:47], v24 offset:30720
    ds_read_b64_tr_b16 v[48:49], v21 offset:30848
    ds_read_b64_tr_b16 v[50:51], v22 offset:30848
    ds_read_b64_tr_b16 v[52:53], v23 offset:30848
    ds_read_b64_tr_b16 v[54:55], v24 offset:30848
    ds_read_b64_tr_b16 v[56:57], v21 offset:30976
    ds_read_b64_tr_b16 v[58:59], v22 offset:30976
    ds_read_b64_tr_b16 v[60:61], v23 offset:30976
    ds_read_b64_tr_b16 v[62:63], v24 offset:30976
    s_waitcnt lgkmcnt(0)
    v_mfma_f32_16x16x16_bf16 v[64:67], v[40:41], v[250:251], v[64:67]
    v_mfma_f32_16x16x16_bf16 v[68:71], v[42:43], v[250:251], v[68:71]
    v_mfma_f32_16x16x16_bf16 v[72:75], v[44:45], v[250:251], v[72:75]
    v_mfma_f32_16x16x16_bf16 v[76:79], v[46:47], v[250:251], v[76:79]
    v_mfma_f32_16x16x16_bf16 v[80:83], v[48:49], v[250:251], v[80:83]
    v_mfma_f32_16x16x16_bf16 v[84:87], v[50:51], v[250:251], v[84:87]
    v_mfma_f32_16x16x16_bf16 v[88:91], v[52:53], v[250:251], v[88:91]
    v_mfma_f32_16x16x16_bf16 v[92:95], v[54:55], v[250:251], v[92:95]
    v_mfma_f32_16x16x16_bf16 v[96:99], v[56:57], v[250:251], v[96:99]
    v_mfma_f32_16x16x16_bf16 v[100:103], v[58:59], v[250:251], v[100:103]
    v_mfma_f32_16x16x16_bf16 v[104:107], v[60:61], v[250:251], v[104:107]
    v_mfma_f32_16x16x16_bf16 v[108:111], v[62:63], v[250:251], v[108:111]
    s_mov_b32 exec_lo, 0x000f000f
    s_mov_b32 exec_hi, 0x000f000f
    ds_write_b128 v26, v[64:67] offset:0
    ds_write_b128 v26, v[68:71] offset:64
    ds_write_b128 v26, v[72:75] offset:128
    ds_write_b128 v26, v[76:79] offset:192
    ds_write_b128 v26, v[80:83] offset:256
    ds_write_b128 v26, v[84:87] offset:320
    ds_write_b128 v26, v[88:91] offset:384
    ds_write_b128 v26, v[92:95] offset:448
    ds_write_b128 v26, v[96:99] offset:512
    ds_write_b128 v26, v[100:103] offset:576
    ds_write_b128 v26, v[104:107] offset:640
    ds_write_b128 v26, v[108:111] offset:704
    s_mov_b64 exec, -1
    s_add_u32 s55, s58, 8
    s_and_b32 s55, s55, 63
    s_mul_i32 s55, s55, 6144
    s_add_u32 m0, s54, 12288
    s_nop 0
    buffer_load_dwordx4 v2, s[20:23], s55 offen nt lds
    s_add_u32 m0, s54, 13312
    s_nop 0
    buffer_load_dwordx4 v3, s[20:23], s55 offen nt lds
    s_add_u32 m0, s54, 14336
    s_nop 0
    buffer_load_dwordx4 v4, s[20:23], s55 offen nt lds
    s_waitcnt lgkmcnt(0)
    s_barrier
    s_cmp_eq_u32 s3, 3
    s_cbranch_scc1 L_qred_0
    ds_read_b128 v[40:43], v27 offset:0
    ds_read_b128 v[44:47], v27 offset:3136
    ds_read_b128 v[48:51], v27 offset:6272
    ds_read_b128 v[52:55], v27 offset:9408
    s_waitcnt lgkmcnt(0)
    v_add_f32 v40, v40, v44
    v_add_f32 v41, v41, v45
    v_add_f32 v42, v42, v46
    v_add_f32 v43, v43, v47
    v_add_f32 v48, v48, v52
    v_add_f32 v49, v49, v53
    v_add_f32 v50, v50, v54
    v_add_f32 v51, v51, v55
    v_add_f32 v40, v40, v48
    v_add_f32 v41, v41, v49
    v_add_f32 v42, v42, v50
    v_add_f32 v43, v43, v51
    v_cvt_pk_bf16_f32 v44, v40, v41
    v_cvt_pk_bf16_f32 v45, v42, v43
    ds_write_b64 v28, v[44:45]
    s_waitcnt lgkmcnt(0)
L_qred_0:
    s_add_u32 m0, s54, 15360
    s_nop 0
    buffer_load_dwordx4 v5, s[20:23], s55 offen nt lds
    s_add_u32 m0, s54, 16384
    s_nop 0
    buffer_load_dwordx4 v6, s[20:23], s55 offen nt lds
    s_add_u32 m0, s54, 17408
    s_nop 0
    buffer_load_dwordx4 v7, s[20:23], s55 offen nt lds
    s_barrier
    ds_read_b128 v[112:115], v29 offset:0
    ds_read_b128 v[116:119], v29 offset:64
    ds_read_b128 v[120:123], v29 offset:128
    ds_read_b128 v[124:127], v29 offset:192
    ds_read_b128 v[128:131], v29 offset:256
    ds_read_b128 v[132:135], v29 offset:320
    v_mov_b32 v33, 0xff800000
    s_add_u32 s55, s58, 12
    s_and_b32 s55, s55, 63
    s_mul_i32 s55, s55, 6144
    s_add_u32 m0, s54, 18432
    s_nop 0
    buffer_load_dwordx4 v2, s[20:23], s55 offen nt lds
    s_waitcnt lgkmcnt(0)
    s_waitcnt vmcnt(13)
    ds_read_b128 v[40:43], v19 offset:0
    ds_read_b128 v[44:47], v20 offset:0
    ds_read_b128 v[48:51], v19 offset:128
    ds_read_b128 v[52:55], v20 offset:128
    ds_read_b128 v[56:59], v19 offset:256
    ds_read_b128 v[60:63], v20 offset:256
    s_waitcnt lgkmcnt(0)
    v_mfma_f32_16x16x32_bf16 v[136:139], v[40:43], v[112:115], 0
    v_mfma_f32_16x16x32_bf16 v[136:139], v[44:47], v[116:119], v[136:139]
    v_mfma_f32_16x16x32_bf16 v[136:139], v[48:51], v[120:123], v[136:139]
    v_mfma_f32_16x16x32_bf16 v[136:139], v[52:55], v[124:127], v[136:139]
    v_mfma_f32_16x16x32_bf16 v[136:139], v[56:59], v[128:131], v[136:139]
    v_mfma_f32_16x16x32_bf16 v[136:139], v[60:63], v[132:135], v[136:139]
    s_waitcnt vmcnt(10)
    s_add_u32 m0, s54, 19456
    s_nop 0
    buffer_load_dwordx4 v3, s[20:23], s55 offen nt lds
    s_waitcnt vmcnt(10)
    s_add_u32 m0, s54, 20480
    s_nop 0
    buffer_load_dwordx4 v4, s[20:23], s55 offen nt lds
    s_mul_i32 s56, s52, 327680
    s_lshl_b32 s57, s53, 7
    s_add_u32 s56, s56, s57
    s_sub_u32 s57, 327680, s57
    s_add_u32 s40, s18, s56
    s_addc_u32 s41, s19, 0
    s_and_b32 s41, s41, 0xffff
    s_mov_b32 s42, s57
    s_mov_b32 s43, 0x20000
    v_and_b32 v36, 1, v34
    v_lshl_add_u32 v36, v36, 2, v35
    v_lshlrev_b32 v36, 4, v36
    v_lshrrev_b32 v37, 1, v34
    v_lshl_add_u32 v36, v37, 12, v36
    s_mul_i32 s56, s3, 81920
    v_add_u32 v39, s56, v36
    v_and_b32 v36, 12, v1
    v_lshl_add_u32 v39, v36, 11, v39
    v_and_b32 v36, 8, v1
    v_lshl_add_u32 v255, v36, 24, v39
    s_mov_b32 s60, 0
    s_mov_b32 s61, 32768
    s_mov_b32 s62, 65536
    s_mov_b32 s48, s16
    s_and_b32 s49, s17, 0xffff
    s_mov_b32 s50, 256
    s_mov_b32 s51, 0x20000
    s_and_b32 s56, s52, 1
    s_lshl_b32 s56, s56, 7
    s_lshl_b32 s57, s52, 1
    s_and_b32 s57, s57, 12
    s_add_u32 s78, s56, s57
    v_xor_b32 v36, 192, v0
    v_or_b32 v36, s53, v36
    v_lshlrev_b32 v253, 8, v36
    s_mul_i32 s56, s76, 0x9e3779b1
    s_or_b32 s56, s56, 1
    v_mov_b32 v252, s56
    buffer_store_dword v252, v253, s[48:51], s78 offen sc1
    s_lshl_b32 s72, s3, 5
    s_add_u32 s72, s72, s53
    s_mul_i32 s56, s52, 80
    s_add_u32 s56, s56, s72
    s_lshl_b32 s56, s56, 12
    s_cmp_lt_u32 s72, 80
    s_cselect_b32 s57, 4096, 0
    s_add_u32 s28, s18, s56
    s_addc_u32 s29, s19, 0
    s_and_b32 s29, s29, 0xffff
    s_mov_b32 s30, s57
    s_mov_b32 s31, 0x20000
    s_mul_i32 s56, s52, 5120
    s_add_u32 s44, s14, s56
    s_addc_u32 s45, s15, 0
    s_and_b32 s45, s45, 0xffff
    s_mov_b32 s46, 5120
    s_mov_b32 s47, 0x20000
    v_lshlrev_b32 v232, 4, v1
    v_add_u32 v233, 4096, v232
    v_add_u32 v235, s54, v232
    v_mul_u32_u24 v234, 1280, v35
    v_and_b32 v36, 4, v1
    v_lshl_add_u32 v234, v36, 1, v234
    v_and_b32 v36, 8, v1
    v_lshl_add_u32 v234, v36, 20, v234
    v_bfe_u32 v36, v1, 4, 1
    v_lshl_add_u32 v234, v36, 2, v234
    v_lshrrev_b32 v36, 5, v1
    v_lshl_add_u32 v234, v36, 1, v234
    s_lshl_b32 s56, s72, 4
    v_add_u32 v234, s56, v234
    v_lshrrev_b32 v36, 3, v1
    v_and_b32 v37, 6, v36
    v_and_b32 v38, 7, v1
    v_xor_b32 v37, v37, v38
    v_lshlrev_b32 v37, 4, v37
    v_mul_u32_u24 v36, 384, v36
    v_add_u32 v236, v36, v37
    v_add_u32 v237, 3072, v236
    v_lshrrev_b32 v36, 2, v1
    v_and_b32 v37, 6, v36
    v_lshlrev_b32 v37, 4, v37
    v_lshl_add_u32 v37, v35, 3, v37
    v_lshlrev_b32 v36, 7, v36
    v_add3_u32 v238, v36, v37, s54
    v_xor_b32 v239, 32, v238
    v_xor_b32 v240, 64, v238
    v_xor_b32 v241, 96, v238
    v_and_b32 v36, 15, v1
    v_lshlrev_b32 v36, 4, v36
    v_lshl_add_u32 v36, v34, 8, v36
    v_add_u32 v243, 147456, v36
    s_lshl_b32 s56, s3, 6
    v_add_u32 v242, s56, v243
    s_waitcnt vmcnt(11)
    s_add_u32 m0, s54, 21504
    s_nop 0
    buffer_load_dwordx4 v5, s[20:23], s55 offen nt lds
    s_waitcnt vmcnt(11)
    s_add_u32 m0, s54, 22528
    s_nop 0
    buffer_load_dwordx4 v6, s[20:23], s55 offen nt lds
    ds_read_b128 v[40:43], v19 offset:6144
    ds_read_b128 v[44:47], v20 offset:6144
    ds_read_b128 v[48:51], v19 offset:6272
    ds_read_b128 v[52:55], v20 offset:6272
    ds_read_b128 v[56:59], v19 offset:6400
    ds_read_b128 v[60:63], v20 offset:6400
    s_nop 1
    v_cvt_pk_bf16_f32 v36, v136, v137
    v_cvt_pk_bf16_f32 v37, v138, v139
    v_lshlrev_b32 v136, 16, v36
    v_and_b32 v137, 0xffff0000, v36
    v_lshlrev_b32 v138, 16, v37
    v_and_b32 v139, 0xffff0000, v37
    v_mul_f32 v136, s70, v136
    v_mul_f32 v137, s70, v137
    v_mul_f32 v138, s70, v138
    v_mul_f32 v139, s70, v139
    v_cvt_pk_bf16_f32 v36, v136, v137
    v_cvt_pk_bf16_f32 v37, v138, v139
    v_lshlrev_b32 v136, 16, v36
    v_and_b32 v137, 0xffff0000, v36
    v_lshlrev_b32 v138, 16, v37
    v_and_b32 v139, 0xffff0000, v37
    v_max3_f32 v33, v33, v136, v137
    v_max3_f32 v33, v33, v138, v139
    s_waitcnt lgkmcnt(0)
    v_mfma_f32_16x16x32_bf16 v[140:143], v[40:43], v[112:115], 0
    v_mfma_f32_16x16x32_bf16 v[140:143], v[44:47], v[116:119], v[140:143]
    v_mfma_f32_16x16x32_bf16 v[140:143], v[48:51], v[120:123], v[140:143]
    v_mfma_f32_16x16x32_bf16 v[140:143], v[52:55], v[124:127], v[140:143]
    v_mfma_f32_16x16x32_bf16 v[140:143], v[56:59], v[128:131], v[140:143]
    v_mfma_f32_16x16x32_bf16 v[140:143], v[60:63], v[132:135], v[140:143]
    s_waitcnt vmcnt(11)
    s_add_u32 m0, s54, 23552
    s_nop 0
    buffer_load_dwordx4 v7, s[20:23], s55 offen nt lds
    s_waitcnt vmcnt(11)
    s_add_u32 s55, s58, 16
    s_and_b32 s55, s55, 63
    s_mul_i32 s55, s55, 6144
    s_add_u32 m0, s54, 24576
    s_nop 0
    buffer_load_dwordx4 v2, s[20:23], s55 offen nt lds
    s_waitcnt vmcnt(11)
    s_add_u32 m0, s54, 25600
    s_nop 0
    buffer_load_dwordx4 v3, s[20:23], s55 offen nt lds
    s_waitcnt vmcnt(11)
    s_add_u32 m0, s54, 26624
    s_nop 0
    buffer_load_dwordx4 v4, s[20:23], s55 offen nt lds
    s_waitcnt vmcnt(11)
    s_add_u32 m0, s54, 27648
    s_nop 0
    buffer_load_dwordx4 v5, s[20:23], s55 offen nt lds
    s_waitcnt vmcnt(11)
    s_add_u32 m0, s54, 28672
    s_nop 0
    buffer_load_dwordx4 v6, s[20:23], s55 offen nt lds
    ds_read_b128 v[40:43], v19 offset:12288
    ds_read_b128 v[44:47], v20 offset:12288
    ds_read_b128 v[48:51], v19 offset:12416
    ds_read_b128 v[52:55], v20 offset:12416
    ds_read_b128 v[56:59], v19 offset:12544
    ds_read_b128 v[60:63], v20 offset:12544
    s_nop 1
    v_cvt_pk_bf16_f32 v36, v140, v141
    v_cvt_pk_bf16_f32 v37, v142, v143
    v_lshlrev_b32 v140, 16, v36
    v_and_b32 v141, 0xffff0000, v36
    v_lshlrev_b32 v142, 16, v37
    v_and_b32 v143, 0xffff0000, v37
    v_mul_f32 v140, s70, v140
    v_mul_f32 v141, s70, v141
    v_mul_f32 v142, s70, v142
    v_mul_f32 v143, s70, v143
    v_cvt_pk_bf16_f32 v36, v140, v141
    v_cvt_pk_bf16_f32 v37, v142, v143
    v_lshlrev_b32 v140, 16, v36
    v_and_b32 v141, 0xffff0000, v36
    v_lshlrev_b32 v142, 16, v37
    v_and_b32 v143, 0xffff0000, v37
    v_max3_f32 v33, v33, v140, v141
    v_max3_f32 v33, v33, v142, v143
    s_waitcnt lgkmcnt(0)
    v_mfma_f32_16x16x32_bf16 v[144:147], v[40:43], v[112:115], 0
    v_mfma_f32_16x16x32_bf16 v[144:147], v[44:47], v[116:119], v[144:147]
    v_mfma_f32_16x16x32_bf16 v[144:147], v[48:51], v[120:123], v[144:147]
    v_mfma_f32_16x16x32_bf16 v[144:147], v[52:55], v[124:127], v[144:147]
    v_mfma_f32_16x16x32_bf16 v[144:147], v[56:59], v[128:131], v[144:147]
    v_mfma_f32_16x16x32_bf16 v[144:147], v[60:63], v[132:135], v[144:147]
    s_waitcnt vmcnt(11)
    s_add_u32 m0, s54, 29696
    s_nop 0
    buffer_load_dwordx4 v7, s[20:23], s55 offen nt lds
    s_waitcnt vmcnt(11)
    s_add_u32 s55, s58, 20
    s_and_b32 s55, s55, 63
    s_mul_i32 s55, s55, 6144
    s_add_u32 m0, s54, 30720
    s_nop 0
    buffer_load_dwordx4 v2, s[20:23], s55 offen nt lds
    s_waitcnt vmcnt(11)
    s_add_u32 m0, s54, 31744
    s_nop 0
    buffer_load_dwordx4 v3, s[20:23], s55 offen nt lds
    s_waitcnt vmcnt(10)
    s_add_u32 m0, s54, 32768
    s_nop 0
    buffer_load_dwordx4 v4, s[20:23], s55 offen nt lds
    s_waitcnt vmcnt(10)
    s_add_u32 m0, s54, 33792
    s_nop 0
    buffer_load_dwordx4 v5, s[20:23], s55 offen nt lds
    s_waitcnt vmcnt(10)
    s_add_u32 m0, s54, 34816
    s_nop 0
    buffer_load_dwordx4 v6, s[20:23], s55 offen nt lds
    ds_read_b128 v[40:43], v19 offset:18432
    ds_read_b128 v[44:47], v20 offset:18432
    ds_read_b128 v[48:51], v19 offset:18560
    ds_read_b128 v[52:55], v20 offset:18560
    ds_read_b128 v[56:59], v19 offset:18688
    ds_read_b128 v[60:63], v20 offset:18688
    s_nop 1
    v_cvt_pk_bf16_f32 v36, v144, v145
    v_cvt_pk_bf16_f32 v37, v146, v147
    v_lshlrev_b32 v144, 16, v36
    v_and_b32 v145, 0xffff0000, v36
    v_lshlrev_b32 v146, 16, v37
    v_and_b32 v147, 0xffff0000, v37
    v_mul_f32 v144, s70, v144
    v_mul_f32 v145, s70, v145
    v_mul_f32 v146, s70, v146
    v_mul_f32 v147, s70, v147
    v_cvt_pk_bf16_f32 v36, v144, v145
    v_cvt_pk_bf16_f32 v37, v146, v147
    v_lshlrev_b32 v144, 16, v36
    v_and_b32 v145, 0xffff0000, v36
    v_lshlrev_b32 v146, 16, v37
    v_and_b32 v147, 0xffff0000, v37
    v_max3_f32 v33, v33, v144, v145
    v_max3_f32 v33, v33, v146, v147
    s_waitcnt lgkmcnt(0)
    v_mfma_f32_16x16x32_bf16 v[148:151], v[40:43], v[112:115], 0
    v_mfma_f32_16x16x32_bf16 v[148:151], v[44:47], v[116:119], v[148:151]
    v_mfma_f32_16x16x32_bf16 v[148:151], v[48:51], v[120:123], v[148:151]
    v_mfma_f32_16x16x32_bf16 v[148:151], v[52:55], v[124:127], v[148:151]
    v_mfma_f32_16x16x32_bf16 v[148:151], v[56:59], v[128:131], v[148:151]
    v_mfma_f32_16x16x32_bf16 v[148:151], v[60:63], v[132:135], v[148:151]
    s_waitcnt vmcnt(10)
    s_add_u32 m0, s54, 35840
    s_nop 0
    buffer_load_dwordx4 v7, s[20:23], s55 offen nt lds
    s_waitcnt vmcnt(10)
    s_add_u32 s55, s58, 24
    s_and_b32 s55, s55, 63
    s_mul_i32 s55, s55, 6144
    s_add_u32 m0, s54, 0
    s_nop 0
    buffer_load_dwordx4 v2, s[20:23], s55 offen nt lds
    s_waitcnt vmcnt(10)
    s_add_u32 m0, s54, 1024
    s_nop 0
    buffer_load_dwordx4 v3, s[20:23], s55 offen nt lds
    s_waitcnt vmcnt(10)
    s_add_u32 m0, s54, 2048
    s_nop 0
    buffer_load_dwordx4 v4, s[20:23], s55 offen nt lds
    s_waitcnt vmcnt(10)
    s_add_u32 m0, s54, 3072
    s_nop 0
    buffer_load_dwordx4 v5, s[20:23], s55 offen nt lds
    s_waitcnt vmcnt(10)
    s_add_u32 m0, s54, 4096
    s_nop 0
    buffer_load_dwordx4 v6, s[20:23], s55 offen nt lds
    ds_read_b128 v[40:43], v19 offset:24576
    ds_read_b128 v[44:47], v20 offset:24576
    ds_read_b128 v[48:51], v19 offset:24704
    ds_read_b128 v[52:55], v20 offset:24704
    ds_read_b128 v[56:59], v19 offset:24832
    ds_read_b128 v[60:63], v20 offset:24832
    s_nop 1
    v_cvt_pk_bf16_f32 v36, v148, v149
    v_cvt_pk_bf16_f32 v37, v150, v151
    v_lshlrev_b32 v148, 16, v36
    v_and_b32 v149, 0xffff0000, v36
    v_lshlrev_b32 v150, 16, v37
    v_and_b32 v151, 0xffff0000, v37
    v_mul_f32 v148, s70, v148
    v_mul_f32 v149, s70, v149
    v_mul_f32 v150, s70, v150
    v_mul_f32 v151, s70, v151
    v_cvt_pk_bf16_f32 v36, v148, v149
    v_cvt_pk_bf16_f32 v37, v150, v151
    v_lshlrev_b32 v148, 16, v36
    v_and_b32 v149, 0xffff0000, v36
    v_lshlrev_b32 v150, 16, v37
    v_and_b32 v151, 0xffff0000, v37
    v_max3_f32 v33, v33, v148, v149
    v_max3_f32 v33, v33, v150, v151
    s_waitcnt lgkmcnt(0)
    v_mfma_f32_16x16x32_bf16 v[152:155], v[40:43], v[112:115], 0
    v_mfma_f32_16x16x32_bf16 v[152:155], v[44:47], v[116:119], v[152:155]
    v_mfma_f32_16x16x32_bf16 v[152:155], v[48:51], v[120:123], v[152:155]
    v_mfma_f32_16x16x32_bf16 v[152:155], v[52:55], v[124:127], v[152:155]
    v_mfma_f32_16x16x32_bf16 v[152:155], v[56:59], v[128:131], v[152:155]
    v_mfma_f32_16x16x32_bf16 v[152:155], v[60:63], v[132:135], v[152:155]
    s_waitcnt vmcnt(10)
    s_add_u32 m0, s54, 5120
    s_nop 0
    buffer_load_dwordx4 v7, s[20:23], s55 offen nt lds
    s_waitcnt vmcnt(10)
    s_add_u32 s55, s58, 28
    s_and_b32 s55, s55, 63
    s_mul_i32 s55, s55, 6144
    s_add_u32 m0, s54, 6144
    s_nop 0
    buffer_load_dwordx4 v2, s[20:23], s55 offen nt lds
    s_waitcnt vmcnt(10)
    s_add_u32 m0, s54, 7168
    s_nop 0
    buffer_load_dwordx4 v3, s[20:23], s55 offen nt lds
    s_waitcnt vmcnt(10)
    s_add_u32 m0, s54, 8192
    s_nop 0
    buffer_load_dwordx4 v4, s[20:23], s55 offen nt lds
    s_waitcnt vmcnt(10)
    s_add_u32 m0, s54, 9216
    s_nop 0
    buffer_load_dwordx4 v5, s[20:23], s55 offen nt lds
    s_waitcnt vmcnt(10)
    s_add_u32 m0, s54, 10240
    s_nop 0
    buffer_load_dwordx4 v6, s[20:23], s55 offen nt lds
    ds_read_b128 v[40:43], v19 offset:30720
    ds_read_b128 v[44:47], v20 offset:30720
    ds_read_b128 v[48:51], v19 offset:30848
    ds_read_b128 v[52:55], v20 offset:30848
    ds_read_b128 v[56:59], v19 offset:30976
    ds_read_b128 v[60:63], v20 offset:30976
    s_nop 1
    v_cvt_pk_bf16_f32 v36, v152, v153
    v_cvt_pk_bf16_f32 v37, v154, v155
    v_lshlrev_b32 v152, 16, v36
    v_and_b32 v153, 0xffff0000, v36
    v_lshlrev_b32 v154, 16, v37
    v_and_b32 v155, 0xffff0000, v37
    v_mul_f32 v152, s70, v152
    v_mul_f32 v153, s70, v153
    v_mul_f32 v154, s70, v154
    v_mul_f32 v155, s70, v155
    v_cvt_pk_bf16_f32 v36, v152, v153
    v_cvt_pk_bf16_f32 v37, v154, v155
    v_lshlrev_b32 v152, 16, v36
    v_and_b32 v153, 0xffff0000, v36
    v_lshlrev_b32 v154, 16, v37
    v_and_b32 v155, 0xffff0000, v37
    v_max3_f32 v33, v33, v152, v153
    v_max3_f32 v33, v33, v154, v155
    s_waitcnt lgkmcnt(0)
    v_mfma_f32_16x16x32_bf16 v[156:159], v[40:43], v[112:115], 0
    v_mfma_f32_16x16x32_bf16 v[156:159], v[44:47], v[116:119], v[156:159]
    v_mfma_f32_16x16x32_bf16 v[156:159], v[48:51], v[120:123], v[156:159]
    v_mfma_f32_16x16x32_bf16 v[156:159], v[52:55], v[124:127], v[156:159]
    v_mfma_f32_16x16x32_bf16 v[156:159], v[56:59], v[128:131], v[156:159]
    v_mfma_f32_16x16x32_bf16 v[156:159], v[60:63], v[132:135], v[156:159]
    s_waitcnt vmcnt(10)
    s_add_u32 m0, s54, 11264
    s_nop 0
    buffer_load_dwordx4 v7, s[20:23], s55 offen nt lds
    s_waitcnt vmcnt(10)
    s_add_u32 s55, s79, 0
    s_add_u32 m0, s54, 12288
    s_nop 0
    buffer_load_dwordx4 v30, s[32:35], s55 offen  lds
    s_waitcnt vmcnt(10)
    s_add_u32 s55, s79, 1024
    s_add_u32 m0, s54, 13312
    s_nop 0
    buffer_load_dwordx4 v30, s[32:35], s55 offen  lds
    s_waitcnt vmcnt(10)
    s_add_u32 s55, s79, 2048
    s_add_u32 m0, s54, 14336
    s_nop 0
    buffer_load_dwordx4 v30, s[32:35], s55 offen  lds
    s_waitcnt vmcnt(10)
    s_add_u32 s55, s79, 3072
    s_add_u32 m0, s54, 15360
    s_nop 0
    buffer_load_dwordx4 v30, s[32:35], s55 offen  lds
    s_waitcnt vmcnt(10)
    s_add_u32 s55, s79, 4096
    s_add_u32 m0, s54, 16384
    s_nop 0
    buffer_load_dwordx4 v30, s[32:35], s55 offen  lds
    ds_read_b128 v[40:43], v19 offset:0
    ds_read_b128 v[44:47], v20 offset:0
    ds_read_b128 v[48:51], v19 offset:128
    ds_read_b128 v[52:55], v20 offset:128
    ds_read_b128 v[56:59], v19 offset:256
    ds_read_b128 v[60:63], v20 offset:256
    s_nop 1
    v_cvt_pk_bf16_f32 v36, v156, v157
    v_cvt_pk_bf16_f32 v37, v158, v159
    v_lshlrev_b32 v156, 16, v36
    v_and_b32 v157, 0xffff0000, v36
    v_lshlrev_b32 v158, 16, v37
    v_and_b32 v159, 0xffff0000, v37
    v_mul_f32 v156, s70, v156
    v_mul_f32 v157, s70, v157
    v_mul_f32 v158, s70, v158
    v_mul_f32 v159, s70, v159
    v_cvt_pk_bf16_f32 v36, v156, v157
    v_cvt_pk_bf16_f32 v37, v158, v159
    v_lshlrev_b32 v156, 16, v36
    v_and_b32 v157, 0xffff0000, v36
    v_lshlrev_b32 v158, 16, v37
    v_and_b32 v159, 0xffff0000, v37
    v_max3_f32 v33, v33, v156, v157
    v_max3_f32 v33, v33, v158, v159
    s_waitcnt lgkmcnt(0)
    v_mfma_f32_16x16x32_bf16 v[160:163], v[40:43], v[112:115], 0
    v_mfma_f32_16x16x32_bf16 v[160:163], v[44:47], v[116:119], v[160:163]
    v_mfma_f32_16x16x32_bf16 v[160:163], v[48:51], v[120:123], v[160:163]
    v_mfma_f32_16x16x32_bf16 v[160:163], v[52:55], v[124:127], v[160:163]
    v_mfma_f32_16x16x32_bf16 v[160:163], v[56:59], v[128:131], v[160:163]
    v_mfma_f32_16x16x32_bf16 v[160:163], v[60:63], v[132:135], v[160:163]
    s_waitcnt vmcnt(10)
    s_add_u32 s55, s79, 5120
    s_add_u32 m0, s54, 18432
    s_nop 0
    buffer_load_dwordx4 v30, s[32:35], s55 offen  lds
    s_waitcnt vmcnt(10)
    s_add_u32 s55, s79, 6144
    s_add_u32 m0, s54, 19456
    s_nop 0
    buffer_load_dwordx4 v30, s[32:35], s55 offen  lds
    s_waitcnt vmcnt(10)
    s_add_u32 s55, s79, 7168
    s_add_u32 m0, s54, 20480
    s_nop 0
    buffer_load_dwordx4 v30, s[32:35], s55 offen  lds
    s_waitcnt vmcnt(10)
    s_add_u32 s55, s79, 8192
    s_add_u32 m0, s54, 21504
    s_nop 0
    buffer_load_dwordx4 v30, s[32:35], s55 offen  lds
    s_waitcnt vmcnt(10)
    s_add_u32 s55, s58, 32
    s_and_b32 s55, s55, 63
    s_mul_i32 s55, s55, 6144
    s_add_u32 m0, s54, 24576
    s_nop 0
    buffer_load_dwordx4 v2, s[20:23], s55 offen nt lds
    s_waitcnt vmcnt(10)
    s_add_u32 m0, s54, 25600
    s_nop 0
    buffer_load_dwordx4 v3, s[20:23], s55 offen nt lds
    ds_read_b128 v[40:43], v19 offset:6144
    ds_read_b128 v[44:47], v20 offset:6144
    ds_read_b128 v[48:51], v19 offset:6272
    ds_read_b128 v[52:55], v20 offset:6272
    ds_read_b128 v[56:59], v19 offset:6400
    ds_read_b128 v[60:63], v20 offset:6400
    s_nop 1
    v_cvt_pk_bf16_f32 v36, v160, v161
    v_cvt_pk_bf16_f32 v37, v162, v163
    v_lshlrev_b32 v160, 16, v36
    v_and_b32 v161, 0xffff0000, v36
    v_lshlrev_b32 v162, 16, v37
    v_and_b32 v163, 0xffff0000, v37
    v_mul_f32 v160, s70, v160
    v_mul_f32 v161, s70, v161
    v_mul_f32 v162, s70, v162
    v_mul_f32 v163, s70, v163
    v_cvt_pk_bf16_f32 v36, v160, v161
    v_cvt_pk_bf16_f32 v37, v162, v163
    v_lshlrev_b32 v160, 16, v36
    v_and_b32 v161, 0xffff0000, v36
    v_lshlrev_b32 v162, 16, v37
    v_and_b32 v163, 0xffff0000, v37
    v_max3_f32 v33, v33, v160, v161
    v_max3_f32 v33, v33, v162, v163
    s_waitcnt lgkmcnt(0)
    v_mfma_f32_16x16x32_bf16 v[164:167], v[40:43], v[112:115], 0
    v_mfma_f32_16x16x32_bf16 v[164:167], v[44:47], v[116:119], v[164:167]
    v_mfma_f32_16x16x32_bf16 v[164:167], v[48:51], v[120:123], v[164:167]
    v_mfma_f32_16x16x32_bf16 v[164:167], v[52:55], v[124:127], v[164:167]
    v_mfma_f32_16x16x32_bf16 v[164:167], v[56:59], v[128:131], v[164:167]
    v_mfma_f32_16x16x32_bf16 v[164:167], v[60:63], v[132:135], v[164:167]
    s_waitcnt vmcnt(10)
    s_add_u32 m0, s54, 26624
    s_nop 0
    buffer_load_dwordx4 v4, s[20:23], s55 offen nt lds
    s_waitcnt vmcnt(10)
    s_add_u32 m0, s54, 27648
    s_nop 0
    buffer_load_dwordx4 v5, s[20:23], s55 offen nt lds
    s_waitcnt vmcnt(10)
    s_add_u32 m0, s54, 28672
    s_nop 0
    buffer_load_dwordx4 v6, s[20:23], s55 offen nt lds
    s_waitcnt vmcnt(10)
    s_add_u32 m0, s54, 29696
    s_nop 0
    buffer_load_dwordx4 v7, s[20:23], s55 offen nt lds
    s_waitcnt vmcnt(10)
    s_add_u32 s55, s58, 36
    s_and_b32 s55, s55, 63
    s_mul_i32 s55, s55, 6144
    s_add_u32 m0, s54, 30720
    s_nop 0
    buffer_load_dwordx4 v2, s[20:23], s55 offen nt lds
    s_waitcnt vmcnt(10)
    s_add_u32 m0, s54, 31744
    s_nop 0
    buffer_load_dwordx4 v3, s[20:23], s55 offen nt lds
    s_waitcnt vmcnt(10)
    s_add_u32 m0, s54, 32768
    s_nop 0
    buffer_load_dwordx4 v4, s[20:23], s55 offen nt lds
    s_waitcnt vmcnt(10)
    s_add_u32 m0, s54, 33792
    s_nop 0
    buffer_load_dwordx4 v5, s[20:23], s55 offen nt lds
    s_waitcnt vmcnt(10)
    s_add_u32 m0, s54, 34816
    s_nop 0
    buffer_load_dwordx4 v6, s[20:23], s55 offen nt lds
    s_waitcnt vmcnt(10)
    s_add_u32 m0, s54, 35840
    s_nop 0
    buffer_load_dwordx4 v7, s[20:23], s55 offen nt lds
    s_waitcnt vmcnt(10)
    s_add_u32 s55, s58, 40
    s_and_b32 s55, s55, 63
    s_mul_i32 s55, s55, 6144
    s_add_u32 m0, s54, 0
    s_nop 0
    buffer_load_dwordx4 v2, s[20:23], s55 offen nt lds
    s_waitcnt vmcnt(10)
    s_add_u32 m0, s54, 1024
    s_nop 0
    buffer_load_dwordx4 v3, s[20:23], s55 offen nt lds
    s_waitcnt vmcnt(10)
    s_add_u32 m0, s54, 2048
    s_nop 0
    buffer_load_dwordx4 v4, s[20:23], s55 offen nt lds
    s_waitcnt vmcnt(10)
    s_add_u32 m0, s54, 3072
    s_nop 0
    buffer_load_dwordx4 v5, s[20:23], s55 offen nt lds
    s_waitcnt vmcnt(10)
    s_add_u32 m0, s54, 4096
    s_nop 0
    buffer_load_dwordx4 v6, s[20:23], s55 offen nt lds
    ds_read_b128 v[40:43], v19 offset:24576
    ds_read_b128 v[44:47], v20 offset:24576
    ds_read_b128 v[48:51], v19 offset:24704
    ds_read_b128 v[52:55], v20 offset:24704
    ds_read_b128 v[56:59], v19 offset:24832
    ds_read_b128 v[60:63], v20 offset:24832
    s_nop 1
    v_cvt_pk_bf16_f32 v36, v164, v165
    v_cvt_pk_bf16_f32 v37, v166, v167
    v_lshlrev_b32 v164, 16, v36
    v_and_b32 v165, 0xffff0000, v36
    v_lshlrev_b32 v166, 16, v37
    v_and_b32 v167, 0xffff0000, v37
    v_mul_f32 v164, s70, v164
    v_mul_f32 v165, s70, v165
    v_mul_f32 v166, s70, v166
    v_mul_f32 v167, s70, v167
    v_cvt_pk_bf16_f32 v36, v164, v165
    v_cvt_pk_bf16_f32 v37, v166, v167
    v_lshlrev_b32 v164, 16, v36
    v_and_b32 v165, 0xffff0000, v36
    v_lshlrev_b32 v166, 16, v37
    v_and_b32 v167, 0xffff0000, v37
    v_max3_f32 v33, v33, v164, v165
    v_max3_f32 v33, v33, v166, v167
    s_waitcnt lgkmcnt(0)
    v_mfma_f32_16x16x32_bf16 v[168:171], v[40:43], v[112:115], 0
    v_mfma_f32_16x16x32_bf16 v[168:171], v[44:47], v[116:119], v[168:171]
    v_mfma_f32_16x16x32_bf16 v[168:171], v[48:51], v[120:123], v[168:171]
    v_mfma_f32_16x16x32_bf16 v[168:171], v[52:55], v[124:127], v[168:171]
    v_mfma_f32_16x16x32_bf16 v[168:171], v[56:59], v[128:131], v[168:171]
    v_mfma_f32_16x16x32_bf16 v[168:171], v[60:63], v[132:135], v[168:171]
    s_waitcnt vmcnt(10)
    s_add_u32 m0, s54, 5120
    s_nop 0
    buffer_load_dwordx4 v7, s[20:23], s55 offen nt lds
    s_waitcnt vmcnt(10)
    s_branch L_page_1
    .p2align 12
L_page_1:
    s_add_u32 s55, s58, 44
    s_and_b32 s55, s55, 63
    s_mul_i32 s55, s55, 6144
    s_add_u32 m0, s54, 6144
    s_nop 0
    buffer_load_dwordx4 v2, s[20:23], s55 offen nt lds
    s_waitcnt vmcnt(10)
    s_add_u32 m0, s54, 7168
    s_nop 0
    buffer_load_dwordx4 v3, s[20:23], s55 offen nt lds
    s_waitcnt vmcnt(10)
    s_add_u32 m0, s54, 8192
    s_nop 0
    buffer_load_dwordx4 v4, s[20:23], s55 offen nt lds
    s_waitcnt vmcnt(10)
    s_add_u32 m0, s54, 9216
    s_nop 0
    buffer_load_dwordx4 v5, s[20:23], s55 offen nt lds
    s_waitcnt vmcnt(10)
    s_add_u32 m0, s54, 10240
    s_nop 0
    buffer_load_dwordx4 v6, s[20:23], s55 offen nt lds
    ds_read_b128 v[40:43], v19 offset:30720
    ds_read_b128 v[44:47], v20 offset:30720
    ds_read_b128 v[48:51], v19 offset:30848
    ds_read_b128 v[52:55], v20 offset:30848
    ds_read_b128 v[56:59], v19 offset:30976
    ds_read_b128 v[60:63], v20 offset:30976
    s_nop 1
    v_cvt_pk_bf16_f32 v36, v168, v169
    v_cvt_pk_bf16_f32 v37, v170, v171
    v_lshlrev_b32 v168, 16, v36
    v_and_b32 v169, 0xffff0000, v36
    v_lshlrev_b32 v170, 16, v37
    v_and_b32 v171, 0xffff0000, v37
    v_mul_f32 v168, s70, v168
    v_mul_f32 v169, s70, v169
    v_mul_f32 v170, s70, v170
    v_mul_f32 v171, s70, v171
    v_cvt_pk_bf16_f32 v36, v168, v169
    v_cvt_pk_bf16_f32 v37, v170, v171
    v_lshlrev_b32 v168, 16, v36
    v_and_b32 v169, 0xffff0000, v36
    v_lshlrev_b32 v170, 16, v37
    v_and_b32 v171, 0xffff0000, v37
    v_max3_f32 v33, v33, v168, v169
    v_max3_f32 v33, v33, v170, v171
    s_waitcnt lgkmcnt(0)
    v_mfma_f32_16x16x32_bf16 v[172:175], v[40:43], v[112:115], 0
    v_mfma_f32_16x16x32_bf16 v[172:175], v[44:47], v[116:119], v[172:175]
    v_mfma_f32_16x16x32_bf16 v[172:175], v[48:51], v[120:123], v[172:175]
    v_mfma_f32_16x16x32_bf16 v[172:175], v[52:55], v[124:127], v[172:175]
    v_mfma_f32_16x16x32_bf16 v[172:175], v[56:59], v[128:131], v[172:175]
    v_mfma_f32_16x16x32_bf16 v[172:175], v[60:63], v[132:135], v[172:175]
    s_waitcnt vmcnt(10)
    s_add_u32 m0, s54, 11264
    s_nop 0
    buffer_load_dwordx4 v7, s[20:23], s55 offen nt lds
    s_waitcnt vmcnt(10)
    s_mov_b32 s55, 0
    s_add_u32 m0, s54, 12288
    s_nop 0
    buffer_load_dwordx4 v14, s[32:35], s55 offen  lds
    s_waitcnt vmcnt(10)
    s_add_u32 m0, s54, 13312
    s_nop 0
    buffer_load_dwordx4 v15, s[32:35], s55 offen  lds
    s_waitcnt vmcnt(10)
    s_add_u32 m0, s54, 14336
    s_nop 0
    buffer_load_dwordx4 v16, s[32:35], s55 offen  lds
    s_waitcnt vmcnt(10)
    s_add_u32 m0, s54, 15360
    s_nop 0
    buffer_load_dwordx4 v17, s[32:35], s55 offen  lds
    s_waitcnt vmcnt(10)
    s_add_u32 m0, s54, 16384
    s_nop 0
    buffer_load_dwordx4 v18, s[32:35], s55 offen  lds
    ds_read_b128 v[40:43], v19 offset:0
    ds_read_b128 v[44:47], v20 offset:0
    ds_read_b128 v[48:51], v19 offset:128
    ds_read_b128 v[52:55], v20 offset:128
    ds_read_b128 v[56:59], v19 offset:256
    ds_read_b128 v[60:63], v20 offset:256
    s_nop 1
    v_cvt_pk_bf16_f32 v36, v172, v173
    v_cvt_pk_bf16_f32 v37, v174, v175
    v_lshlrev_b32 v172, 16, v36
    v_and_b32 v173, 0xffff0000, v36
    v_lshlrev_b32 v174, 16, v37
    v_and_b32 v175, 0xffff0000, v37
    v_mul_f32 v172, s70, v172
    v_mul_f32 v173, s70, v173
    v_mul_f32 v174, s70, v174
    v_mul_f32 v175, s70, v175
    v_cvt_pk_bf16_f32 v36, v172, v173
    v_cvt_pk_bf16_f32 v37, v174, v175
    v_lshlrev_b32 v172, 16, v36
    v_and_b32 v173, 0xffff0000, v36
    v_lshlrev_b32 v174, 16, v37
    v_and_b32 v175, 0xffff0000, v37
    v_max3_f32 v33, v33, v172, v173
    v_max3_f32 v33, v33, v174, v175
    s_waitcnt lgkmcnt(0)
    v_mfma_f32_16x16x32_bf16 v[176:179], v[40:43], v[112:115], 0
    v_mfma_f32_16x16x32_bf16 v[176:179], v[44:47], v[116:119], v[176:179]
    v_mfma_f32_16x16x32_bf16 v[176:179], v[48:51], v[120:123], v[176:179]
    v_mfma_f32_16x16x32_bf16 v[176:179], v[52:55], v[124:127], v[176:179]
    v_mfma_f32_16x16x32_bf16 v[176:179], v[56:59], v[128:131], v[176:179]
    v_mfma_f32_16x16x32_bf16 v[176:179], v[60:63], v[132:135], v[176:179]
    s_waitcnt vmcnt(10)
    s_mov_b32 s55, 20480
    s_add_u32 m0, s54, 18432
    s_nop 0
    buffer_load_dwordx4 v14, s[32:35], s55 offen  lds
    s_waitcnt vmcnt(10)
    s_add_u32 m0, s54, 19456
    s_nop 0
    buffer_load_dwordx4 v15, s[32:35], s55 offen  lds
    s_waitcnt vmcnt(10)
    s_add_u32 m0, s54, 20480
    s_nop 0
    buffer_load_dwordx4 v16, s[32:35], s55 offen  lds
    s_waitcnt vmcnt(10)
    s_add_u32 m0, s54, 21504
    s_nop 0
    buffer_load_dwordx4 v17, s[32:35], s55 offen  lds
    s_waitcnt vmcnt(10)
    s_add_u32 m0, s54, 22528
    s_nop 0
    buffer_load_dwordx4 v18, s[32:35], s55 offen  lds
    s_waitcnt vmcnt(10)
    s_mov_b32 s55, 40960
    s_add_u32 m0, s54, 24576
    s_nop 0
    buffer_load_dwordx4 v14, s[32:35], s55 offen  lds
    ds_read_b128 v[40:43], v19 offset:6144
    ds_read_b128 v[44:47], v20 offset:6144
    ds_read_b128 v[48:51], v19 offset:6272
    ds_read_b128 v[52:55], v20 offset:6272
    ds_read_b128 v[56:59], v19 offset:6400
    ds_read_b128 v[60:63], v20 offset:6400
    s_nop 1
    v_cvt_pk_bf16_f32 v36, v176, v177
    v_cvt_pk_bf16_f32 v37, v178, v179
    v_lshlrev_b32 v176, 16, v36
    v_and_b32 v177, 0xffff0000, v36
    v_lshlrev_b32 v178, 16, v37
    v_and_b32 v179, 0xffff0000, v37
    v_mul_f32 v176, s70, v176
    v_mul_f32 v177, s70, v177
    v_mul_f32 v178, s70, v178
    v_mul_f32 v179, s70, v179
    v_cvt_pk_bf16_f32 v36, v176, v177
    v_cvt_pk_bf16_f32 v37, v178, v179
    v_lshlrev_b32 v176, 16, v36
    v_and_b32 v177, 0xffff0000, v36
    v_lshlrev_b32 v178, 16, v37
    v_and_b32 v179, 0xffff0000, v37
    v_max3_f32 v33, v33, v176, v177
    v_max3_f32 v33, v33, v178, v179
    s_waitcnt lgkmcnt(0)
    v_mfma_f32_16x16x32_bf16 v[180:183], v[40:43], v[112:115], 0
    v_mfma_f32_16x16x32_bf16 v[180:183], v[44:47], v[116:119], v[180:183]
    v_mfma_f32_16x16x32_bf16 v[180:183], v[48:51], v[120:123], v[180:183]
    v_mfma_f32_16x16x32_bf16 v[180:183], v[52:55], v[124:127], v[180:183]
    v_mfma_f32_16x16x32_bf16 v[180:183], v[56:59], v[128:131], v[180:183]
    v_mfma_f32_16x16x32_bf16 v[180:183], v[60:63], v[132:135], v[180:183]
    s_waitcnt vmcnt(10)
    s_add_u32 m0, s54, 25600
    s_nop 0
    buffer_load_dwordx4 v15, s[32:35], s55 offen  lds
    s_waitcnt vmcnt(10)
    s_add_u32 m0, s54, 26624
    s_nop 0
    buffer_load_dwordx4 v16, s[32:35], s55 offen  lds
    s_waitcnt vmcnt(10)
    s_add_u32 m0, s54, 27648
    s_nop 0
    buffer_load_dwordx4 v17, s[32:35], s55 offen  lds
    s_waitcnt vmcnt(10)
    s_add_u32 m0, s54, 28672
    s_nop 0
    buffer_load_dwordx4 v18, s[32:35], s55 offen  lds
    s_waitcnt vmcnt(10)
    s_mov_b32 s55, 61440
    s_add_u32 m0, s54, 30720
    s_nop 0
    buffer_load_dwordx4 v14, s[32:35], s55 offen  lds
    ds_read_b64_tr_b16 a[0:1], v25 offset:12288
    ds_read_b64_tr_b16 a[4:5], v25 offset:12320
    ds_read_b64_tr_b16 a[8:9], v25 offset:12352
    ds_read_b64_tr_b16 a[12:13], v25 offset:12384
    ds_read_b64_tr_b16 a[16:17], v25 offset:12416
    ds_read_b64_tr_b16 a[20:21], v25 offset:12448
    ds_read_b64_tr_b16 a[24:25], v25 offset:12480
    ds_read_b64_tr_b16 a[28:29], v25 offset:12512
    ds_read_b64_tr_b16 a[32:33], v25 offset:12544
    ds_read_b64_tr_b16 a[36:37], v25 offset:12576
    s_waitcnt lgkmcnt(0)
    s_waitcnt vmcnt(10)
    s_add_u32 m0, s54, 31744
    s_nop 0
    buffer_load_dwordx4 v15, s[32:35], s55 offen  lds
    s_waitcnt vmcnt(10)
    s_add_u32 m0, s54, 32768
    s_nop 0
    buffer_load_dwordx4 v16, s[32:35], s55 offen  lds
    s_waitcnt vmcnt(10)
    s_add_u32 m0, s54, 33792
    s_nop 0
    buffer_load_dwordx4 v17, s[32:35], s55 offen  lds
    s_waitcnt vmcnt(10)
    s_add_u32 m0, s54, 34816
    s_nop 0
    buffer_load_dwordx4 v18, s[32:35], s55 offen  lds
    s_waitcnt vmcnt(10)
    s_mov_b32 s55, 81920
    s_add_u32 m0, s54, 0
    s_nop 0
    buffer_load_dwordx4 v14, s[32:35], s55 offen  lds
    ds_read_b64_tr_b16 a[2:3], v25 offset:18432
    ds_read_b64_tr_b16 a[6:7], v25 offset:18464
    ds_read_b64_tr_b16 a[10:11], v25 offset:18496
    ds_read_b64_tr_b16 a[14:15], v25 offset:18528
    ds_read_b64_tr_b16 a[18:19], v25 offset:18560
    ds_read_b64_tr_b16 a[22:23], v25 offset:18592
    ds_read_b64_tr_b16 a[26:27], v25 offset:18624
    ds_read_b64_tr_b16 a[30:31], v25 offset:18656
    ds_read_b64_tr_b16 a[34:35], v25 offset:18688
    ds_read_b64_tr_b16 a[38:39], v25 offset:18720
    s_waitcnt lgkmcnt(0)
    s_waitcnt vmcnt(10)
    s_add_u32 m0, s54, 1024
    s_nop 0
    buffer_load_dwordx4 v15, s[32:35], s55 offen  lds
    s_waitcnt vmcnt(10)
    s_add_u32 m0, s54, 2048
    s_nop 0
    buffer_load_dwordx4 v16, s[32:35], s55 offen  lds
    s_waitcnt vmcnt(10)
    s_add_u32 m0, s54, 3072
    s_nop 0
    buffer_load_dwordx4 v17, s[32:35], s55 offen  lds
    s_waitcnt vmcnt(10)
    s_add_u32 m0, s54, 4096
    s_nop 0
    buffer_load_dwordx4 v18, s[32:35], s55 offen  lds
    s_waitcnt vmcnt(10)
    s_mov_b32 s55, 102400
    s_add_u32 m0, s54, 6144
    s_nop 0
    buffer_load_dwordx4 v14, s[32:35], s55 offen  lds
    ds_read_b64_tr_b16 a[40:41], v25 offset:24576
    ds_read_b64_tr_b16 a[44:45], v25 offset:24608
    ds_read_b64_tr_b16 a[48:49], v25 offset:24640
    ds_read_b64_tr_b16 a[52:53], v25 offset:24672
    ds_read_b64_tr_b16 a[56:57], v25 offset:24704
    ds_read_b64_tr_b16 a[60:61], v25 offset:24736
    ds_read_b64_tr_b16 a[64:65], v25 offset:24768
    ds_read_b64_tr_b16 a[68:69], v25 offset:24800
    ds_read_b64_tr_b16 a[72:73], v25 offset:24832
    ds_read_b64_tr_b16 a[76:77], v25 offset:24864
    s_waitcnt lgkmcnt(0)
    s_waitcnt vmcnt(10)
    s_add_u32 m0, s54, 7168
    s_nop 0
    buffer_load_dwordx4 v15, s[32:35], s55 offen  lds
    s_waitcnt vmcnt(10)
    s_add_u32 m0, s54, 8192
    s_nop 0
    buffer_load_dwordx4 v16, s[32:35], s55 offen  lds
    s_waitcnt vmcnt(10)
    s_add_u32 m0, s54, 9216
    s_nop 0
    buffer_load_dwordx4 v17, s[32:35], s55 offen  lds
    s_waitcnt vmcnt(10)
    s_add_u32 m0, s54, 10240
    s_nop 0
    buffer_load_dwordx4 v18, s[32:35], s55 offen  lds
    s_waitcnt vmcnt(10)
    s_mov_b32 s55, 122880
    s_add_u32 m0, s54, 12288
    s_nop 0
    buffer_load_dwordx4 v14, s[32:35], s55 offen  lds
    ds_read_b64_tr_b16 a[42:43], v25 offset:30720
    ds_read_b64_tr_b16 a[46:47], v25 offset:30752
    ds_read_b64_tr_b16 a[50:51], v25 offset:30784
    ds_read_b64_tr_b16 a[54:55], v25 offset:30816
    ds_read_b64_tr_b16 a[58:59], v25 offset:30848
    ds_read_b64_tr_b16 a[62:63], v25 offset:30880
    ds_read_b64_tr_b16 a[66:67], v25 offset:30912
    ds_read_b64_tr_b16 a[70:71], v25 offset:30944
    ds_read_b64_tr_b16 a[74:75], v25 offset:30976
    ds_read_b64_tr_b16 a[78:79], v25 offset:31008
    s_waitcnt lgkmcnt(0)
    s_waitcnt vmcnt(10)
    s_add_u32 m0, s54, 13312
    s_nop 0
    buffer_load_dwordx4 v15, s[32:35], s55 offen  lds
    s_waitcnt vmcnt(10)
    s_add_u32 m0, s54, 14336
    s_nop 0
    buffer_load_dwordx4 v16, s[32:35], s55 offen  lds
    s_waitcnt vmcnt(10)
    s_add_u32 m0, s54, 15360
    s_nop 0
    buffer_load_dwordx4 v17, s[32:35], s55 offen  lds
    s_waitcnt vmcnt(10)
    s_add_u32 m0, s54, 16384
    s_nop 0
    buffer_load_dwordx4 v18, s[32:35], s55 offen  lds
    s_waitcnt vmcnt(10)
    s_mov_b32 s55, 143360
    s_add_u32 m0, s54, 18432
    s_nop 0
    buffer_load_dwordx4 v14, s[32:35], s55 offen  lds
    ds_read_b64_tr_b16 a[80:81], v25 offset:0
    ds_read_b64_tr_b16 a[84:85], v25 offset:32
    ds_read_b64_tr_b16 a[88:89], v25 offset:64
    ds_read_b64_tr_b16 a[92:93], v25 offset:96
    ds_read_b64_tr_b16 a[96:97], v25 offset:128
    ds_read_b64_tr_b16 a[100:101], v25 offset:160
    ds_read_b64_tr_b16 a[104:105], v25 offset:192
    ds_read_b64_tr_b16 a[108:109], v25 offset:224
    ds_read_b64_tr_b16 a[112:113], v25 offset:256
    ds_read_b64_tr_b16 a[116:117], v25 offset:288
    s_waitcnt lgkmcnt(0)
    s_waitcnt vmcnt(10)
    s_add_u32 m0, s54, 19456
    s_nop 0
    buffer_load_dwordx4 v15, s[32:35], s55 offen  lds
    s_waitcnt vmcnt(10)
    s_add_u32 m0, s54, 20480
    s_nop 0
    buffer_load_dwordx4 v16, s[32:35], s55 offen  lds
    s_waitcnt vmcnt(10)
    s_add_u32 m0, s54, 21504
    s_nop 0
    buffer_load_dwordx4 v17, s[32:35], s55 offen  lds
    s_waitcnt vmcnt(10)
    s_add_u32 m0, s54, 22528
    s_nop 0
    buffer_load_dwordx4 v18, s[32:35], s55 offen  lds
    s_waitcnt vmcnt(10)
    s_mov_b32 s55, 163840
    s_add_u32 m0, s54, 24576
    s_nop 0
    buffer_load_dwordx4 v14, s[32:35], s55 offen  lds
    ds_read_b64_tr_b16 a[82:83], v25 offset:6144
    ds_read_b64_tr_b16 a[86:87], v25 offset:6176
    ds_read_b64_tr_b16 a[90:91], v25 offset:6208
    ds_read_b64_tr_b16 a[94:95], v25 offset:6240
    ds_read_b64_tr_b16 a[98:99], v25 offset:6272
    ds_read_b64_tr_b16 a[102:103], v25 offset:6304
    ds_read_b64_tr_b16 a[106:107], v25 offset:6336
    ds_read_b64_tr_b16 a[110:111], v25 offset:6368
    ds_read_b64_tr_b16 a[114:115], v25 offset:6400
    ds_read_b64_tr_b16 a[118:119], v25 offset:6432
    s_waitcnt lgkmcnt(0)
    s_waitcnt vmcnt(10)
    s_add_u32 m0, s54, 25600
    s_nop 0
    buffer_load_dwordx4 v15, s[32:35], s55 offen  lds
    s_waitcnt vmcnt(10)
    s_add_u32 m0, s54, 26624
    s_nop 0
    buffer_load_dwordx4 v16, s[32:35], s55 offen  lds
    s_waitcnt vmcnt(10)
    s_add_u32 m0, s54, 27648
    s_nop 0
    buffer_load_dwordx4 v17, s[32:35], s55 offen  lds
    s_waitcnt vmcnt(10)
    s_add_u32 m0, s54, 28672
    s_nop 0
    buffer_load_dwordx4 v18, s[32:35], s55 offen  lds
    s_waitcnt vmcnt(10)
    s_mov_b32 s55, 184320
    s_add_u32 m0, s54, 30720
    s_nop 0
    buffer_load_dwordx4 v14, s[32:35], s55 offen  lds
    ds_read_b64_tr_b16 a[120:121], v25 offset:12288
    ds_read_b64_tr_b16 a[124:125], v25 offset:12320
    ds_read_b64_tr_b16 a[128:129], v25 offset:12352
    ds_read_b64_tr_b16 a[132:133], v25 offset:12384
    ds_read_b64_tr_b16 a[136:137], v25 offset:12416
    ds_read_b64_tr_b16 a[140:141], v25 offset:12448
    ds_read_b64_tr_b16 a[144:145], v25 offset:12480
    ds_read_b64_tr_b16 a[148:149], v25 offset:12512
    ds_read_b64_tr_b16 a[152:153], v25 offset:12544
    ds_read_b64_tr_b16 a[156:157], v25 offset:12576
    s_waitcnt lgkmcnt(0)
    s_waitcnt vmcnt(10)
    s_add_u32 m0, s54, 31744
    s_nop 0
    buffer_load_dwordx4 v15, s[32:35], s55 offen  lds
    s_waitcnt vmcnt(10)
    s_add_u32 m0, s54, 32768
    s_nop 0
    buffer_load_dwordx4 v16, s[32:35], s55 offen  lds
    s_waitcnt vmcnt(10)
    s_add_u32 m0, s54, 33792
    s_nop 0
    buffer_load_dwordx4 v17, s[32:35], s55 offen  lds
    s_waitcnt vmcnt(10)
    s_add_u32 m0, s54, 34816
    s_nop 0
    buffer_load_dwordx4 v18, s[32:35], s55 offen  lds
    s_waitcnt vmcnt(10)
    s_mov_b32 s55, 204800
    s_add_u32 m0, s54, 0
    s_nop 0
    buffer_load_dwordx4 v14, s[32:35], s55 offen  lds
    ds_read_b64_tr_b16 a[122:123], v25 offset:18432
    ds_read_b64_tr_b16 a[126:127], v25 offset:18464
    ds_read_b64_tr_b16 a[130:131], v25 offset:18496
    ds_read_b64_tr_b16 a[134:135], v25 offset:18528
    ds_read_b64_tr_b16 a[138:139], v25 offset:18560
    ds_read_b64_tr_b16 a[142:143], v25 offset:18592
    ds_read_b64_tr_b16 a[146:147], v25 offset:18624
    ds_read_b64_tr_b16 a[150:151], v25 offset:18656
    ds_read_b64_tr_b16 a[154:155], v25 offset:18688
    ds_read_b64_tr_b16 a[158:159], v25 offset:18720
    s_waitcnt lgkmcnt(0)
    s_waitcnt vmcnt(10)
    s_add_u32 m0, s54, 1024
    s_nop 0
    buffer_load_dwordx4 v15, s[32:35], s55 offen  lds
    s_waitcnt vmcnt(10)
    s_add_u32 m0, s54, 2048
    s_nop 0
    buffer_load_dwordx4 v16, s[32:35], s55 offen  lds
    s_waitcnt vmcnt(10)
    s_add_u32 m0, s54, 3072
    s_nop 0
    buffer_load_dwordx4 v17, s[32:35], s55 offen  lds
    s_waitcnt vmcnt(10)
    s_add_u32 m0, s54, 4096
    s_nop 0
    buffer_load_dwordx4 v18, s[32:35], s55 offen  lds
    s_waitcnt vmcnt(10)
    s_mov_b32 s55, 225280
    s_add_u32 m0, s54, 6144
    s_nop 0
    buffer_load_dwordx4 v14, s[32:35], s55 offen  lds
    ds_read_b64_tr_b16 a[160:161], v25 offset:24576
    ds_read_b64_tr_b16 a[164:165], v25 offset:24608
    ds_read_b64_tr_b16 a[168:169], v25 offset:24640
    ds_read_b64_tr_b16 a[172:173], v25 offset:24672
    ds_read_b64_tr_b16 a[176:177], v25 offset:24704
    ds_read_b64_tr_b16 a[180:181], v25 offset:24736
    ds_read_b64_tr_b16 a[184:185], v25 offset:24768
    ds_read_b64_tr_b16 a[188:189], v25 offset:24800
    ds_read_b64_tr_b16 a[192:193], v25 offset:24832
    ds_read_b64_tr_b16 a[196:197], v25 offset:24864
    s_waitcnt lgkmcnt(0)
    s_waitcnt vmcnt(10)
    s_add_u32 m0, s54, 7168
    s_nop 0
    buffer_load_dwordx4 v15, s[32:35], s55 offen  lds
    s_waitcnt vmcnt(10)
    s_add_u32 m0, s54, 8192
    s_nop 0
    buffer_load_dwordx4 v16, s[32:35], s55 offen  lds
    s_waitcnt vmcnt(10)
    s_add_u32 m0, s54, 9216
    s_nop 0
    buffer_load_dwordx4 v17, s[32:35], s55 offen  lds
    s_waitcnt vmcnt(10)
    s_add_u32 m0, s54, 10240
    s_nop 0
    buffer_load_dwordx4 v18, s[32:35], s55 offen  lds
    s_waitcnt vmcnt(10)
    s_add_u32 s55, s58, 48
    s_and_b32 s55, s55, 63
    s_mul_i32 s55, s55, 6144
    s_add_u32 m0, s54, 12288
    s_nop 0
    buffer_load_dwordx4 v2, s[20:23], s55 offen nt lds
    ds_read_b64_tr_b16 a[162:163], v25 offset:30720
    ds_read_b64_tr_b16 a[166:167], v25 offset:30752
    ds_read_b64_tr_b16 a[170:171], v25 offset:30784
    ds_read_b64_tr_b16 a[174:175], v25 offset:30816
    ds_read_b64_tr_b16 a[178:179], v25 offset:30848
    ds_read_b64_tr_b16 a[182:183], v25 offset:30880
    ds_read_b64_tr_b16 a[186:187], v25 offset:30912
    ds_read_b64_tr_b16 a[190:191], v25 offset:30944
    ds_read_b64_tr_b16 a[194:195], v25 offset:30976
    ds_read_b64_tr_b16 a[198:199], v25 offset:31008
    s_waitcnt lgkmcnt(0)
    s_waitcnt vmcnt(10)
    s_add_u32 m0, s54, 13312
    s_nop 0
    buffer_load_dwordx4 v3, s[20:23], s55 offen nt lds
    s_waitcnt vmcnt(10)
    s_add_u32 m0, s54, 14336
    s_nop 0
    buffer_load_dwordx4 v4, s[20:23], s55 offen nt lds
    s_waitcnt vmcnt(10)
    s_add_u32 m0, s54, 15360
    s_nop 0
    buffer_load_dwordx4 v5, s[20:23], s55 offen nt lds
    s_waitcnt vmcnt(10)
    s_add_u32 m0, s54, 16384
    s_nop 0
    buffer_load_dwordx4 v6, s[20:23], s55 offen nt lds
    s_waitcnt vmcnt(10)
    s_add_u32 m0, s54, 17408
    s_nop 0
    buffer_load_dwordx4 v7, s[20:23], s55 offen nt lds
    ds_read_b64_tr_b16 a[200:201], v25 offset:0
    ds_read_b64_tr_b16 a[204:205], v25 offset:32
    ds_read_b64_tr_b16 a[208:209], v25 offset:64
    ds_read_b64_tr_b16 a[212:213], v25 offset:96
    ds_read_b64_tr_b16 a[216:217], v25 offset:128
    ds_read_b64_tr_b16 a[220:221], v25 offset:160
    ds_read_b64_tr_b16 a[224:225], v25 offset:192
    ds_read_b64_tr_b16 a[228:229], v25 offset:224
    ds_read_b64_tr_b16 a[232:233], v25 offset:256
    ds_read_b64_tr_b16 a[236:237], v25 offset:288
    s_waitcnt lgkmcnt(0)
    s_waitcnt vmcnt(10)
    s_add_u32 s55, s58, 52
    s_and_b32 s55, s55, 63
    s_mul_i32 s55, s55, 6144
    s_add_u32 m0, s54, 18432
    s_nop 0
    buffer_load_dwordx4 v2, s[20:23], s55 offen nt lds
    s_waitcnt vmcnt(10)
    s_add_u32 m0, s54, 19456
    s_nop 0
    buffer_load_dwordx4 v3, s[20:23], s55 offen nt lds
    s_waitcnt vmcnt(10)
    s_add_u32 m0, s54, 20480
    s_nop 0
    buffer_load_dwordx4 v4, s[20:23], s55 offen nt lds
    s_waitcnt vmcnt(10)
    s_add_u32 m0, s54, 21504
    s_nop 0
    buffer_load_dwordx4 v5, s[20:23], s55 offen nt lds
    s_waitcnt vmcnt(10)
    s_add_u32 m0, s54, 22528
    s_nop 0
    buffer_load_dwordx4 v6, s[20:23], s55 offen nt lds
    ds_read_b64_tr_b16 a[202:203], v25 offset:6144
    ds_read_b64_tr_b16 a[206:207], v25 offset:6176
    ds_read_b64_tr_b16 a[210:211], v25 offset:6208
    ds_read_b64_tr_b16 a[214:215], v25 offset:6240
    ds_read_b64_tr_b16 a[218:219], v25 offset:6272
    ds_read_b64_tr_b16 a[222:223], v25 offset:6304
    ds_read_b64_tr_b16 a[226:227], v25 offset:6336
    ds_read_b64_tr_b16 a[230:231], v25 offset:6368
    ds_read_b64_tr_b16 a[234:235], v25 offset:6400
    ds_read_b64_tr_b16 a[238:239], v25 offset:6432
    s_waitcnt lgkmcnt(0)
    s_waitcnt vmcnt(10)
    s_add_u32 m0, s54, 23552
    s_nop 0
    buffer_load_dwordx4 v7, s[20:23], s55 offen nt lds
    s_waitcnt vmcnt(10)
    s_add_u32 s55, s58, 56
    s_and_b32 s55, s55, 63
    s_mul_i32 s55, s55, 6144
    s_add_u32 m0, s54, 24576
    s_nop 0
    buffer_load_dwordx4 v2, s[20:23], s55 offen nt lds
    s_waitcnt vmcnt(10)
    s_add_u32 m0, s54, 25600
    s_nop 0
    buffer_load_dwordx4 v3, s[20:23], s55 offen nt lds
    s_waitcnt vmcnt(10)
    s_add_u32 m0, s54, 26624
    s_nop 0
    buffer_load_dwordx4 v4, s[20:23], s55 offen nt lds
    s_waitcnt vmcnt(10)
    s_add_u32 m0, s54, 27648
    s_nop 0
    buffer_load_dwordx4 v5, s[20:23], s55 offen nt lds
    s_waitcnt vmcnt(10)
    s_add_u32 m0, s54, 28672
    s_nop 0
    buffer_load_dwordx4 v6, s[20:23], s55 offen nt lds
    ds_read_b128 v[40:43], v19 offset:12288
    ds_read_b128 v[44:47], v20 offset:12288
    ds_read_b128 v[48:51], v19 offset:12416
    ds_read_b128 v[52:55], v20 offset:12416
    ds_read_b128 v[56:59], v19 offset:12544
    ds_read_b128 v[60:63], v20 offset:12544
    s_nop 1
    v_cvt_pk_bf16_f32 v36, v180, v181
    v_cvt_pk_bf16_f32 v37, v182, v183
    v_lshlrev_b32 v180, 16, v36
    v_and_b32 v181, 0xffff0000, v36
    v_lshlrev_b32 v182, 16, v37
    v_and_b32 v183, 0xffff0000, v37
    v_mul_f32 v180, s70, v180
    v_mul_f32 v181, s70, v181
    v_mul_f32 v182, s70, v182
    v_mul_f32 v183, s70, v183
    v_cvt_pk_bf16_f32 v36, v180, v181
    v_cvt_pk_bf16_f32 v37, v182, v183
    v_lshlrev_b32 v180, 16, v36
    v_and_b32 v181, 0xffff0000, v36
    v_lshlrev_b32 v182, 16, v37
    v_and_b32 v183, 0xffff0000, v37
    v_max3_f32 v33, v33, v180, v181
    v_max3_f32 v33, v33, v182, v183
    s_waitcnt lgkmcnt(0)
    v_mfma_f32_16x16x32_bf16 v[184:187], v[40:43], v[112:115], 0
    v_mfma_f32_16x16x32_bf16 v[184:187], v[44:47], v[116:119], v[184:187]
    v_mfma_f32_16x16x32_bf16 v[184:187], v[48:51], v[120:123], v[184:187]
    v_mfma_f32_16x16x32_bf16 v[184:187], v[52:55], v[124:127], v[184:187]
    v_mfma_f32_16x16x32_bf16 v[184:187], v[56:59], v[128:131], v[184:187]
    v_mfma_f32_16x16x32_bf16 v[184:187], v[60:63], v[132:135], v[184:187]
    s_waitcnt vmcnt(10)
    s_add_u32 m0, s54, 29696
    s_nop 0
    buffer_load_dwordx4 v7, s[20:23], s55 offen nt lds
    s_waitcnt vmcnt(10)
    s_add_u32 s55, s58, 60
    s_and_b32 s55, s55, 63
    s_mul_i32 s55, s55, 6144
    s_add_u32 m0, s54, 30720
    s_nop 0
    buffer_load_dwordx4 v2, s[20:23], s55 offen nt lds
    s_waitcnt vmcnt(10)
    s_add_u32 m0, s54, 31744
    s_nop 0
    buffer_load_dwordx4 v3, s[20:23], s55 offen nt lds
    s_waitcnt vmcnt(10)
    s_add_u32 m0, s54, 32768
    s_nop 0
    buffer_load_dwordx4 v4, s[20:23], s55 offen nt lds
    s_waitcnt vmcnt(10)
    s_add_u32 m0, s54, 33792
    s_nop 0
    buffer_load_dwordx4 v5, s[20:23], s55 offen nt lds
    s_waitcnt vmcnt(10)
    s_add_u32 m0, s54, 34816
    s_nop 0
    buffer_load_dwordx4 v6, s[20:23], s55 offen nt lds
    ds_read_b128 v[40:43], v19 offset:18432
    ds_read_b128 v[44:47], v20 offset:18432
    ds_read_b128 v[48:51], v19 offset:18560
    ds_read_b128 v[52:55], v20 offset:18560
    ds_read_b128 v[56:59], v19 offset:18688
    ds_read_b128 v[60:63], v20 offset:18688
    s_nop 1
    v_cvt_pk_bf16_f32 v36, v184, v185
    v_cvt_pk_bf16_f32 v37, v186, v187
    v_lshlrev_b32 v184, 16, v36
    v_and_b32 v185, 0xffff0000, v36
    v_lshlrev_b32 v186, 16, v37
    v_and_b32 v187, 0xffff0000, v37
    v_mul_f32 v184, s70, v184
    v_mul_f32 v185, s70, v185
    v_mul_f32 v186, s70, v186
    v_mul_f32 v187, s70, v187
    v_cvt_pk_bf16_f32 v36, v184, v185
    v_cvt_pk_bf16_f32 v37, v186, v187
    v_lshlrev_b32 v184, 16, v36
    v_and_b32 v185, 0xffff0000, v36
    v_lshlrev_b32 v186, 16, v37
    v_and_b32 v187, 0xffff0000, v37
    v_max3_f32 v33, v33, v184, v185
    v_max3_f32 v33, v33, v186, v187
    s_waitcnt lgkmcnt(0)
    v_mfma_f32_16x16x32_bf16 v[188:191], v[40:43], v[112:115], 0
    v_mfma_f32_16x16x32_bf16 v[188:191], v[44:47], v[116:119], v[188:191]
    v_mfma_f32_16x16x32_bf16 v[188:191], v[48:51], v[120:123], v[188:191]
    v_mfma_f32_16x16x32_bf16 v[188:191], v[52:55], v[124:127], v[188:191]
    v_mfma_f32_16x16x32_bf16 v[188:191], v[56:59], v[128:131], v[188:191]
    v_mfma_f32_16x16x32_bf16 v[188:191], v[60:63], v[132:135], v[188:191]
    s_waitcnt vmcnt(10)
    s_add_u32 m0, s54, 35840
    s_nop 0
    buffer_load_dwordx4 v7, s[20:23], s55 offen nt lds
    s_waitcnt vmcnt(10)
    s_add_u32 s55, s58, 0
    s_and_b32 s55, s55, 63
    s_mul_i32 s55, s55, 6144
    s_add_u32 m0, s54, 0
    s_nop 0
    buffer_load_dwordx4 v2, s[24:27], s55 offen nt lds
    s_waitcnt vmcnt(10)
    s_add_u32 m0, s54, 1024
    s_nop 0
    buffer_load_dwordx4 v3, s[24:27], s55 offen nt lds
    s_waitcnt vmcnt(10)
    s_add_u32 m0, s54, 2048
    s_nop 0
    buffer_load_dwordx4 v4, s[24:27], s55 offen nt lds
    s_waitcnt vmcnt(10)
    s_add_u32 m0, s54, 3072
    s_nop 0
    buffer_load_dwordx4 v5, s[24:27], s55 offen nt lds
    s_waitcnt vmcnt(10)
    s_add_u32 m0, s54, 4096
    s_nop 0
    buffer_load_dwordx4 v6, s[24:27], s55 offen nt lds
    ds_read_b128 v[40:43], v19 offset:24576
    ds_read_b128 v[44:47], v20 offset:24576
    ds_read_b128 v[48:51], v19 offset:24704
    ds_read_b128 v[52:55], v20 offset:24704
    ds_read_b128 v[56:59], v19 offset:24832
    ds_read_b128 v[60:63], v20 offset:24832
    s_nop 1
    v_cvt_pk_bf16_f32 v36, v188, v189
    v_cvt_pk_bf16_f32 v37, v190, v191
    v_lshlrev_b32 v188, 16, v36
    v_and_b32 v189, 0xffff0000, v36
    v_lshlrev_b32 v190, 16, v37
    v_and_b32 v191, 0xffff0000, v37
    v_mul_f32 v188, s70, v188
    v_mul_f32 v189, s70, v189
    v_mul_f32 v190, s70, v190
    v_mul_f32 v191, s70, v191
    v_cvt_pk_bf16_f32 v36, v188, v189
    v_cvt_pk_bf16_f32 v37, v190, v191
    v_lshlrev_b32 v188, 16, v36
    v_and_b32 v189, 0xffff0000, v36
    v_lshlrev_b32 v190, 16, v37
    v_and_b32 v191, 0xffff0000, v37
    v_max3_f32 v33, v33, v188, v189
    v_max3_f32 v33, v33, v190, v191
    s_waitcnt lgkmcnt(0)
    v_mfma_f32_16x16x32_bf16 v[192:195], v[40:43], v[112:115], 0
    v_mfma_f32_16x16x32_bf16 v[192:195], v[44:47], v[116:119], v[192:195]
    v_mfma_f32_16x16x32_bf16 v[192:195], v[48:51], v[120:123], v[192:195]
    v_mfma_f32_16x16x32_bf16 v[192:195], v[52:55], v[124:127], v[192:195]
    v_mfma_f32_16x16x32_bf16 v[192:195], v[56:59], v[128:131], v[192:195]
    v_mfma_f32_16x16x32_bf16 v[192:195], v[60:63], v[132:135], v[192:195]
    s_waitcnt vmcnt(10)
    s_add_u32 m0, s54, 5120
    s_nop 0
    buffer_load_dwordx4 v7, s[24:27], s55 offen nt lds
    s_waitcnt vmcnt(10)
    s_add_u32 s55, s58, 4
    s_and_b32 s55, s55, 63
    s_mul_i32 s55, s55, 6144
    s_add_u32 m0, s54, 6144
    s_nop 0
    buffer_load_dwordx4 v2, s[24:27], s55 offen nt lds
    s_waitcnt vmcnt(10)
    s_add_u32 m0, s54, 7168
    s_nop 0
    buffer_load_dwordx4 v3, s[24:27], s55 offen nt lds
    s_waitcnt vmcnt(10)
    s_add_u32 m0, s54, 8192
    s_nop 0
    buffer_load_dwordx4 v4, s[24:27], s55 offen nt lds
    s_waitcnt vmcnt(10)
    s_add_u32 m0, s54, 9216
    s_nop 0
    buffer_load_dwordx4 v5, s[24:27], s55 offen nt lds
    s_waitcnt vmcnt(10)
    s_add_u32 m0, s54, 10240
    s_nop 0
    buffer_load_dwordx4 v6, s[24:27], s55 offen nt lds
    ds_read_b128 v[40:43], v19 offset:30720
    ds_read_b128 v[44:47], v20 offset:30720
    ds_read_b128 v[48:51], v19 offset:30848
    ds_read_b128 v[52:55], v20 offset:30848
    ds_read_b128 v[56:59], v19 offset:30976
    ds_read_b128 v[60:63], v20 offset:30976
    s_nop 1
    v_cvt_pk_bf16_f32 v36, v192, v193
    v_cvt_pk_bf16_f32 v37, v194, v195
    v_lshlrev_b32 v192, 16, v36
    v_and_b32 v193, 0xffff0000, v36
    v_lshlrev_b32 v194, 16, v37
    v_and_b32 v195, 0xffff0000, v37
    v_mul_f32 v192, s70, v192
    v_mul_f32 v193, s70, v193
    v_mul_f32 v194, s70, v194
    v_mul_f32 v195, s70, v195
    v_cvt_pk_bf16_f32 v36, v192, v193
    v_cvt_pk_bf16_f32 v37, v194, v195
    v_lshlrev_b32 v192, 16, v36
    v_and_b32 v193, 0xffff0000, v36
    v_lshlrev_b32 v194, 16, v37
    v_and_b32 v195, 0xffff0000, v37
    v_max3_f32 v33, v33, v192, v193
    v_max3_f32 v33, v33, v194, v195
    s_waitcnt lgkmcnt(0)
    v_mfma_f32_16x16x32_bf16 v[196:199], v[40:43], v[112:115], 0
    v_mfma_f32_16x16x32_bf16 v[196:199], v[44:47], v[116:119], v[196:199]
    v_mfma_f32_16x16x32_bf16 v[196:199], v[48:51], v[120:123], v[196:199]
    v_mfma_f32_16x16x32_bf16 v[196:199], v[52:55], v[124:127], v[196:199]
    v_mfma_f32_16x16x32_bf16 v[196:199], v[56:59], v[128:131], v[196:199]
    v_mfma_f32_16x16x32_bf16 v[196:199], v[60:63], v[132:135], v[196:199]
    s_waitcnt vmcnt(10)
    s_add_u32 m0, s54, 11264
    s_nop 0
    buffer_load_dwordx4 v7, s[24:27], s55 offen nt lds
    s_waitcnt vmcnt(10)
    s_add_u32 s55, s58, 8
    s_and_b32 s55, s55, 63
    s_mul_i32 s55, s55, 6144
    s_add_u32 m0, s54, 12288
    s_nop 0
    buffer_load_dwordx4 v2, s[24:27], s55 offen nt lds
    s_nop 7
    v_cvt_pk_bf16_f32 v36, v196, v197
    v_cvt_pk_bf16_f32 v37, v198, v199
    v_lshlrev_b32 v196, 16, v36
    v_and_b32 v197, 0xffff0000, v36
    v_lshlrev_b32 v198, 16, v37
    v_and_b32 v199, 0xffff0000, v37
    v_mul_f32 v196, s70, v196
    v_mul_f32 v197, s70, v197
    v_mul_f32 v198, s70, v198
    v_mul_f32 v199, s70, v199
    v_cvt_pk_bf16_f32 v36, v196, v197
    v_cvt_pk_bf16_f32 v37, v198, v199
    v_lshlrev_b32 v196, 16, v36
    v_and_b32 v197, 0xffff0000, v36
    v_lshlrev_b32 v198, 16, v37
    v_and_b32 v199, 0xffff0000, v37
    v_max3_f32 v33, v33, v196, v197
    v_max3_f32 v33, v33, v198, v199
    s_add_u32 m0, s54, 13312
    s_nop 0
    buffer_load_dwordx4 v3, s[24:27], s55 offen nt lds
    s_add_u32 m0, s54, 14336
    s_nop 0
    buffer_load_dwordx4 v4, s[24:27], s55 offen nt lds
    ds_write_b32 v31, v33
    s_waitcnt lgkmcnt(0)
    s_barrier
    ds_read_b128 v[40:43], v32 offset:0
    ds_read_b128 v[44:47], v32 offset:16
    ds_read_b128 v[48:51], v32 offset:32
    ds_read_b128 v[52:55], v32 offset:48
    s_waitcnt lgkmcnt(0)
    v_max3_f32 v33, v33, v40, v41
    v_max3_f32 v33, v33, v42, v43
    v_max3_f32 v33, v33, v44, v45
    v_max3_f32 v33, v33, v46, v47
    v_max3_f32 v33, v33, v48, v49
    v_max3_f32 v33, v33, v50, v51
    v_max3_f32 v33, v33, v52, v53
    v_max3_f32 v33, v33, v54, v55
    v_mul_f32 v33, s71, v33
    s_add_u32 m0, s54, 15360
    s_nop 0
    buffer_load_dwordx4 v5, s[24:27], s55 offen nt lds
    s_add_u32 m0, s54, 16384
    s_nop 0
    buffer_load_dwordx4 v6, s[24:27], s55 offen nt lds
    v_fma_f32 v136, v136, s71, -v33
    v_fma_f32 v137, v137, s71, -v33
    v_fma_f32 v138, v138, s71, -v33
    v_fma_f32 v139, v139, s71, -v33
    v_fma_f32 v140, v140, s71, -v33
    v_fma_f32 v141, v141, s71, -v33
    v_fma_f32 v142, v142, s71, -v33
    v_fma_f32 v143, v143, s71, -v33
    v_fma_f32 v144, v144, s71, -v33
    v_fma_f32 v145, v145, s71, -v33
    v_fma_f32 v146, v146, s71, -v33
    v_fma_f32 v147, v147, s71, -v33
    v_fma_f32 v148, v148, s71, -v33
    v_fma_f32 v149, v149, s71, -v33
    v_fma_f32 v150, v150, s71, -v33
    v_fma_f32 v151, v151, s71, -v33
    v_fma_f32 v152, v152, s71, -v33
    v_fma_f32 v153, v153, s71, -v33
    v_fma_f32 v154, v154, s71, -v33
    v_fma_f32 v155, v155, s71, -v33
    v_fma_f32 v156, v156, s71, -v33
    v_fma_f32 v157, v157, s71, -v33
    v_fma_f32 v158, v158, s71, -v33
    v_fma_f32 v159, v159, s71, -v33
    v_fma_f32 v160, v160, s71, -v33
    v_fma_f32 v161, v161, s71, -v33
    v_fma_f32 v162, v162, s71, -v33
    v_fma_f32 v163, v163, s71, -v33
    v_fma_f32 v164, v164, s71, -v33
    v_fma_f32 v165, v165, s71, -v33
    v_fma_f32 v166, v166, s71, -v33
    v_fma_f32 v167, v167, s71, -v33
    v_fma_f32 v168, v168, s71, -v33
    v_fma_f32 v169, v169, s71, -v33
    v_fma_f32 v170, v170, s71, -v33
    v_fma_f32 v171, v171, s71, -v33
    v_fma_f32 v172, v172, s71, -v33
    v_fma_f32 v173, v173, s71, -v33
    v_fma_f32 v174, v174, s71, -v33
    v_fma_f32 v175, v175, s71, -v33
    v_fma_f32 v176, v176, s71, -v33
    v_fma_f32 v177, v177, s71, -v33
    v_fma_f32 v178, v178, s71, -v33
    v_fma_f32 v179, v179, s71, -v33
    v_fma_f32 v180, v180, s71, -v33
    v_fma_f32 v181, v181, s71, -v33
    v_fma_f32 v182, v182, s71, -v33
    v_fma_f32 v183, v183, s71, -v33
    v_fma_f32 v184, v184, s71, -v33
    v_fma_f32 v185, v185, s71, -v33
    v_fma_f32 v186, v186, s71, -v33
    v_fma_f32 v187, v187, s71, -v33
    v_fma_f32 v188, v188, s71, -v33
    v_fma_f32 v189, v189, s71, -v33
    v_fma_f32 v190, v190, s71, -v33
    v_fma_f32 v191, v191, s71, -v33
    v_fma_f32 v192, v192, s71, -v33
    v_fma_f32 v193, v193, s71, -v33
    v_fma_f32 v194, v194, s71, -v33
    v_fma_f32 v195, v195, s71, -v33
    v_fma_f32 v196, v196, s71, -v33
    v_fma_f32 v197, v197, s71, -v33
    v_fma_f32 v198, v198, s71, -v33
    v_fma_f32 v199, v199, s71, -v33
    s_add_u32 m0, s54, 17408
    s_nop 0
    buffer_load_dwordx4 v7, s[24:27], s55 offen nt lds
    s_add_u32 s55, s58, 12
    s_and_b32 s55, s55, 63
    s_mul_i32 s55, s55, 6144
    s_add_u32 m0, s54, 18432
    s_nop 0
    buffer_load_dwordx4 v2, s[24:27], s55 offen nt lds
    v_exp_f32 v136, v136
    v_exp_f32 v137, v137
    v_exp_f32 v138, v138
    v_exp_f32 v139, v139
    v_exp_f32 v140, v140
    v_exp_f32 v141, v141
    v_exp_f32 v142, v142
    v_exp_f32 v143, v143
    v_exp_f32 v144, v144
    v_exp_f32 v145, v145
    v_exp_f32 v146, v146
    v_exp_f32 v147, v147
    v_exp_f32 v148, v148
    v_exp_f32 v149, v149
    v_exp_f32 v150, v150
    v_exp_f32 v151, v151
    v_exp_f32 v152, v152
    v_exp_f32 v153, v153
    v_exp_f32 v154, v154
    v_exp_f32 v155, v155
    v_exp_f32 v156, v156
    v_exp_f32 v157, v157
    v_exp_f32 v158, v158
    v_exp_f32 v159, v159
    v_exp_f32 v160, v160
    v_exp_f32 v161, v161
    v_exp_f32 v162, v162
    v_exp_f32 v163, v163
    v_exp_f32 v164, v164
    v_exp_f32 v165, v165
    v_exp_f32 v166, v166
    v_exp_f32 v167, v167
    s_add_u32 m0, s54, 19456
    s_nop 0
    buffer_load_dwordx4 v3, s[24:27], s55 offen nt lds
    s_add_u32 m0, s54, 20480
    s_nop 0
    buffer_load_dwordx4 v4, s[24:27], s55 offen nt lds
    v_exp_f32 v168, v168
    v_exp_f32 v169, v169
    v_exp_f32 v170, v170
    v_exp_f32 v171, v171
    v_exp_f32 v172, v172
    v_exp_f32 v173, v173
    v_exp_f32 v174, v174
    v_exp_f32 v175, v175
    v_exp_f32 v176, v176
    v_exp_f32 v177, v177
    v_exp_f32 v178, v178
    v_exp_f32 v179, v179
    v_exp_f32 v180, v180
    v_exp_f32 v181, v181
    v_exp_f32 v182, v182
    v_exp_f32 v183, v183
    v_exp_f32 v184, v184
    v_exp_f32 v185, v185
    v_exp_f32 v186, v186
    v_exp_f32 v187, v187
    v_exp_f32 v188, v188
    v_exp_f32 v189, v189
    v_exp_f32 v190, v190
    v_exp_f32 v191, v191
    v_exp_f32 v192, v192
    v_exp_f32 v193, v193
    v_exp_f32 v194, v194
    v_exp_f32 v195, v195
    v_exp_f32 v196, v196
    v_exp_f32 v197, v197
    v_exp_f32 v198, v198
    v_exp_f32 v199, v199
    s_add_u32 m0, s54, 21504
    s_nop 0
    buffer_load_dwordx4 v5, s[24:27], s55 offen nt lds
    s_add_u32 m0, s54, 22528
    s_nop 0
    buffer_load_dwordx4 v6, s[24:27], s55 offen nt lds
    v_add_f32 v36, v136, v137
    v_add_f32 v37, v138, v139
    v_add_f32 v36, v36, v140
    v_add_f32 v37, v37, v141
    v_add_f32 v36, v36, v142
    v_add_f32 v37, v37, v143
    v_add_f32 v36, v36, v144
    v_add_f32 v37, v37, v145
    v_add_f32 v36, v36, v146
    v_add_f32 v37, v37, v147
    v_add_f32 v36, v36, v148
    v_add_f32 v37, v37, v149
    v_add_f32 v36, v36, v150
    v_add_f32 v37, v37, v151
    v_add_f32 v36, v36, v152
    v_add_f32 v37, v37, v153
    v_add_f32 v36, v36, v154
    v_add_f32 v37, v37, v155
    v_add_f32 v36, v36, v156
    v_add_f32 v37, v37, v157
    v_add_f32 v36, v36, v158
    v_add_f32 v37, v37, v159
    v_add_f32 v36, v36, v160
    v_add_f32 v37, v37, v161
    v_add_f32 v36, v36, v162
    v_add_f32 v37, v37, v163
    v_add_f32 v36, v36, v164
    v_add_f32 v37, v37, v165
    v_add_f32 v36, v36, v166
    v_add_f32 v37, v37, v167
    v_add_f32 v36, v36, v168
    v_add_f32 v37, v37, v169
    v_add_f32 v36, v36, v170
    v_add_f32 v37, v37, v171
    v_add_f32 v36, v36, v172
    v_add_f32 v37, v37, v173
    v_add_f32 v36, v36, v174
    v_add_f32 v37, v37, v175
    v_add_f32 v36, v36, v176
    v_add_f32 v37, v37, v177
    v_add_f32 v36, v36, v178
    v_add_f32 v37, v37, v179
    v_add_f32 v36, v36, v180
    v_add_f32 v37, v37, v181
    v_add_f32 v36, v36, v182
    v_add_f32 v37, v37, v183
    v_add_f32 v36, v36, v184
    v_add_f32 v37, v37, v185
    v_add_f32 v36, v36, v186
    v_add_f32 v37, v37, v187
    v_add_f32 v36, v36, v188
    v_add_f32 v37, v37, v189
    v_add_f32 v36, v36, v190
    v_add_f32 v37, v37, v191
    v_add_f32 v36, v36, v192
    v_add_f32 v37, v37, v193
    v_add_f32 v36, v36, v194
    v_add_f32 v37, v37, v195
    v_add_f32 v36, v36, v196
    v_add_f32 v37, v37, v197
    v_add_f32 v36, v36, v198
    v_add_f32 v37, v37, v199
    v_add_f32 v36, v36, v37
    ds_write_b32 v31, v36 offset:256
    s_waitcnt lgkmcnt(0)
    s_barrier
    ds_read_b128 v[40:43], v32 offset:256
    ds_read_b128 v[44:47], v32 offset:272
    ds_read_b128 v[48:51], v32 offset:288
    ds_read_b128 v[52:55], v32 offset:304
    s_add_u32 m0, s54, 23552
    s_nop 0
    buffer_load_dwordx4 v7, s[24:27], s55 offen nt lds
    s_add_u32 s55, s58, 16
    s_and_b32 s55, s55, 63
    s_mul_i32 s55, s55, 6144
    s_add_u32 m0, s54, 24576
    s_nop 0
    buffer_load_dwordx4 v2, s[24:27], s55 offen nt lds
    s_waitcnt lgkmcnt(0)
    v_add_f32 v40, v40, v48
    v_add_f32 v41, v41, v49
    v_add_f32 v42, v42, v50
    v_add_f32 v43, v43, v51
    v_add_f32 v44, v44, v52
    v_add_f32 v45, v45, v53
    v_add_f32 v46, v46, v54
    v_add_f32 v47, v47, v55
    v_add_f32 v40, v40, v44
    v_add_f32 v41, v41, v45
    v_add_f32 v42, v42, v46
    v_add_f32 v43, v43, v47
    v_add_f32 v40, v40, v41
    v_add_f32 v42, v42, v43
    v_add_f32 v40, v40, v42
    v_rcp_f32 v36, v40
    s_nop 0
    v_mul_f32 v136, v36, v136
    v_mul_f32 v137, v36, v137
    v_mul_f32 v138, v36, v138
    v_mul_f32 v139, v36, v139
    v_mul_f32 v140, v36, v140
    v_mul_f32 v141, v36, v141
    v_mul_f32 v142, v36, v142
    v_mul_f32 v143, v36, v143
    v_mul_f32 v144, v36, v144
    v_mul_f32 v145, v36, v145
    v_mul_f32 v146, v36, v146
    v_mul_f32 v147, v36, v147
    v_mul_f32 v148, v36, v148
    v_mul_f32 v149, v36, v149
    v_mul_f32 v150, v36, v150
    v_mul_f32 v151, v36, v151
    v_mul_f32 v152, v36, v152
    v_mul_f32 v153, v36, v153
    v_mul_f32 v154, v36, v154
    v_mul_f32 v155, v36, v155
    v_mul_f32 v156, v36, v156
    v_mul_f32 v157, v36, v157
    v_mul_f32 v158, v36, v158
    v_mul_f32 v159, v36, v159
    v_mul_f32 v160, v36, v160
    v_mul_f32 v161, v36, v161
    v_mul_f32 v162, v36, v162
    v_mul_f32 v163, v36, v163
    v_mul_f32 v164, v36, v164
    v_mul_f32 v165, v36, v165
    v_mul_f32 v166, v36, v166
    v_mul_f32 v167, v36, v167
    v_mul_f32 v168, v36, v168
    v_mul_f32 v169, v36, v169
    v_mul_f32 v170, v36, v170
    v_mul_f32 v171, v36, v171
    v_mul_f32 v172, v36, v172
    v_mul_f32 v173, v36, v173
    v_mul_f32 v174, v36, v174
    v_mul_f32 v175, v36, v175
    v_mul_f32 v176, v36, v176
    v_mul_f32 v177, v36, v177
    v_mul_f32 v178, v36, v178
    v_mul_f32 v179, v36, v179
    v_mul_f32 v180, v36, v180
    v_mul_f32 v181, v36, v181
    v_mul_f32 v182, v36, v182
    v_mul_f32 v183, v36, v183
    v_mul_f32 v184, v36, v184
    v_mul_f32 v185, v36, v185
    v_mul_f32 v186, v36, v186
    v_mul_f32 v187, v36, v187
    v_mul_f32 v188, v36, v188
    v_mul_f32 v189, v36, v189
    v_mul_f32 v190, v36, v190
    v_mul_f32 v191, v36, v191
    v_mul_f32 v192, v36, v192
    v_mul_f32 v193, v36, v193
    v_mul_f32 v194, v36, v194
    v_mul_f32 v195, v36, v195
    v_mul_f32 v196, v36, v196
    v_mul_f32 v197, v36, v197
    v_mul_f32 v198, v36, v198
    v_mul_f32 v199, v36, v199
    s_add_u32 m0, s54, 25600
    s_nop 0
    buffer_load_dwordx4 v3, s[24:27], s55 offen nt lds
    s_add_u32 m0, s54, 26624
    s_nop 0
    buffer_load_dwordx4 v4, s[24:27], s55 offen nt lds
    v_cvt_pk_bf16_f32 v200, v136, v137
    v_cvt_pk_bf16_f32 v201, v138, v139
    v_cvt_pk_bf16_f32 v202, v140, v141
    v_cvt_pk_bf16_f32 v203, v142, v143
    v_cvt_pk_bf16_f32 v204, v144, v145
    v_cvt_pk_bf16_f32 v205, v146, v147
    v_cvt_pk_bf16_f32 v206, v148, v149
    v_cvt_pk_bf16_f32 v207, v150, v151
    v_cvt_pk_bf16_f32 v208, v152, v153
    v_cvt_pk_bf16_f32 v209, v154, v155
    v_cvt_pk_bf16_f32 v210, v156, v157
    v_cvt_pk_bf16_f32 v211, v158, v159
    v_cvt_pk_bf16_f32 v212, v160, v161
    v_cvt_pk_bf16_f32 v213, v162, v163
    v_cvt_pk_bf16_f32 v214, v164, v165
    v_cvt_pk_bf16_f32 v215, v166, v167
    v_cvt_pk_bf16_f32 v216, v168, v169
    v_cvt_pk_bf16_f32 v217, v170, v171
    v_cvt_pk_bf16_f32 v218, v172, v173
    v_cvt_pk_bf16_f32 v219, v174, v175
    v_cvt_pk_bf16_f32 v220, v176, v177
    v_cvt_pk_bf16_f32 v221, v178, v179
    v_cvt_pk_bf16_f32 v222, v180, v181
    v_cvt_pk_bf16_f32 v223, v182, v183
    v_cvt_pk_bf16_f32 v224, v184, v185
    v_cvt_pk_bf16_f32 v225, v186, v187
    v_cvt_pk_bf16_f32 v226, v188, v189
    v_cvt_pk_bf16_f32 v227, v190, v191
    v_cvt_pk_bf16_f32 v228, v192, v193
    v_cvt_pk_bf16_f32 v229, v194, v195
    v_cvt_pk_bf16_f32 v230, v196, v197
    v_cvt_pk_bf16_f32 v231, v198, v199
    v_mov_b32 v33, 0xffffff00
    s_nop 0
    s_waitcnt vmcnt(21)
    ds_read_b64_tr_b16 v[40:41], v21 offset:0
    ds_read_b64_tr_b16 v[42:43], v22 offset:0
    ds_read_b64_tr_b16 v[44:45], v23 offset:0
    ds_read_b64_tr_b16 v[46:47], v24 offset:0
    ds_read_b64_tr_b16 v[48:49], v21 offset:128
    ds_read_b64_tr_b16 v[50:51], v22 offset:128
    ds_read_b64_tr_b16 v[52:53], v23 offset:128
    ds_read_b64_tr_b16 v[54:55], v24 offset:128
    ds_read_b64_tr_b16 v[56:57], v21 offset:256
    ds_read_b64_tr_b16 v[58:59], v22 offset:256
    ds_read_b64_tr_b16 v[60:61], v23 offset:256
    ds_read_b64_tr_b16 v[62:63], v24 offset:256
    s_waitcnt lgkmcnt(0)
    v_mfma_f32_16x16x16_bf16 v[64:67], v[40:41], v[200:201], 0
    v_mfma_f32_16x16x16_bf16 v[68:71], v[42:43], v[200:201], 0
    v_mfma_f32_16x16x16_bf16 v[72:75], v[44:45], v[200:201], 0
    v_mfma_f32_16x16x16_bf16 v[76:79], v[46:47], v[200:201], 0
    v_mfma_f32_16x16x16_bf16 v[80:83], v[48:49], v[200:201], 0
    v_mfma_f32_16x16x16_bf16 v[84:87], v[50:51], v[200:201], 0
    v_mfma_f32_16x16x16_bf16 v[88:91], v[52:53], v[200:201], 0
    v_mfma_f32_16x16x16_bf16 v[92:95], v[54:55], v[200:201], 0
    v_mfma_f32_16x16x16_bf16 v[96:99], v[56:57], v[200:201], 0
    v_mfma_f32_16x16x16_bf16 v[100:103], v[58:59], v[200:201], 0
    v_mfma_f32_16x16x16_bf16 v[104:107], v[60:61], v[200:201], 0
    v_mfma_f32_16x16x16_bf16 v[108:111], v[62:63], v[200:201], 0
    s_waitcnt vmcnt(10)
    s_add_u32 m0, s54, 27648
    s_nop 0
    buffer_load_dwordx4 v5, s[24:27], s55 offen nt lds
    s_waitcnt vmcnt(10)
    s_add_u32 m0, s54, 28672
    s_nop 0
    buffer_load_dwordx4 v6, s[24:27], s55 offen nt lds
    ds_read_b64_tr_b16 v[40:41], v21 offset:6144
    ds_read_b64_tr_b16 v[42:43], v22 offset:6144
    ds_read_b64_tr_b16 v[44:45], v23 offset:6144
    ds_read_b64_tr_b16 v[46:47], v24 offset:6144
    ds_read_b64_tr_b16 v[48:49], v21 offset:6272
    ds_read_b64_tr_b16 v[50:51], v22 offset:6272
    ds_read_b64_tr_b16 v[52:53], v23 offset:6272
    ds_read_b64_tr_b16 v[54:55], v24 offset:6272
    ds_read_b64_tr_b16 v[56:57], v21 offset:6400
    ds_read_b64_tr_b16 v[58:59], v22 offset:6400
    ds_read_b64_tr_b16 v[60:61], v23 offset:6400
    ds_read_b64_tr_b16 v[62:63], v24 offset:6400
    s_waitcnt lgkmcnt(0)
    v_mfma_f32_16x16x16_bf16 v[64:67], v[40:41], v[202:203], v[64:67]
    v_mfma_f32_16x16x16_bf16 v[68:71], v[42:43], v[202:203], v[68:71]
    v_mfma_f32_16x16x16_bf16 v[72:75], v[44:45], v[202:203], v[72:75]
    v_mfma_f32_16x16x16_bf16 v[76:79], v[46:47], v[202:203], v[76:79]
    v_mfma_f32_16x16x16_bf16 v[80:83], v[48:49], v[202:203], v[80:83]
    v_mfma_f32_16x16x16_bf16 v[84:87], v[50:51], v[202:203], v[84:87]
    v_mfma_f32_16x16x16_bf16 v[88:91], v[52:53], v[202:203], v[88:91]
    v_mfma_f32_16x16x16_bf16 v[92:95], v[54:55], v[202:203], v[92:95]
    v_mfma_f32_16x16x16_bf16 v[96:99], v[56:57], v[202:203], v[96:99]
    v_mfma_f32_16x16x16_bf16 v[100:103], v[58:59], v[202:203], v[100:103]
    v_mfma_f32_16x16x16_bf16 v[104:107], v[60:61], v[202:203], v[104:107]
    v_mfma_f32_16x16x16_bf16 v[108:111], v[62:63], v[202:203], v[108:111]
    s_waitcnt vmcnt(10)
    s_add_u32 m0, s54, 29696
    s_nop 0
    buffer_load_dwordx4 v7, s[24:27], s55 offen nt lds
    s_waitcnt vmcnt(10)
    s_add_u32 s55, s58, 20
    s_and_b32 s55, s55, 63
    s_mul_i32 s55, s55, 6144
    s_add_u32 m0, s54, 30720
    s_nop 0
    buffer_load_dwordx4 v2, s[24:27], s55 offen nt lds
    ds_read_b64_tr_b16 v[40:41], v21 offset:12288
    ds_read_b64_tr_b16 v[42:43], v22 offset:12288
    ds_read_b64_tr_b16 v[44:45], v23 offset:12288
    ds_read_b64_tr_b16 v[46:47], v24 offset:12288
    ds_read_b64_tr_b16 v[48:49], v21 offset:12416
    ds_read_b64_tr_b16 v[50:51], v22 offset:12416
    ds_read_b64_tr_b16 v[52:53], v23 offset:12416
    ds_read_b64_tr_b16 v[54:55], v24 offset:12416
    ds_read_b64_tr_b16 v[56:57], v21 offset:12544
    ds_read_b64_tr_b16 v[58:59], v22 offset:12544
    ds_read_b64_tr_b16 v[60:61], v23 offset:12544
    ds_read_b64_tr_b16 v[62:63], v24 offset:12544
    s_waitcnt lgkmcnt(0)
    v_mfma_f32_16x16x16_bf16 v[64:67], v[40:41], v[204:205], v[64:67]
    v_mfma_f32_16x16x16_bf16 v[68:71], v[42:43], v[204:205], v[68:71]
    v_mfma_f32_16x16x16_bf16 v[72:75], v[44:45], v[204:205], v[72:75]
    v_mfma_f32_16x16x16_bf16 v[76:79], v[46:47], v[204:205], v[76:79]
    v_mfma_f32_16x16x16_bf16 v[80:83], v[48:49], v[204:205], v[80:83]
    v_mfma_f32_16x16x16_bf16 v[84:87], v[50:51], v[204:205], v[84:87]
    v_mfma_f32_16x16x16_bf16 v[88:91], v[52:53], v[204:205], v[88:91]
    v_mfma_f32_16x16x16_bf16 v[92:95], v[54:55], v[204:205], v[92:95]
    v_mfma_f32_16x16x16_bf16 v[96:99], v[56:57], v[204:205], v[96:99]
    v_mfma_f32_16x16x16_bf16 v[100:103], v[58:59], v[204:205], v[100:103]
    v_mfma_f32_16x16x16_bf16 v[104:107], v[60:61], v[204:205], v[104:107]
    v_mfma_f32_16x16x16_bf16 v[108:111], v[62:63], v[204:205], v[108:111]
    s_waitcnt vmcnt(10)
    s_add_u32 m0, s54, 31744
    s_nop 0
    buffer_load_dwordx4 v3, s[24:27], s55 offen nt lds
    s_waitcnt vmcnt(10)
    s_add_u32 m0, s54, 32768
    s_nop 0
    buffer_load_dwordx4 v4, s[24:27], s55 offen nt lds
    s_waitcnt vmcnt(10)
    s_add_u32 m0, s54, 33792
    s_nop 0
    buffer_load_dwordx4 v5, s[24:27], s55 offen nt lds
    s_waitcnt vmcnt(10)
    s_add_u32 m0, s54, 34816
    s_nop 0
    buffer_load_dwordx4 v6, s[24:27], s55 offen nt lds
    ds_read_b64_tr_b16 v[40:41], v21 offset:18432
    ds_read_b64_tr_b16 v[42:43], v22 offset:18432
    ds_read_b64_tr_b16 v[44:45], v23 offset:18432
    ds_read_b64_tr_b16 v[46:47], v24 offset:18432
    ds_read_b64_tr_b16 v[48:49], v21 offset:18560
    ds_read_b64_tr_b16 v[50:51], v22 offset:18560
    ds_read_b64_tr_b16 v[52:53], v23 offset:18560
    ds_read_b64_tr_b16 v[54:55], v24 offset:18560
    ds_read_b64_tr_b16 v[56:57], v21 offset:18688
    ds_read_b64_tr_b16 v[58:59], v22 offset:18688
    ds_read_b64_tr_b16 v[60:61], v23 offset:18688
    ds_read_b64_tr_b16 v[62:63], v24 offset:18688
    s_waitcnt lgkmcnt(0)
    v_mfma_f32_16x16x16_bf16 v[64:67], v[40:41], v[206:207], v[64:67]
    v_mfma_f32_16x16x16_bf16 v[68:71], v[42:43], v[206:207], v[68:71]
    v_mfma_f32_16x16x16_bf16 v[72:75], v[44:45], v[206:207], v[72:75]
    v_mfma_f32_16x16x16_bf16 v[76:79], v[46:47], v[206:207], v[76:79]
    v_mfma_f32_16x16x16_bf16 v[80:83], v[48:49], v[206:207], v[80:83]
    v_mfma_f32_16x16x16_bf16 v[84:87], v[50:51], v[206:207], v[84:87]
    v_mfma_f32_16x16x16_bf16 v[88:91], v[52:53], v[206:207], v[88:91]
    v_mfma_f32_16x16x16_bf16 v[92:95], v[54:55], v[206:207], v[92:95]
    v_mfma_f32_16x16x16_bf16 v[96:99], v[56:57], v[206:207], v[96:99]
    v_mfma_f32_16x16x16_bf16 v[100:103], v[58:59], v[206:207], v[100:103]
    v_mfma_f32_16x16x16_bf16 v[104:107], v[60:61], v[206:207], v[104:107]
    v_mfma_f32_16x16x16_bf16 v[108:111], v[62:63], v[206:207], v[108:111]
    s_waitcnt vmcnt(10)
    s_add_u32 m0, s54, 35840
    s_nop 0
    buffer_load_dwordx4 v7, s[24:27], s55 offen nt lds
    s_waitcnt vmcnt(10)
    s_add_u32 s55, s58, 24
    s_and_b32 s55, s55, 63
    s_mul_i32 s55, s55, 6144
    s_add_u32 m0, s54, 0
    s_nop 0
    buffer_load_dwordx4 v2, s[24:27], s55 offen nt lds
    s_waitcnt vmcnt(10)
    s_add_u32 m0, s54, 1024
    s_nop 0
    buffer_load_dwordx4 v3, s[24:27], s55 offen nt lds
    s_waitcnt vmcnt(10)
    s_add_u32 m0, s54, 2048
    s_nop 0
    buffer_load_dwordx4 v4, s[24:27], s55 offen nt lds
    s_waitcnt vmcnt(10)
    s_add_u32 m0, s54, 3072
    s_nop 0
    buffer_load_dwordx4 v5, s[24:27], s55 offen nt lds
    s_waitcnt vmcnt(10)
    s_add_u32 m0, s54, 4096
    s_nop 0
    buffer_load_dwordx4 v6, s[24:27], s55 offen nt lds
    ds_read_b64_tr_b16 v[40:41], v21 offset:24576
    ds_read_b64_tr_b16 v[42:43], v22 offset:24576
    ds_read_b64_tr_b16 v[44:45], v23 offset:24576
    ds_read_b64_tr_b16 v[46:47], v24 offset:24576
    ds_read_b64_tr_b16 v[48:49], v21 offset:24704
    ds_read_b64_tr_b16 v[50:51], v22 offset:24704
    ds_read_b64_tr_b16 v[52:53], v23 offset:24704
    ds_read_b64_tr_b16 v[54:55], v24 offset:24704
    ds_read_b64_tr_b16 v[56:57], v21 offset:24832
    ds_read_b64_tr_b16 v[58:59], v22 offset:24832
    ds_read_b64_tr_b16 v[60:61], v23 offset:24832
    ds_read_b64_tr_b16 v[62:63], v24 offset:24832
    s_waitcnt lgkmcnt(0)
    v_mfma_f32_16x16x16_bf16 v[64:67], v[40:41], v[208:209], v[64:67]
    v_mfma_f32_16x16x16_bf16 v[68:71], v[42:43], v[208:209], v[68:71]
    v_mfma_f32_16x16x16_bf16 v[72:75], v[44:45], v[208:209], v[72:75]
    v_mfma_f32_16x16x16_bf16 v[76:79], v[46:47], v[208:209], v[76:79]
    v_mfma_f32_16x16x16_bf16 v[80:83], v[48:49], v[208:209], v[80:83]
    v_mfma_f32_16x16x16_bf16 v[84:87], v[50:51], v[208:209], v[84:87]
    v_mfma_f32_16x16x16_bf16 v[88:91], v[52:53], v[208:209], v[88:91]
    v_mfma_f32_16x16x16_bf16 v[92:95], v[54:55], v[208:209], v[92:95]
    v_mfma_f32_16x16x16_bf16 v[96:99], v[56:57], v[208:209], v[96:99]
    v_mfma_f32_16x16x16_bf16 v[100:103], v[58:59], v[208:209], v[100:103]
    v_mfma_f32_16x16x16_bf16 v[104:107], v[60:61], v[208:209], v[104:107]
    v_mfma_f32_16x16x16_bf16 v[108:111], v[62:63], v[208:209], v[108:111]
    s_waitcnt vmcnt(10)
    s_add_u32 m0, s54, 5120
    s_nop 0
    buffer_load_dwordx4 v7, s[24:27], s55 offen nt lds
    s_waitcnt vmcnt(10)
    s_add_u32 s55, s58, 28
    s_and_b32 s55, s55, 63
    s_mul_i32 s55, s55, 6144
    s_add_u32 m0, s54, 6144
    s_nop 0
    buffer_load_dwordx4 v2, s[24:27], s55 offen nt lds
    s_waitcnt vmcnt(10)
    s_add_u32 m0, s54, 7168
    s_nop 0
    buffer_load_dwordx4 v3, s[24:27], s55 offen nt lds
    s_waitcnt vmcnt(10)
    s_add_u32 m0, s54, 8192
    s_nop 0
    buffer_load_dwordx4 v4, s[24:27], s55 offen nt lds
    s_waitcnt vmcnt(10)
    s_add_u32 m0, s54, 9216
    s_nop 0
    buffer_load_dwordx4 v5, s[24:27], s55 offen nt lds
    s_waitcnt vmcnt(10)
    s_add_u32 m0, s54, 10240
    s_nop 0
    buffer_load_dwordx4 v6, s[24:27], s55 offen nt lds
    ds_read_b64_tr_b16 v[40:41], v21 offset:30720
    ds_read_b64_tr_b16 v[42:43], v22 offset:30720
    ds_read_b64_tr_b16 v[44:45], v23 offset:30720
    ds_read_b64_tr_b16 v[46:47], v24 offset:30720
    ds_read_b64_tr_b16 v[48:49], v21 offset:30848
    ds_read_b64_tr_b16 v[50:51], v22 offset:30848
    ds_read_b64_tr_b16 v[52:53], v23 offset:30848
    ds_read_b64_tr_b16 v[54:55], v24 offset:30848
    ds_read_b64_tr_b16 v[56:57], v21 offset:30976
    ds_read_b64_tr_b16 v[58:59], v22 offset:30976
    ds_read_b64_tr_b16 v[60:61], v23 offset:30976
    ds_read_b64_tr_b16 v[62:63], v24 offset:30976
    s_waitcnt lgkmcnt(0)
    v_mfma_f32_16x16x16_bf16 v[64:67], v[40:41], v[210:211], v[64:67]
    v_mfma_f32_16x16x16_bf16 v[68:71], v[42:43], v[210:211], v[68:71]
    v_mfma_f32_16x16x16_bf16 v[72:75], v[44:45], v[210:211], v[72:75]
    v_mfma_f32_16x16x16_bf16 v[76:79], v[46:47], v[210:211], v[76:79]
    v_mfma_f32_16x16x16_bf16 v[80:83], v[48:49], v[210:211], v[80:83]
    v_mfma_f32_16x16x16_bf16 v[84:87], v[50:51], v[210:211], v[84:87]
    v_mfma_f32_16x16x16_bf16 v[88:91], v[52:53], v[210:211], v[88:91]
    v_mfma_f32_16x16x16_bf16 v[92:95], v[54:55], v[210:211], v[92:95]
    v_mfma_f32_16x16x16_bf16 v[96:99], v[56:57], v[210:211], v[96:99]
    v_mfma_f32_16x16x16_bf16 v[100:103], v[58:59], v[210:211], v[100:103]
    v_mfma_f32_16x16x16_bf16 v[104:107], v[60:61], v[210:211], v[104:107]
    v_mfma_f32_16x16x16_bf16 v[108:111], v[62:63], v[210:211], v[108:111]
    s_waitcnt vmcnt(10)
    s_add_u32 m0, s54, 11264
    s_nop 0
    buffer_load_dwordx4 v7, s[24:27], s55 offen nt lds
    s_waitcnt vmcnt(10)
    s_add_u32 s55, s58, 32
    s_and_b32 s55, s55, 63
    s_mul_i32 s55, s55, 6144
    s_add_u32 m0, s54, 12288
    s_nop 0
    buffer_load_dwordx4 v2, s[24:27], s55 offen nt lds
    s_waitcnt vmcnt(10)
    s_add_u32 m0, s54, 13312
    s_nop 0
    buffer_load_dwordx4 v3, s[24:27], s55 offen nt lds
    s_waitcnt vmcnt(10)
    s_add_u32 m0, s54, 14336
    s_nop 0
    buffer_load_dwordx4 v4, s[24:27], s55 offen nt lds
    s_waitcnt vmcnt(10)
    s_add_u32 m0, s54, 15360
    s_nop 0
    buffer_load_dwordx4 v5, s[24:27], s55 offen nt lds
    s_waitcnt vmcnt(10)
    s_add_u32 m0, s54, 16384
    s_nop 0
    buffer_load_dwordx4 v6, s[24:27], s55 offen nt lds
    ds_read_b64_tr_b16 v[40:41], v21 offset:0
    ds_read_b64_tr_b16 v[42:43], v22 offset:0
    ds_read_b64_tr_b16 v[44:45], v23 offset:0
    ds_read_b64_tr_b16 v[46:47], v24 offset:0
    ds_read_b64_tr_b16 v[48:49], v21 offset:128
    ds_read_b64_tr_b16 v[50:51], v22 offset:128
    ds_read_b64_tr_b16 v[52:53], v23 offset:128
    ds_read_b64_tr_b16 v[54:55], v24 offset:128
    ds_read_b64_tr_b16 v[56:57], v21 offset:256
    ds_read_b64_tr_b16 v[58:59], v22 offset:256
    ds_read_b64_tr_b16 v[60:61], v23 offset:256
    ds_read_b64_tr_b16 v[62:63], v24 offset:256
    s_waitcnt lgkmcnt(0)
    v_mfma_f32_16x16x16_bf16 v[64:67], v[40:41], v[212:213], v[64:67]
    v_mfma_f32_16x16x16_bf16 v[68:71], v[42:43], v[212:213], v[68:71]
    v_mfma_f32_16x16x16_bf16 v[72:75], v[44:45], v[212:213], v[72:75]
    v_mfma_f32_16x16x16_bf16 v[76:79], v[46:47], v[212:213], v[76:79]
    v_mfma_f32_16x16x16_bf16 v[80:83], v[48:49], v[212:213], v[80:83]
    v_mfma_f32_16x16x16_bf16 v[84:87], v[50:51], v[212:213], v[84:87]
    v_mfma_f32_16x16x16_bf16 v[88:91], v[52:53], v[212:213], v[88:91]
    v_mfma_f32_16x16x16_bf16 v[92:95], v[54:55], v[212:213], v[92:95]
    v_mfma_f32_16x16x16_bf16 v[96:99], v[56:57], v[212:213], v[96:99]
    v_mfma_f32_16x16x16_bf16 v[100:103], v[58:59], v[212:213], v[100:103]
    v_mfma_f32_16x16x16_bf16 v[104:107], v[60:61], v[212:213], v[104:107]
    v_mfma_f32_16x16x16_bf16 v[108:111], v[62:63], v[212:213], v[108:111]
    s_waitcnt vmcnt(10)
    s_add_u32 m0, s54, 17408
    s_nop 0
    buffer_load_dwordx4 v7, s[24:27], s55 offen nt lds
    s_waitcnt vmcnt(10)
    s_add_u32 s55, s58, 36
    s_and_b32 s55, s55, 63
    s_mul_i32 s55, s55, 6144
    s_add_u32 m0, s54, 18432
    s_nop 0
    buffer_load_dwordx4 v2, s[24:27], s55 offen nt lds
    s_waitcnt vmcnt(10)
    s_add_u32 m0, s54, 19456
    s_nop 0
    buffer_load_dwordx4 v3, s[24:27], s55 offen nt lds
    s_waitcnt vmcnt(10)
    s_add_u32 m0, s54, 20480
    s_nop 0
    buffer_load_dwordx4 v4, s[24:27], s55 offen nt lds
    s_waitcnt vmcnt(10)
    s_add_u32 m0, s54, 21504
    s_nop 0
    buffer_load_dwordx4 v5, s[24:27], s55 offen nt lds
    s_waitcnt vmcnt(10)
    s_add_u32 m0, s54, 22528
    s_nop 0
    buffer_load_dwordx4 v6, s[24:27], s55 offen nt lds
    ds_read_b64_tr_b16 v[40:41], v21 offset:6144
    ds_read_b64_tr_b16 v[42:43], v22 offset:6144
    ds_read_b64_tr_b16 v[44:45], v23 offset:6144
    ds_read_b64_tr_b16 v[46:47], v24 offset:6144
    ds_read_b64_tr_b16 v[48:49], v21 offset:6272
    ds_read_b64_tr_b16 v[50:51], v22 offset:6272
    ds_read_b64_tr_b16 v[52:53], v23 offset:6272
    ds_read_b64_tr_b16 v[54:55], v24 offset:6272
    ds_read_b64_tr_b16 v[56:57], v21 offset:6400
    ds_read_b64_tr_b16 v[58:59], v22 offset:6400
    ds_read_b64_tr_b16 v[60:61], v23 offset:6400
    ds_read_b64_tr_b16 v[62:63], v24 offset:6400
    s_waitcnt lgkmcnt(0)
    v_mfma_f32_16x16x16_bf16 v[64:67], v[40:41], v[214:215], v[64:67]
    v_mfma_f32_16x16x16_bf16 v[68:71], v[42:43], v[214:215], v[68:71]
    v_mfma_f32_16x16x16_bf16 v[72:75], v[44:45], v[214:215], v[72:75]
    v_mfma_f32_16x16x16_bf16 v[76:79], v[46:47], v[214:215], v[76:79]
    v_mfma_f32_16x16x16_bf16 v[80:83], v[48:49], v[214:215], v[80:83]
    v_mfma_f32_16x16x16_bf16 v[84:87], v[50:51], v[214:215], v[84:87]
    v_mfma_f32_16x16x16_bf16 v[88:91], v[52:53], v[214:215], v[88:91]
    v_mfma_f32_16x16x16_bf16 v[92:95], v[54:55], v[214:215], v[92:95]
    v_mfma_f32_16x16x16_bf16 v[96:99], v[56:57], v[214:215], v[96:99]
    v_mfma_f32_16x16x16_bf16 v[100:103], v[58:59], v[214:215], v[100:103]
    v_mfma_f32_16x16x16_bf16 v[104:107], v[60:61], v[214:215], v[104:107]
    v_mfma_f32_16x16x16_bf16 v[108:111], v[62:63], v[214:215], v[108:111]
    s_waitcnt vmcnt(10)
    s_add_u32 m0, s54, 23552
    s_nop 0
    buffer_load_dwordx4 v7, s[24:27], s55 offen nt lds
    s_waitcnt vmcnt(10)
    s_add_u32 s55, s58, 40
    s_and_b32 s55, s55, 63
    s_mul_i32 s55, s55, 6144
    s_add_u32 m0, s54, 24576
    s_nop 0
    buffer_load_dwordx4 v236, s[24:27], s55 offen nt lds
    s_waitcnt vmcnt(10)
    s_add_u32 m0, s54, 25600
    s_nop 0
    buffer_load_dwordx4 v237, s[24:27], s55 offen nt lds
    s_waitcnt vmcnt(10)
    s_add_u32 s55, s58, 44
    s_and_b32 s55, s55, 63
    s_mul_i32 s55, s55, 6144
    s_add_u32 m0, s54, 26624
    s_nop 0
    buffer_load_dwordx4 v236, s[24:27], s55 offen nt lds
    s_waitcnt vmcnt(10)
    s_add_u32 m0, s54, 27648
    s_nop 0
    buffer_load_dwordx4 v237, s[24:27], s55 offen nt lds
    s_waitcnt vmcnt(10)
    s_add_u32 s55, s58, 48
    s_and_b32 s55, s55, 63
    s_mul_i32 s55, s55, 6144
    s_add_u32 m0, s54, 28672
    s_nop 0
    buffer_load_dwordx4 v236, s[24:27], s55 offen nt lds
    ds_read_b64_tr_b16 v[40:41], v21 offset:12288
    ds_read_b64_tr_b16 v[42:43], v22 offset:12288
    ds_read_b64_tr_b16 v[44:45], v23 offset:12288
    ds_read_b64_tr_b16 v[46:47], v24 offset:12288
    ds_read_b64_tr_b16 v[48:49], v21 offset:12416
    ds_read_b64_tr_b16 v[50:51], v22 offset:12416
    ds_read_b64_tr_b16 v[52:53], v23 offset:12416
    ds_read_b64_tr_b16 v[54:55], v24 offset:12416
    ds_read_b64_tr_b16 v[56:57], v21 offset:12544
    ds_read_b64_tr_b16 v[58:59], v22 offset:12544
    ds_read_b64_tr_b16 v[60:61], v23 offset:12544
    ds_read_b64_tr_b16 v[62:63], v24 offset:12544
    s_waitcnt lgkmcnt(0)
    v_mfma_f32_16x16x16_bf16 v[64:67], v[40:41], v[216:217], v[64:67]
    v_mfma_f32_16x16x16_bf16 v[68:71], v[42:43], v[216:217], v[68:71]
    v_mfma_f32_16x16x16_bf16 v[72:75], v[44:45], v[216:217], v[72:75]
    v_mfma_f32_16x16x16_bf16 v[76:79], v[46:47], v[216:217], v[76:79]
    v_mfma_f32_16x16x16_bf16 v[80:83], v[48:49], v[216:217], v[80:83]
    v_mfma_f32_16x16x16_bf16 v[84:87], v[50:51], v[216:217], v[84:87]
    v_mfma_f32_16x16x16_bf16 v[88:91], v[52:53], v[216:217], v[88:91]
    v_mfma_f32_16x16x16_bf16 v[92:95], v[54:55], v[216:217], v[92:95]
    v_mfma_f32_16x16x16_bf16 v[96:99], v[56:57], v[216:217], v[96:99]
    v_mfma_f32_16x16x16_bf16 v[100:103], v[58:59], v[216:217], v[100:103]
    v_mfma_f32_16x16x16_bf16 v[104:107], v[60:61], v[216:217], v[104:107]
    v_mfma_f32_16x16x16_bf16 v[108:111], v[62:63], v[216:217], v[108:111]
    s_waitcnt vmcnt(10)
    s_add_u32 m0, s54, 29696
    s_nop 0
    buffer_load_dwordx4 v237, s[24:27], s55 offen nt lds
    s_waitcnt vmcnt(10)
    s_add_u32 s55, s58, 52
    s_and_b32 s55, s55, 63
    s_mul_i32 s55, s55, 6144
    s_add_u32 m0, s54, 30720
    s_nop 0
    buffer_load_dwordx4 v236, s[24:27], s55 offen nt lds
    s_waitcnt vmcnt(10)
    s_add_u32 m0, s54, 31744
    s_nop 0
    buffer_load_dwordx4 v237, s[24:27], s55 offen nt lds
    s_waitcnt vmcnt(10)
    s_add_u32 s55, s58, 56
    s_and_b32 s55, s55, 63
    s_mul_i32 s55, s55, 6144
    s_add_u32 m0, s54, 32768
    s_nop 0
    buffer_load_dwordx4 v236, s[24:27], s55 offen nt lds
    s_waitcnt vmcnt(10)
    s_add_u32 m0, s54, 33792
    s_nop 0
    buffer_load_dwordx4 v237, s[24:27], s55 offen nt lds
    s_waitcnt vmcnt(10)
    s_add_u32 s55, s58, 60
    s_and_b32 s55, s55, 63
    s_mul_i32 s55, s55, 6144
    s_add_u32 m0, s54, 34816
    s_nop 0
    buffer_load_dwordx4 v236, s[24:27], s55 offen nt lds
    ds_read_b64_tr_b16 v[40:41], v21 offset:18432
    ds_read_b64_tr_b16 v[42:43], v22 offset:18432
    ds_read_b64_tr_b16 v[44:45], v23 offset:18432
    ds_read_b64_tr_b16 v[46:47], v24 offset:18432
    ds_read_b64_tr_b16 v[48:49], v21 offset:18560
    ds_read_b64_tr_b16 v[50:51], v22 offset:18560
    ds_read_b64_tr_b16 v[52:53], v23 offset:18560
    ds_read_b64_tr_b16 v[54:55], v24 offset:18560
    ds_read_b64_tr_b16 v[56:57], v21 offset:18688
    ds_read_b64_tr_b16 v[58:59], v22 offset:18688
    ds_read_b64_tr_b16 v[60:61], v23 offset:18688
    ds_read_b64_tr_b16 v[62:63], v24 offset:18688
    s_waitcnt lgkmcnt(0)
    v_mfma_f32_16x16x16_bf16 v[64:67], v[40:41], v[218:219], v[64:67]
    v_mfma_f32_16x16x16_bf16 v[68:71], v[42:43], v[218:219], v[68:71]
    v_mfma_f32_16x16x16_bf16 v[72:75], v[44:45], v[218:219], v[72:75]
    v_mfma_f32_16x16x16_bf16 v[76:79], v[46:47], v[218:219], v[76:79]
    v_mfma_f32_16x16x16_bf16 v[80:83], v[48:49], v[218:219], v[80:83]
    v_mfma_f32_16x16x16_bf16 v[84:87], v[50:51], v[218:219], v[84:87]
    v_mfma_f32_16x16x16_bf16 v[88:91], v[52:53], v[218:219], v[88:91]
    v_mfma_f32_16x16x16_bf16 v[92:95], v[54:55], v[218:219], v[92:95]
    v_mfma_f32_16x16x16_bf16 v[96:99], v[56:57], v[218:219], v[96:99]
    v_mfma_f32_16x16x16_bf16 v[100:103], v[58:59], v[218:219], v[100:103]
    v_mfma_f32_16x16x16_bf16 v[104:107], v[60:61], v[218:219], v[104:107]
    v_mfma_f32_16x16x16_bf16 v[108:111], v[62:63], v[218:219], v[108:111]
    s_waitcnt vmcnt(10)
    s_add_u32 m0, s54, 35840
    s_nop 0
    buffer_load_dwordx4 v237, s[24:27], s55 offen nt lds
    s_waitcnt vmcnt(10)
    s_add_u32 s55, s58, 40
    s_and_b32 s55, s55, 63
    s_mul_i32 s55, s55, 6144
    s_add_u32 s55, s55, 128
    s_add_u32 m0, s54, 0
    s_nop 0
    buffer_load_dwordx4 v236, s[24:27], s55 offen nt lds
    s_waitcnt vmcnt(10)
    s_add_u32 m0, s54, 1024
    s_nop 0
    buffer_load_dwordx4 v237, s[24:27], s55 offen nt lds
    s_waitcnt vmcnt(10)
    s_add_u32 s55, s58, 44
    s_and_b32 s55, s55, 63
    s_mul_i32 s55, s55, 6144
    s_add_u32 s55, s55, 128
    s_add_u32 m0, s54, 2048
    s_nop 0
    buffer_load_dwordx4 v236, s[24:27], s55 offen nt lds
    s_waitcnt vmcnt(10)
    s_add_u32 m0, s54, 3072
    s_nop 0
    buffer_load_dwordx4 v237, s[24:27], s55 offen nt lds
    s_waitcnt vmcnt(10)
    s_add_u32 s55, s58, 48
    s_and_b32 s55, s55, 63
    s_mul_i32 s55, s55, 6144
    s_add_u32 s55, s55, 128
    s_add_u32 m0, s54, 4096
    s_nop 0
    buffer_load_dwordx4 v236, s[24:27], s55 offen nt lds
    ds_read_b64_tr_b16 v[40:41], v238 offset:24576
    ds_read_b64_tr_b16 v[42:43], v238 offset:26624
    ds_read_b64_tr_b16 v[44:45], v239 offset:24576
    ds_read_b64_tr_b16 v[46:47], v239 offset:26624
    ds_read_b64_tr_b16 v[48:49], v240 offset:24576
    ds_read_b64_tr_b16 v[50:51], v240 offset:26624
    ds_read_b64_tr_b16 v[52:53], v241 offset:24576
    ds_read_b64_tr_b16 v[54:55], v241 offset:26624
    ds_read_b64_tr_b16 v[56:57], v238 offset:28672
    ds_read_b64_tr_b16 v[58:59], v239 offset:28672
    ds_read_b64_tr_b16 v[60:61], v240 offset:28672
    ds_read_b64_tr_b16 v[62:63], v241 offset:28672
    s_waitcnt lgkmcnt(0)
    s_waitcnt vmcnt(10)
    s_add_u32 m0, s54, 5120
    s_nop 0
    buffer_load_dwordx4 v237, s[24:27], s55 offen nt lds
    s_waitcnt vmcnt(10)
    s_add_u32 s55, s58, 52
    s_and_b32 s55, s55, 63
    s_mul_i32 s55, s55, 6144
    s_add_u32 s55, s55, 128
    s_add_u32 m0, s54, 6144
    s_nop 0
    buffer_load_dwordx4 v236, s[24:27], s55 offen nt lds
    v_mfma_f32_16x16x32_bf16 v[64:67], v[40:43], v[220:223], v[64:67]
    v_mfma_f32_16x16x32_bf16 v[68:71], v[44:47], v[220:223], v[68:71]
    v_mfma_f32_16x16x32_bf16 v[72:75], v[48:51], v[220:223], v[72:75]
    v_mfma_f32_16x16x32_bf16 v[76:79], v[52:55], v[220:223], v[76:79]
    s_nop 2
    v_mfma_f32_16x16x16_bf16 v[64:67], v[56:57], v[224:225], v[64:67]
    v_mfma_f32_16x16x16_bf16 v[68:71], v[58:59], v[224:225], v[68:71]
    v_mfma_f32_16x16x16_bf16 v[72:75], v[60:61], v[224:225], v[72:75]
    v_mfma_f32_16x16x16_bf16 v[76:79], v[62:63], v[224:225], v[76:79]
    s_branch L_merge
L_grp_1:
    s_mul_i32 s55, s61, 196608
    s_add_u32 s55, s55, s59
    s_add_u32 m0, s54, 18432
    s_nop 0
    buffer_load_dwordx4 v8, s[28:31], s55 offen  lds
    s_add_u32 m0, s54, 19456
    s_nop 0
    buffer_load_dwordx4 v9, s[28:31], s55 offen  lds
    s_add_u32 m0, s54, 20480
    s_nop 0
    buffer_load_dwordx4 v10, s[28:31], s55 offen  lds
    s_add_u32 m0, s54, 21504
    s_nop 0
    buffer_load_dwordx4 v11, s[28:31], s55 offen  lds
    s_mov_b32 s70, 0x3d93cd3a
    s_mov_b32 s71, 0x3fb8aa3b
    s_mul_i32 s56, s53, 245760
    s_add_u32 s32, s12, s56
    s_addc_u32 s33, s13, 0
    s_and_b32 s33, s33, 0xffff
    s_mov_b32 s34, 245760
    s_mov_b32 s35, 0x20000
    s_mul_i32 s56, s3, 320
    v_add_u32 v36, 0, v1
    v_mul_u32_u24 v37, 205, v36
    v_lshrrev_b32 v37, 12, v37
    v_mul_u32_u24 v37, 960, v37
    v_lshl_add_u32 v37, v36, 4, v37
    v_add_u32 v14, s56, v37
    v_add_u32 v36, 64, v1
    v_mul_u32_u24 v37, 205, v36
    v_lshrrev_b32 v37, 12, v37
    v_mul_u32_u24 v37, 960, v37
    v_lshl_add_u32 v37, v36, 4, v37
    v_add_u32 v15, s56, v37
    v_add_u32 v36, 128, v1
    v_mul_u32_u24 v37, 205, v36
    v_lshrrev_b32 v37, 12, v37
    v_mul_u32_u24 v37, 960, v37
    v_lshl_add_u32 v37, v36, 4, v37
    v_add_u32 v16, s56, v37
    v_add_u32 v36, 192, v1
    v_mul_u32_u24 v37, 205, v36
    v_lshrrev_b32 v37, 12, v37
    v_mul_u32_u24 v37, 960, v37
    v_lshl_add_u32 v37, v36, 4, v37
    v_add_u32 v17, s56, v37
    v_add_u32 v36, 256, v1
    v_mul_u32_u24 v37, 205, v36
    v_lshrrev_b32 v37, 12, v37
    v_mul_u32_u24 v37, 960, v37
    v_lshl_add_u32 v37, v36, 4, v37
    v_add_u32 v18, s56, v37
    v_and_b32 v36, 15, v1
    v_and_b32 v37, 6, v36
    v_xor_b32 v37, v37, v34
    v_lshlrev_b32 v37, 4, v37
    v_mul_u32_u24 v36, 384, v36
    v_add3_u32 v19, v36, v37, s54
    v_xor_b32 v20, 64, v19
    v_lshrrev_b32 v36, 2, v1
    v_and_b32 v37, 6, v36
    v_lshlrev_b32 v37, 4, v37
    v_lshl_add_u32 v37, v35, 3, v37
    v_mul_u32_u24 v38, 384, v36
    v_add3_u32 v21, v38, v37, s54
    v_xor_b32 v22, 32, v21
    v_xor_b32 v23, 64, v21
    v_xor_b32 v24, 96, v21
    v_mul_u32_u24 v38, 320, v36
    v_lshl_add_u32 v38, v35, 3, v38
    v_add_u32 v25, s54, v38
    v_mul_u32_u24 v36, 784, v35
    v_lshl_add_u32 v36, v34, 4, v36
    v_add_u32 v26, s74, v36
    v_mul_u32_u24 v37, 1366, v0
    v_lshrrev_b32 v37, 16, v37
    v_lshlrev_b32 v37, 4, v37
    v_lshl_add_u32 v36, v0, 4, v37
    v_add_u32 v27, 147456, v36
    v_lshl_add_u32 v36, v0, 3, v37
    v_add_u32 v28, 160000, v36
    v_mul_u32_u24 v36, 400, v35
    v_add_u32 v36, 160000, v36
    v_lshl_add_u32 v29, v34, 4, v36
    v_lshlrev_b32 v36, 6, v35
    v_add_u32 v32, 161600, v36
    s_lshl_b32 s56, s3, 4
    v_lshl_add_u32 v36, v34, 2, v32
    v_add_u32 v31, s56, v36
    v_lshlrev_b32 v30, 4, v1
    s_lshr_b32 s79, s52, 2
    s_mul_i32 s79, s79, 122880
    s_mul_i32 s56, s3, 10240
    s_add_u32 s79, s79, s56
    s_add_u32 s79, s79, 36864
    v_mul_u32_u24 v36, 320, v35
    v_lshl_add_u32 v36, v34, 3, v36
    v_add_u32 v36, s74, v36
    s_waitcnt vmcnt(10)
    v_lshl_add_u32 v37, s60, 5, v36
    ds_read_b64 v[232:233], v37
    v_lshl_add_u32 v37, s61, 5, v36
    ds_read_b64 v[234:235], v37
    v_lshl_add_u32 v37, s62, 5, v36
    ds_read_b64 v[236:237], v37
    v_lshl_add_u32 v37, s63, 5, v36
    ds_read_b64 v[238:239], v37
    v_lshl_add_u32 v37, s64, 5, v36
    ds_read_b64 v[240:241], v37
    v_lshl_add_u32 v37, s65, 5, v36
    ds_read_b64 v[242:243], v37
    v_lshl_add_u32 v37, s66, 5, v36
    ds_read_b64 v[244:245], v37
    v_lshl_add_u32 v37, s67, 5, v36
    ds_read_b64 v[246:247], v37
    v_lshl_add_u32 v37, s68, 5, v36
    ds_read_b64 v[248:249], v37
    v_lshl_add_u32 v37, s69, 5, v36
    ds_read_b64 v[250:251], v37
    s_add_u32 m0, s54, 22528
    s_nop 0
    buffer_load_dwordx4 v12, s[28:31], s55 offen  lds
    s_add_u32 m0, s54, 23552
    s_nop 0
    buffer_load_dwordx4 v13, s[28:31], s55 offen  lds
    s_waitcnt vmcnt(11)
    s_add_u32 s55, s58, 0
    s_and_b32 s55, s55, 63
    s_mul_i32 s55, s55, 6144
    s_add_u32 m0, s54, 0
    s_nop 0
    buffer_load_dwordx4 v2, s[20:23], s55 offen nt lds
    s_waitcnt vmcnt(11)
    s_add_u32 m0, s54, 1024
    s_nop 0
    buffer_load_dwordx4 v3, s[20:23], s55 offen nt lds
    s_waitcnt vmcnt(11)
    s_add_u32 m0, s54, 2048
    s_nop 0
    buffer_load_dwordx4 v4, s[20:23], s55 offen nt lds
    s_waitcnt vmcnt(11)
    s_add_u32 m0, s54, 3072
    s_nop 0
    buffer_load_dwordx4 v5, s[20:23], s55 offen nt lds
    s_waitcnt vmcnt(11)
    s_add_u32 m0, s54, 4096
    s_nop 0
    buffer_load_dwordx4 v6, s[20:23], s55 offen nt lds
    s_waitcnt vmcnt(11)
    s_add_u32 m0, s54, 5120
    s_nop 0
    buffer_load_dwordx4 v7, s[20:23], s55 offen nt lds
    ds_read_b64_tr_b16 v[40:41], v21 offset:30720
    ds_read_b64_tr_b16 v[42:43], v22 offset:30720
    ds_read_b64_tr_b16 v[44:45], v23 offset:30720
    ds_read_b64_tr_b16 v[46:47], v24 offset:30720
    ds_read_b64_tr_b16 v[48:49], v21 offset:30848
    ds_read_b64_tr_b16 v[50:51], v22 offset:30848
    ds_read_b64_tr_b16 v[52:53], v23 offset:30848
    ds_read_b64_tr_b16 v[54:55], v24 offset:30848
    ds_read_b64_tr_b16 v[56:57], v21 offset:30976
    ds_read_b64_tr_b16 v[58:59], v22 offset:30976
    ds_read_b64_tr_b16 v[60:61], v23 offset:30976
    ds_read_b64_tr_b16 v[62:63], v24 offset:30976
    s_waitcnt lgkmcnt(0)
    v_mfma_f32_16x16x16_bf16 v[64:67], v[40:41], v[232:233], 0
    v_mfma_f32_16x16x16_bf16 v[68:71], v[42:43], v[232:233], 0
    v_mfma_f32_16x16x16_bf16 v[72:75], v[44:45], v[232:233], 0
    v_mfma_f32_16x16x16_bf16 v[76:79], v[46:47], v[232:233], 0
    v_mfma_f32_16x16x16_bf16 v[80:83], v[48:49], v[232:233], 0
    v_mfma_f32_16x16x16_bf16 v[84:87], v[50:51], v[232:233], 0
    v_mfma_f32_16x16x16_bf16 v[88:91], v[52:53], v[232:233], 0
    v_mfma_f32_16x16x16_bf16 v[92:95], v[54:55], v[232:233], 0
    v_mfma_f32_16x16x16_bf16 v[96:99], v[56:57], v[232:233], 0
    v_mfma_f32_16x16x16_bf16 v[100:103], v[58:59], v[232:233], 0
    v_mfma_f32_16x16x16_bf16 v[104:107], v[60:61], v[232:233], 0
    v_mfma_f32_16x16x16_bf16 v[108:111], v[62:63], v[232:233], 0
    s_waitcnt vmcnt(11)
    s_add_u32 s55, s58, 4
    s_and_b32 s55, s55, 63
    s_mul_i32 s55, s55, 6144
    s_add_u32 m0, s54, 6144
    s_nop 0
    buffer_load_dwordx4 v2, s[20:23], s55 offen nt lds
    s_waitcnt vmcnt(11)
    s_add_u32 m0, s54, 7168
    s_nop 0
    buffer_load_dwordx4 v3, s[20:23], s55 offen nt lds
    s_waitcnt vmcnt(11)
    s_add_u32 m0, s54, 8192
    s_nop 0
    buffer_load_dwordx4 v4, s[20:23], s55 offen nt lds
    s_waitcnt vmcnt(11)
    s_add_u32 m0, s54, 9216
    s_nop 0
    buffer_load_dwordx4 v5, s[20:23], s55 offen nt lds
    s_waitcnt vmcnt(11)
    s_add_u32 m0, s54, 10240
    s_nop 0
    buffer_load_dwordx4 v6, s[20:23], s55 offen nt lds
    s_waitcnt vmcnt(11)
    s_add_u32 m0, s54, 11264
    s_nop 0
    buffer_load_dwordx4 v7, s[20:23], s55 offen nt lds
    ds_read_b64_tr_b16 v[40:41], v21 offset:18432
    ds_read_b64_tr_b16 v[42:43], v22 offset:18432
    ds_read_b64_tr_b16 v[44:45], v23 offset:18432
    ds_read_b64_tr_b16 v[46:47], v24 offset:18432
    ds_read_b64_tr_b16 v[48:49], v21 offset:18560
    ds_read_b64_tr_b16 v[50:51], v22 offset:18560
    ds_read_b64_tr_b16 v[52:53], v23 offset:18560
    ds_read_b64_tr_b16 v[54:55], v24 offset:18560
    ds_read_b64_tr_b16 v[56:57], v21 offset:18688
    ds_read_b64_tr_b16 v[58:59], v22 offset:18688
    ds_read_b64_tr_b16 v[60:61], v23 offset:18688
    ds_read_b64_tr_b16 v[62:63], v24 offset:18688
    s_waitcnt lgkmcnt(0)
    v_mfma_f32_16x16x16_bf16 v[64:67], v[40:41], v[234:235], v[64:67]
    v_mfma_f32_16x16x16_bf16 v[68:71], v[42:43], v[234:235], v[68:71]
    v_mfma_f32_16x16x16_bf16 v[72:75], v[44:45], v[234:235], v[72:75]
    v_mfma_f32_16x16x16_bf16 v[76:79], v[46:47], v[234:235], v[76:79]
    v_mfma_f32_16x16x16_bf16 v[80:83], v[48:49], v[234:235], v[80:83]
    v_mfma_f32_16x16x16_bf16 v[84:87], v[50:51], v[234:235], v[84:87]
    v_mfma_f32_16x16x16_bf16 v[88:91], v[52:53], v[234:235], v[88:91]
    v_mfma_f32_16x16x16_bf16 v[92:95], v[54:55], v[234:235], v[92:95]
    v_mfma_f32_16x16x16_bf16 v[96:99], v[56:57], v[234:235], v[96:99]
    v_mfma_f32_16x16x16_bf16 v[100:103], v[58:59], v[234:235], v[100:103]
    v_mfma_f32_16x16x16_bf16 v[104:107], v[60:61], v[234:235], v[104:107]
    v_mfma_f32_16x16x16_bf16 v[108:111], v[62:63], v[234:235], v[108:111]
    s_waitcnt vmcnt(11)
    s_branch L_page_2
    .p2align 12
L_page_2:
    s_add_u32 s55, s58, 8
    s_and_b32 s55, s55, 63
    s_mul_i32 s55, s55, 6144
    s_add_u32 m0, s54, 12288
    s_nop 0
    buffer_load_dwordx4 v2, s[20:23], s55 offen nt lds
    s_waitcnt vmcnt(11)
    s_add_u32 m0, s54, 13312
    s_nop 0
    buffer_load_dwordx4 v3, s[20:23], s55 offen nt lds
    s_waitcnt vmcnt(11)
    s_add_u32 m0, s54, 14336
    s_nop 0
    buffer_load_dwordx4 v4, s[20:23], s55 offen nt lds
    s_waitcnt vmcnt(11)
    s_add_u32 m0, s54, 15360
    s_nop 0
    buffer_load_dwordx4 v5, s[20:23], s55 offen nt lds
    s_waitcnt vmcnt(11)
    s_add_u32 m0, s54, 16384
    s_nop 0
    buffer_load_dwordx4 v6, s[20:23], s55 offen nt lds
    s_waitcnt vmcnt(11)
    s_add_u32 m0, s54, 17408
    s_nop 0
    buffer_load_dwordx4 v7, s[20:23], s55 offen nt lds
    s_waitcnt vmcnt(11)
    s_mul_i32 s55, s62, 196608
    s_add_u32 s55, s55, s59
    s_add_u32 m0, s54, 24576
    s_nop 0
    buffer_load_dwordx4 v8, s[28:31], s55 offen  lds
    s_waitcnt vmcnt(11)
    s_add_u32 m0, s54, 25600
    s_nop 0
    buffer_load_dwordx4 v9, s[28:31], s55 offen  lds
    s_waitcnt vmcnt(11)
    s_add_u32 m0, s54, 26624
    s_nop 0
    buffer_load_dwordx4 v10, s[28:31], s55 offen  lds
    s_waitcnt vmcnt(11)
    s_add_u32 m0, s54, 27648
    s_nop 0
    buffer_load_dwordx4 v11, s[28:31], s55 offen  lds
    s_waitcnt vmcnt(11)
    s_add_u32 m0, s54, 28672
    s_nop 0
    buffer_load_dwordx4 v12, s[28:31], s55 offen  lds
    s_waitcnt vmcnt(11)
    s_add_u32 m0, s54, 29696
    s_nop 0
    buffer_load_dwordx4 v13, s[28:31], s55 offen  lds
    s_waitcnt vmcnt(11)
    s_mul_i32 s55, s63, 196608
    s_add_u32 s55, s55, s59
    s_add_u32 m0, s54, 30720
    s_nop 0
    buffer_load_dwordx4 v8, s[28:31], s55 offen  lds
    s_waitcnt vmcnt(11)
    s_add_u32 m0, s54, 31744
    s_nop 0
    buffer_load_dwordx4 v9, s[28:31], s55 offen  lds
    s_waitcnt vmcnt(11)
    s_add_u32 m0, s54, 32768
    s_nop 0
    buffer_load_dwordx4 v10, s[28:31], s55 offen  lds
    s_waitcnt vmcnt(11)
    s_add_u32 m0, s54, 33792
    s_nop 0
    buffer_load_dwordx4 v11, s[28:31], s55 offen  lds
    s_waitcnt vmcnt(11)
    s_add_u32 m0, s54, 34816
    s_nop 0
    buffer_load_dwordx4 v12, s[28:31], s55 offen  lds
    s_waitcnt vmcnt(11)
    s_add_u32 m0, s54, 35840
    s_nop 0
    buffer_load_dwordx4 v13, s[28:31], s55 offen  lds
    s_waitcnt vmcnt(11)
    s_mul_i32 s55, s64, 196608
    s_add_u32 s55, s55, s59
    s_add_u32 m0, s54, 18432
    s_nop 0
    buffer_load_dwordx4 v8, s[28:31], s55 offen  lds
    s_waitcnt vmcnt(11)
    s_add_u32 m0, s54, 19456
    s_nop 0
    buffer_load_dwordx4 v9, s[28:31], s55 offen  lds
    s_waitcnt vmcnt(11)
    s_add_u32 m0, s54, 20480
    s_nop 0
    buffer_load_dwordx4 v10, s[28:31], s55 offen  lds
    s_waitcnt vmcnt(11)
    s_add_u32 m0, s54, 21504
    s_nop 0
    buffer_load_dwordx4 v11, s[28:31], s55 offen  lds
    s_waitcnt vmcnt(11)
    s_add_u32 m0, s54, 22528
    s_nop 0
    buffer_load_dwordx4 v12, s[28:31], s55 offen  lds
    s_waitcnt vmcnt(11)
    s_add_u32 m0, s54, 23552
    s_nop 0
    buffer_load_dwordx4 v13, s[28:31], s55 offen  lds
    ds_read_b64_tr_b16 v[40:41], v21 offset:24576
    ds_read_b64_tr_b16 v[42:43], v22 offset:24576
    ds_read_b64_tr_b16 v[44:45], v23 offset:24576
    ds_read_b64_tr_b16 v[46:47], v24 offset:24576
    ds_read_b64_tr_b16 v[48:49], v21 offset:24704
    ds_read_b64_tr_b16 v[50:51], v22 offset:24704
    ds_read_b64_tr_b16 v[52:53], v23 offset:24704
    ds_read_b64_tr_b16 v[54:55], v24 offset:24704
    ds_read_b64_tr_b16 v[56:57], v21 offset:24832
    ds_read_b64_tr_b16 v[58:59], v22 offset:24832
    ds_read_b64_tr_b16 v[60:61], v23 offset:24832
    ds_read_b64_tr_b16 v[62:63], v24 offset:24832
    s_waitcnt lgkmcnt(0)
    v_mfma_f32_16x16x16_bf16 v[64:67], v[40:41], v[236:237], v[64:67]
    v_mfma_f32_16x16x16_bf16 v[68:71], v[42:43], v[236:237], v[68:71]
    v_mfma_f32_16x16x16_bf16 v[72:75], v[44:45], v[236:237], v[72:75]
    v_mfma_f32_16x16x16_bf16 v[76:79], v[46:47], v[236:237], v[76:79]
    v_mfma_f32_16x16x16_bf16 v[80:83], v[48:49], v[236:237], v[80:83]
    v_mfma_f32_16x16x16_bf16 v[84:87], v[50:51], v[236:237], v[84:87]
    v_mfma_f32_16x16x16_bf16 v[88:91], v[52:53], v[236:237], v[88:91]
    v_mfma_f32_16x16x16_bf16 v[92:95], v[54:55], v[236:237], v[92:95]
    v_mfma_f32_16x16x16_bf16 v[96:99], v[56:57], v[236:237], v[96:99]
    v_mfma_f32_16x16x16_bf16 v[100:103], v[58:59], v[236:237], v[100:103]
    v_mfma_f32_16x16x16_bf16 v[104:107], v[60:61], v[236:237], v[104:107]
    v_mfma_f32_16x16x16_bf16 v[108:111], v[62:63], v[236:237], v[108:111]
    s_waitcnt vmcnt(11)
    s_mul_i32 s55, s65, 196608
    s_add_u32 s55, s55, s59
    s_add_u32 m0, s54, 24576
    s_nop 0
    buffer_load_dwordx4 v8, s[28:31], s55 offen  lds
    s_waitcnt vmcnt(11)
    s_add_u32 m0, s54, 25600
    s_nop 0
    buffer_load_dwordx4 v9, s[28:31], s55 offen  lds
    s_waitcnt vmcnt(11)
    s_add_u32 m0, s54, 26624
    s_nop 0
    buffer_load_dwordx4 v10, s[28:31], s55 offen  lds
    s_waitcnt vmcnt(11)
    s_add_u32 m0, s54, 27648
    s_nop 0
    buffer_load_dwordx4 v11, s[28:31], s55 offen  lds
    s_waitcnt vmcnt(11)
    s_add_u32 m0, s54, 28672
    s_nop 0
    buffer_load_dwordx4 v12, s[28:31], s55 offen  lds
    s_waitcnt vmcnt(11)
    s_add_u32 m0, s54, 29696
    s_nop 0
    buffer_load_dwordx4 v13, s[28:31], s55 offen  lds
    ds_read_b64_tr_b16 v[40:41], v21 offset:30720
    ds_read_b64_tr_b16 v[42:43], v22 offset:30720
    ds_read_b64_tr_b16 v[44:45], v23 offset:30720
    ds_read_b64_tr_b16 v[46:47], v24 offset:30720
    ds_read_b64_tr_b16 v[48:49], v21 offset:30848
    ds_read_b64_tr_b16 v[50:51], v22 offset:30848
    ds_read_b64_tr_b16 v[52:53], v23 offset:30848
    ds_read_b64_tr_b16 v[54:55], v24 offset:30848
    ds_read_b64_tr_b16 v[56:57], v21 offset:30976
    ds_read_b64_tr_b16 v[58:59], v22 offset:30976
    ds_read_b64_tr_b16 v[60:61], v23 offset:30976
    ds_read_b64_tr_b16 v[62:63], v24 offset:30976
    s_waitcnt lgkmcnt(0)
    v_mfma_f32_16x16x16_bf16 v[64:67], v[40:41], v[238:239], v[64:67]
    v_mfma_f32_16x16x16_bf16 v[68:71], v[42:43], v[238:239], v[68:71]
    v_mfma_f32_16x16x16_bf16 v[72:75], v[44:45], v[238:239], v[72:75]
    v_mfma_f32_16x16x16_bf16 v[76:79], v[46:47], v[238:239], v[76:79]
    v_mfma_f32_16x16x16_bf16 v[80:83], v[48:49], v[238:239], v[80:83]
    v_mfma_f32_16x16x16_bf16 v[84:87], v[50:51], v[238:239], v[84:87]
    v_mfma_f32_16x16x16_bf16 v[88:91], v[52:53], v[238:239], v[88:91]
    v_mfma_f32_16x16x16_bf16 v[92:95], v[54:55], v[238:239], v[92:95]
    v_mfma_f32_16x16x16_bf16 v[96:99], v[56:57], v[238:239], v[96:99]
    v_mfma_f32_16x16x16_bf16 v[100:103], v[58:59], v[238:239], v[100:103]
    v_mfma_f32_16x16x16_bf16 v[104:107], v[60:61], v[238:239], v[104:107]
    v_mfma_f32_16x16x16_bf16 v[108:111], v[62:63], v[238:239], v[108:111]
    s_waitcnt vmcnt(11)
    s_mul_i32 s55, s66, 196608
    s_add_u32 s55, s55, s59
    s_add_u32 m0, s54, 30720
    s_nop 0
    buffer_load_dwordx4 v8, s[28:31], s55 offen  lds
    s_waitcnt vmcnt(11)
    s_add_u32 m0, s54, 31744
    s_nop 0
    buffer_load_dwordx4 v9, s[28:31], s55 offen  lds
    s_waitcnt vmcnt(11)
    s_add_u32 m0, s54, 32768
    s_nop 0
    buffer_load_dwordx4 v10, s[28:31], s55 offen  lds
    s_waitcnt vmcnt(11)
    s_add_u32 m0, s54, 33792
    s_nop 0
    buffer_load_dwordx4 v11, s[28:31], s55 offen  lds
    s_waitcnt vmcnt(11)
    s_add_u32 m0, s54, 34816
    s_nop 0
    buffer_load_dwordx4 v12, s[28:31], s55 offen  lds
    s_waitcnt vmcnt(11)
    s_add_u32 m0, s54, 35840
    s_nop 0
    buffer_load_dwordx4 v13, s[28:31], s55 offen  lds
    ds_read_b64_tr_b16 v[40:41], v21 offset:18432
    ds_read_b64_tr_b16 v[42:43], v22 offset:18432
    ds_read_b64_tr_b16 v[44:45], v23 offset:18432
    ds_read_b64_tr_b16 v[46:47], v24 offset:18432
    ds_read_b64_tr_b16 v[48:49], v21 offset:18560
    ds_read_b64_tr_b16 v[50:51], v22 offset:18560
    ds_read_b64_tr_b16 v[52:53], v23 offset:18560
    ds_read_b64_tr_b16 v[54:55], v24 offset:18560
    ds_read_b64_tr_b16 v[56:57], v21 offset:18688
    ds_read_b64_tr_b16 v[58:59], v22 offset:18688
    ds_read_b64_tr_b16 v[60:61], v23 offset:18688
    ds_read_b64_tr_b16 v[62:63], v24 offset:18688
    s_waitcnt lgkmcnt(0)
    v_mfma_f32_16x16x16_bf16 v[64:67], v[40:41], v[240:241], v[64:67]
    v_mfma_f32_16x16x16_bf16 v[68:71], v[42:43], v[240:241], v[68:71]
    v_mfma_f32_16x16x16_bf16 v[72:75], v[44:45], v[240:241], v[72:75]
    v_mfma_f32_16x16x16_bf16 v[76:79], v[46:47], v[240:241], v[76:79]
    v_mfma_f32_16x16x16_bf16 v[80:83], v[48:49], v[240:241], v[80:83]
    v_mfma_f32_16x16x16_bf16 v[84:87], v[50:51], v[240:241], v[84:87]
    v_mfma_f32_16x16x16_bf16 v[88:91], v[52:53], v[240:241], v[88:91]
    v_mfma_f32_16x16x16_bf16 v[92:95], v[54:55], v[240:241], v[92:95]
    v_mfma_f32_16x16x16_bf16 v[96:99], v[56:57], v[240:241], v[96:99]
    v_mfma_f32_16x16x16_bf16 v[100:103], v[58:59], v[240:241], v[100:103]
    v_mfma_f32_16x16x16_bf16 v[104:107], v[60:61], v[240:241], v[104:107]
    v_mfma_f32_16x16x16_bf16 v[108:111], v[62:63], v[240:241], v[108:111]
    s_waitcnt vmcnt(11)
    s_mul_i32 s55, s67, 196608
    s_add_u32 s55, s55, s59
    s_add_u32 m0, s54, 18432
    s_nop 0
    buffer_load_dwordx4 v8, s[28:31], s55 offen  lds
    s_waitcnt vmcnt(11)
    s_add_u32 m0, s54, 19456
    s_nop 0
    buffer_load_dwordx4 v9, s[28:31], s55 offen  lds
    s_waitcnt vmcnt(11)
    s_add_u32 m0, s54, 20480
    s_nop 0
    buffer_load_dwordx4 v10, s[28:31], s55 offen  lds
    s_waitcnt vmcnt(11)
    s_add_u32 m0, s54, 21504
    s_nop 0
    buffer_load_dwordx4 v11, s[28:31], s55 offen  lds
    s_waitcnt vmcnt(11)
    s_add_u32 m0, s54, 22528
    s_nop 0
    buffer_load_dwordx4 v12, s[28:31], s55 offen  lds
    s_waitcnt vmcnt(11)
    s_add_u32 m0, s54, 23552
    s_nop 0
    buffer_load_dwordx4 v13, s[28:31], s55 offen  lds
    ds_read_b64_tr_b16 v[40:41], v21 offset:24576
    ds_read_b64_tr_b16 v[42:43], v22 offset:24576
    ds_read_b64_tr_b16 v[44:45], v23 offset:24576
    ds_read_b64_tr_b16 v[46:47], v24 offset:24576
    ds_read_b64_tr_b16 v[48:49], v21 offset:24704
    ds_read_b64_tr_b16 v[50:51], v22 offset:24704
    ds_read_b64_tr_b16 v[52:53], v23 offset:24704
    ds_read_b64_tr_b16 v[54:55], v24 offset:24704
    ds_read_b64_tr_b16 v[56:57], v21 offset:24832
    ds_read_b64_tr_b16 v[58:59], v22 offset:24832
    ds_read_b64_tr_b16 v[60:61], v23 offset:24832
    ds_read_b64_tr_b16 v[62:63], v24 offset:24832
    s_waitcnt lgkmcnt(0)
    v_mfma_f32_16x16x16_bf16 v[64:67], v[40:41], v[242:243], v[64:67]
    v_mfma_f32_16x16x16_bf16 v[68:71], v[42:43], v[242:243], v[68:71]
    v_mfma_f32_16x16x16_bf16 v[72:75], v[44:45], v[242:243], v[72:75]
    v_mfma_f32_16x16x16_bf16 v[76:79], v[46:47], v[242:243], v[76:79]
    v_mfma_f32_16x16x16_bf16 v[80:83], v[48:49], v[242:243], v[80:83]
    v_mfma_f32_16x16x16_bf16 v[84:87], v[50:51], v[242:243], v[84:87]
    v_mfma_f32_16x16x16_bf16 v[88:91], v[52:53], v[242:243], v[88:91]
    v_mfma_f32_16x16x16_bf16 v[92:95], v[54:55], v[242:243], v[92:95]
    v_mfma_f32_16x16x16_bf16 v[96:99], v[56:57], v[242:243], v[96:99]
    v_mfma_f32_16x16x16_bf16 v[100:103], v[58:59], v[242:243], v[100:103]
    v_mfma_f32_16x16x16_bf16 v[104:107], v[60:61], v[242:243], v[104:107]
    v_mfma_f32_16x16x16_bf16 v[108:111], v[62:63], v[242:243], v[108:111]
    s_waitcnt vmcnt(11)
    s_mul_i32 s55, s68, 196608
    s_add_u32 s55, s55, s59
    s_add_u32 m0, s54, 24576
    s_nop 0
    buffer_load_dwordx4 v8, s[28:31], s55 offen  lds
    s_waitcnt vmcnt(11)
    s_add_u32 m0, s54, 25600
    s_nop 0
    buffer_load_dwordx4 v9, s[28:31], s55 offen  lds
    s_waitcnt vmcnt(11)
    s_add_u32 m0, s54, 26624
    s_nop 0
    buffer_load_dwordx4 v10, s[28:31], s55 offen  lds
    s_waitcnt vmcnt(11)
    s_add_u32 m0, s54, 27648
    s_nop 0
    buffer_load_dwordx4 v11, s[28:31], s55 offen  lds
    s_waitcnt vmcnt(11)
    s_add_u32 m0, s54, 28672
    s_nop 0
    buffer_load_dwordx4 v12, s[28:31], s55 offen  lds
    s_waitcnt vmcnt(11)
    s_add_u32 m0, s54, 29696
    s_nop 0
    buffer_load_dwordx4 v13, s[28:31], s55 offen  lds
    ds_read_b64_tr_b16 v[40:41], v21 offset:30720
    ds_read_b64_tr_b16 v[42:43], v22 offset:30720
    ds_read_b64_tr_b16 v[44:45], v23 offset:30720
    ds_read_b64_tr_b16 v[46:47], v24 offset:30720
    ds_read_b64_tr_b16 v[48:49], v21 offset:30848
    ds_read_b64_tr_b16 v[50:51], v22 offset:30848
    ds_read_b64_tr_b16 v[52:53], v23 offset:30848
    ds_read_b64_tr_b16 v[54:55], v24 offset:30848
    ds_read_b64_tr_b16 v[56:57], v21 offset:30976
    ds_read_b64_tr_b16 v[58:59], v22 offset:30976
    ds_read_b64_tr_b16 v[60:61], v23 offset:30976
    ds_read_b64_tr_b16 v[62:63], v24 offset:30976
    s_waitcnt lgkmcnt(0)
    v_mfma_f32_16x16x16_bf16 v[64:67], v[40:41], v[244:245], v[64:67]
    v_mfma_f32_16x16x16_bf16 v[68:71], v[42:43], v[244:245], v[68:71]
    v_mfma_f32_16x16x16_bf16 v[72:75], v[44:45], v[244:245], v[72:75]
    v_mfma_f32_16x16x16_bf16 v[76:79], v[46:47], v[244:245], v[76:79]
    v_mfma_f32_16x16x16_bf16 v[80:83], v[48:49], v[244:245], v[80:83]
    v_mfma_f32_16x16x16_bf16 v[84:87], v[50:51], v[244:245], v[84:87]
    v_mfma_f32_16x16x16_bf16 v[88:91], v[52:53], v[244:245], v[88:91]
    v_mfma_f32_16x16x16_bf16 v[92:95], v[54:55], v[244:245], v[92:95]
    v_mfma_f32_16x16x16_bf16 v[96:99], v[56:57], v[244:245], v[96:99]
    v_mfma_f32_16x16x16_bf16 v[100:103], v[58:59], v[244:245], v[100:103]
    v_mfma_f32_16x16x16_bf16 v[104:107], v[60:61], v[244:245], v[104:107]
    v_mfma_f32_16x16x16_bf16 v[108:111], v[62:63], v[244:245], v[108:111]
    s_waitcnt vmcnt(11)
    s_mul_i32 s55, s69, 196608
    s_add_u32 s55, s55, s59
    s_add_u32 m0, s54, 30720
    s_nop 0
    buffer_load_dwordx4 v8, s[28:31], s55 offen  lds
    s_waitcnt vmcnt(11)
    s_add_u32 m0, s54, 31744
    s_nop 0
    buffer_load_dwordx4 v9, s[28:31], s55 offen  lds
    s_waitcnt vmcnt(11)
    s_add_u32 m0, s54, 32768
    s_nop 0
    buffer_load_dwordx4 v10, s[28:31], s55 offen  lds
    s_waitcnt vmcnt(11)
    s_add_u32 m0, s54, 33792
    s_nop 0
    buffer_load_dwordx4 v11, s[28:31], s55 offen  lds
    s_waitcnt vmcnt(11)
    s_add_u32 m0, s54, 34816
    s_nop 0
    buffer_load_dwordx4 v12, s[28:31], s55 offen  lds
    s_waitcnt vmcnt(11)
    s_add_u32 m0, s54, 35840
    s_nop 0
    buffer_load_dwordx4 v13, s[28:31], s55 offen  lds
    ds_read_b64_tr_b16 v[40:41], v21 offset:18432
    ds_read_b64_tr_b16 v[42:43], v22 offset:18432
    ds_read_b64_tr_b16 v[44:45], v23 offset:18432
    ds_read_b64_tr_b16 v[46:47], v24 offset:18432
    ds_read_b64_tr_b16 v[48:49], v21 offset:18560
    ds_read_b64_tr_b16 v[50:51], v22 offset:18560
    ds_read_b64_tr_b16 v[52:53], v23 offset:18560
    ds_read_b64_tr_b16 v[54:55], v24 offset:18560
    ds_read_b64_tr_b16 v[56:57], v21 offset:18688
    ds_read_b64_tr_b16 v[58:59], v22 offset:18688
    ds_read_b64_tr_b16 v[60:61], v23 offset:18688
    ds_read_b64_tr_b16 v[62:63], v24 offset:18688
    s_waitcnt lgkmcnt(0)
    v_mfma_f32_16x16x16_bf16 v[64:67], v[40:41], v[246:247], v[64:67]
    v_mfma_f32_16x16x16_bf16 v[68:71], v[42:43], v[246:247], v[68:71]
    v_mfma_f32_16x16x16_bf16 v[72:75], v[44:45], v[246:247], v[72:75]
    v_mfma_f32_16x16x16_bf16 v[76:79], v[46:47], v[246:247], v[76:79]
    v_mfma_f32_16x16x16_bf16 v[80:83], v[48:49], v[246:247], v[80:83]
    v_mfma_f32_16x16x16_bf16 v[84:87], v[50:51], v[246:247], v[84:87]
    v_mfma_f32_16x16x16_bf16 v[88:91], v[52:53], v[246:247], v[88:91]
    v_mfma_f32_16x16x16_bf16 v[92:95], v[54:55], v[246:247], v[92:95]
    v_mfma_f32_16x16x16_bf16 v[96:99], v[56:57], v[246:247], v[96:99]
    v_mfma_f32_16x16x16_bf16 v[100:103], v[58:59], v[246:247], v[100:103]
    v_mfma_f32_16x16x16_bf16 v[104:107], v[60:61], v[246:247], v[104:107]
    v_mfma_f32_16x16x16_bf16 v[108:111], v[62:63], v[246:247], v[108:111]
    s_waitcnt vmcnt(11)
    s_add_u32 s55, s58, 12
    s_and_b32 s55, s55, 63
    s_mul_i32 s55, s55, 6144
    s_add_u32 m0, s54, 18432
    s_nop 0
    buffer_load_dwordx4 v2, s[20:23], s55 offen nt lds
    s_waitcnt vmcnt(11)
    s_add_u32 m0, s54, 19456
    s_nop 0
    buffer_load_dwordx4 v3, s[20:23], s55 offen nt lds
    s_waitcnt vmcnt(11)
    s_add_u32 m0, s54, 20480
    s_nop 0
    buffer_load_dwordx4 v4, s[20:23], s55 offen nt lds
    s_waitcnt vmcnt(11)
    s_add_u32 m0, s54, 21504
    s_nop 0
    buffer_load_dwordx4 v5, s[20:23], s55 offen nt lds
    s_waitcnt vmcnt(11)
    s_add_u32 m0, s54, 22528
    s_nop 0
    buffer_load_dwordx4 v6, s[20:23], s55 offen nt lds
    s_waitcnt vmcnt(11)
    s_add_u32 m0, s54, 23552
    s_nop 0
    buffer_load_dwordx4 v7, s[20:23], s55 offen nt lds
    ds_read_b64_tr_b16 v[40:41], v21 offset:24576
    ds_read_b64_tr_b16 v[42:43], v22 offset:24576
    ds_read_b64_tr_b16 v[44:45], v23 offset:24576
    ds_read_b64_tr_b16 v[46:47], v24 offset:24576
    ds_read_b64_tr_b16 v[48:49], v21 offset:24704
    ds_read_b64_tr_b16 v[50:51], v22 offset:24704
    ds_read_b64_tr_b16 v[52:53], v23 offset:24704
    ds_read_b64_tr_b16 v[54:55], v24 offset:24704
    ds_read_b64_tr_b16 v[56:57], v21 offset:24832
    ds_read_b64_tr_b16 v[58:59], v22 offset:24832
    ds_read_b64_tr_b16 v[60:61], v23 offset:24832
    ds_read_b64_tr_b16 v[62:63], v24 offset:24832
    s_waitcnt lgkmcnt(0)
    v_mfma_f32_16x16x16_bf16 v[64:67], v[40:41], v[248:249], v[64:67]
    v_mfma_f32_16x16x16_bf16 v[68:71], v[42:43], v[248:249], v[68:71]
    v_mfma_f32_16x16x16_bf16 v[72:75], v[44:45], v[248:249], v[72:75]
    v_mfma_f32_16x16x16_bf16 v[76:79], v[46:47], v[248:249], v[76:79]
    v_mfma_f32_16x16x16_bf16 v[80:83], v[48:49], v[248:249], v[80:83]
    v_mfma_f32_16x16x16_bf16 v[84:87], v[50:51], v[248:249], v[84:87]
    v_mfma_f32_16x16x16_bf16 v[88:91], v[52:53], v[248:249], v[88:91]
    v_mfma_f32_16x16x16_bf16 v[92:95], v[54:55], v[248:249], v[92:95]
    v_mfma_f32_16x16x16_bf16 v[96:99], v[56:57], v[248:249], v[96:99]
    v_mfma_f32_16x16x16_bf16 v[100:103], v[58:59], v[248:249], v[100:103]
    v_mfma_f32_16x16x16_bf16 v[104:107], v[60:61], v[248:249], v[104:107]
    v_mfma_f32_16x16x16_bf16 v[108:111], v[62:63], v[248:249], v[108:111]
    s_waitcnt vmcnt(11)
    s_add_u32 s55, s58, 16
    s_and_b32 s55, s55, 63
    s_mul_i32 s55, s55, 6144
    s_add_u32 m0, s54, 24576
    s_nop 0
    buffer_load_dwordx4 v2, s[20:23], s55 offen nt lds
    s_waitcnt vmcnt(11)
    s_add_u32 m0, s54, 25600
    s_nop 0
    buffer_load_dwordx4 v3, s[20:23], s55 offen nt lds
    s_waitcnt vmcnt(11)
    s_add_u32 m0, s54, 26624
    s_nop 0
    buffer_load_dwordx4 v4, s[20:23], s55 offen nt lds
    s_waitcnt vmcnt(11)
    s_add_u32 m0, s54, 27648
    s_nop 0
    buffer_load_dwordx4 v5, s[20:23], s55 offen nt lds
    s_waitcnt vmcnt(11)
    s_add_u32 m0, s54, 28672
    s_nop 0
    buffer_load_dwordx4 v6, s[20:23], s55 offen nt lds
    s_waitcnt vmcnt(11)
    s_add_u32 m0, s54, 29696
    s_nop 0
    buffer_load_dwordx4 v7, s[20:23], s55 offen nt lds
    ds_read_b64_tr_b16 v[40:41], v21 offset:30720
    ds_read_b64_tr_b16 v[42:43], v22 offset:30720
    ds_read_b64_tr_b16 v[44:45], v23 offset:30720
    ds_read_b64_tr_b16 v[46:47], v24 offset:30720
    ds_read_b64_tr_b16 v[48:49], v21 offset:30848
    ds_read_b64_tr_b16 v[50:51], v22 offset:30848
    ds_read_b64_tr_b16 v[52:53], v23 offset:30848
    ds_read_b64_tr_b16 v[54:55], v24 offset:30848
    ds_read_b64_tr_b16 v[56:57], v21 offset:30976
    ds_read_b64_tr_b16 v[58:59], v22 offset:30976
    ds_read_b64_tr_b16 v[60:61], v23 offset:30976
    ds_read_b64_tr_b16 v[62:63], v24 offset:30976
    s_waitcnt lgkmcnt(0)
    v_mfma_f32_16x16x16_bf16 v[64:67], v[40:41], v[250:251], v[64:67]
    v_mfma_f32_16x16x16_bf16 v[68:71], v[42:43], v[250:251], v[68:71]
    v_mfma_f32_16x16x16_bf16 v[72:75], v[44:45], v[250:251], v[72:75]
    v_mfma_f32_16x16x16_bf16 v[76:79], v[46:47], v[250:251], v[76:79]
    v_mfma_f32_16x16x16_bf16 v[80:83], v[48:49], v[250:251], v[80:83]
    v_mfma_f32_16x16x16_bf16 v[84:87], v[50:51], v[250:251], v[84:87]
    v_mfma_f32_16x16x16_bf16 v[88:91], v[52:53], v[250:251], v[88:91]
    v_mfma_f32_16x16x16_bf16 v[92:95], v[54:55], v[250:251], v[92:95]
    v_mfma_f32_16x16x16_bf16 v[96:99], v[56:57], v[250:251], v[96:99]
    v_mfma_f32_16x16x16_bf16 v[100:103], v[58:59], v[250:251], v[100:103]
    v_mfma_f32_16x16x16_bf16 v[104:107], v[60:61], v[250:251], v[104:107]
    v_mfma_f32_16x16x16_bf16 v[108:111], v[62:63], v[250:251], v[108:111]
    s_mov_b32 exec_lo, 0x000f000f
    s_mov_b32 exec_hi, 0x000f000f
    ds_write_b128 v26, v[64:67] offset:0
    ds_write_b128 v26, v[68:71] offset:64
    ds_write_b128 v26, v[72:75] offset:128
    ds_write_b128 v26, v[76:79] offset:192
    ds_write_b128 v26, v[80:83] offset:256
    ds_write_b128 v26, v[84:87] offset:320
    ds_write_b128 v26, v[88:91] offset:384
    ds_write_b128 v26, v[92:95] offset:448
    ds_write_b128 v26, v[96:99] offset:512
    ds_write_b128 v26, v[100:103] offset:576
    ds_write_b128 v26, v[104:107] offset:640
    ds_write_b128 v26, v[108:111] offset:704
    s_mov_b64 exec, -1
    s_add_u32 s55, s58, 20
    s_and_b32 s55, s55, 63
    s_mul_i32 s55, s55, 6144
    s_add_u32 m0, s54, 30720
    s_nop 0
    buffer_load_dwordx4 v2, s[20:23], s55 offen nt lds
    s_add_u32 m0, s54, 31744
    s_nop 0
    buffer_load_dwordx4 v3, s[20:23], s55 offen nt lds
    s_add_u32 m0, s54, 32768
    s_nop 0
    buffer_load_dwordx4 v4, s[20:23], s55 offen nt lds
    s_waitcnt lgkmcnt(0)
    s_barrier
    s_cmp_eq_u32 s3, 3
    s_cbranch_scc1 L_qred_1
    ds_read_b128 v[40:43], v27 offset:0
    ds_read_b128 v[44:47], v27 offset:3136
    ds_read_b128 v[48:51], v27 offset:6272
    ds_read_b128 v[52:55], v27 offset:9408
    s_waitcnt lgkmcnt(0)
    v_add_f32 v40, v40, v44
    v_add_f32 v41, v41, v45
    v_add_f32 v42, v42, v46
    v_add_f32 v43, v43, v47
    v_add_f32 v48, v48, v52
    v_add_f32 v49, v49, v53
    v_add_f32 v50, v50, v54
    v_add_f32 v51, v51, v55
    v_add_f32 v40, v40, v48
    v_add_f32 v41, v41, v49
    v_add_f32 v42, v42, v50
    v_add_f32 v43, v43, v51
    v_cvt_pk_bf16_f32 v44, v40, v41
    v_cvt_pk_bf16_f32 v45, v42, v43
    ds_write_b64 v28, v[44:45]
    s_waitcnt lgkmcnt(0)
L_qred_1:
    s_add_u32 m0, s54, 33792
    s_nop 0
    buffer_load_dwordx4 v5, s[20:23], s55 offen nt lds
    s_add_u32 m0, s54, 34816
    s_nop 0
    buffer_load_dwordx4 v6, s[20:23], s55 offen nt lds
    s_add_u32 m0, s54, 35840
    s_nop 0
    buffer_load_dwordx4 v7, s[20:23], s55 offen nt lds
    s_barrier
    ds_read_b128 v[112:115], v29 offset:0
    ds_read_b128 v[116:119], v29 offset:64
    ds_read_b128 v[120:123], v29 offset:128
    ds_read_b128 v[124:127], v29 offset:192
    ds_read_b128 v[128:131], v29 offset:256
    ds_read_b128 v[132:135], v29 offset:320
    v_mov_b32 v33, 0xff800000
    s_waitcnt lgkmcnt(0)
    ds_read_b128 v[40:43], v19 offset:0
    ds_read_b128 v[44:47], v20 offset:0
    ds_read_b128 v[48:51], v19 offset:128
    ds_read_b128 v[52:55], v20 offset:128
    ds_read_b128 v[56:59], v19 offset:256
    ds_read_b128 v[60:63], v20 offset:256
    s_waitcnt lgkmcnt(0)
    v_mfma_f32_16x16x32_bf16 v[136:139], v[40:43], v[112:115], 0
    v_mfma_f32_16x16x32_bf16 v[136:139], v[44:47], v[116:119], v[136:139]
    v_mfma_f32_16x16x32_bf16 v[136:139], v[48:51], v[120:123], v[136:139]
    v_mfma_f32_16x16x32_bf16 v[136:139], v[52:55], v[124:127], v[136:139]
    v_mfma_f32_16x16x32_bf16 v[136:139], v[56:59], v[128:131], v[136:139]
    v_mfma_f32_16x16x32_bf16 v[136:139], v[60:63], v[132:135], v[136:139]
    s_waitcnt vmcnt(10)
    s_add_u32 s55, s58, 24
    s_and_b32 s55, s55, 63
    s_mul_i32 s55, s55, 6144
    s_add_u32 m0, s54, 0
    s_nop 0
    buffer_load_dwordx4 v2, s[20:23], s55 offen nt lds
    s_waitcnt vmcnt(10)
    s_add_u32 m0, s54, 1024
    s_nop 0
    buffer_load_dwordx4 v3, s[20:23], s55 offen nt lds
    s_mul_i32 s56, s52, 327680
    s_lshl_b32 s57, s53, 7
    s_add_u32 s56, s56, s57
    s_sub_u32 s57, 327680, s57
    s_add_u32 s40, s18, s56
    s_addc_u32 s41, s19, 0
    s_and_b32 s41, s41, 0xffff
    s_mov_b32 s42, s57
    s_mov_b32 s43, 0x20000
    v_and_b32 v36, 1, v34
    v_lshl_add_u32 v36, v36, 2, v35
    v_lshlrev_b32 v36, 4, v36
    v_lshrrev_b32 v37, 1, v34
    v_lshl_add_u32 v36, v37, 12, v36
    s_mul_i32 s56, s3, 81920
    v_add_u32 v39, s56, v36
    v_and_b32 v36, 12, v1
    v_lshl_add_u32 v39, v36, 11, v39
    v_and_b32 v36, 8, v1
    v_lshl_add_u32 v255, v36, 24, v39
    s_mov_b32 s60, 0
    s_mov_b32 s61, 32768
    s_mov_b32 s62, 65536
    s_mov_b32 s48, s16
    s_and_b32 s49, s17, 0xffff
    s_mov_b32 s50, 256
    s_mov_b32 s51, 0x20000
    s_and_b32 s56, s52, 1
    s_lshl_b32 s56, s56, 7
    s_lshl_b32 s57, s52, 1
    s_and_b32 s57, s57, 12
    s_add_u32 s78, s56, s57
    v_xor_b32 v36, 192, v0
    v_or_b32 v36, s53, v36
    v_lshlrev_b32 v253, 8, v36
    s_mul_i32 s56, s76, 0x9e3779b1
    s_or_b32 s56, s56, 1
    v_mov_b32 v252, s56
    buffer_store_dword v252, v253, s[48:51], s78 offen sc1
    s_lshl_b32 s72, s3, 5
    s_add_u32 s72, s72, s53
    s_mul_i32 s56, s52, 80
    s_add_u32 s56, s56, s72
    s_lshl_b32 s56, s56, 12
    s_cmp_lt_u32 s72, 80
    s_cselect_b32 s57, 4096, 0
    s_add_u32 s28, s18, s56
    s_addc_u32 s29, s19, 0
    s_and_b32 s29, s29, 0xffff
    s_mov_b32 s30, s57
    s_mov_b32 s31, 0x20000
    s_mul_i32 s56, s52, 5120
    s_add_u32 s44, s14, s56
    s_addc_u32 s45, s15, 0
    s_and_b32 s45, s45, 0xffff
    s_mov_b32 s46, 5120
    s_mov_b32 s47, 0x20000
    v_lshlrev_b32 v232, 4, v1
    v_add_u32 v233, 4096, v232
    v_add_u32 v235, s54, v232
    v_mul_u32_u24 v234, 1280, v35
    v_and_b32 v36, 4, v1
    v_lshl_add_u32 v234, v36, 1, v234
    v_and_b32 v36, 8, v1
    v_lshl_add_u32 v234, v36, 20, v234
    v_bfe_u32 v36, v1, 4, 1
    v_lshl_add_u32 v234, v36, 2, v234
    v_lshrrev_b32 v36, 5, v1
    v_lshl_add_u32 v234, v36, 1, v234
    s_lshl_b32 s56, s72, 4
    v_add_u32 v234, s56, v234
    v_lshrrev_b32 v36, 3, v1
    v_and_b32 v37, 6, v36
    v_and_b32 v38, 7, v1
    v_xor_b32 v37, v37, v38
    v_lshlrev_b32 v37, 4, v37
    v_mul_u32_u24 v36, 384, v36
    v_add_u32 v236, v36, v37
    v_add_u32 v237, 3072, v236
    v_lshrrev_b32 v36, 2, v1
    v_and_b32 v37, 6, v36
    v_lshlrev_b32 v37, 4, v37
    v_lshl_add_u32 v37, v35, 3, v37
    v_lshlrev_b32 v36, 7, v36
    v_add3_u32 v238, v36, v37, s54
    v_xor_b32 v239, 32, v238
    v_xor_b32 v240, 64, v238
    v_xor_b32 v241, 96, v238
    v_and_b32 v36, 15, v1
    v_lshlrev_b32 v36, 4, v36
    v_lshl_add_u32 v36, v34, 8, v36
    v_add_u32 v243, 147456, v36
    s_lshl_b32 s56, s3, 6
    v_add_u32 v242, s56, v243
    ds_read_b128 v[40:43], v19 offset:6144
    ds_read_b128 v[44:47], v20 offset:6144
    ds_read_b128 v[48:51], v19 offset:6272
    ds_read_b128 v[52:55], v20 offset:6272
    ds_read_b128 v[56:59], v19 offset:6400
    ds_read_b128 v[60:63], v20 offset:6400
    s_nop 1
    v_cvt_pk_bf16_f32 v36, v136, v137
    v_cvt_pk_bf16_f32 v37, v138, v139
    v_lshlrev_b32 v136, 16, v36
    v_and_b32 v137, 0xffff0000, v36
    v_lshlrev_b32 v138, 16, v37
    v_and_b32 v139, 0xffff0000, v37
    v_mul_f32 v136, s70, v136
    v_mul_f32 v137, s70, v137
    v_mul_f32 v138, s70, v138
    v_mul_f32 v139, s70, v139
    v_cvt_pk_bf16_f32 v36, v136, v137
    v_cvt_pk_bf16_f32 v37, v138, v139
    v_lshlrev_b32 v136, 16, v36
    v_and_b32 v137, 0xffff0000, v36
    v_lshlrev_b32 v138, 16, v37
    v_and_b32 v139, 0xffff0000, v37
    v_max3_f32 v33, v33, v136, v137
    v_max3_f32 v33, v33, v138, v139
    s_waitcnt lgkmcnt(0)
    v_mfma_f32_16x16x32_bf16 v[140:143], v[40:43], v[112:115], 0
    v_mfma_f32_16x16x32_bf16 v[140:143], v[44:47], v[116:119], v[140:143]
    v_mfma_f32_16x16x32_bf16 v[140:143], v[48:51], v[120:123], v[140:143]
    v_mfma_f32_16x16x32_bf16 v[140:143], v[52:55], v[124:127], v[140:143]
    v_mfma_f32_16x16x32_bf16 v[140:143], v[56:59], v[128:131], v[140:143]
    v_mfma_f32_16x16x32_bf16 v[140:143], v[60:63], v[132:135], v[140:143]
    s_waitcnt vmcnt(11)
    s_add_u32 m0, s54, 2048
    s_nop 0
    buffer_load_dwordx4 v4, s[20:23], s55 offen nt lds
    s_waitcnt vmcnt(11)
    s_add_u32 m0, s54, 3072
    s_nop 0
    buffer_load_dwordx4 v5, s[20:23], s55 offen nt lds
    ds_read_b128 v[40:43], v19 offset:12288
    ds_read_b128 v[44:47], v20 offset:12288
    ds_read_b128 v[48:51], v19 offset:12416
    ds_read_b128 v[52:55], v20 offset:12416
    ds_read_b128 v[56:59], v19 offset:12544
    ds_read_b128 v[60:63], v20 offset:12544
    s_nop 1
    v_cvt_pk_bf16_f32 v36, v140, v141
    v_cvt_pk_bf16_f32 v37, v142, v143
    v_lshlrev_b32 v140, 16, v36
    v_and_b32 v141, 0xffff0000, v36
    v_lshlrev_b32 v142, 16, v37
    v_and_b32 v143, 0xffff0000, v37
    v_mul_f32 v140, s70, v140
    v_mul_f32 v141, s70, v141
    v_mul_f32 v142, s70, v142
    v_mul_f32 v143, s70, v143
    v_cvt_pk_bf16_f32 v36, v140, v141
    v_cvt_pk_bf16_f32 v37, v142, v143
    v_lshlrev_b32 v140, 16, v36
    v_and_b32 v141, 0xffff0000, v36
    v_lshlrev_b32 v142, 16, v37
    v_and_b32 v143, 0xffff0000, v37
    v_max3_f32 v33, v33, v140, v141
    v_max3_f32 v33, v33, v142, v143
    s_waitcnt lgkmcnt(0)
    v_mfma_f32_16x16x32_bf16 v[144:147], v[40:43], v[112:115], 0
    v_mfma_f32_16x16x32_bf16 v[144:147], v[44:47], v[116:119], v[144:147]
    v_mfma_f32_16x16x32_bf16 v[144:147], v[48:51], v[120:123], v[144:147]
    v_mfma_f32_16x16x32_bf16 v[144:147], v[52:55], v[124:127], v[144:147]
    v_mfma_f32_16x16x32_bf16 v[144:147], v[56:59], v[128:131], v[144:147]
    v_mfma_f32_16x16x32_bf16 v[144:147], v[60:63], v[132:135], v[144:147]
    s_waitcnt vmcnt(11)
    s_add_u32 m0, s54, 4096
    s_nop 0
    buffer_load_dwordx4 v6, s[20:23], s55 offen nt lds
    s_waitcnt vmcnt(11)
    s_add_u32 m0, s54, 5120
    s_nop 0
    buffer_load_dwordx4 v7, s[20:23], s55 offen nt lds
    ds_read_b128 v[40:43], v19 offset:18432
    ds_read_b128 v[44:47], v20 offset:18432
    ds_read_b128 v[48:51], v19 offset:18560
    ds_read_b128 v[52:55], v20 offset:18560
    ds_read_b128 v[56:59], v19 offset:18688
    ds_read_b128 v[60:63], v20 offset:18688
    s_nop 1
    v_cvt_pk_bf16_f32 v36, v144, v145
    v_cvt_pk_bf16_f32 v37, v146, v147
    v_lshlrev_b32 v144, 16, v36
    v_and_b32 v145, 0xffff0000, v36
    v_lshlrev_b32 v146, 16, v37
    v_and_b32 v147, 0xffff0000, v37
    v_mul_f32 v144, s70, v144
    v_mul_f32 v145, s70, v145
    v_mul_f32 v146, s70, v146
    v_mul_f32 v147, s70, v147
    v_cvt_pk_bf16_f32 v36, v144, v145
    v_cvt_pk_bf16_f32 v37, v146, v147
    v_lshlrev_b32 v144, 16, v36
    v_and_b32 v145, 0xffff0000, v36
    v_lshlrev_b32 v146, 16, v37
    v_and_b32 v147, 0xffff0000, v37
    v_max3_f32 v33, v33, v144, v145
    v_max3_f32 v33, v33, v146, v147
    s_waitcnt lgkmcnt(0)
    v_mfma_f32_16x16x32_bf16 v[148:151], v[40:43], v[112:115], 0
    v_mfma_f32_16x16x32_bf16 v[148:151], v[44:47], v[116:119], v[148:151]
    v_mfma_f32_16x16x32_bf16 v[148:151], v[48:51], v[120:123], v[148:151]
    v_mfma_f32_16x16x32_bf16 v[148:151], v[52:55], v[124:127], v[148:151]
    v_mfma_f32_16x16x32_bf16 v[148:151], v[56:59], v[128:131], v[148:151]
    v_mfma_f32_16x16x32_bf16 v[148:151], v[60:63], v[132:135], v[148:151]
    s_waitcnt vmcnt(11)
    s_add_u32 s55, s58, 28
    s_and_b32 s55, s55, 63
    s_mul_i32 s55, s55, 6144
    s_add_u32 m0, s54, 6144
    s_nop 0
    buffer_load_dwordx4 v2, s[20:23], s55 offen nt lds
    s_waitcnt vmcnt(11)
    s_add_u32 m0, s54, 7168
    s_nop 0
    buffer_load_dwordx4 v3, s[20:23], s55 offen nt lds
    ds_read_b128 v[40:43], v19 offset:24576
    ds_read_b128 v[44:47], v20 offset:24576
    ds_read_b128 v[48:51], v19 offset:24704
    ds_read_b128 v[52:55], v20 offset:24704
    ds_read_b128 v[56:59], v19 offset:24832
    ds_read_b128 v[60:63], v20 offset:24832
    s_nop 1
    v_cvt_pk_bf16_f32 v36, v148, v149
    v_cvt_pk_bf16_f32 v37, v150, v151
    v_lshlrev_b32 v148, 16, v36
    v_and_b32 v149, 0xffff0000, v36
    v_lshlrev_b32 v150, 16, v37
    v_and_b32 v151, 0xffff0000, v37
    v_mul_f32 v148, s70, v148
    v_mul_f32 v149, s70, v149
    v_mul_f32 v150, s70, v150
    v_mul_f32 v151, s70, v151
    v_cvt_pk_bf16_f32 v36, v148, v149
    v_cvt_pk_bf16_f32 v37, v150, v151
    v_lshlrev_b32 v148, 16, v36
    v_and_b32 v149, 0xffff0000, v36
    v_lshlrev_b32 v150, 16, v37
    v_and_b32 v151, 0xffff0000, v37
    v_max3_f32 v33, v33, v148, v149
    v_max3_f32 v33, v33, v150, v151
    s_waitcnt lgkmcnt(0)
    v_mfma_f32_16x16x32_bf16 v[152:155], v[40:43], v[112:115], 0
    v_mfma_f32_16x16x32_bf16 v[152:155], v[44:47], v[116:119], v[152:155]
    v_mfma_f32_16x16x32_bf16 v[152:155], v[48:51], v[120:123], v[152:155]
    v_mfma_f32_16x16x32_bf16 v[152:155], v[52:55], v[124:127], v[152:155]
    v_mfma_f32_16x16x32_bf16 v[152:155], v[56:59], v[128:131], v[152:155]
    v_mfma_f32_16x16x32_bf16 v[152:155], v[60:63], v[132:135], v[152:155]
    s_waitcnt vmcnt(11)
    s_add_u32 m0, s54, 8192
    s_nop 0
    buffer_load_dwordx4 v4, s[20:23], s55 offen nt lds
    s_waitcnt vmcnt(11)
    s_add_u32 m0, s54, 9216
    s_nop 0
    buffer_load_dwordx4 v5, s[20:23], s55 offen nt lds
    s_waitcnt vmcnt(11)
    s_add_u32 m0, s54, 10240
    s_nop 0
    buffer_load_dwordx4 v6, s[20:23], s55 offen nt lds
    ds_read_b128 v[40:43], v19 offset:30720
    ds_read_b128 v[44:47], v20 offset:30720
    ds_read_b128 v[48:51], v19 offset:30848
    ds_read_b128 v[52:55], v20 offset:30848
    ds_read_b128 v[56:59], v19 offset:30976
    ds_read_b128 v[60:63], v20 offset:30976
    s_nop 1
    v_cvt_pk_bf16_f32 v36, v152, v153
    v_cvt_pk_bf16_f32 v37, v154, v155
    v_lshlrev_b32 v152, 16, v36
    v_and_b32 v153, 0xffff0000, v36
    v_lshlrev_b32 v154, 16, v37
    v_and_b32 v155, 0xffff0000, v37
    v_mul_f32 v152, s70, v152
    v_mul_f32 v153, s70, v153
    v_mul_f32 v154, s70, v154
    v_mul_f32 v155, s70, v155
    v_cvt_pk_bf16_f32 v36, v152, v153
    v_cvt_pk_bf16_f32 v37, v154, v155
    v_lshlrev_b32 v152, 16, v36
    v_and_b32 v153, 0xffff0000, v36
    v_lshlrev_b32 v154, 16, v37
    v_and_b32 v155, 0xffff0000, v37
    v_max3_f32 v33, v33, v152, v153
    v_max3_f32 v33, v33, v154, v155
    s_waitcnt lgkmcnt(0)
    v_mfma_f32_16x16x32_bf16 v[156:159], v[40:43], v[112:115], 0
    v_mfma_f32_16x16x32_bf16 v[156:159], v[44:47], v[116:119], v[156:159]
    v_mfma_f32_16x16x32_bf16 v[156:159], v[48:51], v[120:123], v[156:159]
    v_mfma_f32_16x16x32_bf16 v[156:159], v[52:55], v[124:127], v[156:159]
    v_mfma_f32_16x16x32_bf16 v[156:159], v[56:59], v[128:131], v[156:159]
    v_mfma_f32_16x16x32_bf16 v[156:159], v[60:63], v[132:135], v[156:159]
    s_waitcnt vmcnt(11)
    s_add_u32 m0, s54, 11264
    s_nop 0
    buffer_load_dwordx4 v7, s[20:23], s55 offen nt lds
    s_waitcnt vmcnt(11)
    s_add_u32 s55, s58, 32
    s_and_b32 s55, s55, 63
    s_mul_i32 s55, s55, 6144
    s_add_u32 m0, s54, 12288
    s_nop 0
    buffer_load_dwordx4 v2, s[20:23], s55 offen nt lds
    s_waitcnt vmcnt(10)
    s_add_u32 m0, s54, 13312
    s_nop 0
    buffer_load_dwordx4 v3, s[20:23], s55 offen nt lds
    s_waitcnt vmcnt(10)
    s_add_u32 m0, s54, 14336
    s_nop 0
    buffer_load_dwordx4 v4, s[20:23], s55 offen nt lds
    s_waitcnt vmcnt(10)
    s_add_u32 m0, s54, 15360
    s_nop 0
    buffer_load_dwordx4 v5, s[20:23], s55 offen nt lds
    s_waitcnt vmcnt(10)
    s_add_u32 m0, s54, 16384
    s_nop 0
    buffer_load_dwordx4 v6, s[20:23], s55 offen nt lds
    ds_read_b128 v[40:43], v19 offset:0
    ds_read_b128 v[44:47], v20 offset:0
    ds_read_b128 v[48:51], v19 offset:128
    ds_read_b128 v[52:55], v20 offset:128
    ds_read_b128 v[56:59], v19 offset:256
    ds_read_b128 v[60:63], v20 offset:256
    s_nop 1
    v_cvt_pk_bf16_f32 v36, v156, v157
    v_cvt_pk_bf16_f32 v37, v158, v159
    v_lshlrev_b32 v156, 16, v36
    v_and_b32 v157, 0xffff0000, v36
    v_lshlrev_b32 v158, 16, v37
    v_and_b32 v159, 0xffff0000, v37
    v_mul_f32 v156, s70, v156
    v_mul_f32 v157, s70, v157
    v_mul_f32 v158, s70, v158
    v_mul_f32 v159, s70, v159
    v_cvt_pk_bf16_f32 v36, v156, v157
    v_cvt_pk_bf16_f32 v37, v158, v159
    v_lshlrev_b32 v156, 16, v36
    v_and_b32 v157, 0xffff0000, v36
    v_lshlrev_b32 v158, 16, v37
    v_and_b32 v159, 0xffff0000, v37
    v_max3_f32 v33, v33, v156, v157
    v_max3_f32 v33, v33, v158, v159
    s_waitcnt lgkmcnt(0)
    v_mfma_f32_16x16x32_bf16 v[160:163], v[40:43], v[112:115], 0
    v_mfma_f32_16x16x32_bf16 v[160:163], v[44:47], v[116:119], v[160:163]
    v_mfma_f32_16x16x32_bf16 v[160:163], v[48:51], v[120:123], v[160:163]
    v_mfma_f32_16x16x32_bf16 v[160:163], v[52:55], v[124:127], v[160:163]
    v_mfma_f32_16x16x32_bf16 v[160:163], v[56:59], v[128:131], v[160:163]
    v_mfma_f32_16x16x32_bf16 v[160:163], v[60:63], v[132:135], v[160:163]
    s_waitcnt vmcnt(10)
    s_add_u32 m0, s54, 17408
    s_nop 0
    buffer_load_dwordx4 v7, s[20:23], s55 offen nt lds
    s_waitcnt vmcnt(10)
    s_add_u32 s55, s79, 0
    s_add_u32 m0, s54, 18432
    s_nop 0
    buffer_load_dwordx4 v30, s[32:35], s55 offen  lds
    s_waitcnt vmcnt(10)
    s_add_u32 s55, s79, 1024
    s_add_u32 m0, s54, 19456
    s_nop 0
    buffer_load_dwordx4 v30, s[32:35], s55 offen  lds
    s_waitcnt vmcnt(10)
    s_add_u32 s55, s79, 2048
    s_add_u32 m0, s54, 20480
    s_nop 0
    buffer_load_dwordx4 v30, s[32:35], s55 offen  lds
    s_waitcnt vmcnt(10)
    s_add_u32 s55, s79, 3072
    s_add_u32 m0, s54, 21504
    s_nop 0
    buffer_load_dwordx4 v30, s[32:35], s55 offen  lds
    s_waitcnt vmcnt(10)
    s_add_u32 s55, s79, 4096
    s_add_u32 m0, s54, 22528
    s_nop 0
    buffer_load_dwordx4 v30, s[32:35], s55 offen  lds
    ds_read_b128 v[40:43], v19 offset:6144
    ds_read_b128 v[44:47], v20 offset:6144
    ds_read_b128 v[48:51], v19 offset:6272
    ds_read_b128 v[52:55], v20 offset:6272
    ds_read_b128 v[56:59], v19 offset:6400
    ds_read_b128 v[60:63], v20 offset:6400
    s_nop 1
    v_cvt_pk_bf16_f32 v36, v160, v161
    v_cvt_pk_bf16_f32 v37, v162, v163
    v_lshlrev_b32 v160, 16, v36
    v_and_b32 v161, 0xffff0000, v36
    v_lshlrev_b32 v162, 16, v37
    v_and_b32 v163, 0xffff0000, v37
    v_mul_f32 v160, s70, v160
    v_mul_f32 v161, s70, v161
    v_mul_f32 v162, s70, v162
    v_mul_f32 v163, s70, v163
    v_cvt_pk_bf16_f32 v36, v160, v161
    v_cvt_pk_bf16_f32 v37, v162, v163
    v_lshlrev_b32 v160, 16, v36
    v_and_b32 v161, 0xffff0000, v36
    v_lshlrev_b32 v162, 16, v37
    v_and_b32 v163, 0xffff0000, v37
    v_max3_f32 v33, v33, v160, v161
    v_max3_f32 v33, v33, v162, v163
    s_waitcnt lgkmcnt(0)
    v_mfma_f32_16x16x32_bf16 v[164:167], v[40:43], v[112:115], 0
    v_mfma_f32_16x16x32_bf16 v[164:167], v[44:47], v[116:119], v[164:167]
    v_mfma_f32_16x16x32_bf16 v[164:167], v[48:51], v[120:123], v[164:167]
    v_mfma_f32_16x16x32_bf16 v[164:167], v[52:55], v[124:127], v[164:167]
    v_mfma_f32_16x16x32_bf16 v[164:167], v[56:59], v[128:131], v[164:167]
    v_mfma_f32_16x16x32_bf16 v[164:167], v[60:63], v[132:135], v[164:167]
    s_waitcnt vmcnt(10)
    s_add_u32 s55, s79, 5120
    s_add_u32 m0, s54, 24576
    s_nop 0
    buffer_load_dwordx4 v30, s[32:35], s55 offen  lds
    s_waitcnt vmcnt(10)
    s_add_u32 s55, s79, 6144
    s_add_u32 m0, s54, 25600
    s_nop 0
    buffer_load_dwordx4 v30, s[32:35], s55 offen  lds
    s_waitcnt vmcnt(10)
    s_add_u32 s55, s79, 7168
    s_add_u32 m0, s54, 26624
    s_nop 0
    buffer_load_dwordx4 v30, s[32:35], s55 offen  lds
    s_waitcnt vmcnt(10)
    s_add_u32 s55, s79, 8192
    s_add_u32 m0, s54, 27648
    s_nop 0
    buffer_load_dwordx4 v30, s[32:35], s55 offen  lds
    s_waitcnt vmcnt(10)
    s_add_u32 s55, s79, 9216
    s_add_u32 m0, s54, 28672
    s_nop 0
    buffer_load_dwordx4 v30, s[32:35], s55 offen  lds
    s_waitcnt vmcnt(10)
    s_add_u32 s55, s58, 36
    s_and_b32 s55, s55, 63
    s_mul_i32 s55, s55, 6144
    s_add_u32 m0, s54, 30720
    s_nop 0
    buffer_load_dwordx4 v2, s[20:23], s55 offen nt lds
    ds_read_b128 v[40:43], v19 offset:12288
    ds_read_b128 v[44:47], v20 offset:12288
    ds_read_b128 v[48:51], v19 offset:12416
    ds_read_b128 v[52:55], v20 offset:12416
    ds_read_b128 v[56:59], v19 offset:12544
    ds_read_b128 v[60:63], v20 offset:12544
    s_nop 1
    v_cvt_pk_bf16_f32 v36, v164, v165
    v_cvt_pk_bf16_f32 v37, v166, v167
    v_lshlrev_b32 v164, 16, v36
    v_and_b32 v165, 0xffff0000, v36
    v_lshlrev_b32 v166, 16, v37
    v_and_b32 v167, 0xffff0000, v37
    v_mul_f32 v164, s70, v164
    v_mul_f32 v165, s70, v165
    v_mul_f32 v166, s70, v166
    v_mul_f32 v167, s70, v167
    v_cvt_pk_bf16_f32 v36, v164, v165
    v_cvt_pk_bf16_f32 v37, v166, v167
    v_lshlrev_b32 v164, 16, v36
    v_and_b32 v165, 0xffff0000, v36
    v_lshlrev_b32 v166, 16, v37
    v_and_b32 v167, 0xffff0000, v37
    v_max3_f32 v33, v33, v164, v165
    v_max3_f32 v33, v33, v166, v167
    s_waitcnt lgkmcnt(0)
    v_mfma_f32_16x16x32_bf16 v[168:171], v[40:43], v[112:115], 0
    v_mfma_f32_16x16x32_bf16 v[168:171], v[44:47], v[116:119], v[168:171]
    v_mfma_f32_16x16x32_bf16 v[168:171], v[48:51], v[120:123], v[168:171]
    v_mfma_f32_16x16x32_bf16 v[168:171], v[52:55], v[124:127], v[168:171]
    v_mfma_f32_16x16x32_bf16 v[168:171], v[56:59], v[128:131], v[168:171]
    v_mfma_f32_16x16x32_bf16 v[168:171], v[60:63], v[132:135], v[168:171]
    s_waitcnt vmcnt(10)
    s_add_u32 m0, s54, 31744
    s_nop 0
    buffer_load_dwordx4 v3, s[20:23], s55 offen nt lds
    s_waitcnt vmcnt(10)
    s_add_u32 m0, s54, 32768
    s_nop 0
    buffer_load_dwordx4 v4, s[20:23], s55 offen nt lds
    s_waitcnt vmcnt(10)
    s_add_u32 m0, s54, 33792
    s_nop 0
    buffer_load_dwordx4 v5, s[20:23], s55 offen nt lds
    s_waitcnt vmcnt(10)
    s_add_u32 m0, s54, 34816
    s_nop 0
    buffer_load_dwordx4 v6, s[20:23], s55 offen nt lds
    s_waitcnt vmcnt(10)
    s_add_u32 m0, s54, 35840
    s_nop 0
    buffer_load_dwordx4 v7, s[20:23], s55 offen nt lds
    s_waitcnt vmcnt(10)
    s_add_u32 s55, s58, 40
    s_and_b32 s55, s55, 63
    s_mul_i32 s55, s55, 6144
    s_add_u32 m0, s54, 0
    s_nop 0
    buffer_load_dwordx4 v2, s[20:23], s55 offen nt lds
    s_waitcnt vmcnt(10)
    s_add_u32 m0, s54, 1024
    s_nop 0
    buffer_load_dwordx4 v3, s[20:23], s55 offen nt lds
    s_waitcnt vmcnt(10)
    s_add_u32 m0, s54, 2048
    s_nop 0
    buffer_load_dwordx4 v4, s[20:23], s55 offen nt lds
    s_waitcnt vmcnt(10)
    s_add_u32 m0, s54, 3072
    s_nop 0
    buffer_load_dwordx4 v5, s[20:23], s55 offen nt lds
    s_waitcnt vmcnt(10)
    s_add_u32 m0, s54, 4096
    s_nop 0
    buffer_load_dwordx4 v6, s[20:23], s55 offen nt lds
    s_waitcnt vmcnt(10)
    s_add_u32 m0, s54, 5120
    s_nop 0
    buffer_load_dwordx4 v7, s[20:23], s55 offen nt lds
    s_waitcnt vmcnt(10)
    s_add_u32 s55, s58, 44
    s_and_b32 s55, s55, 63
    s_mul_i32 s55, s55, 6144
    s_add_u32 m0, s54, 6144
    s_nop 0
    buffer_load_dwordx4 v2, s[20:23], s55 offen nt lds
    s_waitcnt vmcnt(10)
    s_add_u32 m0, s54, 7168
    s_nop 0
    buffer_load_dwordx4 v3, s[20:23], s55 offen nt lds
    s_waitcnt vmcnt(10)
    s_add_u32 m0, s54, 8192
    s_nop 0
    buffer_load_dwordx4 v4, s[20:23], s55 offen nt lds
    s_waitcnt vmcnt(10)
    s_add_u32 m0, s54, 9216
    s_nop 0
    buffer_load_dwordx4 v5, s[20:23], s55 offen nt lds
    s_waitcnt vmcnt(10)
    s_add_u32 m0, s54, 10240
    s_nop 0
    buffer_load_dwordx4 v6, s[20:23], s55 offen nt lds
    ds_read_b128 v[40:43], v19 offset:30720
    ds_read_b128 v[44:47], v20 offset:30720
    ds_read_b128 v[48:51], v19 offset:30848
    ds_read_b128 v[52:55], v20 offset:30848
    ds_read_b128 v[56:59], v19 offset:30976
    ds_read_b128 v[60:63], v20 offset:30976
    s_nop 1
    v_cvt_pk_bf16_f32 v36, v168, v169
    v_cvt_pk_bf16_f32 v37, v170, v171
    v_lshlrev_b32 v168, 16, v36
    v_and_b32 v169, 0xffff0000, v36
    v_lshlrev_b32 v170, 16, v37
    v_and_b32 v171, 0xffff0000, v37
    v_mul_f32 v168, s70, v168
    v_mul_f32 v169, s70, v169
    v_mul_f32 v170, s70, v170
    v_mul_f32 v171, s70, v171
    v_cvt_pk_bf16_f32 v36, v168, v169
    v_cvt_pk_bf16_f32 v37, v170, v171
    v_lshlrev_b32 v168, 16, v36
    v_and_b32 v169, 0xffff0000, v36
    v_lshlrev_b32 v170, 16, v37
    v_and_b32 v171, 0xffff0000, v37
    v_max3_f32 v33, v33, v168, v169
    v_max3_f32 v33, v33, v170, v171
    s_waitcnt lgkmcnt(0)
    v_mfma_f32_16x16x32_bf16 v[172:175], v[40:43], v[112:115], 0
    v_mfma_f32_16x16x32_bf16 v[172:175], v[44:47], v[116:119], v[172:175]
    v_mfma_f32_16x16x32_bf16 v[172:175], v[48:51], v[120:123], v[172:175]
    v_mfma_f32_16x16x32_bf16 v[172:175], v[52:55], v[124:127], v[172:175]
    v_mfma_f32_16x16x32_bf16 v[172:175], v[56:59], v[128:131], v[172:175]
    v_mfma_f32_16x16x32_bf16 v[172:175], v[60:63], v[132:135], v[172:175]
    s_waitcnt vmcnt(10)
    s_add_u32 m0, s54, 11264
    s_nop 0
    buffer_load_dwordx4 v7, s[20:23], s55 offen nt lds
    s_waitcnt vmcnt(10)
    s_add_u32 s55, s58, 48
    s_and_b32 s55, s55, 63
    s_mul_i32 s55, s55, 6144
    s_add_u32 m0, s54, 12288
    s_nop 0
    buffer_load_dwordx4 v2, s[20:23], s55 offen nt lds
    s_waitcnt vmcnt(10)
    s_add_u32 m0, s54, 13312
    s_nop 0
    buffer_load_dwordx4 v3, s[20:23], s55 offen nt lds
    s_waitcnt vmcnt(10)
    s_add_u32 m0, s54, 14336
    s_nop 0
    buffer_load_dwordx4 v4, s[20:23], s55 offen nt lds
    s_waitcnt vmcnt(10)
    s_add_u32 m0, s54, 15360
    s_nop 0
    buffer_load_dwordx4 v5, s[20:23], s55 offen nt lds
    s_waitcnt vmcnt(10)
    s_add_u32 m0, s54, 16384
    s_nop 0
    buffer_load_dwordx4 v6, s[20:23], s55 offen nt lds
    ds_read_b128 v[40:43], v19 offset:0
    ds_read_b128 v[44:47], v20 offset:0
    ds_read_b128 v[48:51], v19 offset:128
    ds_read_b128 v[52:55], v20 offset:128
    ds_read_b128 v[56:59], v19 offset:256
    ds_read_b128 v[60:63], v20 offset:256
    s_nop 1
    v_cvt_pk_bf16_f32 v36, v172, v173
    v_cvt_pk_bf16_f32 v37, v174, v175
    v_lshlrev_b32 v172, 16, v36
    v_and_b32 v173, 0xffff0000, v36
    v_lshlrev_b32 v174, 16, v37
    v_and_b32 v175, 0xffff0000, v37
    v_mul_f32 v172, s70, v172
    v_mul_f32 v173, s70, v173
    v_mul_f32 v174, s70, v174
    v_mul_f32 v175, s70, v175
    v_cvt_pk_bf16_f32 v36, v172, v173
    v_cvt_pk_bf16_f32 v37, v174, v175
    v_lshlrev_b32 v172, 16, v36
    v_and_b32 v173, 0xffff0000, v36
    v_lshlrev_b32 v174, 16, v37
    v_and_b32 v175, 0xffff0000, v37
    v_max3_f32 v33, v33, v172, v173
    v_max3_f32 v33, v33, v174, v175
    s_waitcnt lgkmcnt(0)
    v_mfma_f32_16x16x32_bf16 v[176:179], v[40:43], v[112:115], 0
    v_mfma_f32_16x16x32_bf16 v[176:179], v[44:47], v[116:119], v[176:179]
    v_mfma_f32_16x16x32_bf16 v[176:179], v[48:51], v[120:123], v[176:179]
    v_mfma_f32_16x16x32_bf16 v[176:179], v[52:55], v[124:127], v[176:179]
    v_mfma_f32_16x16x32_bf16 v[176:179], v[56:59], v[128:131], v[176:179]
    v_mfma_f32_16x16x32_bf16 v[176:179], v[60:63], v[132:135], v[176:179]
    s_waitcnt vmcnt(10)
    s_add_u32 m0, s54, 17408
    s_nop 0
    buffer_load_dwordx4 v7, s[20:23], s55 offen nt lds
    s_waitcnt vmcnt(10)
    s_add_u32 s55, s58, 52
    s_and_b32 s55, s55, 63
    s_mul_i32 s55, s55, 6144
    s_add_u32 m0, s54, 18432
    s_nop 0
    buffer_load_dwordx4 v2, s[20:23], s55 offen nt lds
    s_waitcnt vmcnt(10)
    s_add_u32 m0, s54, 19456
    s_nop 0
    buffer_load_dwordx4 v3, s[20:23], s55 offen nt lds
    s_waitcnt vmcnt(10)
    s_add_u32 m0, s54, 20480
    s_nop 0
    buffer_load_dwordx4 v4, s[20:23], s55 offen nt lds
    s_waitcnt vmcnt(10)
    s_add_u32 m0, s54, 21504
    s_nop 0
    buffer_load_dwordx4 v5, s[20:23], s55 offen nt lds
    s_waitcnt vmcnt(10)
    s_add_u32 m0, s54, 22528
    s_nop 0
    buffer_load_dwordx4 v6, s[20:23], s55 offen nt lds
    ds_read_b128 v[40:43], v19 offset:6144
    ds_read_b128 v[44:47], v20 offset:6144
    ds_read_b128 v[48:51], v19 offset:6272
    ds_read_b128 v[52:55], v20 offset:6272
    ds_read_b128 v[56:59], v19 offset:6400
    ds_read_b128 v[60:63], v20 offset:6400
    s_nop 1
    v_cvt_pk_bf16_f32 v36, v176, v177
    v_cvt_pk_bf16_f32 v37, v178, v179
    v_lshlrev_b32 v176, 16, v36
    v_and_b32 v177, 0xffff0000, v36
    v_lshlrev_b32 v178, 16, v37
    v_and_b32 v179, 0xffff0000, v37
    v_mul_f32 v176, s70, v176
    v_mul_f32 v177, s70, v177
    v_mul_f32 v178, s70, v178
    v_mul_f32 v179, s70, v179
    v_cvt_pk_bf16_f32 v36, v176, v177
    v_cvt_pk_bf16_f32 v37, v178, v179
    v_lshlrev_b32 v176, 16, v36
    v_and_b32 v177, 0xffff0000, v36
    v_lshlrev_b32 v178, 16, v37
    v_and_b32 v179, 0xffff0000, v37
    v_max3_f32 v33, v33, v176, v177
    v_max3_f32 v33, v33, v178, v179
    s_waitcnt lgkmcnt(0)
    v_mfma_f32_16x16x32_bf16 v[180:183], v[40:43], v[112:115], 0
    v_mfma_f32_16x16x32_bf16 v[180:183], v[44:47], v[116:119], v[180:183]
    v_mfma_f32_16x16x32_bf16 v[180:183], v[48:51], v[120:123], v[180:183]
    v_mfma_f32_16x16x32_bf16 v[180:183], v[52:55], v[124:127], v[180:183]
    v_mfma_f32_16x16x32_bf16 v[180:183], v[56:59], v[128:131], v[180:183]
    v_mfma_f32_16x16x32_bf16 v[180:183], v[60:63], v[132:135], v[180:183]
    s_waitcnt vmcnt(10)
    s_add_u32 m0, s54, 23552
    s_nop 0
    buffer_load_dwordx4 v7, s[20:23], s55 offen nt lds
    s_waitcnt vmcnt(10)
    s_add_u32 s55, s58, 56
    s_and_b32 s55, s55, 63
    s_mul_i32 s55, s55, 6144
    s_add_u32 m0, s54, 24576
    s_nop 0
    buffer_load_dwordx4 v2, s[20:23], s55 offen nt lds
    s_waitcnt vmcnt(10)
    s_add_u32 m0, s54, 25600
    s_nop 0
    buffer_load_dwordx4 v3, s[20:23], s55 offen nt lds
    s_waitcnt vmcnt(10)
    s_add_u32 m0, s54, 26624
    s_nop 0
    buffer_load_dwordx4 v4, s[20:23], s55 offen nt lds
    s_waitcnt vmcnt(10)
    s_add_u32 m0, s54, 27648
    s_nop 0
    buffer_load_dwordx4 v5, s[20:23], s55 offen nt lds
    s_waitcnt vmcnt(10)
    s_add_u32 m0, s54, 28672
    s_nop 0
    buffer_load_dwordx4 v6, s[20:23], s55 offen nt lds
    ds_read_b128 v[40:43], v19 offset:12288
    ds_read_b128 v[44:47], v20 offset:12288
    ds_read_b128 v[48:51], v19 offset:12416
    ds_read_b128 v[52:55], v20 offset:12416
    ds_read_b128 v[56:59], v19 offset:12544
    ds_read_b128 v[60:63], v20 offset:12544
    s_nop 1
    v_cvt_pk_bf16_f32 v36, v180, v181
    v_cvt_pk_bf16_f32 v37, v182, v183
    v_lshlrev_b32 v180, 16, v36
    v_and_b32 v181, 0xffff0000, v36
    v_lshlrev_b32 v182, 16, v37
    v_and_b32 v183, 0xffff0000, v37
    v_mul_f32 v180, s70, v180
    v_mul_f32 v181, s70, v181
    v_mul_f32 v182, s70, v182
    v_mul_f32 v183, s70, v183
    v_cvt_pk_bf16_f32 v36, v180, v181
    v_cvt_pk_bf16_f32 v37, v182, v183
    v_lshlrev_b32 v180, 16, v36
    v_and_b32 v181, 0xffff0000, v36
    v_lshlrev_b32 v182, 16, v37
    v_and_b32 v183, 0xffff0000, v37
    v_max3_f32 v33, v33, v180, v181
    v_max3_f32 v33, v33, v182, v183
    s_waitcnt lgkmcnt(0)
    v_mfma_f32_16x16x32_bf16 v[184:187], v[40:43], v[112:115], 0
    v_mfma_f32_16x16x32_bf16 v[184:187], v[44:47], v[116:119], v[184:187]
    v_mfma_f32_16x16x32_bf16 v[184:187], v[48:51], v[120:123], v[184:187]
    v_mfma_f32_16x16x32_bf16 v[184:187], v[52:55], v[124:127], v[184:187]
    v_mfma_f32_16x16x32_bf16 v[184:187], v[56:59], v[128:131], v[184:187]
    v_mfma_f32_16x16x32_bf16 v[184:187], v[60:63], v[132:135], v[184:187]
    s_waitcnt vmcnt(10)
    s_add_u32 m0, s54, 29696
    s_nop 0
    buffer_load_dwordx4 v7, s[20:23], s55 offen nt lds
    s_waitcnt vmcnt(10)
    s_add_u32 s55, s58, 60
    s_and_b32 s55, s55, 63
    s_mul_i32 s55, s55, 6144
    s_add_u32 m0, s54, 30720
    s_nop 0
    buffer_load_dwordx4 v2, s[20:23], s55 offen nt lds
    s_waitcnt vmcnt(10)
    s_add_u32 m0, s54, 31744
    s_nop 0
    buffer_load_dwordx4 v3, s[20:23], s55 offen nt lds
    s_waitcnt vmcnt(10)
    s_add_u32 m0, s54, 32768
    s_nop 0
    buffer_load_dwordx4 v4, s[20:23], s55 offen nt lds
    s_waitcnt vmcnt(10)
    s_add_u32 m0, s54, 33792
    s_nop 0
    buffer_load_dwordx4 v5, s[20:23], s55 offen nt lds
    s_waitcnt vmcnt(10)
    s_add_u32 m0, s54, 34816
    s_nop 0
    buffer_load_dwordx4 v6, s[20:23], s55 offen nt lds
    ds_read_b128 v[40:43], v19 offset:18432
    ds_read_b128 v[44:47], v20 offset:18432
    ds_read_b128 v[48:51], v19 offset:18560
    ds_read_b128 v[52:55], v20 offset:18560
    ds_read_b128 v[56:59], v19 offset:18688
    ds_read_b128 v[60:63], v20 offset:18688
    s_nop 1
    v_cvt_pk_bf16_f32 v36, v184, v185
    v_cvt_pk_bf16_f32 v37, v186, v187
    v_lshlrev_b32 v184, 16, v36
    v_and_b32 v185, 0xffff0000, v36
    v_lshlrev_b32 v186, 16, v37
    v_and_b32 v187, 0xffff0000, v37
    v_mul_f32 v184, s70, v184
    v_mul_f32 v185, s70, v185
    v_mul_f32 v186, s70, v186
    v_mul_f32 v187, s70, v187
    v_cvt_pk_bf16_f32 v36, v184, v185
    v_cvt_pk_bf16_f32 v37, v186, v187
    v_lshlrev_b32 v184, 16, v36
    v_and_b32 v185, 0xffff0000, v36
    v_lshlrev_b32 v186, 16, v37
    v_and_b32 v187, 0xffff0000, v37
    v_max3_f32 v33, v33, v184, v185
    v_max3_f32 v33, v33, v186, v187
    s_waitcnt lgkmcnt(0)
    v_mfma_f32_16x16x32_bf16 v[188:191], v[40:43], v[112:115], 0
    v_mfma_f32_16x16x32_bf16 v[188:191], v[44:47], v[116:119], v[188:191]
    v_mfma_f32_16x16x32_bf16 v[188:191], v[48:51], v[120:123], v[188:191]
    v_mfma_f32_16x16x32_bf16 v[188:191], v[52:55], v[124:127], v[188:191]
    v_mfma_f32_16x16x32_bf16 v[188:191], v[56:59], v[128:131], v[188:191]
    v_mfma_f32_16x16x32_bf16 v[188:191], v[60:63], v[132:135], v[188:191]
    s_waitcnt vmcnt(10)
    s_add_u32 m0, s54, 35840
    s_nop 0
    buffer_load_dwordx4 v7, s[20:23], s55 offen nt lds
    s_waitcnt vmcnt(10)
    s_add_u32 s55, s58, 0
    s_and_b32 s55, s55, 63
    s_mul_i32 s55, s55, 6144
    s_add_u32 m0, s54, 0
    s_nop 0
    buffer_load_dwordx4 v2, s[24:27], s55 offen nt lds
    s_waitcnt vmcnt(10)
    s_add_u32 m0, s54, 1024
    s_nop 0
    buffer_load_dwordx4 v3, s[24:27], s55 offen nt lds
    s_waitcnt vmcnt(10)
    s_add_u32 m0, s54, 2048
    s_nop 0
    buffer_load_dwordx4 v4, s[24:27], s55 offen nt lds
    s_waitcnt vmcnt(10)
    s_add_u32 m0, s54, 3072
    s_nop 0
    buffer_load_dwordx4 v5, s[24:27], s55 offen nt lds
    s_waitcnt vmcnt(10)
    s_add_u32 m0, s54, 4096
    s_nop 0
    buffer_load_dwordx4 v6, s[24:27], s55 offen nt lds
    ds_read_b128 v[40:43], v19 offset:24576
    ds_read_b128 v[44:47], v20 offset:24576
    ds_read_b128 v[48:51], v19 offset:24704
    ds_read_b128 v[52:55], v20 offset:24704
    ds_read_b128 v[56:59], v19 offset:24832
    ds_read_b128 v[60:63], v20 offset:24832
    s_nop 1
    v_cvt_pk_bf16_f32 v36, v188, v189
    v_cvt_pk_bf16_f32 v37, v190, v191
    v_lshlrev_b32 v188, 16, v36
    v_and_b32 v189, 0xffff0000, v36
    v_lshlrev_b32 v190, 16, v37
    v_and_b32 v191, 0xffff0000, v37
    v_mul_f32 v188, s70, v188
    v_mul_f32 v189, s70, v189
    v_mul_f32 v190, s70, v190
    v_mul_f32 v191, s70, v191
    v_cvt_pk_bf16_f32 v36, v188, v189
    v_cvt_pk_bf16_f32 v37, v190, v191
    v_lshlrev_b32 v188, 16, v36
    v_and_b32 v189, 0xffff0000, v36
    v_lshlrev_b32 v190, 16, v37
    v_and_b32 v191, 0xffff0000, v37
    v_max3_f32 v33, v33, v188, v189
    v_max3_f32 v33, v33, v190, v191
    s_waitcnt lgkmcnt(0)
    v_mfma_f32_16x16x32_bf16 v[192:195], v[40:43], v[112:115], 0
    v_mfma_f32_16x16x32_bf16 v[192:195], v[44:47], v[116:119], v[192:195]
    v_mfma_f32_16x16x32_bf16 v[192:195], v[48:51], v[120:123], v[192:195]
    v_mfma_f32_16x16x32_bf16 v[192:195], v[52:55], v[124:127], v[192:195]
    v_mfma_f32_16x16x32_bf16 v[192:195], v[56:59], v[128:131], v[192:195]
    v_mfma_f32_16x16x32_bf16 v[192:195], v[60:63], v[132:135], v[192:195]
    s_waitcnt vmcnt(10)
    s_add_u32 m0, s54, 5120
    s_nop 0
    buffer_load_dwordx4 v7, s[24:27], s55 offen nt lds
    s_waitcnt vmcnt(10)
    s_add_u32 s55, s58, 4
    s_and_b32 s55, s55, 63
    s_mul_i32 s55, s55, 6144
    s_add_u32 m0, s54, 6144
    s_nop 0
    buffer_load_dwordx4 v2, s[24:27], s55 offen nt lds
    s_waitcnt vmcnt(10)
    s_add_u32 m0, s54, 7168
    s_nop 0
    buffer_load_dwordx4 v3, s[24:27], s55 offen nt lds
    s_waitcnt vmcnt(10)
    s_add_u32 m0, s54, 8192
    s_nop 0
    buffer_load_dwordx4 v4, s[24:27], s55 offen nt lds
    s_waitcnt vmcnt(10)
    s_add_u32 m0, s54, 9216
    s_nop 0
    buffer_load_dwordx4 v5, s[24:27], s55 offen nt lds
    s_waitcnt vmcnt(10)
    s_add_u32 m0, s54, 10240
    s_nop 0
    buffer_load_dwordx4 v6, s[24:27], s55 offen nt lds
    ds_read_b128 v[40:43], v19 offset:30720
    ds_read_b128 v[44:47], v20 offset:30720
    ds_read_b128 v[48:51], v19 offset:30848
    ds_read_b128 v[52:55], v20 offset:30848
    ds_read_b128 v[56:59], v19 offset:30976
    ds_read_b128 v[60:63], v20 offset:30976
    s_nop 1
    v_cvt_pk_bf16_f32 v36, v192, v193
    v_cvt_pk_bf16_f32 v37, v194, v195
    v_lshlrev_b32 v192, 16, v36
    v_and_b32 v193, 0xffff0000, v36
    v_lshlrev_b32 v194, 16, v37
    v_and_b32 v195, 0xffff0000, v37
    v_mul_f32 v192, s70, v192
    v_mul_f32 v193, s70, v193
    v_mul_f32 v194, s70, v194
    v_mul_f32 v195, s70, v195
    v_cvt_pk_bf16_f32 v36, v192, v193
    v_cvt_pk_bf16_f32 v37, v194, v195
    v_lshlrev_b32 v192, 16, v36
    v_and_b32 v193, 0xffff0000, v36
    v_lshlrev_b32 v194, 16, v37
    v_and_b32 v195, 0xffff0000, v37
    v_max3_f32 v33, v33, v192, v193
    v_max3_f32 v33, v33, v194, v195
    s_waitcnt lgkmcnt(0)
    v_mfma_f32_16x16x32_bf16 v[196:199], v[40:43], v[112:115], 0
    v_mfma_f32_16x16x32_bf16 v[196:199], v[44:47], v[116:119], v[196:199]
    v_mfma_f32_16x16x32_bf16 v[196:199], v[48:51], v[120:123], v[196:199]
    v_mfma_f32_16x16x32_bf16 v[196:199], v[52:55], v[124:127], v[196:199]
    v_mfma_f32_16x16x32_bf16 v[196:199], v[56:59], v[128:131], v[196:199]
    v_mfma_f32_16x16x32_bf16 v[196:199], v[60:63], v[132:135], v[196:199]
    s_waitcnt vmcnt(10)
    s_add_u32 m0, s54, 11264
    s_nop 0
    buffer_load_dwordx4 v7, s[24:27], s55 offen nt lds
    s_waitcnt vmcnt(10)
    s_add_u32 s55, s58, 8
    s_and_b32 s55, s55, 63
    s_mul_i32 s55, s55, 6144
    s_add_u32 m0, s54, 12288
    s_nop 0
    buffer_load_dwordx4 v2, s[24:27], s55 offen nt lds
    s_nop 7
    v_cvt_pk_bf16_f32 v36, v196, v197
    v_cvt_pk_bf16_f32 v37, v198, v199
    v_lshlrev_b32 v196, 16, v36
    v_and_b32 v197, 0xffff0000, v36
    v_lshlrev_b32 v198, 16, v37
    v_and_b32 v199, 0xffff0000, v37
    v_mul_f32 v196, s70, v196
    v_mul_f32 v197, s70, v197
    v_mul_f32 v198, s70, v198
    v_mul_f32 v199, s70, v199
    v_cvt_pk_bf16_f32 v36, v196, v197
    v_cvt_pk_bf16_f32 v37, v198, v199
    v_lshlrev_b32 v196, 16, v36
    v_and_b32 v197, 0xffff0000, v36
    v_lshlrev_b32 v198, 16, v37
    v_and_b32 v199, 0xffff0000, v37
    v_max3_f32 v33, v33, v196, v197
    v_max3_f32 v33, v33, v198, v199
    s_add_u32 m0, s54, 13312
    s_nop 0
    buffer_load_dwordx4 v3, s[24:27], s55 offen nt lds
    s_add_u32 m0, s54, 14336
    s_nop 0
    buffer_load_dwordx4 v4, s[24:27], s55 offen nt lds
    ds_write_b32 v31, v33
    s_waitcnt lgkmcnt(0)
    s_barrier
    ds_read_b128 v[40:43], v32 offset:0
    ds_read_b128 v[44:47], v32 offset:16
    ds_read_b128 v[48:51], v32 offset:32
    ds_read_b128 v[52:55], v32 offset:48
    s_waitcnt lgkmcnt(0)
    v_max3_f32 v33, v33, v40, v41
    v_max3_f32 v33, v33, v42, v43
    v_max3_f32 v33, v33, v44, v45
    v_max3_f32 v33, v33, v46, v47
    v_max3_f32 v33, v33, v48, v49
    v_max3_f32 v33, v33, v50, v51
    v_max3_f32 v33, v33, v52, v53
    v_max3_f32 v33, v33, v54, v55
    v_mul_f32 v33, s71, v33
    s_add_u32 m0, s54, 15360
    s_nop 0
    buffer_load_dwordx4 v5, s[24:27], s55 offen nt lds
    s_add_u32 m0, s54, 16384
    s_nop 0
    buffer_load_dwordx4 v6, s[24:27], s55 offen nt lds
    v_fma_f32 v136, v136, s71, -v33
    v_fma_f32 v137, v137, s71, -v33
    v_fma_f32 v138, v138, s71, -v33
    v_fma_f32 v139, v139, s71, -v33
    v_fma_f32 v140, v140, s71, -v33
    v_fma_f32 v141, v141, s71, -v33
    v_fma_f32 v142, v142, s71, -v33
    v_fma_f32 v143, v143, s71, -v33
    v_fma_f32 v144, v144, s71, -v33
    v_fma_f32 v145, v145, s71, -v33
    v_fma_f32 v146, v146, s71, -v33
    v_fma_f32 v147, v147, s71, -v33
    v_fma_f32 v148, v148, s71, -v33
    v_fma_f32 v149, v149, s71, -v33
    v_fma_f32 v150, v150, s71, -v33
    v_fma_f32 v151, v151, s71, -v33
    v_fma_f32 v152, v152, s71, -v33
    v_fma_f32 v153, v153, s71, -v33
    v_fma_f32 v154, v154, s71, -v33
    v_fma_f32 v155, v155, s71, -v33
    v_fma_f32 v156, v156, s71, -v33
    v_fma_f32 v157, v157, s71, -v33
    v_fma_f32 v158, v158, s71, -v33
    v_fma_f32 v159, v159, s71, -v33
    v_fma_f32 v160, v160, s71, -v33
    v_fma_f32 v161, v161, s71, -v33
    v_fma_f32 v162, v162, s71, -v33
    v_fma_f32 v163, v163, s71, -v33
    v_fma_f32 v164, v164, s71, -v33
    v_fma_f32 v165, v165, s71, -v33
    v_fma_f32 v166, v166, s71, -v33
    v_fma_f32 v167, v167, s71, -v33
    v_fma_f32 v168, v168, s71, -v33
    v_fma_f32 v169, v169, s71, -v33
    v_fma_f32 v170, v170, s71, -v33
    v_fma_f32 v171, v171, s71, -v33
    v_fma_f32 v172, v172, s71, -v33
    v_fma_f32 v173, v173, s71, -v33
    v_fma_f32 v174, v174, s71, -v33
    v_fma_f32 v175, v175, s71, -v33
    v_fma_f32 v176, v176, s71, -v33
    v_fma_f32 v177, v177, s71, -v33
    v_fma_f32 v178, v178, s71, -v33
    v_fma_f32 v179, v179, s71, -v33
    v_fma_f32 v180, v180, s71, -v33
    v_fma_f32 v181, v181, s71, -v33
    v_fma_f32 v182, v182, s71, -v33
    v_fma_f32 v183, v183, s71, -v33
    v_fma_f32 v184, v184, s71, -v33
    v_fma_f32 v185, v185, s71, -v33
    v_fma_f32 v186, v186, s71, -v33
    v_fma_f32 v187, v187, s71, -v33
    v_fma_f32 v188, v188, s71, -v33
    v_fma_f32 v189, v189, s71, -v33
    v_fma_f32 v190, v190, s71, -v33
    v_fma_f32 v191, v191, s71, -v33
    v_fma_f32 v192, v192, s71, -v33
    v_fma_f32 v193, v193, s71, -v33
    v_fma_f32 v194, v194, s71, -v33
    v_fma_f32 v195, v195, s71, -v33
    v_fma_f32 v196, v196, s71, -v33
    v_fma_f32 v197, v197, s71, -v33
    v_fma_f32 v198, v198, s71, -v33
    v_fma_f32 v199, v199, s71, -v33
    s_add_u32 m0, s54, 17408
    s_nop 0
    buffer_load_dwordx4 v7, s[24:27], s55 offen nt lds
    s_add_u32 s55, s58, 12
    s_and_b32 s55, s55, 63
    s_mul_i32 s55, s55, 6144
    s_add_u32 m0, s54, 18432
    s_nop 0
    buffer_load_dwordx4 v2, s[24:27], s55 offen nt lds
    v_exp_f32 v136, v136
    v_exp_f32 v137, v137
    v_exp_f32 v138, v138
    v_exp_f32 v139, v139
    v_exp_f32 v140, v140
    v_exp_f32 v141, v141
    v_exp_f32 v142, v142
    v_exp_f32 v143, v143
    v_exp_f32 v144, v144
    v_exp_f32 v145, v145
    v_exp_f32 v146, v146
    v_exp_f32 v147, v147
    v_exp_f32 v148, v148
    v_exp_f32 v149, v149
    v_exp_f32 v150, v150
    v_exp_f32 v151, v151
    v_exp_f32 v152, v152
    v_exp_f32 v153, v153
    v_exp_f32 v154, v154
    v_exp_f32 v155, v155
    v_exp_f32 v156, v156
    v_exp_f32 v157, v157
    v_exp_f32 v158, v158
    v_exp_f32 v159, v159
    v_exp_f32 v160, v160
    v_exp_f32 v161, v161
    v_exp_f32 v162, v162
    v_exp_f32 v163, v163
    v_exp_f32 v164, v164
    v_exp_f32 v165, v165
    v_exp_f32 v166, v166
    v_exp_f32 v167, v167
    s_add_u32 m0, s54, 19456
    s_nop 0
    buffer_load_dwordx4 v3, s[24:27], s55 offen nt lds
    s_add_u32 m0, s54, 20480
    s_nop 0
    buffer_load_dwordx4 v4, s[24:27], s55 offen nt lds
    v_exp_f32 v168, v168
    v_exp_f32 v169, v169
    v_exp_f32 v170, v170
    v_exp_f32 v171, v171
    v_exp_f32 v172, v172
    v_exp_f32 v173, v173
    v_exp_f32 v174, v174
    v_exp_f32 v175, v175
    v_exp_f32 v176, v176
    v_exp_f32 v177, v177
    v_exp_f32 v178, v178
    v_exp_f32 v179, v179
    v_exp_f32 v180, v180
    v_exp_f32 v181, v181
    v_exp_f32 v182, v182
    v_exp_f32 v183, v183
    v_exp_f32 v184, v184
    v_exp_f32 v185, v185
    v_exp_f32 v186, v186
    v_exp_f32 v187, v187
    v_exp_f32 v188, v188
    v_exp_f32 v189, v189
    v_exp_f32 v190, v190
    v_exp_f32 v191, v191
    v_exp_f32 v192, v192
    v_exp_f32 v193, v193
    v_exp_f32 v194, v194
    v_exp_f32 v195, v195
    v_exp_f32 v196, v196
    v_exp_f32 v197, v197
    v_exp_f32 v198, v198
    v_exp_f32 v199, v199
    s_add_u32 m0, s54, 21504
    s_nop 0
    buffer_load_dwordx4 v5, s[24:27], s55 offen nt lds
    s_add_u32 m0, s54, 22528
    s_nop 0
    buffer_load_dwordx4 v6, s[24:27], s55 offen nt lds
    v_add_f32 v36, v136, v137
    v_add_f32 v37, v138, v139
    v_add_f32 v36, v36, v140
    v_add_f32 v37, v37, v141
    v_add_f32 v36, v36, v142
    v_add_f32 v37, v37, v143
    v_add_f32 v36, v36, v144
    v_add_f32 v37, v37, v145
    v_add_f32 v36, v36, v146
    v_add_f32 v37, v37, v147
    v_add_f32 v36, v36, v148
    v_add_f32 v37, v37, v149
    v_add_f32 v36, v36, v150
    v_add_f32 v37, v37, v151
    v_add_f32 v36, v36, v152
    v_add_f32 v37, v37, v153
    v_add_f32 v36, v36, v154
    v_add_f32 v37, v37, v155
    v_add_f32 v36, v36, v156
    v_add_f32 v37, v37, v157
    v_add_f32 v36, v36, v158
    v_add_f32 v37, v37, v159
    v_add_f32 v36, v36, v160
    v_add_f32 v37, v37, v161
    v_add_f32 v36, v36, v162
    v_add_f32 v37, v37, v163
    v_add_f32 v36, v36, v164
    v_add_f32 v37, v37, v165
    v_add_f32 v36, v36, v166
    v_add_f32 v37, v37, v167
    v_add_f32 v36, v36, v168
    v_add_f32 v37, v37, v169
    v_add_f32 v36, v36, v170
    v_add_f32 v37, v37, v171
    v_add_f32 v36, v36, v172
    v_add_f32 v37, v37, v173
    v_add_f32 v36, v36, v174
    v_add_f32 v37, v37, v175
    v_add_f32 v36, v36, v176
    v_add_f32 v37, v37, v177
    v_add_f32 v36, v36, v178
    v_add_f32 v37, v37, v179
    v_add_f32 v36, v36, v180
    v_add_f32 v37, v37, v181
    v_add_f32 v36, v36, v182
    v_add_f32 v37, v37, v183
    v_add_f32 v36, v36, v184
    v_add_f32 v37, v37, v185
    v_add_f32 v36, v36, v186
    v_add_f32 v37, v37, v187
    v_add_f32 v36, v36, v188
    v_add_f32 v37, v37, v189
    v_add_f32 v36, v36, v190
    v_add_f32 v37, v37, v191
    v_add_f32 v36, v36, v192
    v_add_f32 v37, v37, v193
    v_add_f32 v36, v36, v194
    v_add_f32 v37, v37, v195
    v_add_f32 v36, v36, v196
    v_add_f32 v37, v37, v197
    v_add_f32 v36, v36, v198
    v_add_f32 v37, v37, v199
    v_add_f32 v36, v36, v37
    ds_write_b32 v31, v36 offset:256
    s_waitcnt lgkmcnt(0)
    s_barrier
    ds_read_b128 v[40:43], v32 offset:256
    ds_read_b128 v[44:47], v32 offset:272
    ds_read_b128 v[48:51], v32 offset:288
    ds_read_b128 v[52:55], v32 offset:304
    s_add_u32 m0, s54, 23552
    s_nop 0
    buffer_load_dwordx4 v7, s[24:27], s55 offen nt lds
    s_add_u32 s55, s58, 16
    s_and_b32 s55, s55, 63
    s_mul_i32 s55, s55, 6144
    s_add_u32 m0, s54, 24576
    s_nop 0
    buffer_load_dwordx4 v2, s[24:27], s55 offen nt lds
    s_waitcnt lgkmcnt(0)
    v_add_f32 v40, v40, v48
    v_add_f32 v41, v41, v49
    v_add_f32 v42, v42, v50
    v_add_f32 v43, v43, v51
    v_add_f32 v44, v44, v52
    v_add_f32 v45, v45, v53
    v_add_f32 v46, v46, v54
    v_add_f32 v47, v47, v55
    v_add_f32 v40, v40, v44
    v_add_f32 v41, v41, v45
    v_add_f32 v42, v42, v46
    v_add_f32 v43, v43, v47
    v_add_f32 v40, v40, v41
    v_add_f32 v42, v42, v43
    v_add_f32 v40, v40, v42
    v_rcp_f32 v36, v40
    s_nop 0
    v_mul_f32 v136, v36, v136
    v_mul_f32 v137, v36, v137
    v_mul_f32 v138, v36, v138
    v_mul_f32 v139, v36, v139
    v_mul_f32 v140, v36, v140
    v_mul_f32 v141, v36, v141
    v_mul_f32 v142, v36, v142
    v_mul_f32 v143, v36, v143
    v_mul_f32 v144, v36, v144
    v_mul_f32 v145, v36, v145
    v_mul_f32 v146, v36, v146
    v_mul_f32 v147, v36, v147
    v_mul_f32 v148, v36, v148
    v_mul_f32 v149, v36, v149
    v_mul_f32 v150, v36, v150
    v_mul_f32 v151, v36, v151
    v_mul_f32 v152, v36, v152
    v_mul_f32 v153, v36, v153
    v_mul_f32 v154, v36, v154
    v_mul_f32 v155, v36, v155
    v_mul_f32 v156, v36, v156
    v_mul_f32 v157, v36, v157
    v_mul_f32 v158, v36, v158
    v_mul_f32 v159, v36, v159
    v_mul_f32 v160, v36, v160
    v_mul_f32 v161, v36, v161
    v_mul_f32 v162, v36, v162
    v_mul_f32 v163, v36, v163
    v_mul_f32 v164, v36, v164
    v_mul_f32 v165, v36, v165
    v_mul_f32 v166, v36, v166
    v_mul_f32 v167, v36, v167
    v_mul_f32 v168, v36, v168
    v_mul_f32 v169, v36, v169
    v_mul_f32 v170, v36, v170
    v_mul_f32 v171, v36, v171
    v_mul_f32 v172, v36, v172
    v_mul_f32 v173, v36, v173
    v_mul_f32 v174, v36, v174
    v_mul_f32 v175, v36, v175
    v_mul_f32 v176, v36, v176
    v_mul_f32 v177, v36, v177
    v_mul_f32 v178, v36, v178
    v_mul_f32 v179, v36, v179
    v_mul_f32 v180, v36, v180
    v_mul_f32 v181, v36, v181
    v_mul_f32 v182, v36, v182
    v_mul_f32 v183, v36, v183
    v_mul_f32 v184, v36, v184
    v_mul_f32 v185, v36, v185
    v_mul_f32 v186, v36, v186
    v_mul_f32 v187, v36, v187
    v_mul_f32 v188, v36, v188
    v_mul_f32 v189, v36, v189
    v_mul_f32 v190, v36, v190
    v_mul_f32 v191, v36, v191
    v_mul_f32 v192, v36, v192
    v_mul_f32 v193, v36, v193
    v_mul_f32 v194, v36, v194
    v_mul_f32 v195, v36, v195
    v_mul_f32 v196, v36, v196
    v_mul_f32 v197, v36, v197
    v_mul_f32 v198, v36, v198
    v_mul_f32 v199, v36, v199
    s_add_u32 m0, s54, 25600
    s_nop 0
    buffer_load_dwordx4 v3, s[24:27], s55 offen nt lds
    s_add_u32 m0, s54, 26624
    s_nop 0
    buffer_load_dwordx4 v4, s[24:27], s55 offen nt lds
    v_cvt_pk_bf16_f32 v200, v136, v137
    v_cvt_pk_bf16_f32 v201, v138, v139
    v_cvt_pk_bf16_f32 v202, v140, v141
    v_cvt_pk_bf16_f32 v203, v142, v143
    v_cvt_pk_bf16_f32 v204, v144, v145
    v_cvt_pk_bf16_f32 v205, v146, v147
    v_cvt_pk_bf16_f32 v206, v148, v149
    v_cvt_pk_bf16_f32 v207, v150, v151
    v_cvt_pk_bf16_f32 v208, v152, v153
    v_cvt_pk_bf16_f32 v209, v154, v155
    v_cvt_pk_bf16_f32 v210, v156, v157
    v_cvt_pk_bf16_f32 v211, v158, v159
    v_cvt_pk_bf16_f32 v212, v160, v161
    v_cvt_pk_bf16_f32 v213, v162, v163
    v_cvt_pk_bf16_f32 v214, v164, v165
    v_cvt_pk_bf16_f32 v215, v166, v167
    v_cvt_pk_bf16_f32 v216, v168, v169
    v_cvt_pk_bf16_f32 v217, v170, v171
    v_cvt_pk_bf16_f32 v218, v172, v173
    v_cvt_pk_bf16_f32 v219, v174, v175
    v_cvt_pk_bf16_f32 v220, v176, v177
    v_cvt_pk_bf16_f32 v221, v178, v179
    v_cvt_pk_bf16_f32 v222, v180, v181
    v_cvt_pk_bf16_f32 v223, v182, v183
    v_cvt_pk_bf16_f32 v224, v184, v185
    v_cvt_pk_bf16_f32 v225, v186, v187
    v_cvt_pk_bf16_f32 v226, v188, v189
    v_cvt_pk_bf16_f32 v227, v190, v191
    v_cvt_pk_bf16_f32 v228, v192, v193
    v_cvt_pk_bf16_f32 v229, v194, v195
    v_cvt_pk_bf16_f32 v230, v196, v197
    v_cvt_pk_bf16_f32 v231, v198, v199
    v_mov_b32 v33, 0xffffff00
    s_nop 0
    s_waitcnt vmcnt(21)
    ds_read_b64_tr_b16 v[40:41], v21 offset:0
    ds_read_b64_tr_b16 v[42:43], v22 offset:0
    ds_read_b64_tr_b16 v[44:45], v23 offset:0
    ds_read_b64_tr_b16 v[46:47], v24 offset:0
    ds_read_b64_tr_b16 v[48:49], v21 offset:128
    ds_read_b64_tr_b16 v[50:51], v22 offset:128
    ds_read_b64_tr_b16 v[52:53], v23 offset:128
    ds_read_b64_tr_b16 v[54:55], v24 offset:128
    ds_read_b64_tr_b16 v[56:57], v21 offset:256
    ds_read_b64_tr_b16 v[58:59], v22 offset:256
    ds_read_b64_tr_b16 v[60:61], v23 offset:256
    ds_read_b64_tr_b16 v[62:63], v24 offset:256
    s_waitcnt lgkmcnt(0)
    v_mfma_f32_16x16x16_bf16 v[64:67], v[40:41], v[200:201], 0
    v_mfma_f32_16x16x16_bf16 v[68:71], v[42:43], v[200:201], 0
    v_mfma_f32_16x16x16_bf16 v[72:75], v[44:45], v[200:201], 0
    v_mfma_f32_16x16x16_bf16 v[76:79], v[46:47], v[200:201], 0
    v_mfma_f32_16x16x16_bf16 v[80:83], v[48:49], v[200:201], 0
    v_mfma_f32_16x16x16_bf16 v[84:87], v[50:51], v[200:201], 0
    v_mfma_f32_16x16x16_bf16 v[88:91], v[52:53], v[200:201], 0
    v_mfma_f32_16x16x16_bf16 v[92:95], v[54:55], v[200:201], 0
    v_mfma_f32_16x16x16_bf16 v[96:99], v[56:57], v[200:201], 0
    v_mfma_f32_16x16x16_bf16 v[100:103], v[58:59], v[200:201], 0
    v_mfma_f32_16x16x16_bf16 v[104:107], v[60:61], v[200:201], 0
    v_mfma_f32_16x16x16_bf16 v[108:111], v[62:63], v[200:201], 0
    s_waitcnt vmcnt(10)
    s_add_u32 m0, s54, 27648
    s_nop 0
    buffer_load_dwordx4 v5, s[24:27], s55 offen nt lds
    s_waitcnt vmcnt(10)
    s_add_u32 m0, s54, 28672
    s_nop 0
    buffer_load_dwordx4 v6, s[24:27], s55 offen nt lds
    ds_read_b64_tr_b16 v[40:41], v21 offset:6144
    ds_read_b64_tr_b16 v[42:43], v22 offset:6144
    ds_read_b64_tr_b16 v[44:45], v23 offset:6144
    ds_read_b64_tr_b16 v[46:47], v24 offset:6144
    ds_read_b64_tr_b16 v[48:49], v21 offset:6272
    ds_read_b64_tr_b16 v[50:51], v22 offset:6272
    ds_read_b64_tr_b16 v[52:53], v23 offset:6272
    ds_read_b64_tr_b16 v[54:55], v24 offset:6272
    ds_read_b64_tr_b16 v[56:57], v21 offset:6400
    ds_read_b64_tr_b16 v[58:59], v22 offset:6400
    ds_read_b64_tr_b16 v[60:61], v23 offset:6400
    ds_read_b64_tr_b16 v[62:63], v24 offset:6400
    s_waitcnt lgkmcnt(0)
    v_mfma_f32_16x16x16_bf16 v[64:67], v[40:41], v[202:203], v[64:67]
    v_mfma_f32_16x16x16_bf16 v[68:71], v[42:43], v[202:203], v[68:71]
    v_mfma_f32_16x16x16_bf16 v[72:75], v[44:45], v[202:203], v[72:75]
    v_mfma_f32_16x16x16_bf16 v[76:79], v[46:47], v[202:203], v[76:79]
    v_mfma_f32_16x16x16_bf16 v[80:83], v[48:49], v[202:203], v[80:83]
    v_mfma_f32_16x16x16_bf16 v[84:87], v[50:51], v[202:203], v[84:87]
    v_mfma_f32_16x16x16_bf16 v[88:91], v[52:53], v[202:203], v[88:91]
    v_mfma_f32_16x16x16_bf16 v[92:95], v[54:55], v[202:203], v[92:95]
    v_mfma_f32_16x16x16_bf16 v[96:99], v[56:57], v[202:203], v[96:99]
    v_mfma_f32_16x16x16_bf16 v[100:103], v[58:59], v[202:203], v[100:103]
    v_mfma_f32_16x16x16_bf16 v[104:107], v[60:61], v[202:203], v[104:107]
    v_mfma_f32_16x16x16_bf16 v[108:111], v[62:63], v[202:203], v[108:111]
    s_waitcnt vmcnt(10)
    s_add_u32 m0, s54, 29696
    s_nop 0
    buffer_load_dwordx4 v7, s[24:27], s55 offen nt lds
    s_waitcnt vmcnt(10)
    s_branch L_page_3
    .p2align 12
L_page_3:
    s_add_u32 s55, s58, 20
    s_and_b32 s55, s55, 63
    s_mul_i32 s55, s55, 6144
    s_add_u32 m0, s54, 30720
    s_nop 0
    buffer_load_dwordx4 v2, s[24:27], s55 offen nt lds
    ds_read_b64_tr_b16 v[40:41], v21 offset:12288
    ds_read_b64_tr_b16 v[42:43], v22 offset:12288
    ds_read_b64_tr_b16 v[44:45], v23 offset:12288
    ds_read_b64_tr_b16 v[46:47], v24 offset:12288
    ds_read_b64_tr_b16 v[48:49], v21 offset:12416
    ds_read_b64_tr_b16 v[50:51], v22 offset:12416
    ds_read_b64_tr_b16 v[52:53], v23 offset:12416
    ds_read_b64_tr_b16 v[54:55], v24 offset:12416
    ds_read_b64_tr_b16 v[56:57], v21 offset:12544
    ds_read_b64_tr_b16 v[58:59], v22 offset:12544
    ds_read_b64_tr_b16 v[60:61], v23 offset:12544
    ds_read_b64_tr_b16 v[62:63], v24 offset:12544
    s_waitcnt lgkmcnt(0)
    v_mfma_f32_16x16x16_bf16 v[64:67], v[40:41], v[204:205], v[64:67]
    v_mfma_f32_16x16x16_bf16 v[68:71], v[42:43], v[204:205], v[68:71]
    v_mfma_f32_16x16x16_bf16 v[72:75], v[44:45], v[204:205], v[72:75]
    v_mfma_f32_16x16x16_bf16 v[76:79], v[46:47], v[204:205], v[76:79]
    v_mfma_f32_16x16x16_bf16 v[80:83], v[48:49], v[204:205], v[80:83]
    v_mfma_f32_16x16x16_bf16 v[84:87], v[50:51], v[204:205], v[84:87]
    v_mfma_f32_16x16x16_bf16 v[88:91], v[52:53], v[204:205], v[88:91]
    v_mfma_f32_16x16x16_bf16 v[92:95], v[54:55], v[204:205], v[92:95]
    v_mfma_f32_16x16x16_bf16 v[96:99], v[56:57], v[204:205], v[96:99]
    v_mfma_f32_16x16x16_bf16 v[100:103], v[58:59], v[204:205], v[100:103]
    v_mfma_f32_16x16x16_bf16 v[104:107], v[60:61], v[204:205], v[104:107]
    v_mfma_f32_16x16x16_bf16 v[108:111], v[62:63], v[204:205], v[108:111]
    s_waitcnt vmcnt(10)
    s_add_u32 m0, s54, 31744
    s_nop 0
    buffer_load_dwordx4 v3, s[24:27], s55 offen nt lds
    s_waitcnt vmcnt(10)
    s_add_u32 m0, s54, 32768
    s_nop 0
    buffer_load_dwordx4 v4, s[24:27], s55 offen nt lds
    s_waitcnt vmcnt(10)
    s_add_u32 m0, s54, 33792
    s_nop 0
    buffer_load_dwordx4 v5, s[24:27], s55 offen nt lds
    s_waitcnt vmcnt(10)
    s_add_u32 m0, s54, 34816
    s_nop 0
    buffer_load_dwordx4 v6, s[24:27], s55 offen nt lds
    ds_read_b64_tr_b16 v[40:41], v21 offset:18432
    ds_read_b64_tr_b16 v[42:43], v22 offset:18432
    ds_read_b64_tr_b16 v[44:45], v23 offset:18432
    ds_read_b64_tr_b16 v[46:47], v24 offset:18432
    ds_read_b64_tr_b16 v[48:49], v21 offset:18560
    ds_read_b64_tr_b16 v[50:51], v22 offset:18560
    ds_read_b64_tr_b16 v[52:53], v23 offset:18560
    ds_read_b64_tr_b16 v[54:55], v24 offset:18560
    ds_read_b64_tr_b16 v[56:57], v21 offset:18688
    ds_read_b64_tr_b16 v[58:59], v22 offset:18688
    ds_read_b64_tr_b16 v[60:61], v23 offset:18688
    ds_read_b64_tr_b16 v[62:63], v24 offset:18688
    s_waitcnt lgkmcnt(0)
    v_mfma_f32_16x16x16_bf16 v[64:67], v[40:41], v[206:207], v[64:67]
    v_mfma_f32_16x16x16_bf16 v[68:71], v[42:43], v[206:207], v[68:71]
    v_mfma_f32_16x16x16_bf16 v[72:75], v[44:45], v[206:207], v[72:75]
    v_mfma_f32_16x16x16_bf16 v[76:79], v[46:47], v[206:207], v[76:79]
    v_mfma_f32_16x16x16_bf16 v[80:83], v[48:49], v[206:207], v[80:83]
    v_mfma_f32_16x16x16_bf16 v[84:87], v[50:51], v[206:207], v[84:87]
    v_mfma_f32_16x16x16_bf16 v[88:91], v[52:53], v[206:207], v[88:91]
    v_mfma_f32_16x16x16_bf16 v[92:95], v[54:55], v[206:207], v[92:95]
    v_mfma_f32_16x16x16_bf16 v[96:99], v[56:57], v[206:207], v[96:99]
    v_mfma_f32_16x16x16_bf16 v[100:103], v[58:59], v[206:207], v[100:103]
    v_mfma_f32_16x16x16_bf16 v[104:107], v[60:61], v[206:207], v[104:107]
    v_mfma_f32_16x16x16_bf16 v[108:111], v[62:63], v[206:207], v[108:111]
    s_waitcnt vmcnt(10)
    s_add_u32 m0, s54, 35840
    s_nop 0
    buffer_load_dwordx4 v7, s[24:27], s55 offen nt lds
    s_waitcnt vmcnt(10)
    s_mov_b32 s55, 0
    s_add_u32 m0, s54, 0
    s_nop 0
    buffer_load_dwordx4 v14, s[32:35], s55 offen  lds
    s_waitcnt vmcnt(10)
    s_add_u32 m0, s54, 1024
    s_nop 0
    buffer_load_dwordx4 v15, s[32:35], s55 offen  lds
    s_waitcnt vmcnt(10)
    s_add_u32 m0, s54, 2048
    s_nop 0
    buffer_load_dwordx4 v16, s[32:35], s55 offen  lds
    s_waitcnt vmcnt(10)
    s_add_u32 m0, s54, 3072
    s_nop 0
    buffer_load_dwordx4 v17, s[32:35], s55 offen  lds
    s_waitcnt vmcnt(10)
    s_add_u32 m0, s54, 4096
    s_nop 0
    buffer_load_dwordx4 v18, s[32:35], s55 offen  lds
    ds_read_b64_tr_b16 v[40:41], v21 offset:24576
    ds_read_b64_tr_b16 v[42:43], v22 offset:24576
    ds_read_b64_tr_b16 v[44:45], v23 offset:24576
    ds_read_b64_tr_b16 v[46:47], v24 offset:24576
    ds_read_b64_tr_b16 v[48:49], v21 offset:24704
    ds_read_b64_tr_b16 v[50:51], v22 offset:24704
    ds_read_b64_tr_b16 v[52:53], v23 offset:24704
    ds_read_b64_tr_b16 v[54:55], v24 offset:24704
    ds_read_b64_tr_b16 v[56:57], v21 offset:24832
    ds_read_b64_tr_b16 v[58:59], v22 offset:24832
    ds_read_b64_tr_b16 v[60:61], v23 offset:24832
    ds_read_b64_tr_b16 v[62:63], v24 offset:24832
    s_waitcnt lgkmcnt(0)
    v_mfma_f32_16x16x16_bf16 v[64:67], v[40:41], v[208:209], v[64:67]
    v_mfma_f32_16x16x16_bf16 v[68:71], v[42:43], v[208:209], v[68:71]
    v_mfma_f32_16x16x16_bf16 v[72:75], v[44:45], v[208:209], v[72:75]
    v_mfma_f32_16x16x16_bf16 v[76:79], v[46:47], v[208:209], v[76:79]
    v_mfma_f32_16x16x16_bf16 v[80:83], v[48:49], v[208:209], v[80:83]
    v_mfma_f32_16x16x16_bf16 v[84:87], v[50:51], v[208:209], v[84:87]
    v_mfma_f32_16x16x16_bf16 v[88:91], v[52:53], v[208:209], v[88:91]
    v_mfma_f32_16x16x16_bf16 v[92:95], v[54:55], v[208:209], v[92:95]
    v_mfma_f32_16x16x16_bf16 v[96:99], v[56:57], v[208:209], v[96:99]
    v_mfma_f32_16x16x16_bf16 v[100:103], v[58:59], v[208:209], v[100:103]
    v_mfma_f32_16x16x16_bf16 v[104:107], v[60:61], v[208:209], v[104:107]
    v_mfma_f32_16x16x16_bf16 v[108:111], v[62:63], v[208:209], v[108:111]
    s_waitcnt vmcnt(10)
    s_mov_b32 s55, 20480
    s_add_u32 m0, s54, 6144
    s_nop 0
    buffer_load_dwordx4 v14, s[32:35], s55 offen  lds
    s_waitcnt vmcnt(10)
    s_add_u32 m0, s54, 7168
    s_nop 0
    buffer_load_dwordx4 v15, s[32:35], s55 offen  lds
    s_waitcnt vmcnt(10)
    s_add_u32 m0, s54, 8192
    s_nop 0
    buffer_load_dwordx4 v16, s[32:35], s55 offen  lds
    s_waitcnt vmcnt(10)
    s_add_u32 m0, s54, 9216
    s_nop 0
    buffer_load_dwordx4 v17, s[32:35], s55 offen  lds
    s_waitcnt vmcnt(10)
    s_add_u32 m0, s54, 10240
    s_nop 0
    buffer_load_dwordx4 v18, s[32:35], s55 offen  lds
    s_waitcnt vmcnt(10)
    s_mov_b32 s55, 40960
    s_add_u32 m0, s54, 12288
    s_nop 0
    buffer_load_dwordx4 v14, s[32:35], s55 offen  lds
    ds_read_b64_tr_b16 v[40:41], v21 offset:30720
    ds_read_b64_tr_b16 v[42:43], v22 offset:30720
    ds_read_b64_tr_b16 v[44:45], v23 offset:30720
    ds_read_b64_tr_b16 v[46:47], v24 offset:30720
    ds_read_b64_tr_b16 v[48:49], v21 offset:30848
    ds_read_b64_tr_b16 v[50:51], v22 offset:30848
    ds_read_b64_tr_b16 v[52:53], v23 offset:30848
    ds_read_b64_tr_b16 v[54:55], v24 offset:30848
    ds_read_b64_tr_b16 v[56:57], v21 offset:30976
    ds_read_b64_tr_b16 v[58:59], v22 offset:30976
    ds_read_b64_tr_b16 v[60:61], v23 offset:30976
    ds_read_b64_tr_b16 v[62:63], v24 offset:30976
    s_waitcnt lgkmcnt(0)
    v_mfma_f32_16x16x16_bf16 v[64:67], v[40:41], v[210:211], v[64:67]
    v_mfma_f32_16x16x16_bf16 v[68:71], v[42:43], v[210:211], v[68:71]
    v_mfma_f32_16x16x16_bf16 v[72:75], v[44:45], v[210:211], v[72:75]
    v_mfma_f32_16x16x16_bf16 v[76:79], v[46:47], v[210:211], v[76:79]
    v_mfma_f32_16x16x16_bf16 v[80:83], v[48:49], v[210:211], v[80:83]
    v_mfma_f32_16x16x16_bf16 v[84:87], v[50:51], v[210:211], v[84:87]
    v_mfma_f32_16x16x16_bf16 v[88:91], v[52:53], v[210:211], v[88:91]
    v_mfma_f32_16x16x16_bf16 v[92:95], v[54:55], v[210:211], v[92:95]
    v_mfma_f32_16x16x16_bf16 v[96:99], v[56:57], v[210:211], v[96:99]
    v_mfma_f32_16x16x16_bf16 v[100:103], v[58:59], v[210:211], v[100:103]
    v_mfma_f32_16x16x16_bf16 v[104:107], v[60:61], v[210:211], v[104:107]
    v_mfma_f32_16x16x16_bf16 v[108:111], v[62:63], v[210:211], v[108:111]
    s_waitcnt vmcnt(10)
    s_add_u32 m0, s54, 13312
    s_nop 0
    buffer_load_dwordx4 v15, s[32:35], s55 offen  lds
    s_waitcnt vmcnt(10)
    s_add_u32 m0, s54, 14336
    s_nop 0
    buffer_load_dwordx4 v16, s[32:35], s55 offen  lds
    s_waitcnt vmcnt(10)
    s_add_u32 m0, s54, 15360
    s_nop 0
    buffer_load_dwordx4 v17, s[32:35], s55 offen  lds
    s_waitcnt vmcnt(10)
    s_add_u32 m0, s54, 16384
    s_nop 0
    buffer_load_dwordx4 v18, s[32:35], s55 offen  lds
    s_waitcnt vmcnt(10)
    s_mov_b32 s55, 61440
    s_add_u32 m0, s54, 18432
    s_nop 0
    buffer_load_dwordx4 v14, s[32:35], s55 offen  lds
    ds_read_b64_tr_b16 a[0:1], v25 offset:0
    ds_read_b64_tr_b16 a[4:5], v25 offset:32
    ds_read_b64_tr_b16 a[8:9], v25 offset:64
    ds_read_b64_tr_b16 a[12:13], v25 offset:96
    ds_read_b64_tr_b16 a[16:17], v25 offset:128
    ds_read_b64_tr_b16 a[20:21], v25 offset:160
    ds_read_b64_tr_b16 a[24:25], v25 offset:192
    ds_read_b64_tr_b16 a[28:29], v25 offset:224
    ds_read_b64_tr_b16 a[32:33], v25 offset:256
    ds_read_b64_tr_b16 a[36:37], v25 offset:288
    s_waitcnt lgkmcnt(0)
    s_waitcnt vmcnt(10)
    s_add_u32 m0, s54, 19456
    s_nop 0
    buffer_load_dwordx4 v15, s[32:35], s55 offen  lds
    s_waitcnt vmcnt(10)
    s_add_u32 m0, s54, 20480
    s_nop 0
    buffer_load_dwordx4 v16, s[32:35], s55 offen  lds
    s_waitcnt vmcnt(10)
    s_add_u32 m0, s54, 21504
    s_nop 0
    buffer_load_dwordx4 v17, s[32:35], s55 offen  lds
    s_waitcnt vmcnt(10)
    s_add_u32 m0, s54, 22528
    s_nop 0
    buffer_load_dwordx4 v18, s[32:35], s55 offen  lds
    s_waitcnt vmcnt(10)
    s_mov_b32 s55, 81920
    s_add_u32 m0, s54, 24576
    s_nop 0
    buffer_load_dwordx4 v14, s[32:35], s55 offen  lds
    ds_read_b64_tr_b16 a[2:3], v25 offset:6144
    ds_read_b64_tr_b16 a[6:7], v25 offset:6176
    ds_read_b64_tr_b16 a[10:11], v25 offset:6208
    ds_read_b64_tr_b16 a[14:15], v25 offset:6240
    ds_read_b64_tr_b16 a[18:19], v25 offset:6272
    ds_read_b64_tr_b16 a[22:23], v25 offset:6304
    ds_read_b64_tr_b16 a[26:27], v25 offset:6336
    ds_read_b64_tr_b16 a[30:31], v25 offset:6368
    ds_read_b64_tr_b16 a[34:35], v25 offset:6400
    ds_read_b64_tr_b16 a[38:39], v25 offset:6432
    s_waitcnt lgkmcnt(0)
    s_waitcnt vmcnt(10)
    s_add_u32 m0, s54, 25600
    s_nop 0
    buffer_load_dwordx4 v15, s[32:35], s55 offen  lds
    s_waitcnt vmcnt(10)
    s_add_u32 m0, s54, 26624
    s_nop 0
    buffer_load_dwordx4 v16, s[32:35], s55 offen  lds
    s_waitcnt vmcnt(10)
    s_add_u32 m0, s54, 27648
    s_nop 0
    buffer_load_dwordx4 v17, s[32:35], s55 offen  lds
    s_waitcnt vmcnt(10)
    s_add_u32 m0, s54, 28672
    s_nop 0
    buffer_load_dwordx4 v18, s[32:35], s55 offen  lds
    s_waitcnt vmcnt(10)
    s_mov_b32 s55, 102400
    s_add_u32 m0, s54, 30720
    s_nop 0
    buffer_load_dwordx4 v14, s[32:35], s55 offen  lds
    ds_read_b64_tr_b16 a[40:41], v25 offset:12288
    ds_read_b64_tr_b16 a[44:45], v25 offset:12320
    ds_read_b64_tr_b16 a[48:49], v25 offset:12352
    ds_read_b64_tr_b16 a[52:53], v25 offset:12384
    ds_read_b64_tr_b16 a[56:57], v25 offset:12416
    ds_read_b64_tr_b16 a[60:61], v25 offset:12448
    ds_read_b64_tr_b16 a[64:65], v25 offset:12480
    ds_read_b64_tr_b16 a[68:69], v25 offset:12512
    ds_read_b64_tr_b16 a[72:73], v25 offset:12544
    ds_read_b64_tr_b16 a[76:77], v25 offset:12576
    s_waitcnt lgkmcnt(0)
    s_waitcnt vmcnt(10)
    s_add_u32 m0, s54, 31744
    s_nop 0
    buffer_load_dwordx4 v15, s[32:35], s55 offen  lds
    s_waitcnt vmcnt(10)
    s_add_u32 m0, s54, 32768
    s_nop 0
    buffer_load_dwordx4 v16, s[32:35], s55 offen  lds
    s_waitcnt vmcnt(10)
    s_add_u32 m0, s54, 33792
    s_nop 0
    buffer_load_dwordx4 v17, s[32:35], s55 offen  lds
    s_waitcnt vmcnt(10)
    s_add_u32 m0, s54, 34816
    s_nop 0
    buffer_load_dwordx4 v18, s[32:35], s55 offen  lds
    s_waitcnt vmcnt(10)
    s_mov_b32 s55, 122880
    s_add_u32 m0, s54, 0
    s_nop 0
    buffer_load_dwordx4 v14, s[32:35], s55 offen  lds
    ds_read_b64_tr_b16 a[42:43], v25 offset:18432
    ds_read_b64_tr_b16 a[46:47], v25 offset:18464
    ds_read_b64_tr_b16 a[50:51], v25 offset:18496
    ds_read_b64_tr_b16 a[54:55], v25 offset:18528
    ds_read_b64_tr_b16 a[58:59], v25 offset:18560
    ds_read_b64_tr_b16 a[62:63], v25 offset:18592
    ds_read_b64_tr_b16 a[66:67], v25 offset:18624
    ds_read_b64_tr_b16 a[70:71], v25 offset:18656
    ds_read_b64_tr_b16 a[74:75], v25 offset:18688
    ds_read_b64_tr_b16 a[78:79], v25 offset:18720
    s_waitcnt lgkmcnt(0)
    s_waitcnt vmcnt(10)
    s_add_u32 m0, s54, 1024
    s_nop 0
    buffer_load_dwordx4 v15, s[32:35], s55 offen  lds
    s_waitcnt vmcnt(10)
    s_add_u32 m0, s54, 2048
    s_nop 0
    buffer_load_dwordx4 v16, s[32:35], s55 offen  lds
    s_waitcnt vmcnt(10)
    s_add_u32 m0, s54, 3072
    s_nop 0
    buffer_load_dwordx4 v17, s[32:35], s55 offen  lds
    s_waitcnt vmcnt(10)
    s_add_u32 m0, s54, 4096
    s_nop 0
    buffer_load_dwordx4 v18, s[32:35], s55 offen  lds
    s_waitcnt vmcnt(10)
    s_mov_b32 s55, 143360
    s_add_u32 m0, s54, 6144
    s_nop 0
    buffer_load_dwordx4 v14, s[32:35], s55 offen  lds
    ds_read_b64_tr_b16 a[80:81], v25 offset:24576
    ds_read_b64_tr_b16 a[84:85], v25 offset:24608
    ds_read_b64_tr_b16 a[88:89], v25 offset:24640
    ds_read_b64_tr_b16 a[92:93], v25 offset:24672
    ds_read_b64_tr_b16 a[96:97], v25 offset:24704
    ds_read_b64_tr_b16 a[100:101], v25 offset:24736
    ds_read_b64_tr_b16 a[104:105], v25 offset:24768
    ds_read_b64_tr_b16 a[108:109], v25 offset:24800
    ds_read_b64_tr_b16 a[112:113], v25 offset:24832
    ds_read_b64_tr_b16 a[116:117], v25 offset:24864
    s_waitcnt lgkmcnt(0)
    s_waitcnt vmcnt(10)
    s_add_u32 m0, s54, 7168
    s_nop 0
    buffer_load_dwordx4 v15, s[32:35], s55 offen  lds
    s_waitcnt vmcnt(10)
    s_add_u32 m0, s54, 8192
    s_nop 0
    buffer_load_dwordx4 v16, s[32:35], s55 offen  lds
    s_waitcnt vmcnt(10)
    s_add_u32 m0, s54, 9216
    s_nop 0
    buffer_load_dwordx4 v17, s[32:35], s55 offen  lds
    s_waitcnt vmcnt(10)
    s_add_u32 m0, s54, 10240
    s_nop 0
    buffer_load_dwordx4 v18, s[32:35], s55 offen  lds
    s_waitcnt vmcnt(10)
    s_mov_b32 s55, 163840
    s_add_u32 m0, s54, 12288
    s_nop 0
    buffer_load_dwordx4 v14, s[32:35], s55 offen  lds
    ds_read_b64_tr_b16 a[82:83], v25 offset:30720
    ds_read_b64_tr_b16 a[86:87], v25 offset:30752
    ds_read_b64_tr_b16 a[90:91], v25 offset:30784
    ds_read_b64_tr_b16 a[94:95], v25 offset:30816
    ds_read_b64_tr_b16 a[98:99], v25 offset:30848
    ds_read_b64_tr_b16 a[102:103], v25 offset:30880
    ds_read_b64_tr_b16 a[106:107], v25 offset:30912
    ds_read_b64_tr_b16 a[110:111], v25 offset:30944
    ds_read_b64_tr_b16 a[114:115], v25 offset:30976
    ds_read_b64_tr_b16 a[118:119], v25 offset:31008
    s_waitcnt lgkmcnt(0)
    s_waitcnt vmcnt(10)
    s_add_u32 m0, s54, 13312
    s_nop 0
    buffer_load_dwordx4 v15, s[32:35], s55 offen  lds
    s_waitcnt vmcnt(10)
    s_add_u32 m0, s54, 14336
    s_nop 0
    buffer_load_dwordx4 v16, s[32:35], s55 offen  lds
    s_waitcnt vmcnt(10)
    s_add_u32 m0, s54, 15360
    s_nop 0
    buffer_load_dwordx4 v17, s[32:35], s55 offen  lds
    s_waitcnt vmcnt(10)
    s_add_u32 m0, s54, 16384
    s_nop 0
    buffer_load_dwordx4 v18, s[32:35], s55 offen  lds
    s_waitcnt vmcnt(10)
    s_mov_b32 s55, 184320
    s_add_u32 m0, s54, 18432
    s_nop 0
    buffer_load_dwordx4 v14, s[32:35], s55 offen  lds
    ds_read_b64_tr_b16 a[120:121], v25 offset:0
    ds_read_b64_tr_b16 a[124:125], v25 offset:32
    ds_read_b64_tr_b16 a[128:129], v25 offset:64
    ds_read_b64_tr_b16 a[132:133], v25 offset:96
    ds_read_b64_tr_b16 a[136:137], v25 offset:128
    ds_read_b64_tr_b16 a[140:141], v25 offset:160
    ds_read_b64_tr_b16 a[144:145], v25 offset:192
    ds_read_b64_tr_b16 a[148:149], v25 offset:224
    ds_read_b64_tr_b16 a[152:153], v25 offset:256
    ds_read_b64_tr_b16 a[156:157], v25 offset:288
    s_waitcnt lgkmcnt(0)
    s_waitcnt vmcnt(10)
    s_add_u32 m0, s54, 19456
    s_nop 0
    buffer_load_dwordx4 v15, s[32:35], s55 offen  lds
    s_waitcnt vmcnt(10)
    s_add_u32 m0, s54, 20480
    s_nop 0
    buffer_load_dwordx4 v16, s[32:35], s55 offen  lds
    s_waitcnt vmcnt(10)
    s_add_u32 m0, s54, 21504
    s_nop 0
    buffer_load_dwordx4 v17, s[32:35], s55 offen  lds
    s_waitcnt vmcnt(10)
    s_add_u32 m0, s54, 22528
    s_nop 0
    buffer_load_dwordx4 v18, s[32:35], s55 offen  lds
    s_waitcnt vmcnt(10)
    s_mov_b32 s55, 204800
    s_add_u32 m0, s54, 24576
    s_nop 0
    buffer_load_dwordx4 v14, s[32:35], s55 offen  lds
    ds_read_b64_tr_b16 a[122:123], v25 offset:6144
    ds_read_b64_tr_b16 a[126:127], v25 offset:6176
    ds_read_b64_tr_b16 a[130:131], v25 offset:6208
    ds_read_b64_tr_b16 a[134:135], v25 offset:6240
    ds_read_b64_tr_b16 a[138:139], v25 offset:6272
    ds_read_b64_tr_b16 a[142:143], v25 offset:6304
    ds_read_b64_tr_b16 a[146:147], v25 offset:6336
    ds_read_b64_tr_b16 a[150:151], v25 offset:6368
    ds_read_b64_tr_b16 a[154:155], v25 offset:6400
    ds_read_b64_tr_b16 a[158:159], v25 offset:6432
    s_waitcnt lgkmcnt(0)
    s_waitcnt vmcnt(10)
    s_add_u32 m0, s54, 25600
    s_nop 0
    buffer_load_dwordx4 v15, s[32:35], s55 offen  lds
    s_waitcnt vmcnt(10)
    s_add_u32 m0, s54, 26624
    s_nop 0
    buffer_load_dwordx4 v16, s[32:35], s55 offen  lds
    s_waitcnt vmcnt(10)
    s_add_u32 m0, s54, 27648
    s_nop 0
    buffer_load_dwordx4 v17, s[32:35], s55 offen  lds
    s_waitcnt vmcnt(10)
    s_add_u32 m0, s54, 28672
    s_nop 0
    buffer_load_dwordx4 v18, s[32:35], s55 offen  lds
    s_waitcnt vmcnt(10)
    s_mov_b32 s55, 225280
    s_add_u32 m0, s54, 30720
    s_nop 0
    buffer_load_dwordx4 v14, s[32:35], s55 offen  lds
    ds_read_b64_tr_b16 a[160:161], v25 offset:12288
    ds_read_b64_tr_b16 a[164:165], v25 offset:12320
    ds_read_b64_tr_b16 a[168:169], v25 offset:12352
    ds_read_b64_tr_b16 a[172:173], v25 offset:12384
    ds_read_b64_tr_b16 a[176:177], v25 offset:12416
    ds_read_b64_tr_b16 a[180:181], v25 offset:12448
    ds_read_b64_tr_b16 a[184:185], v25 offset:12480
    ds_read_b64_tr_b16 a[188:189], v25 offset:12512
    ds_read_b64_tr_b16 a[192:193], v25 offset:12544
    ds_read_b64_tr_b16 a[196:197], v25 offset:12576
    s_waitcnt lgkmcnt(0)
    s_waitcnt vmcnt(10)
    s_add_u32 m0, s54, 31744
    s_nop 0
    buffer_load_dwordx4 v15, s[32:35], s55 offen  lds
    s_waitcnt vmcnt(10)
    s_add_u32 m0, s54, 32768
    s_nop 0
    buffer_load_dwordx4 v16, s[32:35], s55 offen  lds
    s_waitcnt vmcnt(10)
    s_add_u32 m0, s54, 33792
    s_nop 0
    buffer_load_dwordx4 v17, s[32:35], s55 offen  lds
    s_waitcnt vmcnt(10)
    s_add_u32 m0, s54, 34816
    s_nop 0
    buffer_load_dwordx4 v18, s[32:35], s55 offen  lds
    s_waitcnt vmcnt(10)
    s_add_u32 s55, s58, 24
    s_and_b32 s55, s55, 63
    s_mul_i32 s55, s55, 6144
    s_add_u32 m0, s54, 0
    s_nop 0
    buffer_load_dwordx4 v2, s[24:27], s55 offen nt lds
    ds_read_b64_tr_b16 a[162:163], v25 offset:18432
    ds_read_b64_tr_b16 a[166:167], v25 offset:18464
    ds_read_b64_tr_b16 a[170:171], v25 offset:18496
    ds_read_b64_tr_b16 a[174:175], v25 offset:18528
    ds_read_b64_tr_b16 a[178:179], v25 offset:18560
    ds_read_b64_tr_b16 a[182:183], v25 offset:18592
    ds_read_b64_tr_b16 a[186:187], v25 offset:18624
    ds_read_b64_tr_b16 a[190:191], v25 offset:18656
    ds_read_b64_tr_b16 a[194:195], v25 offset:18688
    ds_read_b64_tr_b16 a[198:199], v25 offset:18720
    s_waitcnt lgkmcnt(0)
    s_waitcnt vmcnt(10)
    s_add_u32 m0, s54, 1024
    s_nop 0
    buffer_load_dwordx4 v3, s[24:27], s55 offen nt lds
    s_waitcnt vmcnt(10)
    s_add_u32 m0, s54, 2048
    s_nop 0
    buffer_load_dwordx4 v4, s[24:27], s55 offen nt lds
    s_waitcnt vmcnt(10)
    s_add_u32 m0, s54, 3072
    s_nop 0
    buffer_load_dwordx4 v5, s[24:27], s55 offen nt lds
    s_waitcnt vmcnt(10)
    s_add_u32 m0, s54, 4096
    s_nop 0
    buffer_load_dwordx4 v6, s[24:27], s55 offen nt lds
    s_waitcnt vmcnt(10)
    s_add_u32 m0, s54, 5120
    s_nop 0
    buffer_load_dwordx4 v7, s[24:27], s55 offen nt lds
    ds_read_b64_tr_b16 a[200:201], v25 offset:24576
    ds_read_b64_tr_b16 a[204:205], v25 offset:24608
    ds_read_b64_tr_b16 a[208:209], v25 offset:24640
    ds_read_b64_tr_b16 a[212:213], v25 offset:24672
    ds_read_b64_tr_b16 a[216:217], v25 offset:24704
    ds_read_b64_tr_b16 a[220:221], v25 offset:24736
    ds_read_b64_tr_b16 a[224:225], v25 offset:24768
    ds_read_b64_tr_b16 a[228:229], v25 offset:24800
    ds_read_b64_tr_b16 a[232:233], v25 offset:24832
    ds_read_b64_tr_b16 a[236:237], v25 offset:24864
    s_waitcnt lgkmcnt(0)
    s_waitcnt vmcnt(10)
    s_add_u32 s55, s58, 28
    s_and_b32 s55, s55, 63
    s_mul_i32 s55, s55, 6144
    s_add_u32 m0, s54, 6144
    s_nop 0
    buffer_load_dwordx4 v2, s[24:27], s55 offen nt lds
    s_waitcnt vmcnt(10)
    s_add_u32 m0, s54, 7168
    s_nop 0
    buffer_load_dwordx4 v3, s[24:27], s55 offen nt lds
    s_waitcnt vmcnt(10)
    s_add_u32 m0, s54, 8192
    s_nop 0
    buffer_load_dwordx4 v4, s[24:27], s55 offen nt lds
    s_waitcnt vmcnt(10)
    s_add_u32 m0, s54, 9216
    s_nop 0
    buffer_load_dwordx4 v5, s[24:27], s55 offen nt lds
    s_waitcnt vmcnt(10)
    s_add_u32 m0, s54, 10240
    s_nop 0
    buffer_load_dwordx4 v6, s[24:27], s55 offen nt lds
    ds_read_b64_tr_b16 a[202:203], v25 offset:30720
    ds_read_b64_tr_b16 a[206:207], v25 offset:30752
    ds_read_b64_tr_b16 a[210:211], v25 offset:30784
    ds_read_b64_tr_b16 a[214:215], v25 offset:30816
    ds_read_b64_tr_b16 a[218:219], v25 offset:30848
    ds_read_b64_tr_b16 a[222:223], v25 offset:30880
    ds_read_b64_tr_b16 a[226:227], v25 offset:30912
    ds_read_b64_tr_b16 a[230:231], v25 offset:30944
    ds_read_b64_tr_b16 a[234:235], v25 offset:30976
    ds_read_b64_tr_b16 a[238:239], v25 offset:31008
    s_waitcnt lgkmcnt(0)
    s_waitcnt vmcnt(10)
    s_add_u32 m0, s54, 11264
    s_nop 0
    buffer_load_dwordx4 v7, s[24:27], s55 offen nt lds
    s_waitcnt vmcnt(10)
    s_add_u32 s55, s58, 32
    s_and_b32 s55, s55, 63
    s_mul_i32 s55, s55, 6144
    s_add_u32 m0, s54, 12288
    s_nop 0
    buffer_load_dwordx4 v2, s[24:27], s55 offen nt lds
    s_waitcnt vmcnt(10)
    s_add_u32 m0, s54, 13312
    s_nop 0
    buffer_load_dwordx4 v3, s[24:27], s55 offen nt lds
    s_waitcnt vmcnt(10)
    s_add_u32 m0, s54, 14336
    s_nop 0
    buffer_load_dwordx4 v4, s[24:27], s55 offen nt lds
    s_waitcnt vmcnt(10)
    s_add_u32 m0, s54, 15360
    s_nop 0
    buffer_load_dwordx4 v5, s[24:27], s55 offen nt lds
    s_waitcnt vmcnt(10)
    s_add_u32 m0, s54, 16384
    s_nop 0
    buffer_load_dwordx4 v6, s[24:27], s55 offen nt lds
    ds_read_b64_tr_b16 v[40:41], v21 offset:0
    ds_read_b64_tr_b16 v[42:43], v22 offset:0
    ds_read_b64_tr_b16 v[44:45], v23 offset:0
    ds_read_b64_tr_b16 v[46:47], v24 offset:0
    ds_read_b64_tr_b16 v[48:49], v21 offset:128
    ds_read_b64_tr_b16 v[50:51], v22 offset:128
    ds_read_b64_tr_b16 v[52:53], v23 offset:128
    ds_read_b64_tr_b16 v[54:55], v24 offset:128
    ds_read_b64_tr_b16 v[56:57], v21 offset:256
    ds_read_b64_tr_b16 v[58:59], v22 offset:256
    ds_read_b64_tr_b16 v[60:61], v23 offset:256
    ds_read_b64_tr_b16 v[62:63], v24 offset:256
    s_waitcnt lgkmcnt(0)
    v_mfma_f32_16x16x16_bf16 v[64:67], v[40:41], v[212:213], v[64:67]
    v_mfma_f32_16x16x16_bf16 v[68:71], v[42:43], v[212:213], v[68:71]
    v_mfma_f32_16x16x16_bf16 v[72:75], v[44:45], v[212:213], v[72:75]
    v_mfma_f32_16x16x16_bf16 v[76:79], v[46:47], v[212:213], v[76:79]
    v_mfma_f32_16x16x16_bf16 v[80:83], v[48:49], v[212:213], v[80:83]
    v_mfma_f32_16x16x16_bf16 v[84:87], v[50:51], v[212:213], v[84:87]
    v_mfma_f32_16x16x16_bf16 v[88:91], v[52:53], v[212:213], v[88:91]
    v_mfma_f32_16x16x16_bf16 v[92:95], v[54:55], v[212:213], v[92:95]
    v_mfma_f32_16x16x16_bf16 v[96:99], v[56:57], v[212:213], v[96:99]
    v_mfma_f32_16x16x16_bf16 v[100:103], v[58:59], v[212:213], v[100:103]
    v_mfma_f32_16x16x16_bf16 v[104:107], v[60:61], v[212:213], v[104:107]
    v_mfma_f32_16x16x16_bf16 v[108:111], v[62:63], v[212:213], v[108:111]
    s_waitcnt vmcnt(10)
    s_add_u32 m0, s54, 17408
    s_nop 0
    buffer_load_dwordx4 v7, s[24:27], s55 offen nt lds
    s_waitcnt vmcnt(10)
    s_add_u32 s55, s58, 36
    s_and_b32 s55, s55, 63
    s_mul_i32 s55, s55, 6144
    s_add_u32 m0, s54, 18432
    s_nop 0
    buffer_load_dwordx4 v2, s[24:27], s55 offen nt lds
    s_waitcnt vmcnt(10)
    s_add_u32 m0, s54, 19456
    s_nop 0
    buffer_load_dwordx4 v3, s[24:27], s55 offen nt lds
    s_waitcnt vmcnt(10)
    s_add_u32 m0, s54, 20480
    s_nop 0
    buffer_load_dwordx4 v4, s[24:27], s55 offen nt lds
    s_waitcnt vmcnt(10)
    s_add_u32 m0, s54, 21504
    s_nop 0
    buffer_load_dwordx4 v5, s[24:27], s55 offen nt lds
    s_waitcnt vmcnt(10)
    s_add_u32 m0, s54, 22528
    s_nop 0
    buffer_load_dwordx4 v6, s[24:27], s55 offen nt lds
    ds_read_b64_tr_b16 v[40:41], v21 offset:6144
    ds_read_b64_tr_b16 v[42:43], v22 offset:6144
    ds_read_b64_tr_b16 v[44:45], v23 offset:6144
    ds_read_b64_tr_b16 v[46:47], v24 offset:6144
    ds_read_b64_tr_b16 v[48:49], v21 offset:6272
    ds_read_b64_tr_b16 v[50:51], v22 offset:6272
    ds_read_b64_tr_b16 v[52:53], v23 offset:6272
    ds_read_b64_tr_b16 v[54:55], v24 offset:6272
    ds_read_b64_tr_b16 v[56:57], v21 offset:6400
    ds_read_b64_tr_b16 v[58:59], v22 offset:6400
    ds_read_b64_tr_b16 v[60:61], v23 offset:6400
    ds_read_b64_tr_b16 v[62:63], v24 offset:6400
    s_waitcnt lgkmcnt(0)
    v_mfma_f32_16x16x16_bf16 v[64:67], v[40:41], v[214:215], v[64:67]
    v_mfma_f32_16x16x16_bf16 v[68:71], v[42:43], v[214:215], v[68:71]
    v_mfma_f32_16x16x16_bf16 v[72:75], v[44:45], v[214:215], v[72:75]
    v_mfma_f32_16x16x16_bf16 v[76:79], v[46:47], v[214:215], v[76:79]
    v_mfma_f32_16x16x16_bf16 v[80:83], v[48:49], v[214:215], v[80:83]
    v_mfma_f32_16x16x16_bf16 v[84:87], v[50:51], v[214:215], v[84:87]
    v_mfma_f32_16x16x16_bf16 v[88:91], v[52:53], v[214:215], v[88:91]
    v_mfma_f32_16x16x16_bf16 v[92:95], v[54:55], v[214:215], v[92:95]
    v_mfma_f32_16x16x16_bf16 v[96:99], v[56:57], v[214:215], v[96:99]
    v_mfma_f32_16x16x16_bf16 v[100:103], v[58:59], v[214:215], v[100:103]
    v_mfma_f32_16x16x16_bf16 v[104:107], v[60:61], v[214:215], v[104:107]
    v_mfma_f32_16x16x16_bf16 v[108:111], v[62:63], v[214:215], v[108:111]
    s_waitcnt vmcnt(10)
    s_add_u32 m0, s54, 23552
    s_nop 0
    buffer_load_dwordx4 v7, s[24:27], s55 offen nt lds
    s_waitcnt vmcnt(10)
    s_add_u32 s55, s58, 40
    s_and_b32 s55, s55, 63
    s_mul_i32 s55, s55, 6144
    s_add_u32 m0, s54, 24576
    s_nop 0
    buffer_load_dwordx4 v236, s[24:27], s55 offen nt lds
    s_waitcnt vmcnt(10)
    s_add_u32 m0, s54, 25600
    s_nop 0
    buffer_load_dwordx4 v237, s[24:27], s55 offen nt lds
    s_waitcnt vmcnt(10)
    s_add_u32 s55, s58, 44
    s_and_b32 s55, s55, 63
    s_mul_i32 s55, s55, 6144
    s_add_u32 m0, s54, 26624
    s_nop 0
    buffer_load_dwordx4 v236, s[24:27], s55 offen nt lds
    s_waitcnt vmcnt(10)
    s_add_u32 m0, s54, 27648
    s_nop 0
    buffer_load_dwordx4 v237, s[24:27], s55 offen nt lds
    s_waitcnt vmcnt(10)
    s_add_u32 s55, s58, 48
    s_and_b32 s55, s55, 63
    s_mul_i32 s55, s55, 6144
    s_add_u32 m0, s54, 28672
    s_nop 0
    buffer_load_dwordx4 v236, s[24:27], s55 offen nt lds
    ds_read_b64_tr_b16 v[40:41], v21 offset:12288
    ds_read_b64_tr_b16 v[42:43], v22 offset:12288
    ds_read_b64_tr_b16 v[44:45], v23 offset:12288
    ds_read_b64_tr_b16 v[46:47], v24 offset:12288
    ds_read_b64_tr_b16 v[48:49], v21 offset:12416
    ds_read_b64_tr_b16 v[50:51], v22 offset:12416
    ds_read_b64_tr_b16 v[52:53], v23 offset:12416
    ds_read_b64_tr_b16 v[54:55], v24 offset:12416
    ds_read_b64_tr_b16 v[56:57], v21 offset:12544
    ds_read_b64_tr_b16 v[58:59], v22 offset:12544
    ds_read_b64_tr_b16 v[60:61], v23 offset:12544
    ds_read_b64_tr_b16 v[62:63], v24 offset:12544
    s_waitcnt lgkmcnt(0)
    v_mfma_f32_16x16x16_bf16 v[64:67], v[40:41], v[216:217], v[64:67]
    v_mfma_f32_16x16x16_bf16 v[68:71], v[42:43], v[216:217], v[68:71]
    v_mfma_f32_16x16x16_bf16 v[72:75], v[44:45], v[216:217], v[72:75]
    v_mfma_f32_16x16x16_bf16 v[76:79], v[46:47], v[216:217], v[76:79]
    v_mfma_f32_16x16x16_bf16 v[80:83], v[48:49], v[216:217], v[80:83]
    v_mfma_f32_16x16x16_bf16 v[84:87], v[50:51], v[216:217], v[84:87]
    v_mfma_f32_16x16x16_bf16 v[88:91], v[52:53], v[216:217], v[88:91]
    v_mfma_f32_16x16x16_bf16 v[92:95], v[54:55], v[216:217], v[92:95]
    v_mfma_f32_16x16x16_bf16 v[96:99], v[56:57], v[216:217], v[96:99]
    v_mfma_f32_16x16x16_bf16 v[100:103], v[58:59], v[216:217], v[100:103]
    v_mfma_f32_16x16x16_bf16 v[104:107], v[60:61], v[216:217], v[104:107]
    v_mfma_f32_16x16x16_bf16 v[108:111], v[62:63], v[216:217], v[108:111]
    s_waitcnt vmcnt(10)
    s_add_u32 m0, s54, 29696
    s_nop 0
    buffer_load_dwordx4 v237, s[24:27], s55 offen nt lds
    s_waitcnt vmcnt(10)
    s_add_u32 s55, s58, 52
    s_and_b32 s55, s55, 63
    s_mul_i32 s55, s55, 6144
    s_add_u32 m0, s54, 30720
    s_nop 0
    buffer_load_dwordx4 v236, s[24:27], s55 offen nt lds
    s_waitcnt vmcnt(10)
    s_add_u32 m0, s54, 31744
    s_nop 0
    buffer_load_dwordx4 v237, s[24:27], s55 offen nt lds
    s_waitcnt vmcnt(10)
    s_add_u32 s55, s58, 56
    s_and_b32 s55, s55, 63
    s_mul_i32 s55, s55, 6144
    s_add_u32 m0, s54, 32768
    s_nop 0
    buffer_load_dwordx4 v236, s[24:27], s55 offen nt lds
    s_waitcnt vmcnt(10)
    s_add_u32 m0, s54, 33792
    s_nop 0
    buffer_load_dwordx4 v237, s[24:27], s55 offen nt lds
    s_waitcnt vmcnt(10)
    s_add_u32 s55, s58, 60
    s_and_b32 s55, s55, 63
    s_mul_i32 s55, s55, 6144
    s_add_u32 m0, s54, 34816
    s_nop 0
    buffer_load_dwordx4 v236, s[24:27], s55 offen nt lds
    ds_read_b64_tr_b16 v[40:41], v21 offset:18432
    ds_read_b64_tr_b16 v[42:43], v22 offset:18432
    ds_read_b64_tr_b16 v[44:45], v23 offset:18432
    ds_read_b64_tr_b16 v[46:47], v24 offset:18432
    ds_read_b64_tr_b16 v[48:49], v21 offset:18560
    ds_read_b64_tr_b16 v[50:51], v22 offset:18560
    ds_read_b64_tr_b16 v[52:53], v23 offset:18560
    ds_read_b64_tr_b16 v[54:55], v24 offset:18560
    ds_read_b64_tr_b16 v[56:57], v21 offset:18688
    ds_read_b64_tr_b16 v[58:59], v22 offset:18688
    ds_read_b64_tr_b16 v[60:61], v23 offset:18688
    ds_read_b64_tr_b16 v[62:63], v24 offset:18688
    s_waitcnt lgkmcnt(0)
    v_mfma_f32_16x16x16_bf16 v[64:67], v[40:41], v[218:219], v[64:67]
    v_mfma_f32_16x16x16_bf16 v[68:71], v[42:43], v[218:219], v[68:71]
    v_mfma_f32_16x16x16_bf16 v[72:75], v[44:45], v[218:219], v[72:75]
    v_mfma_f32_16x16x16_bf16 v[76:79], v[46:47], v[218:219], v[76:79]
    v_mfma_f32_16x16x16_bf16 v[80:83], v[48:49], v[218:219], v[80:83]
    v_mfma_f32_16x16x16_bf16 v[84:87], v[50:51], v[218:219], v[84:87]
    v_mfma_f32_16x16x16_bf16 v[88:91], v[52:53], v[218:219], v[88:91]
    v_mfma_f32_16x16x16_bf16 v[92:95], v[54:55], v[218:219], v[92:95]
    v_mfma_f32_16x16x16_bf16 v[96:99], v[56:57], v[218:219], v[96:99]
    v_mfma_f32_16x16x16_bf16 v[100:103], v[58:59], v[218:219], v[100:103]
    v_mfma_f32_16x16x16_bf16 v[104:107], v[60:61], v[218:219], v[104:107]
    v_mfma_f32_16x16x16_bf16 v[108:111], v[62:63], v[218:219], v[108:111]
    s_waitcnt vmcnt(10)
    s_add_u32 m0, s54, 35840
    s_nop 0
    buffer_load_dwordx4 v237, s[24:27], s55 offen nt lds
    s_waitcnt vmcnt(10)
    s_add_u32 s55, s58, 40
    s_and_b32 s55, s55, 63
    s_mul_i32 s55, s55, 6144
    s_add_u32 s55, s55, 128
    s_add_u32 m0, s54, 0
    s_nop 0
    buffer_load_dwordx4 v236, s[24:27], s55 offen nt lds
    s_waitcnt vmcnt(10)
    s_add_u32 m0, s54, 1024
    s_nop 0
    buffer_load_dwordx4 v237, s[24:27], s55 offen nt lds
    s_waitcnt vmcnt(10)
    s_add_u32 s55, s58, 44
    s_and_b32 s55, s55, 63
    s_mul_i32 s55, s55, 6144
    s_add_u32 s55, s55, 128
    s_add_u32 m0, s54, 2048
    s_nop 0
    buffer_load_dwordx4 v236, s[24:27], s55 offen nt lds
    s_waitcnt vmcnt(10)
    s_add_u32 m0, s54, 3072
    s_nop 0
    buffer_load_dwordx4 v237, s[24:27], s55 offen nt lds
    s_waitcnt vmcnt(10)
    s_add_u32 s55, s58, 48
    s_and_b32 s55, s55, 63
    s_mul_i32 s55, s55, 6144
    s_add_u32 s55, s55, 128
    s_add_u32 m0, s54, 4096
    s_nop 0
    buffer_load_dwordx4 v236, s[24:27], s55 offen nt lds
    ds_read_b64_tr_b16 v[40:41], v238 offset:24576
    ds_read_b64_tr_b16 v[42:43], v238 offset:26624
    ds_read_b64_tr_b16 v[44:45], v239 offset:24576
    ds_read_b64_tr_b16 v[46:47], v239 offset:26624
    ds_read_b64_tr_b16 v[48:49], v240 offset:24576
    ds_read_b64_tr_b16 v[50:51], v240 offset:26624
    ds_read_b64_tr_b16 v[52:53], v241 offset:24576
    ds_read_b64_tr_b16 v[54:55], v241 offset:26624
    ds_read_b64_tr_b16 v[56:57], v238 offset:28672
    ds_read_b64_tr_b16 v[58:59], v239 offset:28672
    ds_read_b64_tr_b16 v[60:61], v240 offset:28672
    ds_read_b64_tr_b16 v[62:63], v241 offset:28672
    s_waitcnt lgkmcnt(0)
    s_waitcnt vmcnt(10)
    s_add_u32 m0, s54, 5120
    s_nop 0
    buffer_load_dwordx4 v237, s[24:27], s55 offen nt lds
    s_waitcnt vmcnt(10)
    s_add_u32 s55, s58, 52
    s_and_b32 s55, s55, 63
    s_mul_i32 s55, s55, 6144
    s_add_u32 s55, s55, 128
    s_add_u32 m0, s54, 6144
    s_nop 0
    buffer_load_dwordx4 v236, s[24:27], s55 offen nt lds
    v_mfma_f32_16x16x32_bf16 v[64:67], v[40:43], v[220:223], v[64:67]
    v_mfma_f32_16x16x32_bf16 v[68:71], v[44:47], v[220:223], v[68:71]
    v_mfma_f32_16x16x32_bf16 v[72:75], v[48:51], v[220:223], v[72:75]
    v_mfma_f32_16x16x32_bf16 v[76:79], v[52:55], v[220:223], v[76:79]
    s_nop 2
    v_mfma_f32_16x16x16_bf16 v[64:67], v[56:57], v[224:225], v[64:67]
    v_mfma_f32_16x16x16_bf16 v[68:71], v[58:59], v[224:225], v[68:71]
    v_mfma_f32_16x16x16_bf16 v[72:75], v[60:61], v[224:225], v[72:75]
    v_mfma_f32_16x16x16_bf16 v[76:79], v[62:63], v[224:225], v[76:79]
    s_branch L_merge
L_grp_2:
    s_add_u32 s55, s58, 0
    s_and_b32 s55, s55, 63
    s_mul_i32 s55, s55, 6144
    s_add_u32 m0, s54, 0
    s_nop 0
    buffer_load_dwordx4 v2, s[20:23], s55 offen nt lds
    s_add_u32 m0, s54, 1024
    s_nop 0
    buffer_load_dwordx4 v3, s[20:23], s55 offen nt lds
    s_add_u32 m0, s54, 2048
    s_nop 0
    buffer_load_dwordx4 v4, s[20:23], s55 offen nt lds
    s_add_u32 m0, s54, 3072
    s_nop 0
    buffer_load_dwordx4 v5, s[20:23], s55 offen nt lds
    s_mov_b32 s70, 0x3d93cd3a
    s_mov_b32 s71, 0x3fb8aa3b
    s_mul_i32 s56, s53, 245760
    s_add_u32 s32, s12, s56
    s_addc_u32 s33, s13, 0
    s_and_b32 s33, s33, 0xffff
    s_mov_b32 s34, 245760
    s_mov_b32 s35, 0x20000
    s_mul_i32 s56, s3, 320
    v_add_u32 v36, 0, v1
    v_mul_u32_u24 v37, 205, v36
    v_lshrrev_b32 v37, 12, v37
    v_mul_u32_u24 v37, 960, v37
    v_lshl_add_u32 v37, v36, 4, v37
    v_add_u32 v14, s56, v37
    v_add_u32 v36, 64, v1
    v_mul_u32_u24 v37, 205, v36
    v_lshrrev_b32 v37, 12, v37
    v_mul_u32_u24 v37, 960, v37
    v_lshl_add_u32 v37, v36, 4, v37
    v_add_u32 v15, s56, v37
    v_add_u32 v36, 128, v1
    v_mul_u32_u24 v37, 205, v36
    v_lshrrev_b32 v37, 12, v37
    v_mul_u32_u24 v37, 960, v37
    v_lshl_add_u32 v37, v36, 4, v37
    v_add_u32 v16, s56, v37
    v_add_u32 v36, 192, v1
    v_mul_u32_u24 v37, 205, v36
    v_lshrrev_b32 v37, 12, v37
    v_mul_u32_u24 v37, 960, v37
    v_lshl_add_u32 v37, v36, 4, v37
    v_add_u32 v17, s56, v37
    v_add_u32 v36, 256, v1
    v_mul_u32_u24 v37, 205, v36
    v_lshrrev_b32 v37, 12, v37
    v_mul_u32_u24 v37, 960, v37
    v_lshl_add_u32 v37, v36, 4, v37
    v_add_u32 v18, s56, v37
    v_and_b32 v36, 15, v1
    v_and_b32 v37, 6, v36
    v_xor_b32 v37, v37, v34
    v_lshlrev_b32 v37, 4, v37
    v_mul_u32_u24 v36, 384, v36
    v_add3_u32 v19, v36, v37, s54
    v_xor_b32 v20, 64, v19
    v_lshrrev_b32 v36, 2, v1
    v_and_b32 v37, 6, v36
    v_lshlrev_b32 v37, 4, v37
    v_lshl_add_u32 v37, v35, 3, v37
    v_mul_u32_u24 v38, 384, v36
    v_add3_u32 v21, v38, v37, s54
    v_xor_b32 v22, 32, v21
    v_xor_b32 v23, 64, v21
    v_xor_b32 v24, 96, v21
    v_mul_u32_u24 v38, 320, v36
    v_lshl_add_u32 v38, v35, 3, v38
    v_add_u32 v25, s54, v38
    v_mul_u32_u24 v36, 784, v35
    v_lshl_add_u32 v36, v34, 4, v36
    v_add_u32 v26, s74, v36
    v_mul_u32_u24 v37, 1366, v0
    v_lshrrev_b32 v37, 16, v37
    v_lshlrev_b32 v37, 4, v37
    v_lshl_add_u32 v36, v0, 4, v37
    v_add_u32 v27, 147456, v36
    v_lshl_add_u32 v36, v0, 3, v37
    v_add_u32 v28, 160000, v36
    v_mul_u32_u24 v36, 400, v35
    v_add_u32 v36, 160000, v36
    v_lshl_add_u32 v29, v34, 4, v36
    v_lshlrev_b32 v36, 6, v35
    v_add_u32 v32, 161600, v36
    s_lshl_b32 s56, s3, 4
    v_lshl_add_u32 v36, v34, 2, v32
    v_add_u32 v31, s56, v36
    v_lshlrev_b32 v30, 4, v1
    s_lshr_b32 s79, s52, 2
    s_mul_i32 s79, s79, 122880
    s_mul_i32 s56, s3, 3072
    s_add_u32 s79, s79, s56
    s_add_u32 s79, s79, 77824
    v_mul_u32_u24 v36, 320, v35
    v_lshl_add_u32 v36, v34, 3, v36
    v_add_u32 v36, s74, v36
    s_waitcnt vmcnt(10)
    v_lshl_add_u32 v37, s60, 5, v36
    ds_read_b64 v[232:233], v37
    v_lshl_add_u32 v37, s61, 5, v36
    ds_read_b64 v[234:235], v37
    v_lshl_add_u32 v37, s62, 5, v36
    ds_read_b64 v[236:237], v37
    v_lshl_add_u32 v37, s63, 5, v36
    ds_read_b64 v[238:239], v37
    v_lshl_add_u32 v37, s64, 5, v36
    ds_read_b64 v[240:241], v37
    v_lshl_add_u32 v37, s65, 5, v36
    ds_read_b64 v[242:243], v37
    v_lshl_add_u32 v37, s66, 5, v36
    ds_read_b64 v[244:245], v37
    v_lshl_add_u32 v37, s67, 5, v36
    ds_read_b64 v[246:247], v37
    v_lshl_add_u32 v37, s68, 5, v36
    ds_read_b64 v[248:249], v37
    v_lshl_add_u32 v37, s69, 5, v36
    ds_read_b64 v[250:251], v37
    s_add_u32 m0, s54, 4096
    s_nop 0
    buffer_load_dwordx4 v6, s[20:23], s55 offen nt lds
    s_add_u32 m0, s54, 5120
    s_nop 0
    buffer_load_dwordx4 v7, s[20:23], s55 offen nt lds
    s_waitcnt vmcnt(11)
    s_add_u32 s55, s58, 4
    s_and_b32 s55, s55, 63
    s_mul_i32 s55, s55, 6144
    s_add_u32 m0, s54, 6144
    s_nop 0
    buffer_load_dwordx4 v2, s[20:23], s55 offen nt lds
    s_waitcnt vmcnt(11)
    s_add_u32 m0, s54, 7168
    s_nop 0
    buffer_load_dwordx4 v3, s[20:23], s55 offen nt lds
    s_waitcnt vmcnt(11)
    s_add_u32 m0, s54, 8192
    s_nop 0
    buffer_load_dwordx4 v4, s[20:23], s55 offen nt lds
    s_waitcnt vmcnt(11)
    s_add_u32 m0, s54, 9216
    s_nop 0
    buffer_load_dwordx4 v5, s[20:23], s55 offen nt lds
    s_waitcnt vmcnt(11)
    s_add_u32 m0, s54, 10240
    s_nop 0
    buffer_load_dwordx4 v6, s[20:23], s55 offen nt lds
    s_waitcnt vmcnt(11)
    s_add_u32 m0, s54, 11264
    s_nop 0
    buffer_load_dwordx4 v7, s[20:23], s55 offen nt lds
    ds_read_b64_tr_b16 v[40:41], v21 offset:24576
    ds_read_b64_tr_b16 v[42:43], v22 offset:24576
    ds_read_b64_tr_b16 v[44:45], v23 offset:24576
    ds_read_b64_tr_b16 v[46:47], v24 offset:24576
    ds_read_b64_tr_b16 v[48:49], v21 offset:24704
    ds_read_b64_tr_b16 v[50:51], v22 offset:24704
    ds_read_b64_tr_b16 v[52:53], v23 offset:24704
    ds_read_b64_tr_b16 v[54:55], v24 offset:24704
    ds_read_b64_tr_b16 v[56:57], v21 offset:24832
    ds_read_b64_tr_b16 v[58:59], v22 offset:24832
    ds_read_b64_tr_b16 v[60:61], v23 offset:24832
    ds_read_b64_tr_b16 v[62:63], v24 offset:24832
    s_waitcnt lgkmcnt(0)
    v_mfma_f32_16x16x16_bf16 v[64:67], v[40:41], v[232:233], 0
    v_mfma_f32_16x16x16_bf16 v[68:71], v[42:43], v[232:233], 0
    v_mfma_f32_16x16x16_bf16 v[72:75], v[44:45], v[232:233], 0
    v_mfma_f32_16x16x16_bf16 v[76:79], v[46:47], v[232:233], 0
    v_mfma_f32_16x16x16_bf16 v[80:83], v[48:49], v[232:233], 0
    v_mfma_f32_16x16x16_bf16 v[84:87], v[50:51], v[232:233], 0
    v_mfma_f32_16x16x16_bf16 v[88:91], v[52:53], v[232:233], 0
    v_mfma_f32_16x16x16_bf16 v[92:95], v[54:55], v[232:233], 0
    v_mfma_f32_16x16x16_bf16 v[96:99], v[56:57], v[232:233], 0
    v_mfma_f32_16x16x16_bf16 v[100:103], v[58:59], v[232:233], 0
    v_mfma_f32_16x16x16_bf16 v[104:107], v[60:61], v[232:233], 0
    v_mfma_f32_16x16x16_bf16 v[108:111], v[62:63], v[232:233], 0
    s_waitcnt vmcnt(11)
    s_add_u32 s55, s58, 8
    s_and_b32 s55, s55, 63
    s_mul_i32 s55, s55, 6144
    s_add_u32 m0, s54, 12288
    s_nop 0
    buffer_load_dwordx4 v2, s[20:23], s55 offen nt lds
    s_waitcnt vmcnt(11)
    s_add_u32 m0, s54, 13312
    s_nop 0
    buffer_load_dwordx4 v3, s[20:23], s55 offen nt lds
    s_waitcnt vmcnt(11)
    s_add_u32 m0, s54, 14336
    s_nop 0
    buffer_load_dwordx4 v4, s[20:23], s55 offen nt lds
    s_waitcnt vmcnt(11)
    s_add_u32 m0, s54, 15360
    s_nop 0
    buffer_load_dwordx4 v5, s[20:23], s55 offen nt lds
    s_waitcnt vmcnt(11)
    s_add_u32 m0, s54, 16384
    s_nop 0
    buffer_load_dwordx4 v6, s[20:23], s55 offen nt lds
    s_waitcnt vmcnt(11)
    s_add_u32 m0, s54, 17408
    s_nop 0
    buffer_load_dwordx4 v7, s[20:23], s55 offen nt lds
    s_waitcnt vmcnt(11)
    s_add_u32 s55, s58, 12
    s_and_b32 s55, s55, 63
    s_mul_i32 s55, s55, 6144
    s_add_u32 m0, s54, 18432
    s_nop 0
    buffer_load_dwordx4 v2, s[20:23], s55 offen nt lds
    s_waitcnt vmcnt(11)
    s_add_u32 m0, s54, 19456
    s_nop 0
    buffer_load_dwordx4 v3, s[20:23], s55 offen nt lds
    s_waitcnt vmcnt(11)
    s_add_u32 m0, s54, 20480
    s_nop 0
    buffer_load_dwordx4 v4, s[20:23], s55 offen nt lds
    s_waitcnt vmcnt(11)
    s_add_u32 m0, s54, 21504
    s_nop 0
    buffer_load_dwordx4 v5, s[20:23], s55 offen nt lds
    s_waitcnt vmcnt(11)
    s_add_u32 m0, s54, 22528
    s_nop 0
    buffer_load_dwordx4 v6, s[20:23], s55 offen nt lds
    s_waitcnt vmcnt(11)
    s_add_u32 m0, s54, 23552
    s_nop 0
    buffer_load_dwordx4 v7, s[20:23], s55 offen nt lds
    s_waitcnt vmcnt(11)
    s_add_u32 s55, s58, 16
    s_and_b32 s55, s55, 63
    s_mul_i32 s55, s55, 6144
    buffer_load_dwordx4 a[216:219], v2, s[20:23], s55 offen nt
    s_waitcnt vmcnt(11)
    buffer_load_dwordx4 a[220:223], v3, s[20:23], s55 offen nt
    s_waitcnt vmcnt(11)
    buffer_load_dwordx4 a[224:227], v4, s[20:23], s55 offen nt
    s_waitcnt vmcnt(11)
    buffer_load_dwordx4 a[228:231], v5, s[20:23], s55 offen nt
    s_waitcnt vmcnt(11)
    buffer_load_dwordx4 a[232:235], v6, s[20:23], s55 offen nt
    s_waitcnt vmcnt(11)
    buffer_load_dwordx4 a[236:239], v7, s[20:23], s55 offen nt
    s_waitcnt vmcnt(11)
    s_add_u32 s55, s58, 20
    s_and_b32 s55, s55, 63
    s_mul_i32 s55, s55, 6144
    buffer_load_dwordx4 a[192:195], v2, s[20:23], s55 offen nt
    s_waitcnt vmcnt(11)
    buffer_load_dwordx4 a[196:199], v3, s[20:23], s55 offen nt
    s_waitcnt vmcnt(11)
    buffer_load_dwordx4 a[200:203], v4, s[20:23], s55 offen nt
    s_waitcnt vmcnt(11)
    buffer_load_dwordx4 a[204:207], v5, s[20:23], s55 offen nt
    s_waitcnt vmcnt(11)
    buffer_load_dwordx4 a[208:211], v6, s[20:23], s55 offen nt
    s_waitcnt vmcnt(11)
    buffer_load_dwordx4 a[212:215], v7, s[20:23], s55 offen nt
    s_waitcnt vmcnt(11)
    s_branch L_page_4
    .p2align 12
L_page_4:
    s_add_u32 s55, s58, 24
    s_and_b32 s55, s55, 63
    s_mul_i32 s55, s55, 6144
    buffer_load_dwordx4 a[168:171], v2, s[20:23], s55 offen nt
    s_waitcnt vmcnt(11)
    buffer_load_dwordx4 a[172:175], v3, s[20:23], s55 offen nt
    s_waitcnt vmcnt(11)
    buffer_load_dwordx4 a[176:179], v4, s[20:23], s55 offen nt
    s_waitcnt vmcnt(11)
    buffer_load_dwordx4 a[180:183], v5, s[20:23], s55 offen nt
    s_waitcnt vmcnt(11)
    buffer_load_dwordx4 a[184:187], v6, s[20:23], s55 offen nt
    s_waitcnt vmcnt(11)
    buffer_load_dwordx4 a[188:191], v7, s[20:23], s55 offen nt
    s_waitcnt vmcnt(11)
    s_mul_i32 s55, s61, 196608
    s_add_u32 s55, s55, s59
    s_add_u32 m0, s54, 30720
    s_nop 0
    buffer_load_dwordx4 v8, s[28:31], s55 offen  lds
    s_waitcnt vmcnt(11)
    s_add_u32 m0, s54, 31744
    s_nop 0
    buffer_load_dwordx4 v9, s[28:31], s55 offen  lds
    s_waitcnt vmcnt(11)
    s_add_u32 m0, s54, 32768
    s_nop 0
    buffer_load_dwordx4 v10, s[28:31], s55 offen  lds
    s_waitcnt vmcnt(11)
    s_add_u32 m0, s54, 33792
    s_nop 0
    buffer_load_dwordx4 v11, s[28:31], s55 offen  lds
    s_waitcnt vmcnt(11)
    s_add_u32 m0, s54, 34816
    s_nop 0
    buffer_load_dwordx4 v12, s[28:31], s55 offen  lds
    s_waitcnt vmcnt(11)
    s_add_u32 m0, s54, 35840
    s_nop 0
    buffer_load_dwordx4 v13, s[28:31], s55 offen  lds
    s_waitcnt vmcnt(11)
    s_mul_i32 s55, s62, 196608
    s_add_u32 s55, s55, s59
    s_add_u32 m0, s54, 24576
    s_nop 0
    buffer_load_dwordx4 v8, s[28:31], s55 offen  lds
    s_waitcnt vmcnt(11)
    s_add_u32 m0, s54, 25600
    s_nop 0
    buffer_load_dwordx4 v9, s[28:31], s55 offen  lds
    s_waitcnt vmcnt(11)
    s_add_u32 m0, s54, 26624
    s_nop 0
    buffer_load_dwordx4 v10, s[28:31], s55 offen  lds
    s_waitcnt vmcnt(11)
    s_add_u32 m0, s54, 27648
    s_nop 0
    buffer_load_dwordx4 v11, s[28:31], s55 offen  lds
    s_waitcnt vmcnt(11)
    s_add_u32 m0, s54, 28672
    s_nop 0
    buffer_load_dwordx4 v12, s[28:31], s55 offen  lds
    s_waitcnt vmcnt(11)
    s_add_u32 m0, s54, 29696
    s_nop 0
    buffer_load_dwordx4 v13, s[28:31], s55 offen  lds
    s_waitcnt vmcnt(6)
    ds_read_b64_tr_b16 v[40:41], v21 offset:30720
    ds_read_b64_tr_b16 v[42:43], v22 offset:30720
    ds_read_b64_tr_b16 v[44:45], v23 offset:30720
    ds_read_b64_tr_b16 v[46:47], v24 offset:30720
    ds_read_b64_tr_b16 v[48:49], v21 offset:30848
    ds_read_b64_tr_b16 v[50:51], v22 offset:30848
    ds_read_b64_tr_b16 v[52:53], v23 offset:30848
    ds_read_b64_tr_b16 v[54:55], v24 offset:30848
    ds_read_b64_tr_b16 v[56:57], v21 offset:30976
    ds_read_b64_tr_b16 v[58:59], v22 offset:30976
    ds_read_b64_tr_b16 v[60:61], v23 offset:30976
    ds_read_b64_tr_b16 v[62:63], v24 offset:30976
    s_waitcnt lgkmcnt(0)
    s_mul_i32 s55, s63, 196608
    s_add_u32 s55, s55, s59
    s_add_u32 m0, s54, 30720
    s_nop 0
    buffer_load_dwordx4 v8, s[28:31], s55 offen  lds
    s_add_u32 m0, s54, 31744
    s_nop 0
    buffer_load_dwordx4 v9, s[28:31], s55 offen  lds
    s_add_u32 m0, s54, 32768
    s_nop 0
    buffer_load_dwordx4 v10, s[28:31], s55 offen  lds
    s_add_u32 m0, s54, 33792
    s_nop 0
    buffer_load_dwordx4 v11, s[28:31], s55 offen  lds
    s_add_u32 m0, s54, 34816
    s_nop 0
    buffer_load_dwordx4 v12, s[28:31], s55 offen  lds
    s_add_u32 m0, s54, 35840
    s_nop 0
    buffer_load_dwordx4 v13, s[28:31], s55 offen  lds
    v_mfma_f32_16x16x16_bf16 v[64:67], v[40:41], v[234:235], v[64:67]
    v_mfma_f32_16x16x16_bf16 v[68:71], v[42:43], v[234:235], v[68:71]
    v_mfma_f32_16x16x16_bf16 v[72:75], v[44:45], v[234:235], v[72:75]
    v_mfma_f32_16x16x16_bf16 v[76:79], v[46:47], v[234:235], v[76:79]
    v_mfma_f32_16x16x16_bf16 v[80:83], v[48:49], v[234:235], v[80:83]
    v_mfma_f32_16x16x16_bf16 v[84:87], v[50:51], v[234:235], v[84:87]
    v_mfma_f32_16x16x16_bf16 v[88:91], v[52:53], v[234:235], v[88:91]
    v_mfma_f32_16x16x16_bf16 v[92:95], v[54:55], v[234:235], v[92:95]
    v_mfma_f32_16x16x16_bf16 v[96:99], v[56:57], v[234:235], v[96:99]
    v_mfma_f32_16x16x16_bf16 v[100:103], v[58:59], v[234:235], v[100:103]
    v_mfma_f32_16x16x16_bf16 v[104:107], v[60:61], v[234:235], v[104:107]
    v_mfma_f32_16x16x16_bf16 v[108:111], v[62:63], v[234:235], v[108:111]
    s_waitcnt vmcnt(6)
    ds_read_b64_tr_b16 v[40:41], v21 offset:24576
    ds_read_b64_tr_b16 v[42:43], v22 offset:24576
    ds_read_b64_tr_b16 v[44:45], v23 offset:24576
    ds_read_b64_tr_b16 v[46:47], v24 offset:24576
    ds_read_b64_tr_b16 v[48:49], v21 offset:24704
    ds_read_b64_tr_b16 v[50:51], v22 offset:24704
    ds_read_b64_tr_b16 v[52:53], v23 offset:24704
    ds_read_b64_tr_b16 v[54:55], v24 offset:24704
    ds_read_b64_tr_b16 v[56:57], v21 offset:24832
    ds_read_b64_tr_b16 v[58:59], v22 offset:24832
    ds_read_b64_tr_b16 v[60:61], v23 offset:24832
    ds_read_b64_tr_b16 v[62:63], v24 offset:24832
    s_waitcnt lgkmcnt(0)
    s_mul_i32 s55, s64, 196608
    s_add_u32 s55, s55, s59
    s_add_u32 m0, s54, 24576
    s_nop 0
    buffer_load_dwordx4 v8, s[28:31], s55 offen  lds
    s_add_u32 m0, s54, 25600
    s_nop 0
    buffer_load_dwordx4 v9, s[28:31], s55 offen  lds
    s_add_u32 m0, s54, 26624
    s_nop 0
    buffer_load_dwordx4 v10, s[28:31], s55 offen  lds
    s_add_u32 m0, s54, 27648
    s_nop 0
    buffer_load_dwordx4 v11, s[28:31], s55 offen  lds
    s_add_u32 m0, s54, 28672
    s_nop 0
    buffer_load_dwordx4 v12, s[28:31], s55 offen  lds
    s_add_u32 m0, s54, 29696
    s_nop 0
    buffer_load_dwordx4 v13, s[28:31], s55 offen  lds
    v_mfma_f32_16x16x16_bf16 v[64:67], v[40:41], v[236:237], v[64:67]
    v_mfma_f32_16x16x16_bf16 v[68:71], v[42:43], v[236:237], v[68:71]
    v_mfma_f32_16x16x16_bf16 v[72:75], v[44:45], v[236:237], v[72:75]
    v_mfma_f32_16x16x16_bf16 v[76:79], v[46:47], v[236:237], v[76:79]
    v_mfma_f32_16x16x16_bf16 v[80:83], v[48:49], v[236:237], v[80:83]
    v_mfma_f32_16x16x16_bf16 v[84:87], v[50:51], v[236:237], v[84:87]
    v_mfma_f32_16x16x16_bf16 v[88:91], v[52:53], v[236:237], v[88:91]
    v_mfma_f32_16x16x16_bf16 v[92:95], v[54:55], v[236:237], v[92:95]
    v_mfma_f32_16x16x16_bf16 v[96:99], v[56:57], v[236:237], v[96:99]
    v_mfma_f32_16x16x16_bf16 v[100:103], v[58:59], v[236:237], v[100:103]
    v_mfma_f32_16x16x16_bf16 v[104:107], v[60:61], v[236:237], v[104:107]
    v_mfma_f32_16x16x16_bf16 v[108:111], v[62:63], v[236:237], v[108:111]
    s_waitcnt vmcnt(6)
    ds_read_b64_tr_b16 v[40:41], v21 offset:30720
    ds_read_b64_tr_b16 v[42:43], v22 offset:30720
    ds_read_b64_tr_b16 v[44:45], v23 offset:30720
    ds_read_b64_tr_b16 v[46:47], v24 offset:30720
    ds_read_b64_tr_b16 v[48:49], v21 offset:30848
    ds_read_b64_tr_b16 v[50:51], v22 offset:30848
    ds_read_b64_tr_b16 v[52:53], v23 offset:30848
    ds_read_b64_tr_b16 v[54:55], v24 offset:30848
    ds_read_b64_tr_b16 v[56:57], v21 offset:30976
    ds_read_b64_tr_b16 v[58:59], v22 offset:30976
    ds_read_b64_tr_b16 v[60:61], v23 offset:30976
    ds_read_b64_tr_b16 v[62:63], v24 offset:30976
    s_waitcnt lgkmcnt(0)
    s_mul_i32 s55, s65, 196608
    s_add_u32 s55, s55, s59
    s_add_u32 m0, s54, 30720
    s_nop 0
    buffer_load_dwordx4 v8, s[28:31], s55 offen  lds
    s_add_u32 m0, s54, 31744
    s_nop 0
    buffer_load_dwordx4 v9, s[28:31], s55 offen  lds
    s_add_u32 m0, s54, 32768
    s_nop 0
    buffer_load_dwordx4 v10, s[28:31], s55 offen  lds
    s_add_u32 m0, s54, 33792
    s_nop 0
    buffer_load_dwordx4 v11, s[28:31], s55 offen  lds
    s_add_u32 m0, s54, 34816
    s_nop 0
    buffer_load_dwordx4 v12, s[28:31], s55 offen  lds
    s_add_u32 m0, s54, 35840
    s_nop 0
    buffer_load_dwordx4 v13, s[28:31], s55 offen  lds
    v_mfma_f32_16x16x16_bf16 v[64:67], v[40:41], v[238:239], v[64:67]
    v_mfma_f32_16x16x16_bf16 v[68:71], v[42:43], v[238:239], v[68:71]
    v_mfma_f32_16x16x16_bf16 v[72:75], v[44:45], v[238:239], v[72:75]
    v_mfma_f32_16x16x16_bf16 v[76:79], v[46:47], v[238:239], v[76:79]
    v_mfma_f32_16x16x16_bf16 v[80:83], v[48:49], v[238:239], v[80:83]
    v_mfma_f32_16x16x16_bf16 v[84:87], v[50:51], v[238:239], v[84:87]
    v_mfma_f32_16x16x16_bf16 v[88:91], v[52:53], v[238:239], v[88:91]
    v_mfma_f32_16x16x16_bf16 v[92:95], v[54:55], v[238:239], v[92:95]
    v_mfma_f32_16x16x16_bf16 v[96:99], v[56:57], v[238:239], v[96:99]
    v_mfma_f32_16x16x16_bf16 v[100:103], v[58:59], v[238:239], v[100:103]
    v_mfma_f32_16x16x16_bf16 v[104:107], v[60:61], v[238:239], v[104:107]
    v_mfma_f32_16x16x16_bf16 v[108:111], v[62:63], v[238:239], v[108:111]
    s_waitcnt vmcnt(6)
    ds_read_b64_tr_b16 v[40:41], v21 offset:24576
    ds_read_b64_tr_b16 v[42:43], v22 offset:24576
    ds_read_b64_tr_b16 v[44:45], v23 offset:24576
    ds_read_b64_tr_b16 v[46:47], v24 offset:24576
    ds_read_b64_tr_b16 v[48:49], v21 offset:24704
    ds_read_b64_tr_b16 v[50:51], v22 offset:24704
    ds_read_b64_tr_b16 v[52:53], v23 offset:24704
    ds_read_b64_tr_b16 v[54:55], v24 offset:24704
    ds_read_b64_tr_b16 v[56:57], v21 offset:24832
    ds_read_b64_tr_b16 v[58:59], v22 offset:24832
    ds_read_b64_tr_b16 v[60:61], v23 offset:24832
    ds_read_b64_tr_b16 v[62:63], v24 offset:24832
    s_waitcnt lgkmcnt(0)
    s_mul_i32 s55, s66, 196608
    s_add_u32 s55, s55, s59
    s_add_u32 m0, s54, 24576
    s_nop 0
    buffer_load_dwordx4 v8, s[28:31], s55 offen  lds
    s_add_u32 m0, s54, 25600
    s_nop 0
    buffer_load_dwordx4 v9, s[28:31], s55 offen  lds
    s_add_u32 m0, s54, 26624
    s_nop 0
    buffer_load_dwordx4 v10, s[28:31], s55 offen  lds
    s_add_u32 m0, s54, 27648
    s_nop 0
    buffer_load_dwordx4 v11, s[28:31], s55 offen  lds
    s_add_u32 m0, s54, 28672
    s_nop 0
    buffer_load_dwordx4 v12, s[28:31], s55 offen  lds
    s_add_u32 m0, s54, 29696
    s_nop 0
    buffer_load_dwordx4 v13, s[28:31], s55 offen  lds
    v_mfma_f32_16x16x16_bf16 v[64:67], v[40:41], v[240:241], v[64:67]
    v_mfma_f32_16x16x16_bf16 v[68:71], v[42:43], v[240:241], v[68:71]
    v_mfma_f32_16x16x16_bf16 v[72:75], v[44:45], v[240:241], v[72:75]
    v_mfma_f32_16x16x16_bf16 v[76:79], v[46:47], v[240:241], v[76:79]
    v_mfma_f32_16x16x16_bf16 v[80:83], v[48:49], v[240:241], v[80:83]
    v_mfma_f32_16x16x16_bf16 v[84:87], v[50:51], v[240:241], v[84:87]
    v_mfma_f32_16x16x16_bf16 v[88:91], v[52:53], v[240:241], v[88:91]
    v_mfma_f32_16x16x16_bf16 v[92:95], v[54:55], v[240:241], v[92:95]
    v_mfma_f32_16x16x16_bf16 v[96:99], v[56:57], v[240:241], v[96:99]
    v_mfma_f32_16x16x16_bf16 v[100:103], v[58:59], v[240:241], v[100:103]
    v_mfma_f32_16x16x16_bf16 v[104:107], v[60:61], v[240:241], v[104:107]
    v_mfma_f32_16x16x16_bf16 v[108:111], v[62:63], v[240:241], v[108:111]
    s_waitcnt vmcnt(6)
    ds_read_b64_tr_b16 v[40:41], v21 offset:30720
    ds_read_b64_tr_b16 v[42:43], v22 offset:30720
    ds_read_b64_tr_b16 v[44:45], v23 offset:30720
    ds_read_b64_tr_b16 v[46:47], v24 offset:30720
    ds_read_b64_tr_b16 v[48:49], v21 offset:30848
    ds_read_b64_tr_b16 v[50:51], v22 offset:30848
    ds_read_b64_tr_b16 v[52:53], v23 offset:30848
    ds_read_b64_tr_b16 v[54:55], v24 offset:30848
    ds_read_b64_tr_b16 v[56:57], v21 offset:30976
    ds_read_b64_tr_b16 v[58:59], v22 offset:30976
    ds_read_b64_tr_b16 v[60:61], v23 offset:30976
    ds_read_b64_tr_b16 v[62:63], v24 offset:30976
    s_waitcnt lgkmcnt(0)
    s_mul_i32 s55, s67, 196608
    s_add_u32 s55, s55, s59
    s_add_u32 m0, s54, 30720
    s_nop 0
    buffer_load_dwordx4 v8, s[28:31], s55 offen  lds
    s_add_u32 m0, s54, 31744
    s_nop 0
    buffer_load_dwordx4 v9, s[28:31], s55 offen  lds
    s_add_u32 m0, s54, 32768
    s_nop 0
    buffer_load_dwordx4 v10, s[28:31], s55 offen  lds
    s_add_u32 m0, s54, 33792
    s_nop 0
    buffer_load_dwordx4 v11, s[28:31], s55 offen  lds
    s_add_u32 m0, s54, 34816
    s_nop 0
    buffer_load_dwordx4 v12, s[28:31], s55 offen  lds
    s_add_u32 m0, s54, 35840
    s_nop 0
    buffer_load_dwordx4 v13, s[28:31], s55 offen  lds
    v_mfma_f32_16x16x16_bf16 v[64:67], v[40:41], v[242:243], v[64:67]
    v_mfma_f32_16x16x16_bf16 v[68:71], v[42:43], v[242:243], v[68:71]
    v_mfma_f32_16x16x16_bf16 v[72:75], v[44:45], v[242:243], v[72:75]
    v_mfma_f32_16x16x16_bf16 v[76:79], v[46:47], v[242:243], v[76:79]
    v_mfma_f32_16x16x16_bf16 v[80:83], v[48:49], v[242:243], v[80:83]
    v_mfma_f32_16x16x16_bf16 v[84:87], v[50:51], v[242:243], v[84:87]
    v_mfma_f32_16x16x16_bf16 v[88:91], v[52:53], v[242:243], v[88:91]
    v_mfma_f32_16x16x16_bf16 v[92:95], v[54:55], v[242:243], v[92:95]
    v_mfma_f32_16x16x16_bf16 v[96:99], v[56:57], v[242:243], v[96:99]
    v_mfma_f32_16x16x16_bf16 v[100:103], v[58:59], v[242:243], v[100:103]
    v_mfma_f32_16x16x16_bf16 v[104:107], v[60:61], v[242:243], v[104:107]
    v_mfma_f32_16x16x16_bf16 v[108:111], v[62:63], v[242:243], v[108:111]
    s_waitcnt vmcnt(6)
    ds_read_b64_tr_b16 v[40:41], v21 offset:24576
    ds_read_b64_tr_b16 v[42:43], v22 offset:24576
    ds_read_b64_tr_b16 v[44:45], v23 offset:24576
    ds_read_b64_tr_b16 v[46:47], v24 offset:24576
    ds_read_b64_tr_b16 v[48:49], v21 offset:24704
    ds_read_b64_tr_b16 v[50:51], v22 offset:24704
    ds_read_b64_tr_b16 v[52:53], v23 offset:24704
    ds_read_b64_tr_b16 v[54:55], v24 offset:24704
    ds_read_b64_tr_b16 v[56:57], v21 offset:24832
    ds_read_b64_tr_b16 v[58:59], v22 offset:24832
    ds_read_b64_tr_b16 v[60:61], v23 offset:24832
    ds_read_b64_tr_b16 v[62:63], v24 offset:24832
    s_waitcnt lgkmcnt(0)
    s_mul_i32 s55, s68, 196608
    s_add_u32 s55, s55, s59
    s_add_u32 m0, s54, 24576
    s_nop 0
    buffer_load_dwordx4 v8, s[28:31], s55 offen  lds
    s_add_u32 m0, s54, 25600
    s_nop 0
    buffer_load_dwordx4 v9, s[28:31], s55 offen  lds
    s_add_u32 m0, s54, 26624
    s_nop 0
    buffer_load_dwordx4 v10, s[28:31], s55 offen  lds
    s_add_u32 m0, s54, 27648
    s_nop 0
    buffer_load_dwordx4 v11, s[28:31], s55 offen  lds
    s_add_u32 m0, s54, 28672
    s_nop 0
    buffer_load_dwordx4 v12, s[28:31], s55 offen  lds
    s_add_u32 m0, s54, 29696
    s_nop 0
    buffer_load_dwordx4 v13, s[28:31], s55 offen  lds
    v_mfma_f32_16x16x16_bf16 v[64:67], v[40:41], v[244:245], v[64:67]
    v_mfma_f32_16x16x16_bf16 v[68:71], v[42:43], v[244:245], v[68:71]
    v_mfma_f32_16x16x16_bf16 v[72:75], v[44:45], v[244:245], v[72:75]
    v_mfma_f32_16x16x16_bf16 v[76:79], v[46:47], v[244:245], v[76:79]
    v_mfma_f32_16x16x16_bf16 v[80:83], v[48:49], v[244:245], v[80:83]
    v_mfma_f32_16x16x16_bf16 v[84:87], v[50:51], v[244:245], v[84:87]
    v_mfma_f32_16x16x16_bf16 v[88:91], v[52:53], v[244:245], v[88:91]
    v_mfma_f32_16x16x16_bf16 v[92:95], v[54:55], v[244:245], v[92:95]
    v_mfma_f32_16x16x16_bf16 v[96:99], v[56:57], v[244:245], v[96:99]
    v_mfma_f32_16x16x16_bf16 v[100:103], v[58:59], v[244:245], v[100:103]
    v_mfma_f32_16x16x16_bf16 v[104:107], v[60:61], v[244:245], v[104:107]
    v_mfma_f32_16x16x16_bf16 v[108:111], v[62:63], v[244:245], v[108:111]
    s_waitcnt vmcnt(6)
    ds_read_b64_tr_b16 v[40:41], v21 offset:30720
    ds_read_b64_tr_b16 v[42:43], v22 offset:30720
    ds_read_b64_tr_b16 v[44:45], v23 offset:30720
    ds_read_b64_tr_b16 v[46:47], v24 offset:30720
    ds_read_b64_tr_b16 v[48:49], v21 offset:30848
    ds_read_b64_tr_b16 v[50:51], v22 offset:30848
    ds_read_b64_tr_b16 v[52:53], v23 offset:30848
    ds_read_b64_tr_b16 v[54:55], v24 offset:30848
    ds_read_b64_tr_b16 v[56:57], v21 offset:30976
    ds_read_b64_tr_b16 v[58:59], v22 offset:30976
    ds_read_b64_tr_b16 v[60:61], v23 offset:30976
    ds_read_b64_tr_b16 v[62:63], v24 offset:30976
    s_waitcnt lgkmcnt(0)
    s_mul_i32 s55, s69, 196608
    s_add_u32 s55, s55, s59
    s_add_u32 m0, s54, 30720
    s_nop 0
    buffer_load_dwordx4 v8, s[28:31], s55 offen  lds
    s_add_u32 m0, s54, 31744
    s_nop 0
    buffer_load_dwordx4 v9, s[28:31], s55 offen  lds
    s_add_u32 m0, s54, 32768
    s_nop 0
    buffer_load_dwordx4 v10, s[28:31], s55 offen  lds
    s_add_u32 m0, s54, 33792
    s_nop 0
    buffer_load_dwordx4 v11, s[28:31], s55 offen  lds
    s_add_u32 m0, s54, 34816
    s_nop 0
    buffer_load_dwordx4 v12, s[28:31], s55 offen  lds
    s_add_u32 m0, s54, 35840
    s_nop 0
    buffer_load_dwordx4 v13, s[28:31], s55 offen  lds
    v_mfma_f32_16x16x16_bf16 v[64:67], v[40:41], v[246:247], v[64:67]
    v_mfma_f32_16x16x16_bf16 v[68:71], v[42:43], v[246:247], v[68:71]
    v_mfma_f32_16x16x16_bf16 v[72:75], v[44:45], v[246:247], v[72:75]
    v_mfma_f32_16x16x16_bf16 v[76:79], v[46:47], v[246:247], v[76:79]
    v_mfma_f32_16x16x16_bf16 v[80:83], v[48:49], v[246:247], v[80:83]
    v_mfma_f32_16x16x16_bf16 v[84:87], v[50:51], v[246:247], v[84:87]
    v_mfma_f32_16x16x16_bf16 v[88:91], v[52:53], v[246:247], v[88:91]
    v_mfma_f32_16x16x16_bf16 v[92:95], v[54:55], v[246:247], v[92:95]
    v_mfma_f32_16x16x16_bf16 v[96:99], v[56:57], v[246:247], v[96:99]
    v_mfma_f32_16x16x16_bf16 v[100:103], v[58:59], v[246:247], v[100:103]
    v_mfma_f32_16x16x16_bf16 v[104:107], v[60:61], v[246:247], v[104:107]
    v_mfma_f32_16x16x16_bf16 v[108:111], v[62:63], v[246:247], v[108:111]
    s_waitcnt vmcnt(11)
    s_add_u32 s55, s58, 28
    s_and_b32 s55, s55, 63
    s_mul_i32 s55, s55, 6144
    buffer_load_dwordx4 a[144:147], v2, s[20:23], s55 offen nt
    s_waitcnt vmcnt(11)
    buffer_load_dwordx4 a[148:151], v3, s[20:23], s55 offen nt
    s_waitcnt vmcnt(11)
    buffer_load_dwordx4 a[152:155], v4, s[20:23], s55 offen nt
    s_waitcnt vmcnt(11)
    buffer_load_dwordx4 a[156:159], v5, s[20:23], s55 offen nt
    s_waitcnt vmcnt(11)
    buffer_load_dwordx4 a[160:163], v6, s[20:23], s55 offen nt
    s_waitcnt vmcnt(11)
    buffer_load_dwordx4 a[164:167], v7, s[20:23], s55 offen nt
    ds_read_b64_tr_b16 v[40:41], v21 offset:24576
    ds_read_b64_tr_b16 v[42:43], v22 offset:24576
    ds_read_b64_tr_b16 v[44:45], v23 offset:24576
    ds_read_b64_tr_b16 v[46:47], v24 offset:24576
    ds_read_b64_tr_b16 v[48:49], v21 offset:24704
    ds_read_b64_tr_b16 v[50:51], v22 offset:24704
    ds_read_b64_tr_b16 v[52:53], v23 offset:24704
    ds_read_b64_tr_b16 v[54:55], v24 offset:24704
    ds_read_b64_tr_b16 v[56:57], v21 offset:24832
    ds_read_b64_tr_b16 v[58:59], v22 offset:24832
    ds_read_b64_tr_b16 v[60:61], v23 offset:24832
    ds_read_b64_tr_b16 v[62:63], v24 offset:24832
    s_waitcnt lgkmcnt(0)
    v_mfma_f32_16x16x16_bf16 v[64:67], v[40:41], v[248:249], v[64:67]
    v_mfma_f32_16x16x16_bf16 v[68:71], v[42:43], v[248:249], v[68:71]
    v_mfma_f32_16x16x16_bf16 v[72:75], v[44:45], v[248:249], v[72:75]
    v_mfma_f32_16x16x16_bf16 v[76:79], v[46:47], v[248:249], v[76:79]
    v_mfma_f32_16x16x16_bf16 v[80:83], v[48:49], v[248:249], v[80:83]
    v_mfma_f32_16x16x16_bf16 v[84:87], v[50:51], v[248:249], v[84:87]
    v_mfma_f32_16x16x16_bf16 v[88:91], v[52:53], v[248:249], v[88:91]
    v_mfma_f32_16x16x16_bf16 v[92:95], v[54:55], v[248:249], v[92:95]
    v_mfma_f32_16x16x16_bf16 v[96:99], v[56:57], v[248:249], v[96:99]
    v_mfma_f32_16x16x16_bf16 v[100:103], v[58:59], v[248:249], v[100:103]
    v_mfma_f32_16x16x16_bf16 v[104:107], v[60:61], v[248:249], v[104:107]
    v_mfma_f32_16x16x16_bf16 v[108:111], v[62:63], v[248:249], v[108:111]
    s_waitcnt vmcnt(11)
    s_add_u32 s55, s58, 32
    s_and_b32 s55, s55, 63
    s_mul_i32 s55, s55, 6144
    buffer_load_dwordx4 a[120:123], v2, s[20:23], s55 offen nt
    s_waitcnt vmcnt(11)
    buffer_load_dwordx4 a[124:127], v3, s[20:23], s55 offen nt
    s_waitcnt vmcnt(11)
    buffer_load_dwordx4 a[128:131], v4, s[20:23], s55 offen nt
    s_waitcnt vmcnt(11)
    buffer_load_dwordx4 a[132:135], v5, s[20:23], s55 offen nt
    s_waitcnt vmcnt(11)
    buffer_load_dwordx4 a[136:139], v6, s[20:23], s55 offen nt
    s_waitcnt vmcnt(11)
    buffer_load_dwordx4 a[140:143], v7, s[20:23], s55 offen nt
    ds_read_b64_tr_b16 v[40:41], v21 offset:30720
    ds_read_b64_tr_b16 v[42:43], v22 offset:30720
    ds_read_b64_tr_b16 v[44:45], v23 offset:30720
    ds_read_b64_tr_b16 v[46:47], v24 offset:30720
    ds_read_b64_tr_b16 v[48:49], v21 offset:30848
    ds_read_b64_tr_b16 v[50:51], v22 offset:30848
    ds_read_b64_tr_b16 v[52:53], v23 offset:30848
    ds_read_b64_tr_b16 v[54:55], v24 offset:30848
    ds_read_b64_tr_b16 v[56:57], v21 offset:30976
    ds_read_b64_tr_b16 v[58:59], v22 offset:30976
    ds_read_b64_tr_b16 v[60:61], v23 offset:30976
    ds_read_b64_tr_b16 v[62:63], v24 offset:30976
    s_waitcnt lgkmcnt(0)
    v_mfma_f32_16x16x16_bf16 v[64:67], v[40:41], v[250:251], v[64:67]
    v_mfma_f32_16x16x16_bf16 v[68:71], v[42:43], v[250:251], v[68:71]
    v_mfma_f32_16x16x16_bf16 v[72:75], v[44:45], v[250:251], v[72:75]
    v_mfma_f32_16x16x16_bf16 v[76:79], v[46:47], v[250:251], v[76:79]
    v_mfma_f32_16x16x16_bf16 v[80:83], v[48:49], v[250:251], v[80:83]
    v_mfma_f32_16x16x16_bf16 v[84:87], v[50:51], v[250:251], v[84:87]
    v_mfma_f32_16x16x16_bf16 v[88:91], v[52:53], v[250:251], v[88:91]
    v_mfma_f32_16x16x16_bf16 v[92:95], v[54:55], v[250:251], v[92:95]
    v_mfma_f32_16x16x16_bf16 v[96:99], v[56:57], v[250:251], v[96:99]
    v_mfma_f32_16x16x16_bf16 v[100:103], v[58:59], v[250:251], v[100:103]
    v_mfma_f32_16x16x16_bf16 v[104:107], v[60:61], v[250:251], v[104:107]
    v_mfma_f32_16x16x16_bf16 v[108:111], v[62:63], v[250:251], v[108:111]
    s_mov_b32 exec_lo, 0x000f000f
    s_mov_b32 exec_hi, 0x000f000f
    ds_write_b128 v26, v[64:67] offset:0
    ds_write_b128 v26, v[68:71] offset:64
    ds_write_b128 v26, v[72:75] offset:128
    ds_write_b128 v26, v[76:79] offset:192
    ds_write_b128 v26, v[80:83] offset:256
    ds_write_b128 v26, v[84:87] offset:320
    ds_write_b128 v26, v[88:91] offset:384
    ds_write_b128 v26, v[92:95] offset:448
    ds_write_b128 v26, v[96:99] offset:512
    ds_write_b128 v26, v[100:103] offset:576
    ds_write_b128 v26, v[104:107] offset:640
    ds_write_b128 v26, v[108:111] offset:704
    s_mov_b64 exec, -1
    s_waitcnt lgkmcnt(0)
    s_barrier
    s_cmp_eq_u32 s3, 3
    s_cbranch_scc1 L_qred_2
    ds_read_b128 v[40:43], v27 offset:0
    ds_read_b128 v[44:47], v27 offset:3136
    ds_read_b128 v[48:51], v27 offset:6272
    ds_read_b128 v[52:55], v27 offset:9408
    s_waitcnt lgkmcnt(0)
    v_add_f32 v40, v40, v44
    v_add_f32 v41, v41, v45
    v_add_f32 v42, v42, v46
    v_add_f32 v43, v43, v47
    v_add_f32 v48, v48, v52
    v_add_f32 v49, v49, v53
    v_add_f32 v50, v50, v54
    v_add_f32 v51, v51, v55
    v_add_f32 v40, v40, v48
    v_add_f32 v41, v41, v49
    v_add_f32 v42, v42, v50
    v_add_f32 v43, v43, v51
    v_cvt_pk_bf16_f32 v44, v40, v41
    v_cvt_pk_bf16_f32 v45, v42, v43
    ds_write_b64 v28, v[44:45]
    s_waitcnt lgkmcnt(0)
L_qred_2:
    s_barrier
    ds_read_b128 v[112:115], v29 offset:0
    ds_read_b128 v[116:119], v29 offset:64
    ds_read_b128 v[120:123], v29 offset:128
    ds_read_b128 v[124:127], v29 offset:192
    ds_read_b128 v[128:131], v29 offset:256
    ds_read_b128 v[132:135], v29 offset:320
    v_mov_b32 v33, 0xff800000
    s_waitcnt lgkmcnt(0)
    ds_read_b128 v[40:43], v19 offset:0
    ds_read_b128 v[44:47], v20 offset:0
    ds_read_b128 v[48:51], v19 offset:128
    ds_read_b128 v[52:55], v20 offset:128
    ds_read_b128 v[56:59], v19 offset:256
    ds_read_b128 v[60:63], v20 offset:256
    s_waitcnt lgkmcnt(0)
    v_mfma_f32_16x16x32_bf16 v[136:139], v[40:43], v[112:115], 0
    v_mfma_f32_16x16x32_bf16 v[136:139], v[44:47], v[116:119], v[136:139]
    v_mfma_f32_16x16x32_bf16 v[136:139], v[48:51], v[120:123], v[136:139]
    v_mfma_f32_16x16x32_bf16 v[136:139], v[52:55], v[124:127], v[136:139]
    v_mfma_f32_16x16x32_bf16 v[136:139], v[56:59], v[128:131], v[136:139]
    v_mfma_f32_16x16x32_bf16 v[136:139], v[60:63], v[132:135], v[136:139]
    s_mul_i32 s56, s52, 327680
    s_lshl_b32 s57, s53, 7
    s_add_u32 s56, s56, s57
    s_sub_u32 s57, 327680, s57
    s_add_u32 s40, s18, s56
    s_addc_u32 s41, s19, 0
    s_and_b32 s41, s41, 0xffff
    s_mov_b32 s42, s57
    s_mov_b32 s43, 0x20000
    v_and_b32 v36, 1, v34
    v_lshl_add_u32 v36, v36, 2, v35
    v_lshlrev_b32 v36, 4, v36
    v_lshrrev_b32 v37, 1, v34
    v_lshl_add_u32 v36, v37, 12, v36
    s_mul_i32 s56, s3, 81920
    v_add_u32 v39, s56, v36
    v_and_b32 v36, 12, v1
    v_lshl_add_u32 v39, v36, 11, v39
    v_and_b32 v36, 8, v1
    v_lshl_add_u32 v255, v36, 24, v39
    s_mov_b32 s60, 0
    s_mov_b32 s61, 32768
    s_mov_b32 s62, 65536
    s_mov_b32 s48, s16
    s_and_b32 s49, s17, 0xffff
    s_mov_b32 s50, 256
    s_mov_b32 s51, 0x20000
    s_and_b32 s56, s52, 1
    s_lshl_b32 s56, s56, 7
    s_lshl_b32 s57, s52, 1
    s_and_b32 s57, s57, 12
    s_add_u32 s78, s56, s57
    v_xor_b32 v36, 192, v0
    v_or_b32 v36, s53, v36
    v_lshlrev_b32 v253, 8, v36
    s_mul_i32 s56, s76, 0x9e3779b1
    s_or_b32 s56, s56, 1
    v_mov_b32 v252, s56
    buffer_store_dword v252, v253, s[48:51], s78 offen sc1
    s_lshl_b32 s72, s3, 5
    s_add_u32 s72, s72, s53
    s_mul_i32 s56, s52, 80
    s_add_u32 s56, s56, s72
    s_lshl_b32 s56, s56, 12
    s_cmp_lt_u32 s72, 80
    s_cselect_b32 s57, 4096, 0
    s_add_u32 s28, s18, s56
    s_addc_u32 s29, s19, 0
    s_and_b32 s29, s29, 0xffff
    s_mov_b32 s30, s57
    s_mov_b32 s31, 0x20000
    s_mul_i32 s56, s52, 5120
    s_add_u32 s44, s14, s56
    s_addc_u32 s45, s15, 0
    s_and_b32 s45, s45, 0xffff
    s_mov_b32 s46, 5120
    s_mov_b32 s47, 0x20000
    v_lshlrev_b32 v232, 4, v1
    v_add_u32 v233, 4096, v232
    v_add_u32 v235, s54, v232
    v_mul_u32_u24 v234, 1280, v35
    v_and_b32 v36, 4, v1
    v_lshl_add_u32 v234, v36, 1, v234
    v_and_b32 v36, 8, v1
    v_lshl_add_u32 v234, v36, 20, v234
    v_bfe_u32 v36, v1, 4, 1
    v_lshl_add_u32 v234, v36, 2, v234
    v_lshrrev_b32 v36, 5, v1
    v_lshl_add_u32 v234, v36, 1, v234
    s_lshl_b32 s56, s72, 4
    v_add_u32 v234, s56, v234
    v_lshrrev_b32 v36, 3, v1
    v_and_b32 v37, 6, v36
    v_and_b32 v38, 7, v1
    v_xor_b32 v37, v37, v38
    v_lshlrev_b32 v37, 4, v37
    v_mul_u32_u24 v36, 384, v36
    v_add_u32 v236, v36, v37
    v_add_u32 v237, 3072, v236
    v_lshrrev_b32 v36, 2, v1
    v_and_b32 v37, 6, v36
    v_lshlrev_b32 v37, 4, v37
    v_lshl_add_u32 v37, v35, 3, v37
    v_lshlrev_b32 v36, 7, v36
    v_add3_u32 v238, v36, v37, s54
    v_xor_b32 v239, 32, v238
    v_xor_b32 v240, 64, v238
    v_xor_b32 v241, 96, v238
    v_and_b32 v36, 15, v1
    v_lshlrev_b32 v36, 4, v36
    v_lshl_add_u32 v36, v34, 8, v36
    v_add_u32 v243, 147456, v36
    s_lshl_b32 s56, s3, 6
    v_add_u32 v242, s56, v243
    ds_read_b128 v[40:43], v19 offset:6144
    ds_read_b128 v[44:47], v20 offset:6144
    ds_read_b128 v[48:51], v19 offset:6272
    ds_read_b128 v[52:55], v20 offset:6272
    ds_read_b128 v[56:59], v19 offset:6400
    ds_read_b128 v[60:63], v20 offset:6400
    s_nop 1
    v_cvt_pk_bf16_f32 v36, v136, v137
    v_cvt_pk_bf16_f32 v37, v138, v139
    v_lshlrev_b32 v136, 16, v36
    v_and_b32 v137, 0xffff0000, v36
    v_lshlrev_b32 v138, 16, v37
    v_and_b32 v139, 0xffff0000, v37
    v_mul_f32 v136, s70, v136
    v_mul_f32 v137, s70, v137
    v_mul_f32 v138, s70, v138
    v_mul_f32 v139, s70, v139
    v_cvt_pk_bf16_f32 v36, v136, v137
    v_cvt_pk_bf16_f32 v37, v138, v139
    v_lshlrev_b32 v136, 16, v36
    v_and_b32 v137, 0xffff0000, v36
    v_lshlrev_b32 v138, 16, v37
    v_and_b32 v139, 0xffff0000, v37
    v_max3_f32 v33, v33, v136, v137
    v_max3_f32 v33, v33, v138, v139
    s_waitcnt lgkmcnt(0)
    v_mfma_f32_16x16x32_bf16 v[140:143], v[40:43], v[112:115], 0
    v_mfma_f32_16x16x32_bf16 v[140:143], v[44:47], v[116:119], v[140:143]
    v_mfma_f32_16x16x32_bf16 v[140:143], v[48:51], v[120:123], v[140:143]
    v_mfma_f32_16x16x32_bf16 v[140:143], v[52:55], v[124:127], v[140:143]
    v_mfma_f32_16x16x32_bf16 v[140:143], v[56:59], v[128:131], v[140:143]
    v_mfma_f32_16x16x32_bf16 v[140:143], v[60:63], v[132:135], v[140:143]
    ds_read_b128 v[40:43], v19 offset:12288
    ds_read_b128 v[44:47], v20 offset:12288
    ds_read_b128 v[48:51], v19 offset:12416
    ds_read_b128 v[52:55], v20 offset:12416
    ds_read_b128 v[56:59], v19 offset:12544
    ds_read_b128 v[60:63], v20 offset:12544
    s_nop 1
    v_cvt_pk_bf16_f32 v36, v140, v141
    v_cvt_pk_bf16_f32 v37, v142, v143
    v_lshlrev_b32 v140, 16, v36
    v_and_b32 v141, 0xffff0000, v36
    v_lshlrev_b32 v142, 16, v37
    v_and_b32 v143, 0xffff0000, v37
    v_mul_f32 v140, s70, v140
    v_mul_f32 v141, s70, v141
    v_mul_f32 v142, s70, v142
    v_mul_f32 v143, s70, v143
    v_cvt_pk_bf16_f32 v36, v140, v141
    v_cvt_pk_bf16_f32 v37, v142, v143
    v_lshlrev_b32 v140, 16, v36
    v_and_b32 v141, 0xffff0000, v36
    v_lshlrev_b32 v142, 16, v37
    v_and_b32 v143, 0xffff0000, v37
    v_max3_f32 v33, v33, v140, v141
    v_max3_f32 v33, v33, v142, v143
    s_waitcnt lgkmcnt(0)
    v_mfma_f32_16x16x32_bf16 v[144:147], v[40:43], v[112:115], 0
    v_mfma_f32_16x16x32_bf16 v[144:147], v[44:47], v[116:119], v[144:147]
    v_mfma_f32_16x16x32_bf16 v[144:147], v[48:51], v[120:123], v[144:147]
    v_mfma_f32_16x16x32_bf16 v[144:147], v[52:55], v[124:127], v[144:147]
    v_mfma_f32_16x16x32_bf16 v[144:147], v[56:59], v[128:131], v[144:147]
    v_mfma_f32_16x16x32_bf16 v[144:147], v[60:63], v[132:135], v[144:147]
    ds_read_b128 v[40:43], v19 offset:18432
    ds_read_b128 v[44:47], v20 offset:18432
    ds_read_b128 v[48:51], v19 offset:18560
    ds_read_b128 v[52:55], v20 offset:18560
    ds_read_b128 v[56:59], v19 offset:18688
    ds_read_b128 v[60:63], v20 offset:18688
    s_nop 1
    v_cvt_pk_bf16_f32 v36, v144, v145
    v_cvt_pk_bf16_f32 v37, v146, v147
    v_lshlrev_b32 v144, 16, v36
    v_and_b32 v145, 0xffff0000, v36
    v_lshlrev_b32 v146, 16, v37
    v_and_b32 v147, 0xffff0000, v37
    v_mul_f32 v144, s70, v144
    v_mul_f32 v145, s70, v145
    v_mul_f32 v146, s70, v146
    v_mul_f32 v147, s70, v147
    v_cvt_pk_bf16_f32 v36, v144, v145
    v_cvt_pk_bf16_f32 v37, v146, v147
    v_lshlrev_b32 v144, 16, v36
    v_and_b32 v145, 0xffff0000, v36
    v_lshlrev_b32 v146, 16, v37
    v_and_b32 v147, 0xffff0000, v37
    v_max3_f32 v33, v33, v144, v145
    v_max3_f32 v33, v33, v146, v147
    s_waitcnt lgkmcnt(0)
    v_mfma_f32_16x16x32_bf16 v[148:151], v[40:43], v[112:115], 0
    v_mfma_f32_16x16x32_bf16 v[148:151], v[44:47], v[116:119], v[148:151]
    v_mfma_f32_16x16x32_bf16 v[148:151], v[48:51], v[120:123], v[148:151]
    v_mfma_f32_16x16x32_bf16 v[148:151], v[52:55], v[124:127], v[148:151]
    v_mfma_f32_16x16x32_bf16 v[148:151], v[56:59], v[128:131], v[148:151]
    v_mfma_f32_16x16x32_bf16 v[148:151], v[60:63], v[132:135], v[148:151]
    s_waitcnt vmcnt(11)
    s_add_u32 s55, s58, 36
    s_and_b32 s55, s55, 63
    s_mul_i32 s55, s55, 6144
    s_add_u32 m0, s54, 18432
    s_nop 0
    buffer_load_dwordx4 v2, s[20:23], s55 offen nt lds
    s_waitcnt vmcnt(11)
    s_add_u32 m0, s54, 19456
    s_nop 0
    buffer_load_dwordx4 v3, s[20:23], s55 offen nt lds
    ds_write_b128 v235, a[216:219] offset:0
    ds_write_b128 v235, a[220:223] offset:1024
    ds_write_b128 v235, a[224:227] offset:2048
    ds_write_b128 v235, a[228:231] offset:3072
    ds_write_b128 v235, a[232:235] offset:4096
    ds_write_b128 v235, a[236:239] offset:5120
    ds_read_b128 v[40:43], v19 offset:0
    ds_read_b128 v[44:47], v20 offset:0
    ds_read_b128 v[48:51], v19 offset:128
    ds_read_b128 v[52:55], v20 offset:128
    ds_read_b128 v[56:59], v19 offset:256
    ds_read_b128 v[60:63], v20 offset:256
    s_nop 1
    v_cvt_pk_bf16_f32 v36, v148, v149
    v_cvt_pk_bf16_f32 v37, v150, v151
    v_lshlrev_b32 v148, 16, v36
    v_and_b32 v149, 0xffff0000, v36
    v_lshlrev_b32 v150, 16, v37
    v_and_b32 v151, 0xffff0000, v37
    v_mul_f32 v148, s70, v148
    v_mul_f32 v149, s70, v149
    v_mul_f32 v150, s70, v150
    v_mul_f32 v151, s70, v151
    v_cvt_pk_bf16_f32 v36, v148, v149
    v_cvt_pk_bf16_f32 v37, v150, v151
    v_lshlrev_b32 v148, 16, v36
    v_and_b32 v149, 0xffff0000, v36
    v_lshlrev_b32 v150, 16, v37
    v_and_b32 v151, 0xffff0000, v37
    v_max3_f32 v33, v33, v148, v149
    v_max3_f32 v33, v33, v150, v151
    s_waitcnt lgkmcnt(0)
    v_mfma_f32_16x16x32_bf16 v[152:155], v[40:43], v[112:115], 0
    v_mfma_f32_16x16x32_bf16 v[152:155], v[44:47], v[116:119], v[152:155]
    v_mfma_f32_16x16x32_bf16 v[152:155], v[48:51], v[120:123], v[152:155]
    v_mfma_f32_16x16x32_bf16 v[152:155], v[52:55], v[124:127], v[152:155]
    v_mfma_f32_16x16x32_bf16 v[152:155], v[56:59], v[128:131], v[152:155]
    v_mfma_f32_16x16x32_bf16 v[152:155], v[60:63], v[132:135], v[152:155]
    s_waitcnt vmcnt(11)
    s_add_u32 m0, s54, 20480
    s_nop 0
    buffer_load_dwordx4 v4, s[20:23], s55 offen nt lds
    s_waitcnt vmcnt(11)
    s_add_u32 m0, s54, 21504
    s_nop 0
    buffer_load_dwordx4 v5, s[20:23], s55 offen nt lds
    s_waitcnt vmcnt(11)
    s_add_u32 m0, s54, 22528
    s_nop 0
    buffer_load_dwordx4 v6, s[20:23], s55 offen nt lds
    ds_write_b128 v235, a[192:195] offset:0
    ds_write_b128 v235, a[196:199] offset:1024
    ds_write_b128 v235, a[200:203] offset:2048
    ds_write_b128 v235, a[204:207] offset:3072
    ds_write_b128 v235, a[208:211] offset:4096
    ds_write_b128 v235, a[212:215] offset:5120
    ds_read_b128 v[40:43], v19 offset:0
    ds_read_b128 v[44:47], v20 offset:0
    ds_read_b128 v[48:51], v19 offset:128
    ds_read_b128 v[52:55], v20 offset:128
    ds_read_b128 v[56:59], v19 offset:256
    ds_read_b128 v[60:63], v20 offset:256
    s_nop 1
    v_cvt_pk_bf16_f32 v36, v152, v153
    v_cvt_pk_bf16_f32 v37, v154, v155
    v_lshlrev_b32 v152, 16, v36
    v_and_b32 v153, 0xffff0000, v36
    v_lshlrev_b32 v154, 16, v37
    v_and_b32 v155, 0xffff0000, v37
    v_mul_f32 v152, s70, v152
    v_mul_f32 v153, s70, v153
    v_mul_f32 v154, s70, v154
    v_mul_f32 v155, s70, v155
    v_cvt_pk_bf16_f32 v36, v152, v153
    v_cvt_pk_bf16_f32 v37, v154, v155
    v_lshlrev_b32 v152, 16, v36
    v_and_b32 v153, 0xffff0000, v36
    v_lshlrev_b32 v154, 16, v37
    v_and_b32 v155, 0xffff0000, v37
    v_max3_f32 v33, v33, v152, v153
    v_max3_f32 v33, v33, v154, v155
    s_waitcnt lgkmcnt(0)
    v_mfma_f32_16x16x32_bf16 v[156:159], v[40:43], v[112:115], 0
    v_mfma_f32_16x16x32_bf16 v[156:159], v[44:47], v[116:119], v[156:159]
    v_mfma_f32_16x16x32_bf16 v[156:159], v[48:51], v[120:123], v[156:159]
    v_mfma_f32_16x16x32_bf16 v[156:159], v[52:55], v[124:127], v[156:159]
    v_mfma_f32_16x16x32_bf16 v[156:159], v[56:59], v[128:131], v[156:159]
    v_mfma_f32_16x16x32_bf16 v[156:159], v[60:63], v[132:135], v[156:159]
    s_waitcnt vmcnt(11)
    s_add_u32 m0, s54, 23552
    s_nop 0
    buffer_load_dwordx4 v7, s[20:23], s55 offen nt lds
    s_waitcnt vmcnt(11)
    s_add_u32 s55, s58, 40
    s_and_b32 s55, s55, 63
    s_mul_i32 s55, s55, 6144
    s_add_u32 m0, s54, 24576
    s_nop 0
    buffer_load_dwordx4 v2, s[20:23], s55 offen nt lds
    s_waitcnt vmcnt(11)
    s_add_u32 m0, s54, 25600
    s_nop 0
    buffer_load_dwordx4 v3, s[20:23], s55 offen nt lds
    ds_write_b128 v235, a[168:171] offset:0
    ds_write_b128 v235, a[172:175] offset:1024
    ds_write_b128 v235, a[176:179] offset:2048
    ds_write_b128 v235, a[180:183] offset:3072
    ds_write_b128 v235, a[184:187] offset:4096
    ds_write_b128 v235, a[188:191] offset:5120
    ds_read_b128 v[40:43], v19 offset:0
    ds_read_b128 v[44:47], v20 offset:0
    ds_read_b128 v[48:51], v19 offset:128
    ds_read_b128 v[52:55], v20 offset:128
    ds_read_b128 v[56:59], v19 offset:256
    ds_read_b128 v[60:63], v20 offset:256
    s_nop 1
    v_cvt_pk_bf16_f32 v36, v156, v157
    v_cvt_pk_bf16_f32 v37, v158, v159
    v_lshlrev_b32 v156, 16, v36
    v_and_b32 v157, 0xffff0000, v36
    v_lshlrev_b32 v158, 16, v37
    v_and_b32 v159, 0xffff0000, v37
    v_mul_f32 v156, s70, v156
    v_mul_f32 v157, s70, v157
    v_mul_f32 v158, s70, v158
    v_mul_f32 v159, s70, v159
    v_cvt_pk_bf16_f32 v36, v156, v157
    v_cvt_pk_bf16_f32 v37, v158, v159
    v_lshlrev_b32 v156, 16, v36
    v_and_b32 v157, 0xffff0000, v36
    v_lshlrev_b32 v158, 16, v37
    v_and_b32 v159, 0xffff0000, v37
    v_max3_f32 v33, v33, v156, v157
    v_max3_f32 v33, v33, v158, v159
    s_waitcnt lgkmcnt(0)
    v_mfma_f32_16x16x32_bf16 v[160:163], v[40:43], v[112:115], 0
    v_mfma_f32_16x16x32_bf16 v[160:163], v[44:47], v[116:119], v[160:163]
    v_mfma_f32_16x16x32_bf16 v[160:163], v[48:51], v[120:123], v[160:163]
    v_mfma_f32_16x16x32_bf16 v[160:163], v[52:55], v[124:127], v[160:163]
    v_mfma_f32_16x16x32_bf16 v[160:163], v[56:59], v[128:131], v[160:163]
    v_mfma_f32_16x16x32_bf16 v[160:163], v[60:63], v[132:135], v[160:163]
    s_waitcnt vmcnt(11)
    s_add_u32 m0, s54, 26624
    s_nop 0
    buffer_load_dwordx4 v4, s[20:23], s55 offen nt lds
    s_waitcnt vmcnt(11)
    s_add_u32 m0, s54, 27648
    s_nop 0
    buffer_load_dwordx4 v5, s[20:23], s55 offen nt lds
    s_waitcnt vmcnt(11)
    s_add_u32 m0, s54, 28672
    s_nop 0
    buffer_load_dwordx4 v6, s[20:23], s55 offen nt lds
    ds_write_b128 v235, a[144:147] offset:0
    ds_write_b128 v235, a[148:151] offset:1024
    ds_write_b128 v235, a[152:155] offset:2048
    ds_write_b128 v235, a[156:159] offset:3072
    ds_write_b128 v235, a[160:163] offset:4096
    ds_write_b128 v235, a[164:167] offset:5120
    ds_read_b128 v[40:43], v19 offset:0
    ds_read_b128 v[44:47], v20 offset:0
    ds_read_b128 v[48:51], v19 offset:128
    ds_read_b128 v[52:55], v20 offset:128
    ds_read_b128 v[56:59], v19 offset:256
    ds_read_b128 v[60:63], v20 offset:256
    s_nop 1
    v_cvt_pk_bf16_f32 v36, v160, v161
    v_cvt_pk_bf16_f32 v37, v162, v163
    v_lshlrev_b32 v160, 16, v36
    v_and_b32 v161, 0xffff0000, v36
    v_lshlrev_b32 v162, 16, v37
    v_and_b32 v163, 0xffff0000, v37
    v_mul_f32 v160, s70, v160
    v_mul_f32 v161, s70, v161
    v_mul_f32 v162, s70, v162
    v_mul_f32 v163, s70, v163
    v_cvt_pk_bf16_f32 v36, v160, v161
    v_cvt_pk_bf16_f32 v37, v162, v163
    v_lshlrev_b32 v160, 16, v36
    v_and_b32 v161, 0xffff0000, v36
    v_lshlrev_b32 v162, 16, v37
    v_and_b32 v163, 0xffff0000, v37
    v_max3_f32 v33, v33, v160, v161
    v_max3_f32 v33, v33, v162, v163
    s_waitcnt lgkmcnt(0)
    v_mfma_f32_16x16x32_bf16 v[164:167], v[40:43], v[112:115], 0
    v_mfma_f32_16x16x32_bf16 v[164:167], v[44:47], v[116:119], v[164:167]
    v_mfma_f32_16x16x32_bf16 v[164:167], v[48:51], v[120:123], v[164:167]
    v_mfma_f32_16x16x32_bf16 v[164:167], v[52:55], v[124:127], v[164:167]
    v_mfma_f32_16x16x32_bf16 v[164:167], v[56:59], v[128:131], v[164:167]
    v_mfma_f32_16x16x32_bf16 v[164:167], v[60:63], v[132:135], v[164:167]
    s_waitcnt vmcnt(10)
    s_add_u32 m0, s54, 29696
    s_nop 0
    buffer_load_dwordx4 v7, s[20:23], s55 offen nt lds
    s_waitcnt vmcnt(10)
    s_add_u32 s55, s79, 0
    s_add_u32 m0, s54, 30720
    s_nop 0
    buffer_load_dwordx4 v30, s[32:35], s55 offen  lds
    s_waitcnt vmcnt(10)
    s_add_u32 s55, s79, 1024
    s_add_u32 m0, s54, 31744
    s_nop 0
    buffer_load_dwordx4 v30, s[32:35], s55 offen  lds
    ds_write_b128 v235, a[120:123] offset:0
    ds_write_b128 v235, a[124:127] offset:1024
    ds_write_b128 v235, a[128:131] offset:2048
    ds_write_b128 v235, a[132:135] offset:3072
    ds_write_b128 v235, a[136:139] offset:4096
    ds_write_b128 v235, a[140:143] offset:5120
    ds_read_b128 v[40:43], v19 offset:0
    ds_read_b128 v[44:47], v20 offset:0
    ds_read_b128 v[48:51], v19 offset:128
    ds_read_b128 v[52:55], v20 offset:128
    ds_read_b128 v[56:59], v19 offset:256
    ds_read_b128 v[60:63], v20 offset:256
    s_nop 1
    v_cvt_pk_bf16_f32 v36, v164, v165
    v_cvt_pk_bf16_f32 v37, v166, v167
    v_lshlrev_b32 v164, 16, v36
    v_and_b32 v165, 0xffff0000, v36
    v_lshlrev_b32 v166, 16, v37
    v_and_b32 v167, 0xffff0000, v37
    v_mul_f32 v164, s70, v164
    v_mul_f32 v165, s70, v165
    v_mul_f32 v166, s70, v166
    v_mul_f32 v167, s70, v167
    v_cvt_pk_bf16_f32 v36, v164, v165
    v_cvt_pk_bf16_f32 v37, v166, v167
    v_lshlrev_b32 v164, 16, v36
    v_and_b32 v165, 0xffff0000, v36
    v_lshlrev_b32 v166, 16, v37
    v_and_b32 v167, 0xffff0000, v37
    v_max3_f32 v33, v33, v164, v165
    v_max3_f32 v33, v33, v166, v167
    s_waitcnt lgkmcnt(0)
    v_mfma_f32_16x16x32_bf16 v[168:171], v[40:43], v[112:115], 0
    v_mfma_f32_16x16x32_bf16 v[168:171], v[44:47], v[116:119], v[168:171]
    v_mfma_f32_16x16x32_bf16 v[168:171], v[48:51], v[120:123], v[168:171]
    v_mfma_f32_16x16x32_bf16 v[168:171], v[52:55], v[124:127], v[168:171]
    v_mfma_f32_16x16x32_bf16 v[168:171], v[56:59], v[128:131], v[168:171]
    v_mfma_f32_16x16x32_bf16 v[168:171], v[60:63], v[132:135], v[168:171]
    s_waitcnt vmcnt(10)
    s_add_u32 s55, s79, 2048
    s_add_u32 m0, s54, 32768
    s_nop 0
    buffer_load_dwordx4 v30, s[32:35], s55 offen  lds
    s_waitcnt vmcnt(10)
    s_add_u32 s55, s58, 44
    s_and_b32 s55, s55, 63
    s_mul_i32 s55, s55, 6144
    s_add_u32 m0, s54, 6144
    s_nop 0
    buffer_load_dwordx4 v2, s[20:23], s55 offen nt lds
    s_waitcnt vmcnt(10)
    s_add_u32 m0, s54, 7168
    s_nop 0
    buffer_load_dwordx4 v3, s[20:23], s55 offen nt lds
    ds_read_b128 v[40:43], v19 offset:18432
    ds_read_b128 v[44:47], v20 offset:18432
    ds_read_b128 v[48:51], v19 offset:18560
    ds_read_b128 v[52:55], v20 offset:18560
    ds_read_b128 v[56:59], v19 offset:18688
    ds_read_b128 v[60:63], v20 offset:18688
    s_nop 1
    v_cvt_pk_bf16_f32 v36, v168, v169
    v_cvt_pk_bf16_f32 v37, v170, v171
    v_lshlrev_b32 v168, 16, v36
    v_and_b32 v169, 0xffff0000, v36
    v_lshlrev_b32 v170, 16, v37
    v_and_b32 v171, 0xffff0000, v37
    v_mul_f32 v168, s70, v168
    v_mul_f32 v169, s70, v169
    v_mul_f32 v170, s70, v170
    v_mul_f32 v171, s70, v171
    v_cvt_pk_bf16_f32 v36, v168, v169
    v_cvt_pk_bf16_f32 v37, v170, v171
    v_lshlrev_b32 v168, 16, v36
    v_and_b32 v169, 0xffff0000, v36
    v_lshlrev_b32 v170, 16, v37
    v_and_b32 v171, 0xffff0000, v37
    v_max3_f32 v33, v33, v168, v169
    v_max3_f32 v33, v33, v170, v171
    s_waitcnt lgkmcnt(0)
    v_mfma_f32_16x16x32_bf16 v[172:175], v[40:43], v[112:115], 0
    v_mfma_f32_16x16x32_bf16 v[172:175], v[44:47], v[116:119], v[172:175]
    v_mfma_f32_16x16x32_bf16 v[172:175], v[48:51], v[120:123], v[172:175]
    v_mfma_f32_16x16x32_bf16 v[172:175], v[52:55], v[124:127], v[172:175]
    v_mfma_f32_16x16x32_bf16 v[172:175], v[56:59], v[128:131], v[172:175]
    v_mfma_f32_16x16x32_bf16 v[172:175], v[60:63], v[132:135], v[172:175]
    s_waitcnt vmcnt(10)
    s_add_u32 m0, s54, 8192
    s_nop 0
    buffer_load_dwordx4 v4, s[20:23], s55 offen nt lds
    s_waitcnt vmcnt(10)
    s_add_u32 m0, s54, 9216
    s_nop 0
    buffer_load_dwordx4 v5, s[20:23], s55 offen nt lds
    s_waitcnt vmcnt(10)
    s_add_u32 m0, s54, 10240
    s_nop 0
    buffer_load_dwordx4 v6, s[20:23], s55 offen nt lds
    s_waitcnt vmcnt(10)
    s_add_u32 m0, s54, 11264
    s_nop 0
    buffer_load_dwordx4 v7, s[20:23], s55 offen nt lds
    s_waitcnt vmcnt(10)
    s_add_u32 s55, s58, 48
    s_and_b32 s55, s55, 63
    s_mul_i32 s55, s55, 6144
    s_add_u32 m0, s54, 12288
    s_nop 0
    buffer_load_dwordx4 v2, s[20:23], s55 offen nt lds
    s_waitcnt vmcnt(10)
    s_add_u32 m0, s54, 13312
    s_nop 0
    buffer_load_dwordx4 v3, s[20:23], s55 offen nt lds
    ds_read_b128 v[40:43], v19 offset:24576
    ds_read_b128 v[44:47], v20 offset:24576
    ds_read_b128 v[48:51], v19 offset:24704
    ds_read_b128 v[52:55], v20 offset:24704
    ds_read_b128 v[56:59], v19 offset:24832
    ds_read_b128 v[60:63], v20 offset:24832
    s_nop 1
    v_cvt_pk_bf16_f32 v36, v172, v173
    v_cvt_pk_bf16_f32 v37, v174, v175
    v_lshlrev_b32 v172, 16, v36
    v_and_b32 v173, 0xffff0000, v36
    v_lshlrev_b32 v174, 16, v37
    v_and_b32 v175, 0xffff0000, v37
    v_mul_f32 v172, s70, v172
    v_mul_f32 v173, s70, v173
    v_mul_f32 v174, s70, v174
    v_mul_f32 v175, s70, v175
    v_cvt_pk_bf16_f32 v36, v172, v173
    v_cvt_pk_bf16_f32 v37, v174, v175
    v_lshlrev_b32 v172, 16, v36
    v_and_b32 v173, 0xffff0000, v36
    v_lshlrev_b32 v174, 16, v37
    v_and_b32 v175, 0xffff0000, v37
    v_max3_f32 v33, v33, v172, v173
    v_max3_f32 v33, v33, v174, v175
    s_waitcnt lgkmcnt(0)
    v_mfma_f32_16x16x32_bf16 v[176:179], v[40:43], v[112:115], 0
    v_mfma_f32_16x16x32_bf16 v[176:179], v[44:47], v[116:119], v[176:179]
    v_mfma_f32_16x16x32_bf16 v[176:179], v[48:51], v[120:123], v[176:179]
    v_mfma_f32_16x16x32_bf16 v[176:179], v[52:55], v[124:127], v[176:179]
    v_mfma_f32_16x16x32_bf16 v[176:179], v[56:59], v[128:131], v[176:179]
    v_mfma_f32_16x16x32_bf16 v[176:179], v[60:63], v[132:135], v[176:179]
    s_waitcnt vmcnt(10)
    s_add_u32 m0, s54, 14336
    s_nop 0
    buffer_load_dwordx4 v4, s[20:23], s55 offen nt lds
    s_waitcnt vmcnt(10)
    s_add_u32 m0, s54, 15360
    s_nop 0
    buffer_load_dwordx4 v5, s[20:23], s55 offen nt lds
    s_waitcnt vmcnt(10)
    s_add_u32 m0, s54, 16384
    s_nop 0
    buffer_load_dwordx4 v6, s[20:23], s55 offen nt lds
    s_waitcnt vmcnt(10)
    s_add_u32 m0, s54, 17408
    s_nop 0
    buffer_load_dwordx4 v7, s[20:23], s55 offen nt lds
    s_waitcnt vmcnt(10)
    s_add_u32 s55, s58, 52
    s_and_b32 s55, s55, 63
    s_mul_i32 s55, s55, 6144
    s_add_u32 m0, s54, 18432
    s_nop 0
    buffer_load_dwordx4 v2, s[20:23], s55 offen nt lds
    s_waitcnt vmcnt(10)
    s_add_u32 m0, s54, 19456
    s_nop 0
    buffer_load_dwordx4 v3, s[20:23], s55 offen nt lds
    s_waitcnt vmcnt(10)
    s_add_u32 m0, s54, 20480
    s_nop 0
    buffer_load_dwordx4 v4, s[20:23], s55 offen nt lds
    s_waitcnt vmcnt(10)
    s_add_u32 m0, s54, 21504
    s_nop 0
    buffer_load_dwordx4 v5, s[20:23], s55 offen nt lds
    s_waitcnt vmcnt(10)
    s_add_u32 m0, s54, 22528
    s_nop 0
    buffer_load_dwordx4 v6, s[20:23], s55 offen nt lds
    ds_read_b128 v[40:43], v19 offset:6144
    ds_read_b128 v[44:47], v20 offset:6144
    ds_read_b128 v[48:51], v19 offset:6272
    ds_read_b128 v[52:55], v20 offset:6272
    ds_read_b128 v[56:59], v19 offset:6400
    ds_read_b128 v[60:63], v20 offset:6400
    s_nop 1
    v_cvt_pk_bf16_f32 v36, v176, v177
    v_cvt_pk_bf16_f32 v37, v178, v179
    v_lshlrev_b32 v176, 16, v36
    v_and_b32 v177, 0xffff0000, v36
    v_lshlrev_b32 v178, 16, v37
    v_and_b32 v179, 0xffff0000, v37
    v_mul_f32 v176, s70, v176
    v_mul_f32 v177, s70, v177
    v_mul_f32 v178, s70, v178
    v_mul_f32 v179, s70, v179
    v_cvt_pk_bf16_f32 v36, v176, v177
    v_cvt_pk_bf16_f32 v37, v178, v179
    v_lshlrev_b32 v176, 16, v36
    v_and_b32 v177, 0xffff0000, v36
    v_lshlrev_b32 v178, 16, v37
    v_and_b32 v179, 0xffff0000, v37
    v_max3_f32 v33, v33, v176, v177
    v_max3_f32 v33, v33, v178, v179
    s_waitcnt lgkmcnt(0)
    v_mfma_f32_16x16x32_bf16 v[180:183], v[40:43], v[112:115], 0
    v_mfma_f32_16x16x32_bf16 v[180:183], v[44:47], v[116:119], v[180:183]
    v_mfma_f32_16x16x32_bf16 v[180:183], v[48:51], v[120:123], v[180:183]
    v_mfma_f32_16x16x32_bf16 v[180:183], v[52:55], v[124:127], v[180:183]
    v_mfma_f32_16x16x32_bf16 v[180:183], v[56:59], v[128:131], v[180:183]
    v_mfma_f32_16x16x32_bf16 v[180:183], v[60:63], v[132:135], v[180:183]
    s_waitcnt vmcnt(10)
    s_add_u32 m0, s54, 23552
    s_nop 0
    buffer_load_dwordx4 v7, s[20:23], s55 offen nt lds
    s_waitcnt vmcnt(10)
    s_branch L_page_5
    .p2align 12
L_page_5:
    s_add_u32 s55, s58, 56
    s_and_b32 s55, s55, 63
    s_mul_i32 s55, s55, 6144
    s_add_u32 m0, s54, 24576
    s_nop 0
    buffer_load_dwordx4 v2, s[20:23], s55 offen nt lds
    s_waitcnt vmcnt(10)
    s_add_u32 m0, s54, 25600
    s_nop 0
    buffer_load_dwordx4 v3, s[20:23], s55 offen nt lds
    s_waitcnt vmcnt(10)
    s_add_u32 m0, s54, 26624
    s_nop 0
    buffer_load_dwordx4 v4, s[20:23], s55 offen nt lds
    s_waitcnt vmcnt(10)
    s_add_u32 m0, s54, 27648
    s_nop 0
    buffer_load_dwordx4 v5, s[20:23], s55 offen nt lds
    s_waitcnt vmcnt(10)
    s_add_u32 m0, s54, 28672
    s_nop 0
    buffer_load_dwordx4 v6, s[20:23], s55 offen nt lds
    ds_read_b128 v[40:43], v19 offset:12288
    ds_read_b128 v[44:47], v20 offset:12288
    ds_read_b128 v[48:51], v19 offset:12416
    ds_read_b128 v[52:55], v20 offset:12416
    ds_read_b128 v[56:59], v19 offset:12544
    ds_read_b128 v[60:63], v20 offset:12544
    s_nop 1
    v_cvt_pk_bf16_f32 v36, v180, v181
    v_cvt_pk_bf16_f32 v37, v182, v183
    v_lshlrev_b32 v180, 16, v36
    v_and_b32 v181, 0xffff0000, v36
    v_lshlrev_b32 v182, 16, v37
    v_and_b32 v183, 0xffff0000, v37
    v_mul_f32 v180, s70, v180
    v_mul_f32 v181, s70, v181
    v_mul_f32 v182, s70, v182
    v_mul_f32 v183, s70, v183
    v_cvt_pk_bf16_f32 v36, v180, v181
    v_cvt_pk_bf16_f32 v37, v182, v183
    v_lshlrev_b32 v180, 16, v36
    v_and_b32 v181, 0xffff0000, v36
    v_lshlrev_b32 v182, 16, v37
    v_and_b32 v183, 0xffff0000, v37
    v_max3_f32 v33, v33, v180, v181
    v_max3_f32 v33, v33, v182, v183
    s_waitcnt lgkmcnt(0)
    v_mfma_f32_16x16x32_bf16 v[184:187], v[40:43], v[112:115], 0
    v_mfma_f32_16x16x32_bf16 v[184:187], v[44:47], v[116:119], v[184:187]
    v_mfma_f32_16x16x32_bf16 v[184:187], v[48:51], v[120:123], v[184:187]
    v_mfma_f32_16x16x32_bf16 v[184:187], v[52:55], v[124:127], v[184:187]
    v_mfma_f32_16x16x32_bf16 v[184:187], v[56:59], v[128:131], v[184:187]
    v_mfma_f32_16x16x32_bf16 v[184:187], v[60:63], v[132:135], v[184:187]
    s_waitcnt vmcnt(10)
    s_add_u32 m0, s54, 29696
    s_nop 0
    buffer_load_dwordx4 v7, s[20:23], s55 offen nt lds
    s_waitcnt vmcnt(10)
    s_mov_b32 s55, 0
    s_add_u32 m0, s54, 30720
    s_nop 0
    buffer_load_dwordx4 v14, s[32:35], s55 offen  lds
    s_waitcnt vmcnt(10)
    s_add_u32 m0, s54, 31744
    s_nop 0
    buffer_load_dwordx4 v15, s[32:35], s55 offen  lds
    s_waitcnt vmcnt(10)
    s_add_u32 m0, s54, 32768
    s_nop 0
    buffer_load_dwordx4 v16, s[32:35], s55 offen  lds
    s_waitcnt vmcnt(10)
    s_add_u32 m0, s54, 33792
    s_nop 0
    buffer_load_dwordx4 v17, s[32:35], s55 offen  lds
    s_waitcnt vmcnt(10)
    s_add_u32 m0, s54, 34816
    s_nop 0
    buffer_load_dwordx4 v18, s[32:35], s55 offen  lds
    ds_read_b128 v[40:43], v19 offset:18432
    ds_read_b128 v[44:47], v20 offset:18432
    ds_read_b128 v[48:51], v19 offset:18560
    ds_read_b128 v[52:55], v20 offset:18560
    ds_read_b128 v[56:59], v19 offset:18688
    ds_read_b128 v[60:63], v20 offset:18688
    s_nop 1
    v_cvt_pk_bf16_f32 v36, v184, v185
    v_cvt_pk_bf16_f32 v37, v186, v187
    v_lshlrev_b32 v184, 16, v36
    v_and_b32 v185, 0xffff0000, v36
    v_lshlrev_b32 v186, 16, v37
    v_and_b32 v187, 0xffff0000, v37
    v_mul_f32 v184, s70, v184
    v_mul_f32 v185, s70, v185
    v_mul_f32 v186, s70, v186
    v_mul_f32 v187, s70, v187
    v_cvt_pk_bf16_f32 v36, v184, v185
    v_cvt_pk_bf16_f32 v37, v186, v187
    v_lshlrev_b32 v184, 16, v36
    v_and_b32 v185, 0xffff0000, v36
    v_lshlrev_b32 v186, 16, v37
    v_and_b32 v187, 0xffff0000, v37
    v_max3_f32 v33, v33, v184, v185
    v_max3_f32 v33, v33, v186, v187
    s_waitcnt lgkmcnt(0)
    v_mfma_f32_16x16x32_bf16 v[188:191], v[40:43], v[112:115], 0
    v_mfma_f32_16x16x32_bf16 v[188:191], v[44:47], v[116:119], v[188:191]
    v_mfma_f32_16x16x32_bf16 v[188:191], v[48:51], v[120:123], v[188:191]
    v_mfma_f32_16x16x32_bf16 v[188:191], v[52:55], v[124:127], v[188:191]
    v_mfma_f32_16x16x32_bf16 v[188:191], v[56:59], v[128:131], v[188:191]
    v_mfma_f32_16x16x32_bf16 v[188:191], v[60:63], v[132:135], v[188:191]
    s_waitcnt vmcnt(10)
    s_mov_b32 s55, 20480
    s_add_u32 m0, s54, 0
    s_nop 0
    buffer_load_dwordx4 v14, s[32:35], s55 offen  lds
    s_waitcnt vmcnt(10)
    s_add_u32 m0, s54, 1024
    s_nop 0
    buffer_load_dwordx4 v15, s[32:35], s55 offen  lds
    s_waitcnt vmcnt(10)
    s_add_u32 m0, s54, 2048
    s_nop 0
    buffer_load_dwordx4 v16, s[32:35], s55 offen  lds
    s_waitcnt vmcnt(10)
    s_add_u32 m0, s54, 3072
    s_nop 0
    buffer_load_dwordx4 v17, s[32:35], s55 offen  lds
    s_waitcnt vmcnt(10)
    s_add_u32 m0, s54, 4096
    s_nop 0
    buffer_load_dwordx4 v18, s[32:35], s55 offen  lds
    s_waitcnt vmcnt(10)
    s_mov_b32 s55, 40960
    s_add_u32 m0, s54, 6144
    s_nop 0
    buffer_load_dwordx4 v14, s[32:35], s55 offen  lds
    ds_read_b128 v[40:43], v19 offset:24576
    ds_read_b128 v[44:47], v20 offset:24576
    ds_read_b128 v[48:51], v19 offset:24704
    ds_read_b128 v[52:55], v20 offset:24704
    ds_read_b128 v[56:59], v19 offset:24832
    ds_read_b128 v[60:63], v20 offset:24832
    s_nop 1
    v_cvt_pk_bf16_f32 v36, v188, v189
    v_cvt_pk_bf16_f32 v37, v190, v191
    v_lshlrev_b32 v188, 16, v36
    v_and_b32 v189, 0xffff0000, v36
    v_lshlrev_b32 v190, 16, v37
    v_and_b32 v191, 0xffff0000, v37
    v_mul_f32 v188, s70, v188
    v_mul_f32 v189, s70, v189
    v_mul_f32 v190, s70, v190
    v_mul_f32 v191, s70, v191
    v_cvt_pk_bf16_f32 v36, v188, v189
    v_cvt_pk_bf16_f32 v37, v190, v191
    v_lshlrev_b32 v188, 16, v36
    v_and_b32 v189, 0xffff0000, v36
    v_lshlrev_b32 v190, 16, v37
    v_and_b32 v191, 0xffff0000, v37
    v_max3_f32 v33, v33, v188, v189
    v_max3_f32 v33, v33, v190, v191
    s_waitcnt lgkmcnt(0)
    v_mfma_f32_16x16x32_bf16 v[192:195], v[40:43], v[112:115], 0
    v_mfma_f32_16x16x32_bf16 v[192:195], v[44:47], v[116:119], v[192:195]
    v_mfma_f32_16x16x32_bf16 v[192:195], v[48:51], v[120:123], v[192:195]
    v_mfma_f32_16x16x32_bf16 v[192:195], v[52:55], v[124:127], v[192:195]
    v_mfma_f32_16x16x32_bf16 v[192:195], v[56:59], v[128:131], v[192:195]
    v_mfma_f32_16x16x32_bf16 v[192:195], v[60:63], v[132:135], v[192:195]
    s_waitcnt vmcnt(10)
    s_add_u32 m0, s54, 7168
    s_nop 0
    buffer_load_dwordx4 v15, s[32:35], s55 offen  lds
    s_waitcnt vmcnt(10)
    s_add_u32 m0, s54, 8192
    s_nop 0
    buffer_load_dwordx4 v16, s[32:35], s55 offen  lds
    s_waitcnt vmcnt(10)
    s_add_u32 m0, s54, 9216
    s_nop 0
    buffer_load_dwordx4 v17, s[32:35], s55 offen  lds
    s_waitcnt vmcnt(10)
    s_add_u32 m0, s54, 10240
    s_nop 0
    buffer_load_dwordx4 v18, s[32:35], s55 offen  lds
    s_waitcnt vmcnt(10)
    s_mov_b32 s55, 61440
    s_add_u32 m0, s54, 12288
    s_nop 0
    buffer_load_dwordx4 v14, s[32:35], s55 offen  lds
    ds_read_b64_tr_b16 a[0:1], v25 offset:30720
    ds_read_b64_tr_b16 a[4:5], v25 offset:30752
    ds_read_b64_tr_b16 a[8:9], v25 offset:30784
    ds_read_b64_tr_b16 a[12:13], v25 offset:30816
    ds_read_b64_tr_b16 a[16:17], v25 offset:30848
    ds_read_b64_tr_b16 a[20:21], v25 offset:30880
    ds_read_b64_tr_b16 a[24:25], v25 offset:30912
    ds_read_b64_tr_b16 a[28:29], v25 offset:30944
    ds_read_b64_tr_b16 a[32:33], v25 offset:30976
    ds_read_b64_tr_b16 a[36:37], v25 offset:31008
    s_waitcnt lgkmcnt(0)
    s_waitcnt vmcnt(10)
    s_add_u32 m0, s54, 13312
    s_nop 0
    buffer_load_dwordx4 v15, s[32:35], s55 offen  lds
    s_waitcnt vmcnt(10)
    s_add_u32 m0, s54, 14336
    s_nop 0
    buffer_load_dwordx4 v16, s[32:35], s55 offen  lds
    s_waitcnt vmcnt(10)
    s_add_u32 m0, s54, 15360
    s_nop 0
    buffer_load_dwordx4 v17, s[32:35], s55 offen  lds
    s_waitcnt vmcnt(10)
    s_add_u32 m0, s54, 16384
    s_nop 0
    buffer_load_dwordx4 v18, s[32:35], s55 offen  lds
    s_waitcnt vmcnt(10)
    s_mov_b32 s55, 81920
    s_add_u32 m0, s54, 18432
    s_nop 0
    buffer_load_dwordx4 v14, s[32:35], s55 offen  lds
    ds_read_b64_tr_b16 a[2:3], v25 offset:0
    ds_read_b64_tr_b16 a[6:7], v25 offset:32
    ds_read_b64_tr_b16 a[10:11], v25 offset:64
    ds_read_b64_tr_b16 a[14:15], v25 offset:96
    ds_read_b64_tr_b16 a[18:19], v25 offset:128
    ds_read_b64_tr_b16 a[22:23], v25 offset:160
    ds_read_b64_tr_b16 a[26:27], v25 offset:192
    ds_read_b64_tr_b16 a[30:31], v25 offset:224
    ds_read_b64_tr_b16 a[34:35], v25 offset:256
    ds_read_b64_tr_b16 a[38:39], v25 offset:288
    s_waitcnt lgkmcnt(0)
    s_waitcnt vmcnt(10)
    s_add_u32 m0, s54, 19456
    s_nop 0
    buffer_load_dwordx4 v15, s[32:35], s55 offen  lds
    s_waitcnt vmcnt(10)
    s_add_u32 m0, s54, 20480
    s_nop 0
    buffer_load_dwordx4 v16, s[32:35], s55 offen  lds
    s_waitcnt vmcnt(10)
    s_add_u32 m0, s54, 21504
    s_nop 0
    buffer_load_dwordx4 v17, s[32:35], s55 offen  lds
    s_waitcnt vmcnt(10)
    s_add_u32 m0, s54, 22528
    s_nop 0
    buffer_load_dwordx4 v18, s[32:35], s55 offen  lds
    s_waitcnt vmcnt(10)
    s_mov_b32 s55, 102400
    s_add_u32 m0, s54, 24576
    s_nop 0
    buffer_load_dwordx4 v14, s[32:35], s55 offen  lds
    ds_read_b64_tr_b16 a[40:41], v25 offset:6144
    ds_read_b64_tr_b16 a[44:45], v25 offset:6176
    ds_read_b64_tr_b16 a[48:49], v25 offset:6208
    ds_read_b64_tr_b16 a[52:53], v25 offset:6240
    ds_read_b64_tr_b16 a[56:57], v25 offset:6272
    ds_read_b64_tr_b16 a[60:61], v25 offset:6304
    ds_read_b64_tr_b16 a[64:65], v25 offset:6336
    ds_read_b64_tr_b16 a[68:69], v25 offset:6368
    ds_read_b64_tr_b16 a[72:73], v25 offset:6400
    ds_read_b64_tr_b16 a[76:77], v25 offset:6432
    s_waitcnt lgkmcnt(0)
    s_waitcnt vmcnt(10)
    s_add_u32 m0, s54, 25600
    s_nop 0
    buffer_load_dwordx4 v15, s[32:35], s55 offen  lds
    s_waitcnt vmcnt(10)
    s_add_u32 m0, s54, 26624
    s_nop 0
    buffer_load_dwordx4 v16, s[32:35], s55 offen  lds
    s_waitcnt vmcnt(10)
    s_add_u32 m0, s54, 27648
    s_nop 0
    buffer_load_dwordx4 v17, s[32:35], s55 offen  lds
    s_waitcnt vmcnt(10)
    s_add_u32 m0, s54, 28672
    s_nop 0
    buffer_load_dwordx4 v18, s[32:35], s55 offen  lds
    s_waitcnt vmcnt(10)
    s_mov_b32 s55, 122880
    s_add_u32 m0, s54, 30720
    s_nop 0
    buffer_load_dwordx4 v14, s[32:35], s55 offen  lds
    ds_read_b64_tr_b16 a[42:43], v25 offset:12288
    ds_read_b64_tr_b16 a[46:47], v25 offset:12320
    ds_read_b64_tr_b16 a[50:51], v25 offset:12352
    ds_read_b64_tr_b16 a[54:55], v25 offset:12384
    ds_read_b64_tr_b16 a[58:59], v25 offset:12416
    ds_read_b64_tr_b16 a[62:63], v25 offset:12448
    ds_read_b64_tr_b16 a[66:67], v25 offset:12480
    ds_read_b64_tr_b16 a[70:71], v25 offset:12512
    ds_read_b64_tr_b16 a[74:75], v25 offset:12544
    ds_read_b64_tr_b16 a[78:79], v25 offset:12576
    s_waitcnt lgkmcnt(0)
    s_waitcnt vmcnt(10)
    s_add_u32 m0, s54, 31744
    s_nop 0
    buffer_load_dwordx4 v15, s[32:35], s55 offen  lds
    s_waitcnt vmcnt(10)
    s_add_u32 m0, s54, 32768
    s_nop 0
    buffer_load_dwordx4 v16, s[32:35], s55 offen  lds
    s_waitcnt vmcnt(10)
    s_add_u32 m0, s54, 33792
    s_nop 0
    buffer_load_dwordx4 v17, s[32:35], s55 offen  lds
    s_waitcnt vmcnt(10)
    s_add_u32 m0, s54, 34816
    s_nop 0
    buffer_load_dwordx4 v18, s[32:35], s55 offen  lds
    s_waitcnt vmcnt(10)
    s_mov_b32 s55, 143360
    s_add_u32 m0, s54, 0
    s_nop 0
    buffer_load_dwordx4 v14, s[32:35], s55 offen  lds
    ds_read_b64_tr_b16 a[80:81], v25 offset:18432
    ds_read_b64_tr_b16 a[84:85], v25 offset:18464
    ds_read_b64_tr_b16 a[88:89], v25 offset:18496
    ds_read_b64_tr_b16 a[92:93], v25 offset:18528
    ds_read_b64_tr_b16 a[96:97], v25 offset:18560
    ds_read_b64_tr_b16 a[100:101], v25 offset:18592
    ds_read_b64_tr_b16 a[104:105], v25 offset:18624
    ds_read_b64_tr_b16 a[108:109], v25 offset:18656
    ds_read_b64_tr_b16 a[112:113], v25 offset:18688
    ds_read_b64_tr_b16 a[116:117], v25 offset:18720
    s_waitcnt lgkmcnt(0)
    s_waitcnt vmcnt(10)
    s_add_u32 m0, s54, 1024
    s_nop 0
    buffer_load_dwordx4 v15, s[32:35], s55 offen  lds
    s_waitcnt vmcnt(10)
    s_add_u32 m0, s54, 2048
    s_nop 0
    buffer_load_dwordx4 v16, s[32:35], s55 offen  lds
    s_waitcnt vmcnt(10)
    s_add_u32 m0, s54, 3072
    s_nop 0
    buffer_load_dwordx4 v17, s[32:35], s55 offen  lds
    s_waitcnt vmcnt(10)
    s_add_u32 m0, s54, 4096
    s_nop 0
    buffer_load_dwordx4 v18, s[32:35], s55 offen  lds
    s_waitcnt vmcnt(10)
    s_mov_b32 s55, 163840
    s_add_u32 m0, s54, 6144
    s_nop 0
    buffer_load_dwordx4 v14, s[32:35], s55 offen  lds
    ds_read_b64_tr_b16 a[82:83], v25 offset:24576
    ds_read_b64_tr_b16 a[86:87], v25 offset:24608
    ds_read_b64_tr_b16 a[90:91], v25 offset:24640
    ds_read_b64_tr_b16 a[94:95], v25 offset:24672
    ds_read_b64_tr_b16 a[98:99], v25 offset:24704
    ds_read_b64_tr_b16 a[102:103], v25 offset:24736
    ds_read_b64_tr_b16 a[106:107], v25 offset:24768
    ds_read_b64_tr_b16 a[110:111], v25 offset:24800
    ds_read_b64_tr_b16 a[114:115], v25 offset:24832
    ds_read_b64_tr_b16 a[118:119], v25 offset:24864
    s_waitcnt lgkmcnt(0)
    s_waitcnt vmcnt(10)
    s_add_u32 m0, s54, 7168
    s_nop 0
    buffer_load_dwordx4 v15, s[32:35], s55 offen  lds
    s_waitcnt vmcnt(10)
    s_add_u32 m0, s54, 8192
    s_nop 0
    buffer_load_dwordx4 v16, s[32:35], s55 offen  lds
    s_waitcnt vmcnt(10)
    s_add_u32 m0, s54, 9216
    s_nop 0
    buffer_load_dwordx4 v17, s[32:35], s55 offen  lds
    s_waitcnt vmcnt(10)
    s_add_u32 m0, s54, 10240
    s_nop 0
    buffer_load_dwordx4 v18, s[32:35], s55 offen  lds
    s_waitcnt vmcnt(10)
    s_mov_b32 s55, 184320
    s_add_u32 m0, s54, 12288
    s_nop 0
    buffer_load_dwordx4 v14, s[32:35], s55 offen  lds
    ds_read_b64_tr_b16 a[120:121], v25 offset:30720
    ds_read_b64_tr_b16 a[124:125], v25 offset:30752
    ds_read_b64_tr_b16 a[128:129], v25 offset:30784
    ds_read_b64_tr_b16 a[132:133], v25 offset:30816
    ds_read_b64_tr_b16 a[136:137], v25 offset:30848
    ds_read_b64_tr_b16 a[140:141], v25 offset:30880
    ds_read_b64_tr_b16 a[144:145], v25 offset:30912
    ds_read_b64_tr_b16 a[148:149], v25 offset:30944
    ds_read_b64_tr_b16 a[152:153], v25 offset:30976
    ds_read_b64_tr_b16 a[156:157], v25 offset:31008
    s_waitcnt lgkmcnt(0)
    s_waitcnt vmcnt(10)
    s_add_u32 m0, s54, 13312
    s_nop 0
    buffer_load_dwordx4 v15, s[32:35], s55 offen  lds
    s_waitcnt vmcnt(10)
    s_add_u32 m0, s54, 14336
    s_nop 0
    buffer_load_dwordx4 v16, s[32:35], s55 offen  lds
    s_waitcnt vmcnt(10)
    s_add_u32 m0, s54, 15360
    s_nop 0
    buffer_load_dwordx4 v17, s[32:35], s55 offen  lds
    s_waitcnt vmcnt(10)
    s_add_u32 m0, s54, 16384
    s_nop 0
    buffer_load_dwordx4 v18, s[32:35], s55 offen  lds
    s_waitcnt vmcnt(10)
    s_mov_b32 s55, 204800
    s_add_u32 m0, s54, 18432
    s_nop 0
    buffer_load_dwordx4 v14, s[32:35], s55 offen  lds
    ds_read_b64_tr_b16 a[122:123], v25 offset:0
    ds_read_b64_tr_b16 a[126:127], v25 offset:32
    ds_read_b64_tr_b16 a[130:131], v25 offset:64
    ds_read_b64_tr_b16 a[134:135], v25 offset:96
    ds_read_b64_tr_b16 a[138:139], v25 offset:128
    ds_read_b64_tr_b16 a[142:143], v25 offset:160
    ds_read_b64_tr_b16 a[146:147], v25 offset:192
    ds_read_b64_tr_b16 a[150:151], v25 offset:224
    ds_read_b64_tr_b16 a[154:155], v25 offset:256
    ds_read_b64_tr_b16 a[158:159], v25 offset:288
    s_waitcnt lgkmcnt(0)
    s_waitcnt vmcnt(10)
    s_add_u32 m0, s54, 19456
    s_nop 0
    buffer_load_dwordx4 v15, s[32:35], s55 offen  lds
    s_waitcnt vmcnt(10)
    s_add_u32 m0, s54, 20480
    s_nop 0
    buffer_load_dwordx4 v16, s[32:35], s55 offen  lds
    s_waitcnt vmcnt(10)
    s_add_u32 m0, s54, 21504
    s_nop 0
    buffer_load_dwordx4 v17, s[32:35], s55 offen  lds
    s_waitcnt vmcnt(10)
    s_add_u32 m0, s54, 22528
    s_nop 0
    buffer_load_dwordx4 v18, s[32:35], s55 offen  lds
    s_waitcnt vmcnt(10)
    s_mov_b32 s55, 225280
    s_add_u32 m0, s54, 24576
    s_nop 0
    buffer_load_dwordx4 v14, s[32:35], s55 offen  lds
    ds_read_b64_tr_b16 a[160:161], v25 offset:6144
    ds_read_b64_tr_b16 a[164:165], v25 offset:6176
    ds_read_b64_tr_b16 a[168:169], v25 offset:6208
    ds_read_b64_tr_b16 a[172:173], v25 offset:6240
    ds_read_b64_tr_b16 a[176:177], v25 offset:6272
    ds_read_b64_tr_b16 a[180:181], v25 offset:6304
    ds_read_b64_tr_b16 a[184:185], v25 offset:6336
    ds_read_b64_tr_b16 a[188:189], v25 offset:6368
    ds_read_b64_tr_b16 a[192:193], v25 offset:6400
    ds_read_b64_tr_b16 a[196:197], v25 offset:6432
    s_waitcnt lgkmcnt(0)
    s_waitcnt vmcnt(10)
    s_add_u32 m0, s54, 25600
    s_nop 0
    buffer_load_dwordx4 v15, s[32:35], s55 offen  lds
    s_waitcnt vmcnt(10)
    s_add_u32 m0, s54, 26624
    s_nop 0
    buffer_load_dwordx4 v16, s[32:35], s55 offen  lds
    s_waitcnt vmcnt(10)
    s_add_u32 m0, s54, 27648
    s_nop 0
    buffer_load_dwordx4 v17, s[32:35], s55 offen  lds
    s_waitcnt vmcnt(10)
    s_add_u32 m0, s54, 28672
    s_nop 0
    buffer_load_dwordx4 v18, s[32:35], s55 offen  lds
    s_waitcnt vmcnt(10)
    s_add_u32 s55, s58, 60
    s_and_b32 s55, s55, 63
    s_mul_i32 s55, s55, 6144
    s_add_u32 m0, s54, 30720
    s_nop 0
    buffer_load_dwordx4 v2, s[20:23], s55 offen nt lds
    ds_read_b64_tr_b16 a[162:163], v25 offset:12288
    ds_read_b64_tr_b16 a[166:167], v25 offset:12320
    ds_read_b64_tr_b16 a[170:171], v25 offset:12352
    ds_read_b64_tr_b16 a[174:175], v25 offset:12384
    ds_read_b64_tr_b16 a[178:179], v25 offset:12416
    ds_read_b64_tr_b16 a[182:183], v25 offset:12448
    ds_read_b64_tr_b16 a[186:187], v25 offset:12480
    ds_read_b64_tr_b16 a[190:191], v25 offset:12512
    ds_read_b64_tr_b16 a[194:195], v25 offset:12544
    ds_read_b64_tr_b16 a[198:199], v25 offset:12576
    s_waitcnt lgkmcnt(0)
    s_waitcnt vmcnt(10)
    s_add_u32 m0, s54, 31744
    s_nop 0
    buffer_load_dwordx4 v3, s[20:23], s55 offen nt lds
    s_waitcnt vmcnt(10)
    s_add_u32 m0, s54, 32768
    s_nop 0
    buffer_load_dwordx4 v4, s[20:23], s55 offen nt lds
    s_waitcnt vmcnt(10)
    s_add_u32 m0, s54, 33792
    s_nop 0
    buffer_load_dwordx4 v5, s[20:23], s55 offen nt lds
    s_waitcnt vmcnt(10)
    s_add_u32 m0, s54, 34816
    s_nop 0
    buffer_load_dwordx4 v6, s[20:23], s55 offen nt lds
    s_waitcnt vmcnt(10)
    s_add_u32 m0, s54, 35840
    s_nop 0
    buffer_load_dwordx4 v7, s[20:23], s55 offen nt lds
    ds_read_b64_tr_b16 a[200:201], v25 offset:18432
    ds_read_b64_tr_b16 a[204:205], v25 offset:18464
    ds_read_b64_tr_b16 a[208:209], v25 offset:18496
    ds_read_b64_tr_b16 a[212:213], v25 offset:18528
    ds_read_b64_tr_b16 a[216:217], v25 offset:18560
    ds_read_b64_tr_b16 a[220:221], v25 offset:18592
    ds_read_b64_tr_b16 a[224:225], v25 offset:18624
    ds_read_b64_tr_b16 a[228:229], v25 offset:18656
    ds_read_b64_tr_b16 a[232:233], v25 offset:18688
    ds_read_b64_tr_b16 a[236:237], v25 offset:18720
    s_waitcnt lgkmcnt(0)
    s_waitcnt vmcnt(10)
    s_add_u32 s55, s58, 0
    s_and_b32 s55, s55, 63
    s_mul_i32 s55, s55, 6144
    s_add_u32 m0, s54, 0
    s_nop 0
    buffer_load_dwordx4 v2, s[24:27], s55 offen nt lds
    s_waitcnt vmcnt(10)
    s_add_u32 m0, s54, 1024
    s_nop 0
    buffer_load_dwordx4 v3, s[24:27], s55 offen nt lds
    s_waitcnt vmcnt(10)
    s_add_u32 m0, s54, 2048
    s_nop 0
    buffer_load_dwordx4 v4, s[24:27], s55 offen nt lds
    s_waitcnt vmcnt(10)
    s_add_u32 m0, s54, 3072
    s_nop 0
    buffer_load_dwordx4 v5, s[24:27], s55 offen nt lds
    s_waitcnt vmcnt(10)
    s_add_u32 m0, s54, 4096
    s_nop 0
    buffer_load_dwordx4 v6, s[24:27], s55 offen nt lds
    ds_read_b64_tr_b16 a[202:203], v25 offset:24576
    ds_read_b64_tr_b16 a[206:207], v25 offset:24608
    ds_read_b64_tr_b16 a[210:211], v25 offset:24640
    ds_read_b64_tr_b16 a[214:215], v25 offset:24672
    ds_read_b64_tr_b16 a[218:219], v25 offset:24704
    ds_read_b64_tr_b16 a[222:223], v25 offset:24736
    ds_read_b64_tr_b16 a[226:227], v25 offset:24768
    ds_read_b64_tr_b16 a[230:231], v25 offset:24800
    ds_read_b64_tr_b16 a[234:235], v25 offset:24832
    ds_read_b64_tr_b16 a[238:239], v25 offset:24864
    s_waitcnt lgkmcnt(0)
    s_waitcnt vmcnt(10)
    s_add_u32 m0, s54, 5120
    s_nop 0
    buffer_load_dwordx4 v7, s[24:27], s55 offen nt lds
    s_waitcnt vmcnt(10)
    s_add_u32 s55, s58, 4
    s_and_b32 s55, s55, 63
    s_mul_i32 s55, s55, 6144
    s_add_u32 m0, s54, 6144
    s_nop 0
    buffer_load_dwordx4 v2, s[24:27], s55 offen nt lds
    s_waitcnt vmcnt(10)
    s_add_u32 m0, s54, 7168
    s_nop 0
    buffer_load_dwordx4 v3, s[24:27], s55 offen nt lds
    s_waitcnt vmcnt(10)
    s_add_u32 m0, s54, 8192
    s_nop 0
    buffer_load_dwordx4 v4, s[24:27], s55 offen nt lds
    s_waitcnt vmcnt(10)
    s_add_u32 m0, s54, 9216
    s_nop 0
    buffer_load_dwordx4 v5, s[24:27], s55 offen nt lds
    s_waitcnt vmcnt(10)
    s_add_u32 m0, s54, 10240
    s_nop 0
    buffer_load_dwordx4 v6, s[24:27], s55 offen nt lds
    ds_read_b128 v[40:43], v19 offset:30720
    ds_read_b128 v[44:47], v20 offset:30720
    ds_read_b128 v[48:51], v19 offset:30848
    ds_read_b128 v[52:55], v20 offset:30848
    ds_read_b128 v[56:59], v19 offset:30976
    ds_read_b128 v[60:63], v20 offset:30976
    s_nop 1
    v_cvt_pk_bf16_f32 v36, v192, v193
    v_cvt_pk_bf16_f32 v37, v194, v195
    v_lshlrev_b32 v192, 16, v36
    v_and_b32 v193, 0xffff0000, v36
    v_lshlrev_b32 v194, 16, v37
    v_and_b32 v195, 0xffff0000, v37
    v_mul_f32 v192, s70, v192
    v_mul_f32 v193, s70, v193
    v_mul_f32 v194, s70, v194
    v_mul_f32 v195, s70, v195
    v_cvt_pk_bf16_f32 v36, v192, v193
    v_cvt_pk_bf16_f32 v37, v194, v195
    v_lshlrev_b32 v192, 16, v36
    v_and_b32 v193, 0xffff0000, v36
    v_lshlrev_b32 v194, 16, v37
    v_and_b32 v195, 0xffff0000, v37
    v_max3_f32 v33, v33, v192, v193
    v_max3_f32 v33, v33, v194, v195
    s_waitcnt lgkmcnt(0)
    v_mfma_f32_16x16x32_bf16 v[196:199], v[40:43], v[112:115], 0
    v_mfma_f32_16x16x32_bf16 v[196:199], v[44:47], v[116:119], v[196:199]
    v_mfma_f32_16x16x32_bf16 v[196:199], v[48:51], v[120:123], v[196:199]
    v_mfma_f32_16x16x32_bf16 v[196:199], v[52:55], v[124:127], v[196:199]
    v_mfma_f32_16x16x32_bf16 v[196:199], v[56:59], v[128:131], v[196:199]
    v_mfma_f32_16x16x32_bf16 v[196:199], v[60:63], v[132:135], v[196:199]
    s_waitcnt vmcnt(10)
    s_add_u32 m0, s54, 11264
    s_nop 0
    buffer_load_dwordx4 v7, s[24:27], s55 offen nt lds
    s_waitcnt vmcnt(10)
    s_add_u32 s55, s58, 8
    s_and_b32 s55, s55, 63
    s_mul_i32 s55, s55, 6144
    s_add_u32 m0, s54, 12288
    s_nop 0
    buffer_load_dwordx4 v2, s[24:27], s55 offen nt lds
    s_nop 7
    v_cvt_pk_bf16_f32 v36, v196, v197
    v_cvt_pk_bf16_f32 v37, v198, v199
    v_lshlrev_b32 v196, 16, v36
    v_and_b32 v197, 0xffff0000, v36
    v_lshlrev_b32 v198, 16, v37
    v_and_b32 v199, 0xffff0000, v37
    v_mul_f32 v196, s70, v196
    v_mul_f32 v197, s70, v197
    v_mul_f32 v198, s70, v198
    v_mul_f32 v199, s70, v199
    v_cvt_pk_bf16_f32 v36, v196, v197
    v_cvt_pk_bf16_f32 v37, v198, v199
    v_lshlrev_b32 v196, 16, v36
    v_and_b32 v197, 0xffff0000, v36
    v_lshlrev_b32 v198, 16, v37
    v_and_b32 v199, 0xffff0000, v37
    v_max3_f32 v33, v33, v196, v197
    v_max3_f32 v33, v33, v198, v199
    s_add_u32 m0, s54, 13312
    s_nop 0
    buffer_load_dwordx4 v3, s[24:27], s55 offen nt lds
    s_add_u32 m0, s54, 14336
    s_nop 0
    buffer_load_dwordx4 v4, s[24:27], s55 offen nt lds
    ds_write_b32 v31, v33
    s_waitcnt lgkmcnt(0)
    s_barrier
    ds_read_b128 v[40:43], v32 offset:0
    ds_read_b128 v[44:47], v32 offset:16
    ds_read_b128 v[48:51], v32 offset:32
    ds_read_b128 v[52:55], v32 offset:48
    s_waitcnt lgkmcnt(0)
    v_max3_f32 v33, v33, v40, v41
    v_max3_f32 v33, v33, v42, v43
    v_max3_f32 v33, v33, v44, v45
    v_max3_f32 v33, v33, v46, v47
    v_max3_f32 v33, v33, v48, v49
    v_max3_f32 v33, v33, v50, v51
    v_max3_f32 v33, v33, v52, v53
    v_max3_f32 v33, v33, v54, v55
    v_mul_f32 v33, s71, v33
    s_add_u32 m0, s54, 15360
    s_nop 0
    buffer_load_dwordx4 v5, s[24:27], s55 offen nt lds
    s_add_u32 m0, s54, 16384
    s_nop 0
    buffer_load_dwordx4 v6, s[24:27], s55 offen nt lds
    v_fma_f32 v136, v136, s71, -v33
    v_fma_f32 v137, v137, s71, -v33
    v_fma_f32 v138, v138, s71, -v33
    v_fma_f32 v139, v139, s71, -v33
    v_fma_f32 v140, v140, s71, -v33
    v_fma_f32 v141, v141, s71, -v33
    v_fma_f32 v142, v142, s71, -v33
    v_fma_f32 v143, v143, s71, -v33
    v_fma_f32 v144, v144, s71, -v33
    v_fma_f32 v145, v145, s71, -v33
    v_fma_f32 v146, v146, s71, -v33
    v_fma_f32 v147, v147, s71, -v33
    v_fma_f32 v148, v148, s71, -v33
    v_fma_f32 v149, v149, s71, -v33
    v_fma_f32 v150, v150, s71, -v33
    v_fma_f32 v151, v151, s71, -v33
    v_fma_f32 v152, v152, s71, -v33
    v_fma_f32 v153, v153, s71, -v33
    v_fma_f32 v154, v154, s71, -v33
    v_fma_f32 v155, v155, s71, -v33
    v_fma_f32 v156, v156, s71, -v33
    v_fma_f32 v157, v157, s71, -v33
    v_fma_f32 v158, v158, s71, -v33
    v_fma_f32 v159, v159, s71, -v33
    v_fma_f32 v160, v160, s71, -v33
    v_fma_f32 v161, v161, s71, -v33
    v_fma_f32 v162, v162, s71, -v33
    v_fma_f32 v163, v163, s71, -v33
    v_fma_f32 v164, v164, s71, -v33
    v_fma_f32 v165, v165, s71, -v33
    v_fma_f32 v166, v166, s71, -v33
    v_fma_f32 v167, v167, s71, -v33
    v_fma_f32 v168, v168, s71, -v33
    v_fma_f32 v169, v169, s71, -v33
    v_fma_f32 v170, v170, s71, -v33
    v_fma_f32 v171, v171, s71, -v33
    v_fma_f32 v172, v172, s71, -v33
    v_fma_f32 v173, v173, s71, -v33
    v_fma_f32 v174, v174, s71, -v33
    v_fma_f32 v175, v175, s71, -v33
    v_fma_f32 v176, v176, s71, -v33
    v_fma_f32 v177, v177, s71, -v33
    v_fma_f32 v178, v178, s71, -v33
    v_fma_f32 v179, v179, s71, -v33
    v_fma_f32 v180, v180, s71, -v33
    v_fma_f32 v181, v181, s71, -v33
    v_fma_f32 v182, v182, s71, -v33
    v_fma_f32 v183, v183, s71, -v33
    v_fma_f32 v184, v184, s71, -v33
    v_fma_f32 v185, v185, s71, -v33
    v_fma_f32 v186, v186, s71, -v33
    v_fma_f32 v187, v187, s71, -v33
    v_fma_f32 v188, v188, s71, -v33
    v_fma_f32 v189, v189, s71, -v33
    v_fma_f32 v190, v190, s71, -v33
    v_fma_f32 v191, v191, s71, -v33
    v_fma_f32 v192, v192, s71, -v33
    v_fma_f32 v193, v193, s71, -v33
    v_fma_f32 v194, v194, s71, -v33
    v_fma_f32 v195, v195, s71, -v33
    v_fma_f32 v196, v196, s71, -v33
    v_fma_f32 v197, v197, s71, -v33
    v_fma_f32 v198, v198, s71, -v33
    v_fma_f32 v199, v199, s71, -v33
    s_add_u32 m0, s54, 17408
    s_nop 0
    buffer_load_dwordx4 v7, s[24:27], s55 offen nt lds
    s_add_u32 s55, s58, 12
    s_and_b32 s55, s55, 63
    s_mul_i32 s55, s55, 6144
    s_add_u32 m0, s54, 18432
    s_nop 0
    buffer_load_dwordx4 v2, s[24:27], s55 offen nt lds
    v_exp_f32 v136, v136
    v_exp_f32 v137, v137
    v_exp_f32 v138, v138
    v_exp_f32 v139, v139
    v_exp_f32 v140, v140
    v_exp_f32 v141, v141
    v_exp_f32 v142, v142
    v_exp_f32 v143, v143
    v_exp_f32 v144, v144
    v_exp_f32 v145, v145
    v_exp_f32 v146, v146
    v_exp_f32 v147, v147
    v_exp_f32 v148, v148
    v_exp_f32 v149, v149
    v_exp_f32 v150, v150
    v_exp_f32 v151, v151
    v_exp_f32 v152, v152
    v_exp_f32 v153, v153
    v_exp_f32 v154, v154
    v_exp_f32 v155, v155
    v_exp_f32 v156, v156
    v_exp_f32 v157, v157
    v_exp_f32 v158, v158
    v_exp_f32 v159, v159
    v_exp_f32 v160, v160
    v_exp_f32 v161, v161
    v_exp_f32 v162, v162
    v_exp_f32 v163, v163
    v_exp_f32 v164, v164
    v_exp_f32 v165, v165
    v_exp_f32 v166, v166
    v_exp_f32 v167, v167
    s_add_u32 m0, s54, 19456
    s_nop 0
    buffer_load_dwordx4 v3, s[24:27], s55 offen nt lds
    s_add_u32 m0, s54, 20480
    s_nop 0
    buffer_load_dwordx4 v4, s[24:27], s55 offen nt lds
    v_exp_f32 v168, v168
    v_exp_f32 v169, v169
    v_exp_f32 v170, v170
    v_exp_f32 v171, v171
    v_exp_f32 v172, v172
    v_exp_f32 v173, v173
    v_exp_f32 v174, v174
    v_exp_f32 v175, v175
    v_exp_f32 v176, v176
    v_exp_f32 v177, v177
    v_exp_f32 v178, v178
    v_exp_f32 v179, v179
    v_exp_f32 v180, v180
    v_exp_f32 v181, v181
    v_exp_f32 v182, v182
    v_exp_f32 v183, v183
    v_exp_f32 v184, v184
    v_exp_f32 v185, v185
    v_exp_f32 v186, v186
    v_exp_f32 v187, v187
    v_exp_f32 v188, v188
    v_exp_f32 v189, v189
    v_exp_f32 v190, v190
    v_exp_f32 v191, v191
    v_exp_f32 v192, v192
    v_exp_f32 v193, v193
    v_exp_f32 v194, v194
    v_exp_f32 v195, v195
    v_exp_f32 v196, v196
    v_exp_f32 v197, v197
    v_exp_f32 v198, v198
    v_exp_f32 v199, v199
    s_add_u32 m0, s54, 21504
    s_nop 0
    buffer_load_dwordx4 v5, s[24:27], s55 offen nt lds
    s_add_u32 m0, s54, 22528
    s_nop 0
    buffer_load_dwordx4 v6, s[24:27], s55 offen nt lds
    v_add_f32 v36, v136, v137
    v_add_f32 v37, v138, v139
    v_add_f32 v36, v36, v140
    v_add_f32 v37, v37, v141
    v_add_f32 v36, v36, v142
    v_add_f32 v37, v37, v143
    v_add_f32 v36, v36, v144
    v_add_f32 v37, v37, v145
    v_add_f32 v36, v36, v146
    v_add_f32 v37, v37, v147
    v_add_f32 v36, v36, v148
    v_add_f32 v37, v37, v149
    v_add_f32 v36, v36, v150
    v_add_f32 v37, v37, v151
    v_add_f32 v36, v36, v152
    v_add_f32 v37, v37, v153
    v_add_f32 v36, v36, v154
    v_add_f32 v37, v37, v155
    v_add_f32 v36, v36, v156
    v_add_f32 v37, v37, v157
    v_add_f32 v36, v36, v158
    v_add_f32 v37, v37, v159
    v_add_f32 v36, v36, v160
    v_add_f32 v37, v37, v161
    v_add_f32 v36, v36, v162
    v_add_f32 v37, v37, v163
    v_add_f32 v36, v36, v164
    v_add_f32 v37, v37, v165
    v_add_f32 v36, v36, v166
    v_add_f32 v37, v37, v167
    v_add_f32 v36, v36, v168
    v_add_f32 v37, v37, v169
    v_add_f32 v36, v36, v170
    v_add_f32 v37, v37, v171
    v_add_f32 v36, v36, v172
    v_add_f32 v37, v37, v173
    v_add_f32 v36, v36, v174
    v_add_f32 v37, v37, v175
    v_add_f32 v36, v36, v176
    v_add_f32 v37, v37, v177
    v_add_f32 v36, v36, v178
    v_add_f32 v37, v37, v179
    v_add_f32 v36, v36, v180
    v_add_f32 v37, v37, v181
    v_add_f32 v36, v36, v182
    v_add_f32 v37, v37, v183
    v_add_f32 v36, v36, v184
    v_add_f32 v37, v37, v185
    v_add_f32 v36, v36, v186
    v_add_f32 v37, v37, v187
    v_add_f32 v36, v36, v188
    v_add_f32 v37, v37, v189
    v_add_f32 v36, v36, v190
    v_add_f32 v37, v37, v191
    v_add_f32 v36, v36, v192
    v_add_f32 v37, v37, v193
    v_add_f32 v36, v36, v194
    v_add_f32 v37, v37, v195
    v_add_f32 v36, v36, v196
    v_add_f32 v37, v37, v197
    v_add_f32 v36, v36, v198
    v_add_f32 v37, v37, v199
    v_add_f32 v36, v36, v37
    ds_write_b32 v31, v36 offset:256
    s_waitcnt lgkmcnt(0)
    s_barrier
    ds_read_b128 v[40:43], v32 offset:256
    ds_read_b128 v[44:47], v32 offset:272
    ds_read_b128 v[48:51], v32 offset:288
    ds_read_b128 v[52:55], v32 offset:304
    s_add_u32 m0, s54, 23552
    s_nop 0
    buffer_load_dwordx4 v7, s[24:27], s55 offen nt lds
    s_add_u32 s55, s58, 16
    s_and_b32 s55, s55, 63
    s_mul_i32 s55, s55, 6144
    s_add_u32 m0, s54, 24576
    s_nop 0
    buffer_load_dwordx4 v2, s[24:27], s55 offen nt lds
    s_waitcnt lgkmcnt(0)
    v_add_f32 v40, v40, v48
    v_add_f32 v41, v41, v49
    v_add_f32 v42, v42, v50
    v_add_f32 v43, v43, v51
    v_add_f32 v44, v44, v52
    v_add_f32 v45, v45, v53
    v_add_f32 v46, v46, v54
    v_add_f32 v47, v47, v55
    v_add_f32 v40, v40, v44
    v_add_f32 v41, v41, v45
    v_add_f32 v42, v42, v46
    v_add_f32 v43, v43, v47
    v_add_f32 v40, v40, v41
    v_add_f32 v42, v42, v43
    v_add_f32 v40, v40, v42
    v_rcp_f32 v36, v40
    s_nop 0
    v_mul_f32 v136, v36, v136
    v_mul_f32 v137, v36, v137
    v_mul_f32 v138, v36, v138
    v_mul_f32 v139, v36, v139
    v_mul_f32 v140, v36, v140
    v_mul_f32 v141, v36, v141
    v_mul_f32 v142, v36, v142
    v_mul_f32 v143, v36, v143
    v_mul_f32 v144, v36, v144
    v_mul_f32 v145, v36, v145
    v_mul_f32 v146, v36, v146
    v_mul_f32 v147, v36, v147
    v_mul_f32 v148, v36, v148
    v_mul_f32 v149, v36, v149
    v_mul_f32 v150, v36, v150
    v_mul_f32 v151, v36, v151
    v_mul_f32 v152, v36, v152
    v_mul_f32 v153, v36, v153
    v_mul_f32 v154, v36, v154
    v_mul_f32 v155, v36, v155
    v_mul_f32 v156, v36, v156
    v_mul_f32 v157, v36, v157
    v_mul_f32 v158, v36, v158
    v_mul_f32 v159, v36, v159
    v_mul_f32 v160, v36, v160
    v_mul_f32 v161, v36, v161
    v_mul_f32 v162, v36, v162
    v_mul_f32 v163, v36, v163
    v_mul_f32 v164, v36, v164
    v_mul_f32 v165, v36, v165
    v_mul_f32 v166, v36, v166
    v_mul_f32 v167, v36, v167
    v_mul_f32 v168, v36, v168
    v_mul_f32 v169, v36, v169
    v_mul_f32 v170, v36, v170
    v_mul_f32 v171, v36, v171
    v_mul_f32 v172, v36, v172
    v_mul_f32 v173, v36, v173
    v_mul_f32 v174, v36, v174
    v_mul_f32 v175, v36, v175
    v_mul_f32 v176, v36, v176
    v_mul_f32 v177, v36, v177
    v_mul_f32 v178, v36, v178
    v_mul_f32 v179, v36, v179
    v_mul_f32 v180, v36, v180
    v_mul_f32 v181, v36, v181
    v_mul_f32 v182, v36, v182
    v_mul_f32 v183, v36, v183
    v_mul_f32 v184, v36, v184
    v_mul_f32 v185, v36, v185
    v_mul_f32 v186, v36, v186
    v_mul_f32 v187, v36, v187
    v_mul_f32 v188, v36, v188
    v_mul_f32 v189, v36, v189
    v_mul_f32 v190, v36, v190
    v_mul_f32 v191, v36, v191
    v_mul_f32 v192, v36, v192
    v_mul_f32 v193, v36, v193
    v_mul_f32 v194, v36, v194
    v_mul_f32 v195, v36, v195
    v_mul_f32 v196, v36, v196
    v_mul_f32 v197, v36, v197
    v_mul_f32 v198, v36, v198
    v_mul_f32 v199, v36, v199
    s_add_u32 m0, s54, 25600
    s_nop 0
    buffer_load_dwordx4 v3, s[24:27], s55 offen nt lds
    s_add_u32 m0, s54, 26624
    s_nop 0
    buffer_load_dwordx4 v4, s[24:27], s55 offen nt lds
    v_cvt_pk_bf16_f32 v200, v136, v137
    v_cvt_pk_bf16_f32 v201, v138, v139
    v_cvt_pk_bf16_f32 v202, v140, v141
    v_cvt_pk_bf16_f32 v203, v142, v143
    v_cvt_pk_bf16_f32 v204, v144, v145
    v_cvt_pk_bf16_f32 v205, v146, v147
    v_cvt_pk_bf16_f32 v206, v148, v149
    v_cvt_pk_bf16_f32 v207, v150, v151
    v_cvt_pk_bf16_f32 v208, v152, v153
    v_cvt_pk_bf16_f32 v209, v154, v155
    v_cvt_pk_bf16_f32 v210, v156, v157
    v_cvt_pk_bf16_f32 v211, v158, v159
    v_cvt_pk_bf16_f32 v212, v160, v161
    v_cvt_pk_bf16_f32 v213, v162, v163
    v_cvt_pk_bf16_f32 v214, v164, v165
    v_cvt_pk_bf16_f32 v215, v166, v167
    v_cvt_pk_bf16_f32 v216, v168, v169
    v_cvt_pk_bf16_f32 v217, v170, v171
    v_cvt_pk_bf16_f32 v218, v172, v173
    v_cvt_pk_bf16_f32 v219, v174, v175
    v_cvt_pk_bf16_f32 v220, v176, v177
    v_cvt_pk_bf16_f32 v221, v178, v179
    v_cvt_pk_bf16_f32 v222, v180, v181
    v_cvt_pk_bf16_f32 v223, v182, v183
    v_cvt_pk_bf16_f32 v224, v184, v185
    v_cvt_pk_bf16_f32 v225, v186, v187
    v_cvt_pk_bf16_f32 v226, v188, v189
    v_cvt_pk_bf16_f32 v227, v190, v191
    v_cvt_pk_bf16_f32 v228, v192, v193
    v_cvt_pk_bf16_f32 v229, v194, v195
    v_cvt_pk_bf16_f32 v230, v196, v197
    v_cvt_pk_bf16_f32 v231, v198, v199
    v_mov_b32 v33, 0xffffff00
    s_nop 0
    s_waitcnt vmcnt(21)
    ds_read_b64_tr_b16 v[40:41], v21 offset:0
    ds_read_b64_tr_b16 v[42:43], v22 offset:0
    ds_read_b64_tr_b16 v[44:45], v23 offset:0
    ds_read_b64_tr_b16 v[46:47], v24 offset:0
    ds_read_b64_tr_b16 v[48:49], v21 offset:128
    ds_read_b64_tr_b16 v[50:51], v22 offset:128
    ds_read_b64_tr_b16 v[52:53], v23 offset:128
    ds_read_b64_tr_b16 v[54:55], v24 offset:128
    ds_read_b64_tr_b16 v[56:57], v21 offset:256
    ds_read_b64_tr_b16 v[58:59], v22 offset:256
    ds_read_b64_tr_b16 v[60:61], v23 offset:256
    ds_read_b64_tr_b16 v[62:63], v24 offset:256
    s_waitcnt lgkmcnt(0)
    v_mfma_f32_16x16x16_bf16 v[64:67], v[40:41], v[200:201], 0
    v_mfma_f32_16x16x16_bf16 v[68:71], v[42:43], v[200:201], 0
    v_mfma_f32_16x16x16_bf16 v[72:75], v[44:45], v[200:201], 0
    v_mfma_f32_16x16x16_bf16 v[76:79], v[46:47], v[200:201], 0
    v_mfma_f32_16x16x16_bf16 v[80:83], v[48:49], v[200:201], 0
    v_mfma_f32_16x16x16_bf16 v[84:87], v[50:51], v[200:201], 0
    v_mfma_f32_16x16x16_bf16 v[88:91], v[52:53], v[200:201], 0
    v_mfma_f32_16x16x16_bf16 v[92:95], v[54:55], v[200:201], 0
    v_mfma_f32_16x16x16_bf16 v[96:99], v[56:57], v[200:201], 0
    v_mfma_f32_16x16x16_bf16 v[100:103], v[58:59], v[200:201], 0
    v_mfma_f32_16x16x16_bf16 v[104:107], v[60:61], v[200:201], 0
    v_mfma_f32_16x16x16_bf16 v[108:111], v[62:63], v[200:201], 0
    s_waitcnt vmcnt(10)
    s_add_u32 m0, s54, 27648
    s_nop 0
    buffer_load_dwordx4 v5, s[24:27], s55 offen nt lds
    s_waitcnt vmcnt(10)
    s_add_u32 m0, s54, 28672
    s_nop 0
    buffer_load_dwordx4 v6, s[24:27], s55 offen nt lds
    ds_read_b64_tr_b16 v[40:41], v21 offset:6144
    ds_read_b64_tr_b16 v[42:43], v22 offset:6144
    ds_read_b64_tr_b16 v[44:45], v23 offset:6144
    ds_read_b64_tr_b16 v[46:47], v24 offset:6144
    ds_read_b64_tr_b16 v[48:49], v21 offset:6272
    ds_read_b64_tr_b16 v[50:51], v22 offset:6272
    ds_read_b64_tr_b16 v[52:53], v23 offset:6272
    ds_read_b64_tr_b16 v[54:55], v24 offset:6272
    ds_read_b64_tr_b16 v[56:57], v21 offset:6400
    ds_read_b64_tr_b16 v[58:59], v22 offset:6400
    ds_read_b64_tr_b16 v[60:61], v23 offset:6400
    ds_read_b64_tr_b16 v[62:63], v24 offset:6400
    s_waitcnt lgkmcnt(0)
    v_mfma_f32_16x16x16_bf16 v[64:67], v[40:41], v[202:203], v[64:67]
    v_mfma_f32_16x16x16_bf16 v[68:71], v[42:43], v[202:203], v[68:71]
    v_mfma_f32_16x16x16_bf16 v[72:75], v[44:45], v[202:203], v[72:75]
    v_mfma_f32_16x16x16_bf16 v[76:79], v[46:47], v[202:203], v[76:79]
    v_mfma_f32_16x16x16_bf16 v[80:83], v[48:49], v[202:203], v[80:83]
    v_mfma_f32_16x16x16_bf16 v[84:87], v[50:51], v[202:203], v[84:87]
    v_mfma_f32_16x16x16_bf16 v[88:91], v[52:53], v[202:203], v[88:91]
    v_mfma_f32_16x16x16_bf16 v[92:95], v[54:55], v[202:203], v[92:95]
    v_mfma_f32_16x16x16_bf16 v[96:99], v[56:57], v[202:203], v[96:99]
    v_mfma_f32_16x16x16_bf16 v[100:103], v[58:59], v[202:203], v[100:103]
    v_mfma_f32_16x16x16_bf16 v[104:107], v[60:61], v[202:203], v[104:107]
    v_mfma_f32_16x16x16_bf16 v[108:111], v[62:63], v[202:203], v[108:111]
    s_waitcnt vmcnt(10)
    s_add_u32 m0, s54, 29696
    s_nop 0
    buffer_load_dwordx4 v7, s[24:27], s55 offen nt lds
    s_waitcnt vmcnt(10)
    s_add_u32 s55, s58, 20
    s_and_b32 s55, s55, 63
    s_mul_i32 s55, s55, 6144
    s_add_u32 m0, s54, 30720
    s_nop 0
    buffer_load_dwordx4 v2, s[24:27], s55 offen nt lds
    ds_read_b64_tr_b16 v[40:41], v21 offset:12288
    ds_read_b64_tr_b16 v[42:43], v22 offset:12288
    ds_read_b64_tr_b16 v[44:45], v23 offset:12288
    ds_read_b64_tr_b16 v[46:47], v24 offset:12288
    ds_read_b64_tr_b16 v[48:49], v21 offset:12416
    ds_read_b64_tr_b16 v[50:51], v22 offset:12416
    ds_read_b64_tr_b16 v[52:53], v23 offset:12416
    ds_read_b64_tr_b16 v[54:55], v24 offset:12416
    ds_read_b64_tr_b16 v[56:57], v21 offset:12544
    ds_read_b64_tr_b16 v[58:59], v22 offset:12544
    ds_read_b64_tr_b16 v[60:61], v23 offset:12544
    ds_read_b64_tr_b16 v[62:63], v24 offset:12544
    s_waitcnt lgkmcnt(0)
    v_mfma_f32_16x16x16_bf16 v[64:67], v[40:41], v[204:205], v[64:67]
    v_mfma_f32_16x16x16_bf16 v[68:71], v[42:43], v[204:205], v[68:71]
    v_mfma_f32_16x16x16_bf16 v[72:75], v[44:45], v[204:205], v[72:75]
    v_mfma_f32_16x16x16_bf16 v[76:79], v[46:47], v[204:205], v[76:79]
    v_mfma_f32_16x16x16_bf16 v[80:83], v[48:49], v[204:205], v[80:83]
    v_mfma_f32_16x16x16_bf16 v[84:87], v[50:51], v[204:205], v[84:87]
    v_mfma_f32_16x16x16_bf16 v[88:91], v[52:53], v[204:205], v[88:91]
    v_mfma_f32_16x16x16_bf16 v[92:95], v[54:55], v[204:205], v[92:95]
    v_mfma_f32_16x16x16_bf16 v[96:99], v[56:57], v[204:205], v[96:99]
    v_mfma_f32_16x16x16_bf16 v[100:103], v[58:59], v[204:205], v[100:103]
    v_mfma_f32_16x16x16_bf16 v[104:107], v[60:61], v[204:205], v[104:107]
    v_mfma_f32_16x16x16_bf16 v[108:111], v[62:63], v[204:205], v[108:111]
    s_waitcnt vmcnt(10)
    s_add_u32 m0, s54, 31744
    s_nop 0
    buffer_load_dwordx4 v3, s[24:27], s55 offen nt lds
    s_waitcnt vmcnt(10)
    s_add_u32 m0, s54, 32768
    s_nop 0
    buffer_load_dwordx4 v4, s[24:27], s55 offen nt lds
    s_waitcnt vmcnt(10)
    s_add_u32 m0, s54, 33792
    s_nop 0
    buffer_load_dwordx4 v5, s[24:27], s55 offen nt lds
    s_waitcnt vmcnt(10)
    s_add_u32 m0, s54, 34816
    s_nop 0
    buffer_load_dwordx4 v6, s[24:27], s55 offen nt lds
    ds_read_b64_tr_b16 v[40:41], v21 offset:18432
    ds_read_b64_tr_b16 v[42:43], v22 offset:18432
    ds_read_b64_tr_b16 v[44:45], v23 offset:18432
    ds_read_b64_tr_b16 v[46:47], v24 offset:18432
    ds_read_b64_tr_b16 v[48:49], v21 offset:18560
    ds_read_b64_tr_b16 v[50:51], v22 offset:18560
    ds_read_b64_tr_b16 v[52:53], v23 offset:18560
    ds_read_b64_tr_b16 v[54:55], v24 offset:18560
    ds_read_b64_tr_b16 v[56:57], v21 offset:18688
    ds_read_b64_tr_b16 v[58:59], v22 offset:18688
    ds_read_b64_tr_b16 v[60:61], v23 offset:18688
    ds_read_b64_tr_b16 v[62:63], v24 offset:18688
    s_waitcnt lgkmcnt(0)
    v_mfma_f32_16x16x16_bf16 v[64:67], v[40:41], v[206:207], v[64:67]
    v_mfma_f32_16x16x16_bf16 v[68:71], v[42:43], v[206:207], v[68:71]
    v_mfma_f32_16x16x16_bf16 v[72:75], v[44:45], v[206:207], v[72:75]
    v_mfma_f32_16x16x16_bf16 v[76:79], v[46:47], v[206:207], v[76:79]
    v_mfma_f32_16x16x16_bf16 v[80:83], v[48:49], v[206:207], v[80:83]
    v_mfma_f32_16x16x16_bf16 v[84:87], v[50:51], v[206:207], v[84:87]
    v_mfma_f32_16x16x16_bf16 v[88:91], v[52:53], v[206:207], v[88:91]
    v_mfma_f32_16x16x16_bf16 v[92:95], v[54:55], v[206:207], v[92:95]
    v_mfma_f32_16x16x16_bf16 v[96:99], v[56:57], v[206:207], v[96:99]
    v_mfma_f32_16x16x16_bf16 v[100:103], v[58:59], v[206:207], v[100:103]
    v_mfma_f32_16x16x16_bf16 v[104:107], v[60:61], v[206:207], v[104:107]
    v_mfma_f32_16x16x16_bf16 v[108:111], v[62:63], v[206:207], v[108:111]
    s_waitcnt vmcnt(10)
    s_add_u32 m0, s54, 35840
    s_nop 0
    buffer_load_dwordx4 v7, s[24:27], s55 offen nt lds
    s_waitcnt vmcnt(10)
    s_add_u32 s55, s58, 24
    s_and_b32 s55, s55, 63
    s_mul_i32 s55, s55, 6144
    s_add_u32 m0, s54, 0
    s_nop 0
    buffer_load_dwordx4 v2, s[24:27], s55 offen nt lds
    s_waitcnt vmcnt(10)
    s_add_u32 m0, s54, 1024
    s_nop 0
    buffer_load_dwordx4 v3, s[24:27], s55 offen nt lds
    s_waitcnt vmcnt(10)
    s_add_u32 m0, s54, 2048
    s_nop 0
    buffer_load_dwordx4 v4, s[24:27], s55 offen nt lds
    s_waitcnt vmcnt(10)
    s_add_u32 m0, s54, 3072
    s_nop 0
    buffer_load_dwordx4 v5, s[24:27], s55 offen nt lds
    s_waitcnt vmcnt(10)
    s_add_u32 m0, s54, 4096
    s_nop 0
    buffer_load_dwordx4 v6, s[24:27], s55 offen nt lds
    ds_read_b64_tr_b16 v[40:41], v21 offset:24576
    ds_read_b64_tr_b16 v[42:43], v22 offset:24576
    ds_read_b64_tr_b16 v[44:45], v23 offset:24576
    ds_read_b64_tr_b16 v[46:47], v24 offset:24576
    ds_read_b64_tr_b16 v[48:49], v21 offset:24704
    ds_read_b64_tr_b16 v[50:51], v22 offset:24704
    ds_read_b64_tr_b16 v[52:53], v23 offset:24704
    ds_read_b64_tr_b16 v[54:55], v24 offset:24704
    ds_read_b64_tr_b16 v[56:57], v21 offset:24832
    ds_read_b64_tr_b16 v[58:59], v22 offset:24832
    ds_read_b64_tr_b16 v[60:61], v23 offset:24832
    ds_read_b64_tr_b16 v[62:63], v24 offset:24832
    s_waitcnt lgkmcnt(0)
    v_mfma_f32_16x16x16_bf16 v[64:67], v[40:41], v[208:209], v[64:67]
    v_mfma_f32_16x16x16_bf16 v[68:71], v[42:43], v[208:209], v[68:71]
    v_mfma_f32_16x16x16_bf16 v[72:75], v[44:45], v[208:209], v[72:75]
    v_mfma_f32_16x16x16_bf16 v[76:79], v[46:47], v[208:209], v[76:79]
    v_mfma_f32_16x16x16_bf16 v[80:83], v[48:49], v[208:209], v[80:83]
    v_mfma_f32_16x16x16_bf16 v[84:87], v[50:51], v[208:209], v[84:87]
    v_mfma_f32_16x16x16_bf16 v[88:91], v[52:53], v[208:209], v[88:91]
    v_mfma_f32_16x16x16_bf16 v[92:95], v[54:55], v[208:209], v[92:95]
    v_mfma_f32_16x16x16_bf16 v[96:99], v[56:57], v[208:209], v[96:99]
    v_mfma_f32_16x16x16_bf16 v[100:103], v[58:59], v[208:209], v[100:103]
    v_mfma_f32_16x16x16_bf16 v[104:107], v[60:61], v[208:209], v[104:107]
    v_mfma_f32_16x16x16_bf16 v[108:111], v[62:63], v[208:209], v[108:111]
    s_waitcnt vmcnt(10)
    s_add_u32 m0, s54, 5120
    s_nop 0
    buffer_load_dwordx4 v7, s[24:27], s55 offen nt lds
    s_waitcnt vmcnt(10)
    s_add_u32 s55, s58, 28
    s_and_b32 s55, s55, 63
    s_mul_i32 s55, s55, 6144
    s_add_u32 m0, s54, 6144
    s_nop 0
    buffer_load_dwordx4 v2, s[24:27], s55 offen nt lds
    s_waitcnt vmcnt(10)
    s_add_u32 m0, s54, 7168
    s_nop 0
    buffer_load_dwordx4 v3, s[24:27], s55 offen nt lds
    s_waitcnt vmcnt(10)
    s_add_u32 m0, s54, 8192
    s_nop 0
    buffer_load_dwordx4 v4, s[24:27], s55 offen nt lds
    s_waitcnt vmcnt(10)
    s_add_u32 m0, s54, 9216
    s_nop 0
    buffer_load_dwordx4 v5, s[24:27], s55 offen nt lds
    s_waitcnt vmcnt(10)
    s_add_u32 m0, s54, 10240
    s_nop 0
    buffer_load_dwordx4 v6, s[24:27], s55 offen nt lds
    ds_read_b64_tr_b16 v[40:41], v21 offset:30720
    ds_read_b64_tr_b16 v[42:43], v22 offset:30720
    ds_read_b64_tr_b16 v[44:45], v23 offset:30720
    ds_read_b64_tr_b16 v[46:47], v24 offset:30720
    ds_read_b64_tr_b16 v[48:49], v21 offset:30848
    ds_read_b64_tr_b16 v[50:51], v22 offset:30848
    ds_read_b64_tr_b16 v[52:53], v23 offset:30848
    ds_read_b64_tr_b16 v[54:55], v24 offset:30848
    ds_read_b64_tr_b16 v[56:57], v21 offset:30976
    ds_read_b64_tr_b16 v[58:59], v22 offset:30976
    ds_read_b64_tr_b16 v[60:61], v23 offset:30976
    ds_read_b64_tr_b16 v[62:63], v24 offset:30976
    s_waitcnt lgkmcnt(0)
    v_mfma_f32_16x16x16_bf16 v[64:67], v[40:41], v[210:211], v[64:67]
    v_mfma_f32_16x16x16_bf16 v[68:71], v[42:43], v[210:211], v[68:71]
    v_mfma_f32_16x16x16_bf16 v[72:75], v[44:45], v[210:211], v[72:75]
    v_mfma_f32_16x16x16_bf16 v[76:79], v[46:47], v[210:211], v[76:79]
    v_mfma_f32_16x16x16_bf16 v[80:83], v[48:49], v[210:211], v[80:83]
    v_mfma_f32_16x16x16_bf16 v[84:87], v[50:51], v[210:211], v[84:87]
    v_mfma_f32_16x16x16_bf16 v[88:91], v[52:53], v[210:211], v[88:91]
    v_mfma_f32_16x16x16_bf16 v[92:95], v[54:55], v[210:211], v[92:95]
    v_mfma_f32_16x16x16_bf16 v[96:99], v[56:57], v[210:211], v[96:99]
    v_mfma_f32_16x16x16_bf16 v[100:103], v[58:59], v[210:211], v[100:103]
    v_mfma_f32_16x16x16_bf16 v[104:107], v[60:61], v[210:211], v[104:107]
    v_mfma_f32_16x16x16_bf16 v[108:111], v[62:63], v[210:211], v[108:111]
    s_waitcnt vmcnt(10)
    s_add_u32 m0, s54, 11264
    s_nop 0
    buffer_load_dwordx4 v7, s[24:27], s55 offen nt lds
    s_waitcnt vmcnt(10)
    s_add_u32 s55, s58, 32
    s_and_b32 s55, s55, 63
    s_mul_i32 s55, s55, 6144
    s_add_u32 m0, s54, 12288
    s_nop 0
    buffer_load_dwordx4 v2, s[24:27], s55 offen nt lds
    s_waitcnt vmcnt(10)
    s_add_u32 m0, s54, 13312
    s_nop 0
    buffer_load_dwordx4 v3, s[24:27], s55 offen nt lds
    s_waitcnt vmcnt(10)
    s_add_u32 m0, s54, 14336
    s_nop 0
    buffer_load_dwordx4 v4, s[24:27], s55 offen nt lds
    s_waitcnt vmcnt(10)
    s_add_u32 m0, s54, 15360
    s_nop 0
    buffer_load_dwordx4 v5, s[24:27], s55 offen nt lds
    s_waitcnt vmcnt(10)
    s_add_u32 m0, s54, 16384
    s_nop 0
    buffer_load_dwordx4 v6, s[24:27], s55 offen nt lds
    ds_read_b64_tr_b16 v[40:41], v21 offset:0
    ds_read_b64_tr_b16 v[42:43], v22 offset:0
    ds_read_b64_tr_b16 v[44:45], v23 offset:0
    ds_read_b64_tr_b16 v[46:47], v24 offset:0
    ds_read_b64_tr_b16 v[48:49], v21 offset:128
    ds_read_b64_tr_b16 v[50:51], v22 offset:128
    ds_read_b64_tr_b16 v[52:53], v23 offset:128
    ds_read_b64_tr_b16 v[54:55], v24 offset:128
    ds_read_b64_tr_b16 v[56:57], v21 offset:256
    ds_read_b64_tr_b16 v[58:59], v22 offset:256
    ds_read_b64_tr_b16 v[60:61], v23 offset:256
    ds_read_b64_tr_b16 v[62:63], v24 offset:256
    s_waitcnt lgkmcnt(0)
    v_mfma_f32_16x16x16_bf16 v[64:67], v[40:41], v[212:213], v[64:67]
    v_mfma_f32_16x16x16_bf16 v[68:71], v[42:43], v[212:213], v[68:71]
    v_mfma_f32_16x16x16_bf16 v[72:75], v[44:45], v[212:213], v[72:75]
    v_mfma_f32_16x16x16_bf16 v[76:79], v[46:47], v[212:213], v[76:79]
    v_mfma_f32_16x16x16_bf16 v[80:83], v[48:49], v[212:213], v[80:83]
    v_mfma_f32_16x16x16_bf16 v[84:87], v[50:51], v[212:213], v[84:87]
    v_mfma_f32_16x16x16_bf16 v[88:91], v[52:53], v[212:213], v[88:91]
    v_mfma_f32_16x16x16_bf16 v[92:95], v[54:55], v[212:213], v[92:95]
    v_mfma_f32_16x16x16_bf16 v[96:99], v[56:57], v[212:213], v[96:99]
    v_mfma_f32_16x16x16_bf16 v[100:103], v[58:59], v[212:213], v[100:103]
    v_mfma_f32_16x16x16_bf16 v[104:107], v[60:61], v[212:213], v[104:107]
    v_mfma_f32_16x16x16_bf16 v[108:111], v[62:63], v[212:213], v[108:111]
    s_waitcnt vmcnt(10)
    s_add_u32 m0, s54, 17408
    s_nop 0
    buffer_load_dwordx4 v7, s[24:27], s55 offen nt lds
    s_waitcnt vmcnt(10)
    s_add_u32 s55, s58, 36
    s_and_b32 s55, s55, 63
    s_mul_i32 s55, s55, 6144
    s_add_u32 m0, s54, 18432
    s_nop 0
    buffer_load_dwordx4 v2, s[24:27], s55 offen nt lds
    s_waitcnt vmcnt(10)
    s_add_u32 m0, s54, 19456
    s_nop 0
    buffer_load_dwordx4 v3, s[24:27], s55 offen nt lds
    s_waitcnt vmcnt(10)
    s_add_u32 m0, s54, 20480
    s_nop 0
    buffer_load_dwordx4 v4, s[24:27], s55 offen nt lds
    s_waitcnt vmcnt(10)
    s_add_u32 m0, s54, 21504
    s_nop 0
    buffer_load_dwordx4 v5, s[24:27], s55 offen nt lds
    s_waitcnt vmcnt(10)
    s_add_u32 m0, s54, 22528
    s_nop 0
    buffer_load_dwordx4 v6, s[24:27], s55 offen nt lds
    ds_read_b64_tr_b16 v[40:41], v21 offset:6144
    ds_read_b64_tr_b16 v[42:43], v22 offset:6144
    ds_read_b64_tr_b16 v[44:45], v23 offset:6144
    ds_read_b64_tr_b16 v[46:47], v24 offset:6144
    ds_read_b64_tr_b16 v[48:49], v21 offset:6272
    ds_read_b64_tr_b16 v[50:51], v22 offset:6272
    ds_read_b64_tr_b16 v[52:53], v23 offset:6272
    ds_read_b64_tr_b16 v[54:55], v24 offset:6272
    ds_read_b64_tr_b16 v[56:57], v21 offset:6400
    ds_read_b64_tr_b16 v[58:59], v22 offset:6400
    ds_read_b64_tr_b16 v[60:61], v23 offset:6400
    ds_read_b64_tr_b16 v[62:63], v24 offset:6400
    s_waitcnt lgkmcnt(0)
    v_mfma_f32_16x16x16_bf16 v[64:67], v[40:41], v[214:215], v[64:67]
    v_mfma_f32_16x16x16_bf16 v[68:71], v[42:43], v[214:215], v[68:71]
    v_mfma_f32_16x16x16_bf16 v[72:75], v[44:45], v[214:215], v[72:75]
    v_mfma_f32_16x16x16_bf16 v[76:79], v[46:47], v[214:215], v[76:79]
    v_mfma_f32_16x16x16_bf16 v[80:83], v[48:49], v[214:215], v[80:83]
    v_mfma_f32_16x16x16_bf16 v[84:87], v[50:51], v[214:215], v[84:87]
    v_mfma_f32_16x16x16_bf16 v[88:91], v[52:53], v[214:215], v[88:91]
    v_mfma_f32_16x16x16_bf16 v[92:95], v[54:55], v[214:215], v[92:95]
    v_mfma_f32_16x16x16_bf16 v[96:99], v[56:57], v[214:215], v[96:99]
    v_mfma_f32_16x16x16_bf16 v[100:103], v[58:59], v[214:215], v[100:103]
    v_mfma_f32_16x16x16_bf16 v[104:107], v[60:61], v[214:215], v[104:107]
    v_mfma_f32_16x16x16_bf16 v[108:111], v[62:63], v[214:215], v[108:111]
    s_waitcnt vmcnt(10)
    s_add_u32 m0, s54, 23552
    s_nop 0
    buffer_load_dwordx4 v7, s[24:27], s55 offen nt lds
    s_waitcnt vmcnt(10)
    s_add_u32 s55, s58, 40
    s_and_b32 s55, s55, 63
    s_mul_i32 s55, s55, 6144
    s_add_u32 m0, s54, 24576
    s_nop 0
    buffer_load_dwordx4 v236, s[24:27], s55 offen nt lds
    s_waitcnt vmcnt(10)
    s_add_u32 m0, s54, 25600
    s_nop 0
    buffer_load_dwordx4 v237, s[24:27], s55 offen nt lds
    s_waitcnt vmcnt(10)
    s_add_u32 s55, s58, 44
    s_and_b32 s55, s55, 63
    s_mul_i32 s55, s55, 6144
    s_add_u32 m0, s54, 26624
    s_nop 0
    buffer_load_dwordx4 v236, s[24:27], s55 offen nt lds
    s_waitcnt vmcnt(10)
    s_add_u32 m0, s54, 27648
    s_nop 0
    buffer_load_dwordx4 v237, s[24:27], s55 offen nt lds
    s_waitcnt vmcnt(10)
    s_add_u32 s55, s58, 48
    s_and_b32 s55, s55, 63
    s_mul_i32 s55, s55, 6144
    s_add_u32 m0, s54, 28672
    s_nop 0
    buffer_load_dwordx4 v236, s[24:27], s55 offen nt lds
    ds_read_b64_tr_b16 v[40:41], v21 offset:12288
    ds_read_b64_tr_b16 v[42:43], v22 offset:12288
    ds_read_b64_tr_b16 v[44:45], v23 offset:12288
    ds_read_b64_tr_b16 v[46:47], v24 offset:12288
    ds_read_b64_tr_b16 v[48:49], v21 offset:12416
    ds_read_b64_tr_b16 v[50:51], v22 offset:12416
    ds_read_b64_tr_b16 v[52:53], v23 offset:12416
    ds_read_b64_tr_b16 v[54:55], v24 offset:12416
    ds_read_b64_tr_b16 v[56:57], v21 offset:12544
    ds_read_b64_tr_b16 v[58:59], v22 offset:12544
    ds_read_b64_tr_b16 v[60:61], v23 offset:12544
    ds_read_b64_tr_b16 v[62:63], v24 offset:12544
    s_waitcnt lgkmcnt(0)
    v_mfma_f32_16x16x16_bf16 v[64:67], v[40:41], v[216:217], v[64:67]
    v_mfma_f32_16x16x16_bf16 v[68:71], v[42:43], v[216:217], v[68:71]
    v_mfma_f32_16x16x16_bf16 v[72:75], v[44:45], v[216:217], v[72:75]
    v_mfma_f32_16x16x16_bf16 v[76:79], v[46:47], v[216:217], v[76:79]
    v_mfma_f32_16x16x16_bf16 v[80:83], v[48:49], v[216:217], v[80:83]
    v_mfma_f32_16x16x16_bf16 v[84:87], v[50:51], v[216:217], v[84:87]
    v_mfma_f32_16x16x16_bf16 v[88:91], v[52:53], v[216:217], v[88:91]
    v_mfma_f32_16x16x16_bf16 v[92:95], v[54:55], v[216:217], v[92:95]
    v_mfma_f32_16x16x16_bf16 v[96:99], v[56:57], v[216:217], v[96:99]
    v_mfma_f32_16x16x16_bf16 v[100:103], v[58:59], v[216:217], v[100:103]
    v_mfma_f32_16x16x16_bf16 v[104:107], v[60:61], v[216:217], v[104:107]
    v_mfma_f32_16x16x16_bf16 v[108:111], v[62:63], v[216:217], v[108:111]
    s_waitcnt vmcnt(10)
    s_add_u32 m0, s54, 29696
    s_nop 0
    buffer_load_dwordx4 v237, s[24:27], s55 offen nt lds
    s_waitcnt vmcnt(10)
    s_add_u32 s55, s58, 52
    s_and_b32 s55, s55, 63
    s_mul_i32 s55, s55, 6144
    s_add_u32 m0, s54, 30720
    s_nop 0
    buffer_load_dwordx4 v236, s[24:27], s55 offen nt lds
    s_waitcnt vmcnt(10)
    s_add_u32 m0, s54, 31744
    s_nop 0
    buffer_load_dwordx4 v237, s[24:27], s55 offen nt lds
    s_waitcnt vmcnt(10)
    s_add_u32 s55, s58, 56
    s_and_b32 s55, s55, 63
    s_mul_i32 s55, s55, 6144
    s_add_u32 m0, s54, 32768
    s_nop 0
    buffer_load_dwordx4 v236, s[24:27], s55 offen nt lds
    s_waitcnt vmcnt(10)
    s_add_u32 m0, s54, 33792
    s_nop 0
    buffer_load_dwordx4 v237, s[24:27], s55 offen nt lds
    s_waitcnt vmcnt(10)
    s_add_u32 s55, s58, 60
    s_and_b32 s55, s55, 63
    s_mul_i32 s55, s55, 6144
    s_add_u32 m0, s54, 34816
    s_nop 0
    buffer_load_dwordx4 v236, s[24:27], s55 offen nt lds
    ds_read_b64_tr_b16 v[40:41], v21 offset:18432
    ds_read_b64_tr_b16 v[42:43], v22 offset:18432
    ds_read_b64_tr_b16 v[44:45], v23 offset:18432
    ds_read_b64_tr_b16 v[46:47], v24 offset:18432
    ds_read_b64_tr_b16 v[48:49], v21 offset:18560
    ds_read_b64_tr_b16 v[50:51], v22 offset:18560
    ds_read_b64_tr_b16 v[52:53], v23 offset:18560
    ds_read_b64_tr_b16 v[54:55], v24 offset:18560
    ds_read_b64_tr_b16 v[56:57], v21 offset:18688
    ds_read_b64_tr_b16 v[58:59], v22 offset:18688
    ds_read_b64_tr_b16 v[60:61], v23 offset:18688
    ds_read_b64_tr_b16 v[62:63], v24 offset:18688
    s_waitcnt lgkmcnt(0)
    v_mfma_f32_16x16x16_bf16 v[64:67], v[40:41], v[218:219], v[64:67]
    v_mfma_f32_16x16x16_bf16 v[68:71], v[42:43], v[218:219], v[68:71]
    v_mfma_f32_16x16x16_bf16 v[72:75], v[44:45], v[218:219], v[72:75]
    v_mfma_f32_16x16x16_bf16 v[76:79], v[46:47], v[218:219], v[76:79]
    v_mfma_f32_16x16x16_bf16 v[80:83], v[48:49], v[218:219], v[80:83]
    v_mfma_f32_16x16x16_bf16 v[84:87], v[50:51], v[218:219], v[84:87]
    v_mfma_f32_16x16x16_bf16 v[88:91], v[52:53], v[218:219], v[88:91]
    v_mfma_f32_16x16x16_bf16 v[92:95], v[54:55], v[218:219], v[92:95]
    v_mfma_f32_16x16x16_bf16 v[96:99], v[56:57], v[218:219], v[96:99]
    v_mfma_f32_16x16x16_bf16 v[100:103], v[58:59], v[218:219], v[100:103]
    v_mfma_f32_16x16x16_bf16 v[104:107], v[60:61], v[218:219], v[104:107]
    v_mfma_f32_16x16x16_bf16 v[108:111], v[62:63], v[218:219], v[108:111]
    s_waitcnt vmcnt(10)
    s_add_u32 m0, s54, 35840
    s_nop 0
    buffer_load_dwordx4 v237, s[24:27], s55 offen nt lds
    s_waitcnt vmcnt(10)
    s_add_u32 s55, s58, 40
    s_and_b32 s55, s55, 63
    s_mul_i32 s55, s55, 6144
    s_add_u32 s55, s55, 128
    s_add_u32 m0, s54, 0
    s_nop 0
    buffer_load_dwordx4 v236, s[24:27], s55 offen nt lds
    s_waitcnt vmcnt(10)
    s_add_u32 m0, s54, 1024
    s_nop 0
    buffer_load_dwordx4 v237, s[24:27], s55 offen nt lds
    s_waitcnt vmcnt(10)
    s_add_u32 s55, s58, 44
    s_and_b32 s55, s55, 63
    s_mul_i32 s55, s55, 6144
    s_add_u32 s55, s55, 128
    s_add_u32 m0, s54, 2048
    s_nop 0
    buffer_load_dwordx4 v236, s[24:27], s55 offen nt lds
    s_waitcnt vmcnt(10)
    s_add_u32 m0, s54, 3072
    s_nop 0
    buffer_load_dwordx4 v237, s[24:27], s55 offen nt lds
    s_waitcnt vmcnt(10)
    s_add_u32 s55, s58, 48
    s_and_b32 s55, s55, 63
    s_mul_i32 s55, s55, 6144
    s_add_u32 s55, s55, 128
    s_add_u32 m0, s54, 4096
    s_nop 0
    buffer_load_dwordx4 v236, s[24:27], s55 offen nt lds
    ds_read_b64_tr_b16 v[40:41], v238 offset:24576
    ds_read_b64_tr_b16 v[42:43], v238 offset:26624
    ds_read_b64_tr_b16 v[44:45], v239 offset:24576
    ds_read_b64_tr_b16 v[46:47], v239 offset:26624
    ds_read_b64_tr_b16 v[48:49], v240 offset:24576
    ds_read_b64_tr_b16 v[50:51], v240 offset:26624
    ds_read_b64_tr_b16 v[52:53], v241 offset:24576
    ds_read_b64_tr_b16 v[54:55], v241 offset:26624
    ds_read_b64_tr_b16 v[56:57], v238 offset:28672
    ds_read_b64_tr_b16 v[58:59], v239 offset:28672
    ds_read_b64_tr_b16 v[60:61], v240 offset:28672
    ds_read_b64_tr_b16 v[62:63], v241 offset:28672
    s_waitcnt lgkmcnt(0)
    s_waitcnt vmcnt(10)
    s_add_u32 m0, s54, 5120
    s_nop 0
    buffer_load_dwordx4 v237, s[24:27], s55 offen nt lds
    s_waitcnt vmcnt(10)
    s_add_u32 s55, s58, 52
    s_and_b32 s55, s55, 63
    s_mul_i32 s55, s55, 6144
    s_add_u32 s55, s55, 128
    s_add_u32 m0, s54, 6144
    s_nop 0
    buffer_load_dwordx4 v236, s[24:27], s55 offen nt lds
    v_mfma_f32_16x16x32_bf16 v[64:67], v[40:43], v[220:223], v[64:67]
    v_mfma_f32_16x16x32_bf16 v[68:71], v[44:47], v[220:223], v[68:71]
    v_mfma_f32_16x16x32_bf16 v[72:75], v[48:51], v[220:223], v[72:75]
    v_mfma_f32_16x16x32_bf16 v[76:79], v[52:55], v[220:223], v[76:79]
    s_nop 2
    v_mfma_f32_16x16x16_bf16 v[64:67], v[56:57], v[224:225], v[64:67]
    v_mfma_f32_16x16x16_bf16 v[68:71], v[58:59], v[224:225], v[68:71]
    v_mfma_f32_16x16x16_bf16 v[72:75], v[60:61], v[224:225], v[72:75]
    v_mfma_f32_16x16x16_bf16 v[76:79], v[62:63], v[224:225], v[76:79]
    s_branch L_merge
L_grp_3:
    s_add_u32 s55, s58, 0
    s_and_b32 s55, s55, 63
    s_mul_i32 s55, s55, 6144
    s_add_u32 m0, s54, 0
    s_nop 0
    buffer_load_dwordx4 v2, s[20:23], s55 offen nt lds
    s_add_u32 m0, s54, 1024
    s_nop 0
    buffer_load_dwordx4 v3, s[20:23], s55 offen nt lds
    s_add_u32 m0, s54, 2048
    s_nop 0
    buffer_load_dwordx4 v4, s[20:23], s55 offen nt lds
    s_add_u32 m0, s54, 3072
    s_nop 0
    buffer_load_dwordx4 v5, s[20:23], s55 offen nt lds
    s_mov_b32 s70, 0x3d93cd3a
    s_mov_b32 s71, 0x3fb8aa3b
    s_mul_i32 s56, s53, 245760
    s_add_u32 s32, s12, s56
    s_addc_u32 s33, s13, 0
    s_and_b32 s33, s33, 0xffff
    s_mov_b32 s34, 245760
    s_mov_b32 s35, 0x20000
    s_mul_i32 s56, s3, 320
    v_add_u32 v36, 0, v1
    v_mul_u32_u24 v37, 205, v36
    v_lshrrev_b32 v37, 12, v37
    v_mul_u32_u24 v37, 960, v37
    v_lshl_add_u32 v37, v36, 4, v37
    v_add_u32 v14, s56, v37
    v_add_u32 v36, 64, v1
    v_mul_u32_u24 v37, 205, v36
    v_lshrrev_b32 v37, 12, v37
    v_mul_u32_u24 v37, 960, v37
    v_lshl_add_u32 v37, v36, 4, v37
    v_add_u32 v15, s56, v37
    v_add_u32 v36, 128, v1
    v_mul_u32_u24 v37, 205, v36
    v_lshrrev_b32 v37, 12, v37
    v_mul_u32_u24 v37, 960, v37
    v_lshl_add_u32 v37, v36, 4, v37
    v_add_u32 v16, s56, v37
    v_add_u32 v36, 192, v1
    v_mul_u32_u24 v37, 205, v36
    v_lshrrev_b32 v37, 12, v37
    v_mul_u32_u24 v37, 960, v37
    v_lshl_add_u32 v37, v36, 4, v37
    v_add_u32 v17, s56, v37
    v_add_u32 v36, 256, v1
    v_mul_u32_u24 v37, 205, v36
    v_lshrrev_b32 v37, 12, v37
    v_mul_u32_u24 v37, 960, v37
    v_lshl_add_u32 v37, v36, 4, v37
    v_add_u32 v18, s56, v37
    v_and_b32 v36, 15, v1
    v_and_b32 v37, 6, v36
    v_xor_b32 v37, v37, v34
    v_lshlrev_b32 v37, 4, v37
    v_mul_u32_u24 v36, 384, v36
    v_add3_u32 v19, v36, v37, s54
    v_xor_b32 v20, 64, v19
    v_lshrrev_b32 v36, 2, v1
    v_and_b32 v37, 6, v36
    v_lshlrev_b32 v37, 4, v37
    v_lshl_add_u32 v37, v35, 3, v37
    v_mul_u32_u24 v38, 384, v36
    v_add3_u32 v21, v38, v37, s54
    v_xor_b32 v22, 32, v21
    v_xor_b32 v23, 64, v21
    v_xor_b32 v24, 96, v21
    v_mul_u32_u24 v38, 320, v36
    v_lshl_add_u32 v38, v35, 3, v38
    v_add_u32 v25, s54, v38
    v_mul_u32_u24 v36, 784, v35
    v_lshl_add_u32 v36, v34, 4, v36
    v_add_u32 v26, s74, v36
    v_mul_u32_u24 v37, 1366, v0
    v_lshrrev_b32 v37, 16, v37
    v_lshlrev_b32 v37, 4, v37
    v_lshl_add_u32 v36, v0, 4, v37
    v_add_u32 v27, 147456, v36
    v_lshl_add_u32 v36, v0, 3, v37
    v_add_u32 v28, 160000, v36
    v_mul_u32_u24 v36, 400, v35
    v_add_u32 v36, 160000, v36
    v_lshl_add_u32 v29, v34, 4, v36
    v_lshlrev_b32 v36, 6, v35
    v_add_u32 v32, 161600, v36
    s_lshl_b32 s56, s3, 4
    v_lshl_add_u32 v36, v34, 2, v32
    v_add_u32 v31, s56, v36
    v_lshlrev_b32 v30, 4, v1
    s_lshr_b32 s79, s52, 2
    s_mul_i32 s79, s79, 122880
    s_mul_i32 s56, s3, 8192
    s_add_u32 s79, s79, s56
    s_add_u32 s79, s79, 90112
    v_mul_u32_u24 v36, 320, v35
    v_lshl_add_u32 v36, v34, 3, v36
    v_add_u32 v36, s74, v36
    s_waitcnt vmcnt(10)
    v_lshl_add_u32 v37, s60, 5, v36
    ds_read_b64 v[232:233], v37
    v_lshl_add_u32 v37, s61, 5, v36
    ds_read_b64 v[234:235], v37
    v_lshl_add_u32 v37, s62, 5, v36
    ds_read_b64 v[236:237], v37
    v_lshl_add_u32 v37, s63, 5, v36
    ds_read_b64 v[238:239], v37
    v_lshl_add_u32 v37, s64, 5, v36
    ds_read_b64 v[240:241], v37
    v_lshl_add_u32 v37, s65, 5, v36
    ds_read_b64 v[242:243], v37
    v_lshl_add_u32 v37, s66, 5, v36
    ds_read_b64 v[244:245], v37
    v_lshl_add_u32 v37, s67, 5, v36
    ds_read_b64 v[246:247], v37
    v_lshl_add_u32 v37, s68, 5, v36
    ds_read_b64 v[248:249], v37
    v_lshl_add_u32 v37, s69, 5, v36
    ds_read_b64 v[250:251], v37
    s_add_u32 m0, s54, 4096
    s_nop 0
    buffer_load_dwordx4 v6, s[20:23], s55 offen nt lds
    s_add_u32 m0, s54, 5120
    s_nop 0
    buffer_load_dwordx4 v7, s[20:23], s55 offen nt lds
    s_waitcnt vmcnt(11)
    s_add_u32 s55, s58, 4
    s_and_b32 s55, s55, 63
    s_mul_i32 s55, s55, 6144
    s_add_u32 m0, s54, 6144
    s_nop 0
    buffer_load_dwordx4 v2, s[20:23], s55 offen nt lds
    s_waitcnt vmcnt(11)
    s_add_u32 m0, s54, 7168
    s_nop 0
    buffer_load_dwordx4 v3, s[20:23], s55 offen nt lds
    s_waitcnt vmcnt(11)
    s_add_u32 m0, s54, 8192
    s_nop 0
    buffer_load_dwordx4 v4, s[20:23], s55 offen nt lds
    s_waitcnt vmcnt(11)
    s_add_u32 m0, s54, 9216
    s_nop 0
    buffer_load_dwordx4 v5, s[20:23], s55 offen nt lds
    s_waitcnt vmcnt(11)
    s_add_u32 m0, s54, 10240
    s_nop 0
    buffer_load_dwordx4 v6, s[20:23], s55 offen nt lds
    s_waitcnt vmcnt(11)
    s_add_u32 m0, s54, 11264
    s_nop 0
    buffer_load_dwordx4 v7, s[20:23], s55 offen nt lds
    ds_read_b64_tr_b16 v[40:41], v21 offset:24576
    ds_read_b64_tr_b16 v[42:43], v22 offset:24576
    ds_read_b64_tr_b16 v[44:45], v23 offset:24576
    ds_read_b64_tr_b16 v[46:47], v24 offset:24576
    ds_read_b64_tr_b16 v[48:49], v21 offset:24704
    ds_read_b64_tr_b16 v[50:51], v22 offset:24704
    ds_read_b64_tr_b16 v[52:53], v23 offset:24704
    ds_read_b64_tr_b16 v[54:55], v24 offset:24704
    ds_read_b64_tr_b16 v[56:57], v21 offset:24832
    ds_read_b64_tr_b16 v[58:59], v22 offset:24832
    ds_read_b64_tr_b16 v[60:61], v23 offset:24832
    ds_read_b64_tr_b16 v[62:63], v24 offset:24832
    s_waitcnt lgkmcnt(0)
    v_mfma_f32_16x16x16_bf16 v[64:67], v[40:41], v[232:233], 0
    v_mfma_f32_16x16x16_bf16 v[68:71], v[42:43], v[232:233], 0
    v_mfma_f32_16x16x16_bf16 v[72:75], v[44:45], v[232:233], 0
    v_mfma_f32_16x16x16_bf16 v[76:79], v[46:47], v[232:233], 0
    v_mfma_f32_16x16x16_bf16 v[80:83], v[48:49], v[232:233], 0
    v_mfma_f32_16x16x16_bf16 v[84:87], v[50:51], v[232:233], 0
    v_mfma_f32_16x16x16_bf16 v[88:91], v[52:53], v[232:233], 0
    v_mfma_f32_16x16x16_bf16 v[92:95], v[54:55], v[232:233], 0
    v_mfma_f32_16x16x16_bf16 v[96:99], v[56:57], v[232:233], 0
    v_mfma_f32_16x16x16_bf16 v[100:103], v[58:59], v[232:233], 0
    v_mfma_f32_16x16x16_bf16 v[104:107], v[60:61], v[232:233], 0
    v_mfma_f32_16x16x16_bf16 v[108:111], v[62:63], v[232:233], 0
    s_waitcnt vmcnt(11)
    s_add_u32 s55, s58, 8
    s_and_b32 s55, s55, 63
    s_mul_i32 s55, s55, 6144
    s_add_u32 m0, s54, 12288
    s_nop 0
    buffer_load_dwordx4 v2, s[20:23], s55 offen nt lds
    s_waitcnt vmcnt(11)
    s_add_u32 m0, s54, 13312
    s_nop 0
    buffer_load_dwordx4 v3, s[20:23], s55 offen nt lds
    s_waitcnt vmcnt(11)
    s_add_u32 m0, s54, 14336
    s_nop 0
    buffer_load_dwordx4 v4, s[20:23], s55 offen nt lds
    s_waitcnt vmcnt(11)
    s_add_u32 m0, s54, 15360
    s_nop 0
    buffer_load_dwordx4 v5, s[20:23], s55 offen nt lds
    s_waitcnt vmcnt(11)
    s_add_u32 m0, s54, 16384
    s_nop 0
    buffer_load_dwordx4 v6, s[20:23], s55 offen nt lds
    s_waitcnt vmcnt(11)
    s_add_u32 m0, s54, 17408
    s_nop 0
    buffer_load_dwordx4 v7, s[20:23], s55 offen nt lds
    s_waitcnt vmcnt(11)
    s_add_u32 s55, s58, 12
    s_and_b32 s55, s55, 63
    s_mul_i32 s55, s55, 6144
    s_add_u32 m0, s54, 18432
    s_nop 0
    buffer_load_dwordx4 v2, s[20:23], s55 offen nt lds
    s_waitcnt vmcnt(11)
    s_add_u32 m0, s54, 19456
    s_nop 0
    buffer_load_dwordx4 v3, s[20:23], s55 offen nt lds
    s_waitcnt vmcnt(11)
    s_add_u32 m0, s54, 20480
    s_nop 0
    buffer_load_dwordx4 v4, s[20:23], s55 offen nt lds
    s_waitcnt vmcnt(11)
    s_add_u32 m0, s54, 21504
    s_nop 0
    buffer_load_dwordx4 v5, s[20:23], s55 offen nt lds
    s_waitcnt vmcnt(11)
    s_add_u32 m0, s54, 22528
    s_nop 0
    buffer_load_dwordx4 v6, s[20:23], s55 offen nt lds
    s_waitcnt vmcnt(11)
    s_add_u32 m0, s54, 23552
    s_nop 0
    buffer_load_dwordx4 v7, s[20:23], s55 offen nt lds
    s_waitcnt vmcnt(11)
    s_add_u32 s55, s58, 16
    s_and_b32 s55, s55, 63
    s_mul_i32 s55, s55, 6144
    buffer_load_dwordx4 a[216:219], v2, s[20:23], s55 offen nt
    s_waitcnt vmcnt(11)
    buffer_load_dwordx4 a[220:223], v3, s[20:23], s55 offen nt
    s_waitcnt vmcnt(11)
    buffer_load_dwordx4 a[224:227], v4, s[20:23], s55 offen nt
    s_waitcnt vmcnt(11)
    buffer_load_dwordx4 a[228:231], v5, s[20:23], s55 offen nt
    s_waitcnt vmcnt(11)
    buffer_load_dwordx4 a[232:235], v6, s[20:23], s55 offen nt
    s_waitcnt vmcnt(11)
    buffer_load_dwordx4 a[236:239], v7, s[20:23], s55 offen nt
    s_waitcnt vmcnt(11)
    s_add_u32 s55, s58, 20
    s_and_b32 s55, s55, 63
    s_mul_i32 s55, s55, 6144
    buffer_load_dwordx4 a[192:195], v2, s[20:23], s55 offen nt
    s_waitcnt vmcnt(11)
    buffer_load_dwordx4 a[196:199], v3, s[20:23], s55 offen nt
    s_waitcnt vmcnt(11)
    buffer_load_dwordx4 a[200:203], v4, s[20:23], s55 offen nt
    s_waitcnt vmcnt(11)
    buffer_load_dwordx4 a[204:207], v5, s[20:23], s55 offen nt
    s_waitcnt vmcnt(11)
    buffer_load_dwordx4 a[208:211], v6, s[20:23], s55 offen nt
    s_waitcnt vmcnt(11)
    buffer_load_dwordx4 a[212:215], v7, s[20:23], s55 offen nt
    s_waitcnt vmcnt(11)
    s_add_u32 s55, s58, 24
    s_and_b32 s55, s55, 63
    s_mul_i32 s55, s55, 6144
    buffer_load_dwordx4 a[168:171], v2, s[20:23], s55 offen nt
    s_waitcnt vmcnt(11)
    buffer_load_dwordx4 a[172:175], v3, s[20:23], s55 offen nt
    s_waitcnt vmcnt(11)
    buffer_load_dwordx4 a[176:179], v4, s[20:23], s55 offen nt
    s_waitcnt vmcnt(11)
    buffer_load_dwordx4 a[180:183], v5, s[20:23], s55 offen nt
    s_waitcnt vmcnt(11)
    buffer_load_dwordx4 a[184:187], v6, s[20:23], s55 offen nt
    s_waitcnt vmcnt(11)
    buffer_load_dwordx4 a[188:191], v7, s[20:23], s55 offen nt
    s_waitcnt vmcnt(11)
    s_add_u32 s55, s58, 28
    s_and_b32 s55, s55, 63
    s_mul_i32 s55, s55, 6144
    buffer_load_dwordx4 a[144:147], v2, s[20:23], s55 offen nt
    s_waitcnt vmcnt(11)
    buffer_load_dwordx4 a[148:151], v3, s[20:23], s55 offen nt
    s_waitcnt vmcnt(11)
    buffer_load_dwordx4 a[152:155], v4, s[20:23], s55 offen nt
    s_waitcnt vmcnt(11)
    buffer_load_dwordx4 a[156:159], v5, s[20:23], s55 offen nt
    s_waitcnt vmcnt(11)
    buffer_load_dwordx4 a[160:163], v6, s[20:23], s55 offen nt
    s_waitcnt vmcnt(11)
    buffer_load_dwordx4 a[164:167], v7, s[20:23], s55 offen nt
    s_waitcnt vmcnt(11)
    s_add_u32 s55, s58, 32
    s_and_b32 s55, s55, 63
    s_mul_i32 s55, s55, 6144
    buffer_load_dwordx4 a[120:123], v2, s[20:23], s55 offen nt
    s_waitcnt vmcnt(11)
    buffer_load_dwordx4 a[124:127], v3, s[20:23], s55 offen nt
    s_waitcnt vmcnt(11)
    buffer_load_dwordx4 a[128:131], v4, s[20:23], s55 offen nt
    s_waitcnt vmcnt(11)
    buffer_load_dwordx4 a[132:135], v5, s[20:23], s55 offen nt
    s_waitcnt vmcnt(11)
    buffer_load_dwordx4 a[136:139], v6, s[20:23], s55 offen nt
    s_waitcnt vmcnt(11)
    buffer_load_dwordx4 a[140:143], v7, s[20:23], s55 offen nt
    s_waitcnt vmcnt(11)
    s_branch L_page_6
    .p2align 12
L_page_6:
    s_add_u32 s55, s58, 36
    s_and_b32 s55, s55, 63
    s_mul_i32 s55, s55, 6144
    buffer_load_dwordx4 a[96:99], v2, s[20:23], s55 offen nt
    s_waitcnt vmcnt(11)
    buffer_load_dwordx4 a[100:103], v3, s[20:23], s55 offen nt
    s_waitcnt vmcnt(11)
    buffer_load_dwordx4 a[104:107], v4, s[20:23], s55 offen nt
    s_waitcnt vmcnt(11)
    buffer_load_dwordx4 a[108:111], v5, s[20:23], s55 offen nt
    s_waitcnt vmcnt(11)
    buffer_load_dwordx4 a[112:115], v6, s[20:23], s55 offen nt
    s_waitcnt vmcnt(11)
    buffer_load_dwordx4 a[116:119], v7, s[20:23], s55 offen nt
    s_waitcnt vmcnt(11)
    s_mul_i32 s55, s61, 196608
    s_add_u32 s55, s55, s59
    s_add_u32 m0, s54, 30720
    s_nop 0
    buffer_load_dwordx4 v8, s[28:31], s55 offen  lds
    s_waitcnt vmcnt(11)
    s_add_u32 m0, s54, 31744
    s_nop 0
    buffer_load_dwordx4 v9, s[28:31], s55 offen  lds
    s_waitcnt vmcnt(11)
    s_add_u32 m0, s54, 32768
    s_nop 0
    buffer_load_dwordx4 v10, s[28:31], s55 offen  lds
    s_waitcnt vmcnt(11)
    s_add_u32 m0, s54, 33792
    s_nop 0
    buffer_load_dwordx4 v11, s[28:31], s55 offen  lds
    s_waitcnt vmcnt(11)
    s_add_u32 m0, s54, 34816
    s_nop 0
    buffer_load_dwordx4 v12, s[28:31], s55 offen  lds
    s_waitcnt vmcnt(11)
    s_add_u32 m0, s54, 35840
    s_nop 0
    buffer_load_dwordx4 v13, s[28:31], s55 offen  lds
    s_waitcnt vmcnt(11)
    s_mul_i32 s55, s62, 196608
    s_add_u32 s55, s55, s59
    s_add_u32 m0, s54, 24576
    s_nop 0
    buffer_load_dwordx4 v8, s[28:31], s55 offen  lds
    s_waitcnt vmcnt(11)
    s_add_u32 m0, s54, 25600
    s_nop 0
    buffer_load_dwordx4 v9, s[28:31], s55 offen  lds
    s_waitcnt vmcnt(11)
    s_add_u32 m0, s54, 26624
    s_nop 0
    buffer_load_dwordx4 v10, s[28:31], s55 offen  lds
    s_waitcnt vmcnt(11)
    s_add_u32 m0, s54, 27648
    s_nop 0
    buffer_load_dwordx4 v11, s[28:31], s55 offen  lds
    s_waitcnt vmcnt(11)
    s_add_u32 m0, s54, 28672
    s_nop 0
    buffer_load_dwordx4 v12, s[28:31], s55 offen  lds
    s_waitcnt vmcnt(11)
    s_add_u32 m0, s54, 29696
    s_nop 0
    buffer_load_dwordx4 v13, s[28:31], s55 offen  lds
    s_waitcnt vmcnt(6)
    ds_read_b64_tr_b16 v[40:41], v21 offset:30720
    ds_read_b64_tr_b16 v[42:43], v22 offset:30720
    ds_read_b64_tr_b16 v[44:45], v23 offset:30720
    ds_read_b64_tr_b16 v[46:47], v24 offset:30720
    ds_read_b64_tr_b16 v[48:49], v21 offset:30848
    ds_read_b64_tr_b16 v[50:51], v22 offset:30848
    ds_read_b64_tr_b16 v[52:53], v23 offset:30848
    ds_read_b64_tr_b16 v[54:55], v24 offset:30848
    ds_read_b64_tr_b16 v[56:57], v21 offset:30976
    ds_read_b64_tr_b16 v[58:59], v22 offset:30976
    ds_read_b64_tr_b16 v[60:61], v23 offset:30976
    ds_read_b64_tr_b16 v[62:63], v24 offset:30976
    s_waitcnt lgkmcnt(0)
    s_mul_i32 s55, s63, 196608
    s_add_u32 s55, s55, s59
    s_add_u32 m0, s54, 30720
    s_nop 0
    buffer_load_dwordx4 v8, s[28:31], s55 offen  lds
    s_add_u32 m0, s54, 31744
    s_nop 0
    buffer_load_dwordx4 v9, s[28:31], s55 offen  lds
    s_add_u32 m0, s54, 32768
    s_nop 0
    buffer_load_dwordx4 v10, s[28:31], s55 offen  lds
    s_add_u32 m0, s54, 33792
    s_nop 0
    buffer_load_dwordx4 v11, s[28:31], s55 offen  lds
    s_add_u32 m0, s54, 34816
    s_nop 0
    buffer_load_dwordx4 v12, s[28:31], s55 offen  lds
    s_add_u32 m0, s54, 35840
    s_nop 0
    buffer_load_dwordx4 v13, s[28:31], s55 offen  lds
    v_mfma_f32_16x16x16_bf16 v[64:67], v[40:41], v[234:235], v[64:67]
    v_mfma_f32_16x16x16_bf16 v[68:71], v[42:43], v[234:235], v[68:71]
    v_mfma_f32_16x16x16_bf16 v[72:75], v[44:45], v[234:235], v[72:75]
    v_mfma_f32_16x16x16_bf16 v[76:79], v[46:47], v[234:235], v[76:79]
    v_mfma_f32_16x16x16_bf16 v[80:83], v[48:49], v[234:235], v[80:83]
    v_mfma_f32_16x16x16_bf16 v[84:87], v[50:51], v[234:235], v[84:87]
    v_mfma_f32_16x16x16_bf16 v[88:91], v[52:53], v[234:235], v[88:91]
    v_mfma_f32_16x16x16_bf16 v[92:95], v[54:55], v[234:235], v[92:95]
    v_mfma_f32_16x16x16_bf16 v[96:99], v[56:57], v[234:235], v[96:99]
    v_mfma_f32_16x16x16_bf16 v[100:103], v[58:59], v[234:235], v[100:103]
    v_mfma_f32_16x16x16_bf16 v[104:107], v[60:61], v[234:235], v[104:107]
    v_mfma_f32_16x16x16_bf16 v[108:111], v[62:63], v[234:235], v[108:111]
    s_waitcnt vmcnt(6)
    ds_read_b64_tr_b16 v[40:41], v21 offset:24576
    ds_read_b64_tr_b16 v[42:43], v22 offset:24576
    ds_read_b64_tr_b16 v[44:45], v23 offset:24576
    ds_read_b64_tr_b16 v[46:47], v24 offset:24576
    ds_read_b64_tr_b16 v[48:49], v21 offset:24704
    ds_read_b64_tr_b16 v[50:51], v22 offset:24704
    ds_read_b64_tr_b16 v[52:53], v23 offset:24704
    ds_read_b64_tr_b16 v[54:55], v24 offset:24704
    ds_read_b64_tr_b16 v[56:57], v21 offset:24832
    ds_read_b64_tr_b16 v[58:59], v22 offset:24832
    ds_read_b64_tr_b16 v[60:61], v23 offset:24832
    ds_read_b64_tr_b16 v[62:63], v24 offset:24832
    s_waitcnt lgkmcnt(0)
    s_mul_i32 s55, s64, 196608
    s_add_u32 s55, s55, s59
    s_add_u32 m0, s54, 24576
    s_nop 0
    buffer_load_dwordx4 v8, s[28:31], s55 offen  lds
    s_add_u32 m0, s54, 25600
    s_nop 0
    buffer_load_dwordx4 v9, s[28:31], s55 offen  lds
    s_add_u32 m0, s54, 26624
    s_nop 0
    buffer_load_dwordx4 v10, s[28:31], s55 offen  lds
    s_add_u32 m0, s54, 27648
    s_nop 0
    buffer_load_dwordx4 v11, s[28:31], s55 offen  lds
    s_add_u32 m0, s54, 28672
    s_nop 0
    buffer_load_dwordx4 v12, s[28:31], s55 offen  lds
    s_add_u32 m0, s54, 29696
    s_nop 0
    buffer_load_dwordx4 v13, s[28:31], s55 offen  lds
    v_mfma_f32_16x16x16_bf16 v[64:67], v[40:41], v[236:237], v[64:67]
    v_mfma_f32_16x16x16_bf16 v[68:71], v[42:43], v[236:237], v[68:71]
    v_mfma_f32_16x16x16_bf16 v[72:75], v[44:45], v[236:237], v[72:75]
    v_mfma_f32_16x16x16_bf16 v[76:79], v[46:47], v[236:237], v[76:79]
    v_mfma_f32_16x16x16_bf16 v[80:83], v[48:49], v[236:237], v[80:83]
    v_mfma_f32_16x16x16_bf16 v[84:87], v[50:51], v[236:237], v[84:87]
    v_mfma_f32_16x16x16_bf16 v[88:91], v[52:53], v[236:237], v[88:91]
    v_mfma_f32_16x16x16_bf16 v[92:95], v[54:55], v[236:237], v[92:95]
    v_mfma_f32_16x16x16_bf16 v[96:99], v[56:57], v[236:237], v[96:99]
    v_mfma_f32_16x16x16_bf16 v[100:103], v[58:59], v[236:237], v[100:103]
    v_mfma_f32_16x16x16_bf16 v[104:107], v[60:61], v[236:237], v[104:107]
    v_mfma_f32_16x16x16_bf16 v[108:111], v[62:63], v[236:237], v[108:111]
    s_waitcnt vmcnt(6)
    ds_read_b64_tr_b16 v[40:41], v21 offset:30720
    ds_read_b64_tr_b16 v[42:43], v22 offset:30720
    ds_read_b64_tr_b16 v[44:45], v23 offset:30720
    ds_read_b64_tr_b16 v[46:47], v24 offset:30720
    ds_read_b64_tr_b16 v[48:49], v21 offset:30848
    ds_read_b64_tr_b16 v[50:51], v22 offset:30848
    ds_read_b64_tr_b16 v[52:53], v23 offset:30848
    ds_read_b64_tr_b16 v[54:55], v24 offset:30848
    ds_read_b64_tr_b16 v[56:57], v21 offset:30976
    ds_read_b64_tr_b16 v[58:59], v22 offset:30976
    ds_read_b64_tr_b16 v[60:61], v23 offset:30976
    ds_read_b64_tr_b16 v[62:63], v24 offset:30976
    s_waitcnt lgkmcnt(0)
    s_mul_i32 s55, s65, 196608
    s_add_u32 s55, s55, s59
    s_add_u32 m0, s54, 30720
    s_nop 0
    buffer_load_dwordx4 v8, s[28:31], s55 offen  lds
    s_add_u32 m0, s54, 31744
    s_nop 0
    buffer_load_dwordx4 v9, s[28:31], s55 offen  lds
    s_add_u32 m0, s54, 32768
    s_nop 0
    buffer_load_dwordx4 v10, s[28:31], s55 offen  lds
    s_add_u32 m0, s54, 33792
    s_nop 0
    buffer_load_dwordx4 v11, s[28:31], s55 offen  lds
    s_add_u32 m0, s54, 34816
    s_nop 0
    buffer_load_dwordx4 v12, s[28:31], s55 offen  lds
    s_add_u32 m0, s54, 35840
    s_nop 0
    buffer_load_dwordx4 v13, s[28:31], s55 offen  lds
    v_mfma_f32_16x16x16_bf16 v[64:67], v[40:41], v[238:239], v[64:67]
    v_mfma_f32_16x16x16_bf16 v[68:71], v[42:43], v[238:239], v[68:71]
    v_mfma_f32_16x16x16_bf16 v[72:75], v[44:45], v[238:239], v[72:75]
    v_mfma_f32_16x16x16_bf16 v[76:79], v[46:47], v[238:239], v[76:79]
    v_mfma_f32_16x16x16_bf16 v[80:83], v[48:49], v[238:239], v[80:83]
    v_mfma_f32_16x16x16_bf16 v[84:87], v[50:51], v[238:239], v[84:87]
    v_mfma_f32_16x16x16_bf16 v[88:91], v[52:53], v[238:239], v[88:91]
    v_mfma_f32_16x16x16_bf16 v[92:95], v[54:55], v[238:239], v[92:95]
    v_mfma_f32_16x16x16_bf16 v[96:99], v[56:57], v[238:239], v[96:99]
    v_mfma_f32_16x16x16_bf16 v[100:103], v[58:59], v[238:239], v[100:103]
    v_mfma_f32_16x16x16_bf16 v[104:107], v[60:61], v[238:239], v[104:107]
    v_mfma_f32_16x16x16_bf16 v[108:111], v[62:63], v[238:239], v[108:111]
    s_waitcnt vmcnt(6)
    ds_read_b64_tr_b16 v[40:41], v21 offset:24576
    ds_read_b64_tr_b16 v[42:43], v22 offset:24576
    ds_read_b64_tr_b16 v[44:45], v23 offset:24576
    ds_read_b64_tr_b16 v[46:47], v24 offset:24576
    ds_read_b64_tr_b16 v[48:49], v21 offset:24704
    ds_read_b64_tr_b16 v[50:51], v22 offset:24704
    ds_read_b64_tr_b16 v[52:53], v23 offset:24704
    ds_read_b64_tr_b16 v[54:55], v24 offset:24704
    ds_read_b64_tr_b16 v[56:57], v21 offset:24832
    ds_read_b64_tr_b16 v[58:59], v22 offset:24832
    ds_read_b64_tr_b16 v[60:61], v23 offset:24832
    ds_read_b64_tr_b16 v[62:63], v24 offset:24832
    s_waitcnt lgkmcnt(0)
    s_mul_i32 s55, s66, 196608
    s_add_u32 s55, s55, s59
    s_add_u32 m0, s54, 24576
    s_nop 0
    buffer_load_dwordx4 v8, s[28:31], s55 offen  lds
    s_add_u32 m0, s54, 25600
    s_nop 0
    buffer_load_dwordx4 v9, s[28:31], s55 offen  lds
    s_add_u32 m0, s54, 26624
    s_nop 0
    buffer_load_dwordx4 v10, s[28:31], s55 offen  lds
    s_add_u32 m0, s54, 27648
    s_nop 0
    buffer_load_dwordx4 v11, s[28:31], s55 offen  lds
    s_add_u32 m0, s54, 28672
    s_nop 0
    buffer_load_dwordx4 v12, s[28:31], s55 offen  lds
    s_add_u32 m0, s54, 29696
    s_nop 0
    buffer_load_dwordx4 v13, s[28:31], s55 offen  lds
    v_mfma_f32_16x16x16_bf16 v[64:67], v[40:41], v[240:241], v[64:67]
    v_mfma_f32_16x16x16_bf16 v[68:71], v[42:43], v[240:241], v[68:71]
    v_mfma_f32_16x16x16_bf16 v[72:75], v[44:45], v[240:241], v[72:75]
    v_mfma_f32_16x16x16_bf16 v[76:79], v[46:47], v[240:241], v[76:79]
    v_mfma_f32_16x16x16_bf16 v[80:83], v[48:49], v[240:241], v[80:83]
    v_mfma_f32_16x16x16_bf16 v[84:87], v[50:51], v[240:241], v[84:87]
    v_mfma_f32_16x16x16_bf16 v[88:91], v[52:53], v[240:241], v[88:91]
    v_mfma_f32_16x16x16_bf16 v[92:95], v[54:55], v[240:241], v[92:95]
    v_mfma_f32_16x16x16_bf16 v[96:99], v[56:57], v[240:241], v[96:99]
    v_mfma_f32_16x16x16_bf16 v[100:103], v[58:59], v[240:241], v[100:103]
    v_mfma_f32_16x16x16_bf16 v[104:107], v[60:61], v[240:241], v[104:107]
    v_mfma_f32_16x16x16_bf16 v[108:111], v[62:63], v[240:241], v[108:111]
    s_waitcnt vmcnt(6)
    ds_read_b64_tr_b16 v[40:41], v21 offset:30720
    ds_read_b64_tr_b16 v[42:43], v22 offset:30720
    ds_read_b64_tr_b16 v[44:45], v23 offset:30720
    ds_read_b64_tr_b16 v[46:47], v24 offset:30720
    ds_read_b64_tr_b16 v[48:49], v21 offset:30848
    ds_read_b64_tr_b16 v[50:51], v22 offset:30848
    ds_read_b64_tr_b16 v[52:53], v23 offset:30848
    ds_read_b64_tr_b16 v[54:55], v24 offset:30848
    ds_read_b64_tr_b16 v[56:57], v21 offset:30976
    ds_read_b64_tr_b16 v[58:59], v22 offset:30976
    ds_read_b64_tr_b16 v[60:61], v23 offset:30976
    ds_read_b64_tr_b16 v[62:63], v24 offset:30976
    s_waitcnt lgkmcnt(0)
    s_mul_i32 s55, s67, 196608
    s_add_u32 s55, s55, s59
    s_add_u32 m0, s54, 30720
    s_nop 0
    buffer_load_dwordx4 v8, s[28:31], s55 offen  lds
    s_add_u32 m0, s54, 31744
    s_nop 0
    buffer_load_dwordx4 v9, s[28:31], s55 offen  lds
    s_add_u32 m0, s54, 32768
    s_nop 0
    buffer_load_dwordx4 v10, s[28:31], s55 offen  lds
    s_add_u32 m0, s54, 33792
    s_nop 0
    buffer_load_dwordx4 v11, s[28:31], s55 offen  lds
    s_add_u32 m0, s54, 34816
    s_nop 0
    buffer_load_dwordx4 v12, s[28:31], s55 offen  lds
    s_add_u32 m0, s54, 35840
    s_nop 0
    buffer_load_dwordx4 v13, s[28:31], s55 offen  lds
    v_mfma_f32_16x16x16_bf16 v[64:67], v[40:41], v[242:243], v[64:67]
    v_mfma_f32_16x16x16_bf16 v[68:71], v[42:43], v[242:243], v[68:71]
    v_mfma_f32_16x16x16_bf16 v[72:75], v[44:45], v[242:243], v[72:75]
    v_mfma_f32_16x16x16_bf16 v[76:79], v[46:47], v[242:243], v[76:79]
    v_mfma_f32_16x16x16_bf16 v[80:83], v[48:49], v[242:243], v[80:83]
    v_mfma_f32_16x16x16_bf16 v[84:87], v[50:51], v[242:243], v[84:87]
    v_mfma_f32_16x16x16_bf16 v[88:91], v[52:53], v[242:243], v[88:91]
    v_mfma_f32_16x16x16_bf16 v[92:95], v[54:55], v[242:243], v[92:95]
    v_mfma_f32_16x16x16_bf16 v[96:99], v[56:57], v[242:243], v[96:99]
    v_mfma_f32_16x16x16_bf16 v[100:103], v[58:59], v[242:243], v[100:103]
    v_mfma_f32_16x16x16_bf16 v[104:107], v[60:61], v[242:243], v[104:107]
    v_mfma_f32_16x16x16_bf16 v[108:111], v[62:63], v[242:243], v[108:111]
    s_waitcnt vmcnt(6)
    ds_read_b64_tr_b16 v[40:41], v21 offset:24576
    ds_read_b64_tr_b16 v[42:43], v22 offset:24576
    ds_read_b64_tr_b16 v[44:45], v23 offset:24576
    ds_read_b64_tr_b16 v[46:47], v24 offset:24576
    ds_read_b64_tr_b16 v[48:49], v21 offset:24704
    ds_read_b64_tr_b16 v[50:51], v22 offset:24704
    ds_read_b64_tr_b16 v[52:53], v23 offset:24704
    ds_read_b64_tr_b16 v[54:55], v24 offset:24704
    ds_read_b64_tr_b16 v[56:57], v21 offset:24832
    ds_read_b64_tr_b16 v[58:59], v22 offset:24832
    ds_read_b64_tr_b16 v[60:61], v23 offset:24832
    ds_read_b64_tr_b16 v[62:63], v24 offset:24832
    s_waitcnt lgkmcnt(0)
    s_mul_i32 s55, s68, 196608
    s_add_u32 s55, s55, s59
    s_add_u32 m0, s54, 24576
    s_nop 0
    buffer_load_dwordx4 v8, s[28:31], s55 offen  lds
    s_add_u32 m0, s54, 25600
    s_nop 0
    buffer_load_dwordx4 v9, s[28:31], s55 offen  lds
    s_add_u32 m0, s54, 26624
    s_nop 0
    buffer_load_dwordx4 v10, s[28:31], s55 offen  lds
    s_add_u32 m0, s54, 27648
    s_nop 0
    buffer_load_dwordx4 v11, s[28:31], s55 offen  lds
    s_add_u32 m0, s54, 28672
    s_nop 0
    buffer_load_dwordx4 v12, s[28:31], s55 offen  lds
    s_add_u32 m0, s54, 29696
    s_nop 0
    buffer_load_dwordx4 v13, s[28:31], s55 offen  lds
    v_mfma_f32_16x16x16_bf16 v[64:67], v[40:41], v[244:245], v[64:67]
    v_mfma_f32_16x16x16_bf16 v[68:71], v[42:43], v[244:245], v[68:71]
    v_mfma_f32_16x16x16_bf16 v[72:75], v[44:45], v[244:245], v[72:75]
    v_mfma_f32_16x16x16_bf16 v[76:79], v[46:47], v[244:245], v[76:79]
    v_mfma_f32_16x16x16_bf16 v[80:83], v[48:49], v[244:245], v[80:83]
    v_mfma_f32_16x16x16_bf16 v[84:87], v[50:51], v[244:245], v[84:87]
    v_mfma_f32_16x16x16_bf16 v[88:91], v[52:53], v[244:245], v[88:91]
    v_mfma_f32_16x16x16_bf16 v[92:95], v[54:55], v[244:245], v[92:95]
    v_mfma_f32_16x16x16_bf16 v[96:99], v[56:57], v[244:245], v[96:99]
    v_mfma_f32_16x16x16_bf16 v[100:103], v[58:59], v[244:245], v[100:103]
    v_mfma_f32_16x16x16_bf16 v[104:107], v[60:61], v[244:245], v[104:107]
    v_mfma_f32_16x16x16_bf16 v[108:111], v[62:63], v[244:245], v[108:111]
    s_waitcnt vmcnt(6)
    ds_read_b64_tr_b16 v[40:41], v21 offset:30720
    ds_read_b64_tr_b16 v[42:43], v22 offset:30720
    ds_read_b64_tr_b16 v[44:45], v23 offset:30720
    ds_read_b64_tr_b16 v[46:47], v24 offset:30720
    ds_read_b64_tr_b16 v[48:49], v21 offset:30848
    ds_read_b64_tr_b16 v[50:51], v22 offset:30848
    ds_read_b64_tr_b16 v[52:53], v23 offset:30848
    ds_read_b64_tr_b16 v[54:55], v24 offset:30848
    ds_read_b64_tr_b16 v[56:57], v21 offset:30976
    ds_read_b64_tr_b16 v[58:59], v22 offset:30976
    ds_read_b64_tr_b16 v[60:61], v23 offset:30976
    ds_read_b64_tr_b16 v[62:63], v24 offset:30976
    s_waitcnt lgkmcnt(0)
    s_mul_i32 s55, s69, 196608
    s_add_u32 s55, s55, s59
    s_add_u32 m0, s54, 30720
    s_nop 0
    buffer_load_dwordx4 v8, s[28:31], s55 offen  lds
    s_add_u32 m0, s54, 31744
    s_nop 0
    buffer_load_dwordx4 v9, s[28:31], s55 offen  lds
    s_add_u32 m0, s54, 32768
    s_nop 0
    buffer_load_dwordx4 v10, s[28:31], s55 offen  lds
    s_add_u32 m0, s54, 33792
    s_nop 0
    buffer_load_dwordx4 v11, s[28:31], s55 offen  lds
    s_add_u32 m0, s54, 34816
    s_nop 0
    buffer_load_dwordx4 v12, s[28:31], s55 offen  lds
    s_add_u32 m0, s54, 35840
    s_nop 0
    buffer_load_dwordx4 v13, s[28:31], s55 offen  lds
    v_mfma_f32_16x16x16_bf16 v[64:67], v[40:41], v[246:247], v[64:67]
    v_mfma_f32_16x16x16_bf16 v[68:71], v[42:43], v[246:247], v[68:71]
    v_mfma_f32_16x16x16_bf16 v[72:75], v[44:45], v[246:247], v[72:75]
    v_mfma_f32_16x16x16_bf16 v[76:79], v[46:47], v[246:247], v[76:79]
    v_mfma_f32_16x16x16_bf16 v[80:83], v[48:49], v[246:247], v[80:83]
    v_mfma_f32_16x16x16_bf16 v[84:87], v[50:51], v[246:247], v[84:87]
    v_mfma_f32_16x16x16_bf16 v[88:91], v[52:53], v[246:247], v[88:91]
    v_mfma_f32_16x16x16_bf16 v[92:95], v[54:55], v[246:247], v[92:95]
    v_mfma_f32_16x16x16_bf16 v[96:99], v[56:57], v[246:247], v[96:99]
    v_mfma_f32_16x16x16_bf16 v[100:103], v[58:59], v[246:247], v[100:103]
    v_mfma_f32_16x16x16_bf16 v[104:107], v[60:61], v[246:247], v[104:107]
    v_mfma_f32_16x16x16_bf16 v[108:111], v[62:63], v[246:247], v[108:111]
    s_waitcnt vmcnt(11)
    s_add_u32 s55, s58, 40
    s_and_b32 s55, s55, 63
    s_mul_i32 s55, s55, 6144
    buffer_load_dwordx4 a[72:75], v2, s[20:23], s55 offen nt
    s_waitcnt vmcnt(11)
    buffer_load_dwordx4 a[76:79], v3, s[20:23], s55 offen nt
    s_waitcnt vmcnt(11)
    buffer_load_dwordx4 a[80:83], v4, s[20:23], s55 offen nt
    s_waitcnt vmcnt(11)
    buffer_load_dwordx4 a[84:87], v5, s[20:23], s55 offen nt
    s_waitcnt vmcnt(11)
    buffer_load_dwordx4 a[88:91], v6, s[20:23], s55 offen nt
    s_waitcnt vmcnt(11)
    buffer_load_dwordx4 a[92:95], v7, s[20:23], s55 offen nt
    ds_read_b64_tr_b16 v[40:41], v21 offset:24576
    ds_read_b64_tr_b16 v[42:43], v22 offset:24576
    ds_read_b64_tr_b16 v[44:45], v23 offset:24576
    ds_read_b64_tr_b16 v[46:47], v24 offset:24576
    ds_read_b64_tr_b16 v[48:49], v21 offset:24704
    ds_read_b64_tr_b16 v[50:51], v22 offset:24704
    ds_read_b64_tr_b16 v[52:53], v23 offset:24704
    ds_read_b64_tr_b16 v[54:55], v24 offset:24704
    ds_read_b64_tr_b16 v[56:57], v21 offset:24832
    ds_read_b64_tr_b16 v[58:59], v22 offset:24832
    ds_read_b64_tr_b16 v[60:61], v23 offset:24832
    ds_read_b64_tr_b16 v[62:63], v24 offset:24832
    s_waitcnt lgkmcnt(0)
    v_mfma_f32_16x16x16_bf16 v[64:67], v[40:41], v[248:249], v[64:67]
    v_mfma_f32_16x16x16_bf16 v[68:71], v[42:43], v[248:249], v[68:71]
    v_mfma_f32_16x16x16_bf16 v[72:75], v[44:45], v[248:249], v[72:75]
    v_mfma_f32_16x16x16_bf16 v[76:79], v[46:47], v[248:249], v[76:79]
    v_mfma_f32_16x16x16_bf16 v[80:83], v[48:49], v[248:249], v[80:83]
    v_mfma_f32_16x16x16_bf16 v[84:87], v[50:51], v[248:249], v[84:87]
    v_mfma_f32_16x16x16_bf16 v[88:91], v[52:53], v[248:249], v[88:91]
    v_mfma_f32_16x16x16_bf16 v[92:95], v[54:55], v[248:249], v[92:95]
    v_mfma_f32_16x16x16_bf16 v[96:99], v[56:57], v[248:249], v[96:99]
    v_mfma_f32_16x16x16_bf16 v[100:103], v[58:59], v[248:249], v[100:103]
    v_mfma_f32_16x16x16_bf16 v[104:107], v[60:61], v[248:249], v[104:107]
    v_mfma_f32_16x16x16_bf16 v[108:111], v[62:63], v[248:249], v[108:111]
    s_waitcnt vmcnt(11)
    s_add_u32 s55, s58, 44
    s_and_b32 s55, s55, 63
    s_mul_i32 s55, s55, 6144
    buffer_load_dwordx4 a[48:51], v2, s[20:23], s55 offen nt
    s_waitcnt vmcnt(11)
    buffer_load_dwordx4 a[52:55], v3, s[20:23], s55 offen nt
    s_waitcnt vmcnt(11)
    buffer_load_dwordx4 a[56:59], v4, s[20:23], s55 offen nt
    s_waitcnt vmcnt(11)
    buffer_load_dwordx4 a[60:63], v5, s[20:23], s55 offen nt
    s_waitcnt vmcnt(11)
    buffer_load_dwordx4 a[64:67], v6, s[20:23], s55 offen nt
    s_waitcnt vmcnt(11)
    buffer_load_dwordx4 a[68:71], v7, s[20:23], s55 offen nt
    ds_read_b64_tr_b16 v[40:41], v21 offset:30720
    ds_read_b64_tr_b16 v[42:43], v22 offset:30720
    ds_read_b64_tr_b16 v[44:45], v23 offset:30720
    ds_read_b64_tr_b16 v[46:47], v24 offset:30720
    ds_read_b64_tr_b16 v[48:49], v21 offset:30848
    ds_read_b64_tr_b16 v[50:51], v22 offset:30848
    ds_read_b64_tr_b16 v[52:53], v23 offset:30848
    ds_read_b64_tr_b16 v[54:55], v24 offset:30848
    ds_read_b64_tr_b16 v[56:57], v21 offset:30976
    ds_read_b64_tr_b16 v[58:59], v22 offset:30976
    ds_read_b64_tr_b16 v[60:61], v23 offset:30976
    ds_read_b64_tr_b16 v[62:63], v24 offset:30976
    s_waitcnt lgkmcnt(0)
    v_mfma_f32_16x16x16_bf16 v[64:67], v[40:41], v[250:251], v[64:67]
    v_mfma_f32_16x16x16_bf16 v[68:71], v[42:43], v[250:251], v[68:71]
    v_mfma_f32_16x16x16_bf16 v[72:75], v[44:45], v[250:251], v[72:75]
    v_mfma_f32_16x16x16_bf16 v[76:79], v[46:47], v[250:251], v[76:79]
    v_mfma_f32_16x16x16_bf16 v[80:83], v[48:49], v[250:251], v[80:83]
    v_mfma_f32_16x16x16_bf16 v[84:87], v[50:51], v[250:251], v[84:87]
    v_mfma_f32_16x16x16_bf16 v[88:91], v[52:53], v[250:251], v[88:91]
    v_mfma_f32_16x16x16_bf16 v[92:95], v[54:55], v[250:251], v[92:95]
    v_mfma_f32_16x16x16_bf16 v[96:99], v[56:57], v[250:251], v[96:99]
    v_mfma_f32_16x16x16_bf16 v[100:103], v[58:59], v[250:251], v[100:103]
    v_mfma_f32_16x16x16_bf16 v[104:107], v[60:61], v[250:251], v[104:107]
    v_mfma_f32_16x16x16_bf16 v[108:111], v[62:63], v[250:251], v[108:111]
    s_mov_b32 exec_lo, 0x000f000f
    s_mov_b32 exec_hi, 0x000f000f
    ds_write_b128 v26, v[64:67] offset:0
    ds_write_b128 v26, v[68:71] offset:64
    ds_write_b128 v26, v[72:75] offset:128
    ds_write_b128 v26, v[76:79] offset:192
    ds_write_b128 v26, v[80:83] offset:256
    ds_write_b128 v26, v[84:87] offset:320
    ds_write_b128 v26, v[88:91] offset:384
    ds_write_b128 v26, v[92:95] offset:448
    ds_write_b128 v26, v[96:99] offset:512
    ds_write_b128 v26, v[100:103] offset:576
    ds_write_b128 v26, v[104:107] offset:640
    ds_write_b128 v26, v[108:111] offset:704
    s_mov_b64 exec, -1
    s_waitcnt lgkmcnt(0)
    s_barrier
    s_cmp_eq_u32 s3, 3
    s_cbranch_scc1 L_qred_3
    ds_read_b128 v[40:43], v27 offset:0
    ds_read_b128 v[44:47], v27 offset:3136
    ds_read_b128 v[48:51], v27 offset:6272
    ds_read_b128 v[52:55], v27 offset:9408
    s_waitcnt lgkmcnt(0)
    v_add_f32 v40, v40, v44
    v_add_f32 v41, v41, v45
    v_add_f32 v42, v42, v46
    v_add_f32 v43, v43, v47
    v_add_f32 v48, v48, v52
    v_add_f32 v49, v49, v53
    v_add_f32 v50, v50, v54
    v_add_f32 v51, v51, v55
    v_add_f32 v40, v40, v48
    v_add_f32 v41, v41, v49
    v_add_f32 v42, v42, v50
    v_add_f32 v43, v43, v51
    v_cvt_pk_bf16_f32 v44, v40, v41
    v_cvt_pk_bf16_f32 v45, v42, v43
    ds_write_b64 v28, v[44:45]
    s_waitcnt lgkmcnt(0)
L_qred_3:
    s_barrier
    ds_read_b128 v[112:115], v29 offset:0
    ds_read_b128 v[116:119], v29 offset:64
    ds_read_b128 v[120:123], v29 offset:128
    ds_read_b128 v[124:127], v29 offset:192
    ds_read_b128 v[128:131], v29 offset:256
    ds_read_b128 v[132:135], v29 offset:320
    v_mov_b32 v33, 0xff800000
    s_waitcnt lgkmcnt(0)
    ds_read_b128 v[40:43], v19 offset:0
    ds_read_b128 v[44:47], v20 offset:0
    ds_read_b128 v[48:51], v19 offset:128
    ds_read_b128 v[52:55], v20 offset:128
    ds_read_b128 v[56:59], v19 offset:256
    ds_read_b128 v[60:63], v20 offset:256
    s_waitcnt lgkmcnt(0)
    v_mfma_f32_16x16x32_bf16 v[136:139], v[40:43], v[112:115], 0
    v_mfma_f32_16x16x32_bf16 v[136:139], v[44:47], v[116:119], v[136:139]
    v_mfma_f32_16x16x32_bf16 v[136:139], v[48:51], v[120:123], v[136:139]
    v_mfma_f32_16x16x32_bf16 v[136:139], v[52:55], v[124:127], v[136:139]
    v_mfma_f32_16x16x32_bf16 v[136:139], v[56:59], v[128:131], v[136:139]
    v_mfma_f32_16x16x32_bf16 v[136:139], v[60:63], v[132:135], v[136:139]
    s_waitcnt vmcnt(10)
    s_add_u32 s55, s79, 0
    s_add_u32 m0, s54, 0
    s_nop 0
    buffer_load_dwordx4 v30, s[32:35], s55 offen  lds
    s_waitcnt vmcnt(10)
    s_add_u32 s55, s79, 1024
    s_add_u32 m0, s54, 1024
    s_nop 0
    buffer_load_dwordx4 v30, s[32:35], s55 offen  lds
    s_mul_i32 s56, s52, 327680
    s_lshl_b32 s57, s53, 7
    s_add_u32 s56, s56, s57
    s_sub_u32 s57, 327680, s57
    s_add_u32 s40, s18, s56
    s_addc_u32 s41, s19, 0
    s_and_b32 s41, s41, 0xffff
    s_mov_b32 s42, s57
    s_mov_b32 s43, 0x20000
    v_and_b32 v36, 1, v34
    v_lshl_add_u32 v36, v36, 2, v35
    v_lshlrev_b32 v36, 4, v36
    v_lshrrev_b32 v37, 1, v34
    v_lshl_add_u32 v36, v37, 12, v36
    s_mul_i32 s56, s3, 81920
    v_add_u32 v39, s56, v36
    v_and_b32 v36, 12, v1
    v_lshl_add_u32 v39, v36, 11, v39
    v_and_b32 v36, 8, v1
    v_lshl_add_u32 v255, v36, 24, v39
    s_mov_b32 s60, 0
    s_mov_b32 s61, 32768
    s_mov_b32 s62, 65536
    s_mov_b32 s48, s16
    s_and_b32 s49, s17, 0xffff
    s_mov_b32 s50, 256
    s_mov_b32 s51, 0x20000
    s_and_b32 s56, s52, 1
    s_lshl_b32 s56, s56, 7
    s_lshl_b32 s57, s52, 1
    s_and_b32 s57, s57, 12
    s_add_u32 s78, s56, s57
    v_xor_b32 v36, 192, v0
    v_or_b32 v36, s53, v36
    v_lshlrev_b32 v253, 8, v36
    s_mul_i32 s56, s76, 0x9e3779b1
    s_or_b32 s56, s56, 1
    v_mov_b32 v252, s56
    buffer_store_dword v252, v253, s[48:51], s78 offen sc1
    s_lshl_b32 s72, s3, 5
    s_add_u32 s72, s72, s53
    s_mul_i32 s56, s52, 80
    s_add_u32 s56, s56, s72
    s_lshl_b32 s56, s56, 12
    s_cmp_lt_u32 s72, 80
    s_cselect_b32 s57, 4096, 0
    s_add_u32 s28, s18, s56
    s_addc_u32 s29, s19, 0
    s_and_b32 s29, s29, 0xffff
    s_mov_b32 s30, s57
    s_mov_b32 s31, 0x20000
    s_mul_i32 s56, s52, 5120
    s_add_u32 s44, s14, s56
    s_addc_u32 s45, s15, 0
    s_and_b32 s45, s45, 0xffff
    s_mov_b32 s46, 5120
    s_mov_b32 s47, 0x20000
    v_lshlrev_b32 v232, 4, v1
    v_add_u32 v233, 4096, v232
    v_add_u32 v235, s54, v232
    v_mul_u32_u24 v234, 1280, v35
    v_and_b32 v36, 4, v1
    v_lshl_add_u32 v234, v36, 1, v234
    v_and_b32 v36, 8, v1
    v_lshl_add_u32 v234, v36, 20, v234
    v_bfe_u32 v36, v1, 4, 1
    v_lshl_add_u32 v234, v36, 2, v234
    v_lshrrev_b32 v36, 5, v1
    v_lshl_add_u32 v234, v36, 1, v234
    s_lshl_b32 s56, s72, 4
    v_add_u32 v234, s56, v234
    v_lshrrev_b32 v36, 3, v1
    v_and_b32 v37, 6, v36
    v_and_b32 v38, 7, v1
    v_xor_b32 v37, v37, v38
    v_lshlrev_b32 v37, 4, v37
    v_mul_u32_u24 v36, 384, v36
    v_add_u32 v236, v36, v37
    v_add_u32 v237, 3072, v236
    v_lshrrev_b32 v36, 2, v1
    v_and_b32 v37, 6, v36
    v_lshlrev_b32 v37, 4, v37
    v_lshl_add_u32 v37, v35, 3, v37
    v_lshlrev_b32 v36, 7, v36
    v_add3_u32 v238, v36, v37, s54
    v_xor_b32 v239, 32, v238
    v_xor_b32 v240, 64, v238
    v_xor_b32 v241, 96, v238
    v_and_b32 v36, 15, v1
    v_lshlrev_b32 v36, 4, v36
    v_lshl_add_u32 v36, v34, 8, v36
    v_add_u32 v243, 147456, v36
    s_lshl_b32 s56, s3, 6
    v_add_u32 v242, s56, v243
    ds_read_b128 v[40:43], v19 offset:6144
    ds_read_b128 v[44:47], v20 offset:6144
    ds_read_b128 v[48:51], v19 offset:6272
    ds_read_b128 v[52:55], v20 offset:6272
    ds_read_b128 v[56:59], v19 offset:6400
    ds_read_b128 v[60:63], v20 offset:6400
    s_nop 1
    v_cvt_pk_bf16_f32 v36, v136, v137
    v_cvt_pk_bf16_f32 v37, v138, v139
    v_lshlrev_b32 v136, 16, v36
    v_and_b32 v137, 0xffff0000, v36
    v_lshlrev_b32 v138, 16, v37
    v_and_b32 v139, 0xffff0000, v37
    v_mul_f32 v136, s70, v136
    v_mul_f32 v137, s70, v137
    v_mul_f32 v138, s70, v138
    v_mul_f32 v139, s70, v139
    v_cvt_pk_bf16_f32 v36, v136, v137
    v_cvt_pk_bf16_f32 v37, v138, v139
    v_lshlrev_b32 v136, 16, v36
    v_and_b32 v137, 0xffff0000, v36
    v_lshlrev_b32 v138, 16, v37
    v_and_b32 v139, 0xffff0000, v37
    v_max3_f32 v33, v33, v136, v137
    v_max3_f32 v33, v33, v138, v139
    s_waitcnt lgkmcnt(0)
    v_mfma_f32_16x16x32_bf16 v[140:143], v[40:43], v[112:115], 0
    v_mfma_f32_16x16x32_bf16 v[140:143], v[44:47], v[116:119], v[140:143]
    v_mfma_f32_16x16x32_bf16 v[140:143], v[48:51], v[120:123], v[140:143]
    v_mfma_f32_16x16x32_bf16 v[140:143], v[52:55], v[124:127], v[140:143]
    v_mfma_f32_16x16x32_bf16 v[140:143], v[56:59], v[128:131], v[140:143]
    v_mfma_f32_16x16x32_bf16 v[140:143], v[60:63], v[132:135], v[140:143]
    s_waitcnt vmcnt(11)
    s_add_u32 s55, s79, 2048
    s_add_u32 m0, s54, 2048
    s_nop 0
    buffer_load_dwordx4 v30, s[32:35], s55 offen  lds
    s_waitcnt vmcnt(11)
    s_add_u32 s55, s79, 3072
    s_add_u32 m0, s54, 3072
    s_nop 0
    buffer_load_dwordx4 v30, s[32:35], s55 offen  lds
    ds_read_b128 v[40:43], v19 offset:12288
    ds_read_b128 v[44:47], v20 offset:12288
    ds_read_b128 v[48:51], v19 offset:12416
    ds_read_b128 v[52:55], v20 offset:12416
    ds_read_b128 v[56:59], v19 offset:12544
    ds_read_b128 v[60:63], v20 offset:12544
    s_nop 1
    v_cvt_pk_bf16_f32 v36, v140, v141
    v_cvt_pk_bf16_f32 v37, v142, v143
    v_lshlrev_b32 v140, 16, v36
    v_and_b32 v141, 0xffff0000, v36
    v_lshlrev_b32 v142, 16, v37
    v_and_b32 v143, 0xffff0000, v37
    v_mul_f32 v140, s70, v140
    v_mul_f32 v141, s70, v141
    v_mul_f32 v142, s70, v142
    v_mul_f32 v143, s70, v143
    v_cvt_pk_bf16_f32 v36, v140, v141
    v_cvt_pk_bf16_f32 v37, v142, v143
    v_lshlrev_b32 v140, 16, v36
    v_and_b32 v141, 0xffff0000, v36
    v_lshlrev_b32 v142, 16, v37
    v_and_b32 v143, 0xffff0000, v37
    v_max3_f32 v33, v33, v140, v141
    v_max3_f32 v33, v33, v142, v143
    s_waitcnt lgkmcnt(0)
    v_mfma_f32_16x16x32_bf16 v[144:147], v[40:43], v[112:115], 0
    v_mfma_f32_16x16x32_bf16 v[144:147], v[44:47], v[116:119], v[144:147]
    v_mfma_f32_16x16x32_bf16 v[144:147], v[48:51], v[120:123], v[144:147]
    v_mfma_f32_16x16x32_bf16 v[144:147], v[52:55], v[124:127], v[144:147]
    v_mfma_f32_16x16x32_bf16 v[144:147], v[56:59], v[128:131], v[144:147]
    v_mfma_f32_16x16x32_bf16 v[144:147], v[60:63], v[132:135], v[144:147]
    s_waitcnt vmcnt(11)
    s_add_u32 s55, s79, 4096
    s_add_u32 m0, s54, 6144
    s_nop 0
    buffer_load_dwordx4 v30, s[32:35], s55 offen  lds
    s_waitcnt vmcnt(11)
    s_add_u32 s55, s79, 5120
    s_add_u32 m0, s54, 7168
    s_nop 0
    buffer_load_dwordx4 v30, s[32:35], s55 offen  lds
    ds_read_b128 v[40:43], v19 offset:18432
    ds_read_b128 v[44:47], v20 offset:18432
    ds_read_b128 v[48:51], v19 offset:18560
    ds_read_b128 v[52:55], v20 offset:18560
    ds_read_b128 v[56:59], v19 offset:18688
    ds_read_b128 v[60:63], v20 offset:18688
    s_nop 1
    v_cvt_pk_bf16_f32 v36, v144, v145
    v_cvt_pk_bf16_f32 v37, v146, v147
    v_lshlrev_b32 v144, 16, v36
    v_and_b32 v145, 0xffff0000, v36
    v_lshlrev_b32 v146, 16, v37
    v_and_b32 v147, 0xffff0000, v37
    v_mul_f32 v144, s70, v144
    v_mul_f32 v145, s70, v145
    v_mul_f32 v146, s70, v146
    v_mul_f32 v147, s70, v147
    v_cvt_pk_bf16_f32 v36, v144, v145
    v_cvt_pk_bf16_f32 v37, v146, v147
    v_lshlrev_b32 v144, 16, v36
    v_and_b32 v145, 0xffff0000, v36
    v_lshlrev_b32 v146, 16, v37
    v_and_b32 v147, 0xffff0000, v37
    v_max3_f32 v33, v33, v144, v145
    v_max3_f32 v33, v33, v146, v147
    s_waitcnt lgkmcnt(0)
    v_mfma_f32_16x16x32_bf16 v[148:151], v[40:43], v[112:115], 0
    v_mfma_f32_16x16x32_bf16 v[148:151], v[44:47], v[116:119], v[148:151]
    v_mfma_f32_16x16x32_bf16 v[148:151], v[48:51], v[120:123], v[148:151]
    v_mfma_f32_16x16x32_bf16 v[148:151], v[52:55], v[124:127], v[148:151]
    v_mfma_f32_16x16x32_bf16 v[148:151], v[56:59], v[128:131], v[148:151]
    v_mfma_f32_16x16x32_bf16 v[148:151], v[60:63], v[132:135], v[148:151]
    s_waitcnt vmcnt(11)
    s_add_u32 s55, s79, 6144
    s_add_u32 m0, s54, 8192
    s_nop 0
    buffer_load_dwordx4 v30, s[32:35], s55 offen  lds
    s_waitcnt vmcnt(11)
    s_add_u32 s55, s79, 7168
    s_add_u32 m0, s54, 9216
    s_nop 0
    buffer_load_dwordx4 v30, s[32:35], s55 offen  lds
    ds_write_b128 v235, a[216:219] offset:30720
    ds_write_b128 v235, a[220:223] offset:31744
    ds_write_b128 v235, a[224:227] offset:32768
    ds_write_b128 v235, a[228:231] offset:33792
    ds_write_b128 v235, a[232:235] offset:34816
    ds_write_b128 v235, a[236:239] offset:35840
    ds_read_b128 v[40:43], v19 offset:30720
    ds_read_b128 v[44:47], v20 offset:30720
    ds_read_b128 v[48:51], v19 offset:30848
    ds_read_b128 v[52:55], v20 offset:30848
    ds_read_b128 v[56:59], v19 offset:30976
    ds_read_b128 v[60:63], v20 offset:30976
    s_nop 1
    v_cvt_pk_bf16_f32 v36, v148, v149
    v_cvt_pk_bf16_f32 v37, v150, v151
    v_lshlrev_b32 v148, 16, v36
    v_and_b32 v149, 0xffff0000, v36
    v_lshlrev_b32 v150, 16, v37
    v_and_b32 v151, 0xffff0000, v37
    v_mul_f32 v148, s70, v148
    v_mul_f32 v149, s70, v149
    v_mul_f32 v150, s70, v150
    v_mul_f32 v151, s70, v151
    v_cvt_pk_bf16_f32 v36, v148, v149
    v_cvt_pk_bf16_f32 v37, v150, v151
    v_lshlrev_b32 v148, 16, v36
    v_and_b32 v149, 0xffff0000, v36
    v_lshlrev_b32 v150, 16, v37
    v_and_b32 v151, 0xffff0000, v37
    v_max3_f32 v33, v33, v148, v149
    v_max3_f32 v33, v33, v150, v151
    s_waitcnt lgkmcnt(0)
    v_mfma_f32_16x16x32_bf16 v[152:155], v[40:43], v[112:115], 0
    v_mfma_f32_16x16x32_bf16 v[152:155], v[44:47], v[116:119], v[152:155]
    v_mfma_f32_16x16x32_bf16 v[152:155], v[48:51], v[120:123], v[152:155]
    v_mfma_f32_16x16x32_bf16 v[152:155], v[52:55], v[124:127], v[152:155]
    v_mfma_f32_16x16x32_bf16 v[152:155], v[56:59], v[128:131], v[152:155]
    v_mfma_f32_16x16x32_bf16 v[152:155], v[60:63], v[132:135], v[152:155]
    s_waitcnt vmcnt(11)
    s_add_u32 s55, s58, 48
    s_and_b32 s55, s55, 63
    s_mul_i32 s55, s55, 6144
    s_add_u32 m0, s54, 12288
    s_nop 0
    buffer_load_dwordx4 v2, s[20:23], s55 offen nt lds
    s_waitcnt vmcnt(11)
    s_add_u32 m0, s54, 13312
    s_nop 0
    buffer_load_dwordx4 v3, s[20:23], s55 offen nt lds
    s_waitcnt vmcnt(11)
    s_add_u32 m0, s54, 14336
    s_nop 0
    buffer_load_dwordx4 v4, s[20:23], s55 offen nt lds
    ds_write_b128 v235, a[192:195] offset:30720
    ds_write_b128 v235, a[196:199] offset:31744
    ds_write_b128 v235, a[200:203] offset:32768
    ds_write_b128 v235, a[204:207] offset:33792
    ds_write_b128 v235, a[208:211] offset:34816
    ds_write_b128 v235, a[212:215] offset:35840
    ds_read_b128 v[40:43], v19 offset:30720
    ds_read_b128 v[44:47], v20 offset:30720
    ds_read_b128 v[48:51], v19 offset:30848
    ds_read_b128 v[52:55], v20 offset:30848
    ds_read_b128 v[56:59], v19 offset:30976
    ds_read_b128 v[60:63], v20 offset:30976
    s_nop 1
    v_cvt_pk_bf16_f32 v36, v152, v153
    v_cvt_pk_bf16_f32 v37, v154, v155
    v_lshlrev_b32 v152, 16, v36
    v_and_b32 v153, 0xffff0000, v36
    v_lshlrev_b32 v154, 16, v37
    v_and_b32 v155, 0xffff0000, v37
    v_mul_f32 v152, s70, v152
    v_mul_f32 v153, s70, v153
    v_mul_f32 v154, s70, v154
    v_mul_f32 v155, s70, v155
    v_cvt_pk_bf16_f32 v36, v152, v153
    v_cvt_pk_bf16_f32 v37, v154, v155
    v_lshlrev_b32 v152, 16, v36
    v_and_b32 v153, 0xffff0000, v36
    v_lshlrev_b32 v154, 16, v37
    v_and_b32 v155, 0xffff0000, v37
    v_max3_f32 v33, v33, v152, v153
    v_max3_f32 v33, v33, v154, v155
    s_waitcnt lgkmcnt(0)
    v_mfma_f32_16x16x32_bf16 v[156:159], v[40:43], v[112:115], 0
    v_mfma_f32_16x16x32_bf16 v[156:159], v[44:47], v[116:119], v[156:159]
    v_mfma_f32_16x16x32_bf16 v[156:159], v[48:51], v[120:123], v[156:159]
    v_mfma_f32_16x16x32_bf16 v[156:159], v[52:55], v[124:127], v[156:159]
    v_mfma_f32_16x16x32_bf16 v[156:159], v[56:59], v[128:131], v[156:159]
    v_mfma_f32_16x16x32_bf16 v[156:159], v[60:63], v[132:135], v[156:159]
    s_waitcnt vmcnt(11)
    s_add_u32 m0, s54, 15360
    s_nop 0
    buffer_load_dwordx4 v5, s[20:23], s55 offen nt lds
    s_waitcnt vmcnt(11)
    s_add_u32 m0, s54, 16384
    s_nop 0
    buffer_load_dwordx4 v6, s[20:23], s55 offen nt lds
    s_waitcnt vmcnt(10)
    s_add_u32 m0, s54, 17408
    s_nop 0
    buffer_load_dwordx4 v7, s[20:23], s55 offen nt lds
    ds_write_b128 v235, a[168:171] offset:30720
    ds_write_b128 v235, a[172:175] offset:31744
    ds_write_b128 v235, a[176:179] offset:32768
    ds_write_b128 v235, a[180:183] offset:33792
    ds_write_b128 v235, a[184:187] offset:34816
    ds_write_b128 v235, a[188:191] offset:35840
    ds_read_b128 v[40:43], v19 offset:30720
    ds_read_b128 v[44:47], v20 offset:30720
    ds_read_b128 v[48:51], v19 offset:30848
    ds_read_b128 v[52:55], v20 offset:30848
    ds_read_b128 v[56:59], v19 offset:30976
    ds_read_b128 v[60:63], v20 offset:30976
    s_nop 1
    v_cvt_pk_bf16_f32 v36, v156, v157
    v_cvt_pk_bf16_f32 v37, v158, v159
    v_lshlrev_b32 v156, 16, v36
    v_and_b32 v157, 0xffff0000, v36
    v_lshlrev_b32 v158, 16, v37
    v_and_b32 v159, 0xffff0000, v37
    v_mul_f32 v156, s70, v156
    v_mul_f32 v157, s70, v157
    v_mul_f32 v158, s70, v158
    v_mul_f32 v159, s70, v159
    v_cvt_pk_bf16_f32 v36, v156, v157
    v_cvt_pk_bf16_f32 v37, v158, v159
    v_lshlrev_b32 v156, 16, v36
    v_and_b32 v157, 0xffff0000, v36
    v_lshlrev_b32 v158, 16, v37
    v_and_b32 v159, 0xffff0000, v37
    v_max3_f32 v33, v33, v156, v157
    v_max3_f32 v33, v33, v158, v159
    s_waitcnt lgkmcnt(0)
    v_mfma_f32_16x16x32_bf16 v[160:163], v[40:43], v[112:115], 0
    v_mfma_f32_16x16x32_bf16 v[160:163], v[44:47], v[116:119], v[160:163]
    v_mfma_f32_16x16x32_bf16 v[160:163], v[48:51], v[120:123], v[160:163]
    v_mfma_f32_16x16x32_bf16 v[160:163], v[52:55], v[124:127], v[160:163]
    v_mfma_f32_16x16x32_bf16 v[160:163], v[56:59], v[128:131], v[160:163]
    v_mfma_f32_16x16x32_bf16 v[160:163], v[60:63], v[132:135], v[160:163]
    s_waitcnt vmcnt(10)
    s_add_u32 s55, s58, 52
    s_and_b32 s55, s55, 63
    s_mul_i32 s55, s55, 6144
    s_add_u32 m0, s54, 18432
    s_nop 0
    buffer_load_dwordx4 v2, s[20:23], s55 offen nt lds
    s_waitcnt vmcnt(10)
    s_add_u32 m0, s54, 19456
    s_nop 0
    buffer_load_dwordx4 v3, s[20:23], s55 offen nt lds
    s_waitcnt vmcnt(10)
    s_add_u32 m0, s54, 20480
    s_nop 0
    buffer_load_dwordx4 v4, s[20:23], s55 offen nt lds
    ds_write_b128 v235, a[144:147] offset:30720
    ds_write_b128 v235, a[148:151] offset:31744
    ds_write_b128 v235, a[152:155] offset:32768
    ds_write_b128 v235, a[156:159] offset:33792
    ds_write_b128 v235, a[160:163] offset:34816
    ds_write_b128 v235, a[164:167] offset:35840
    ds_read_b128 v[40:43], v19 offset:30720
    ds_read_b128 v[44:47], v20 offset:30720
    ds_read_b128 v[48:51], v19 offset:30848
    ds_read_b128 v[52:55], v20 offset:30848
    ds_read_b128 v[56:59], v19 offset:30976
    ds_read_b128 v[60:63], v20 offset:30976
    s_nop 1
    v_cvt_pk_bf16_f32 v36, v160, v161
    v_cvt_pk_bf16_f32 v37, v162, v163
    v_lshlrev_b32 v160, 16, v36
    v_and_b32 v161, 0xffff0000, v36
    v_lshlrev_b32 v162, 16, v37
    v_and_b32 v163, 0xffff0000, v37
    v_mul_f32 v160, s70, v160
    v_mul_f32 v161, s70, v161
    v_mul_f32 v162, s70, v162
    v_mul_f32 v163, s70, v163
    v_cvt_pk_bf16_f32 v36, v160, v161
    v_cvt_pk_bf16_f32 v37, v162, v163
    v_lshlrev_b32 v160, 16, v36
    v_and_b32 v161, 0xffff0000, v36
    v_lshlrev_b32 v162, 16, v37
    v_and_b32 v163, 0xffff0000, v37
    v_max3_f32 v33, v33, v160, v161
    v_max3_f32 v33, v33, v162, v163
    s_waitcnt lgkmcnt(0)
    v_mfma_f32_16x16x32_bf16 v[164:167], v[40:43], v[112:115], 0
    v_mfma_f32_16x16x32_bf16 v[164:167], v[44:47], v[116:119], v[164:167]
    v_mfma_f32_16x16x32_bf16 v[164:167], v[48:51], v[120:123], v[164:167]
    v_mfma_f32_16x16x32_bf16 v[164:167], v[52:55], v[124:127], v[164:167]
    v_mfma_f32_16x16x32_bf16 v[164:167], v[56:59], v[128:131], v[164:167]
    v_mfma_f32_16x16x32_bf16 v[164:167], v[60:63], v[132:135], v[164:167]
    s_waitcnt vmcnt(10)
    s_add_u32 m0, s54, 21504
    s_nop 0
    buffer_load_dwordx4 v5, s[20:23], s55 offen nt lds
    s_waitcnt vmcnt(10)
    s_add_u32 m0, s54, 22528
    s_nop 0
    buffer_load_dwordx4 v6, s[20:23], s55 offen nt lds
    s_waitcnt vmcnt(10)
    s_add_u32 m0, s54, 23552
    s_nop 0
    buffer_load_dwordx4 v7, s[20:23], s55 offen nt lds
    ds_write_b128 v235, a[120:123] offset:30720
    ds_write_b128 v235, a[124:127] offset:31744
    ds_write_b128 v235, a[128:131] offset:32768
    ds_write_b128 v235, a[132:135] offset:33792
    ds_write_b128 v235, a[136:139] offset:34816
    ds_write_b128 v235, a[140:143] offset:35840
    ds_read_b128 v[40:43], v19 offset:30720
    ds_read_b128 v[44:47], v20 offset:30720
    ds_read_b128 v[48:51], v19 offset:30848
    ds_read_b128 v[52:55], v20 offset:30848
    ds_read_b128 v[56:59], v19 offset:30976
    ds_read_b128 v[60:63], v20 offset:30976
    s_nop 1
    v_cvt_pk_bf16_f32 v36, v164, v165
    v_cvt_pk_bf16_f32 v37, v166, v167
    v_lshlrev_b32 v164, 16, v36
    v_and_b32 v165, 0xffff0000, v36
    v_lshlrev_b32 v166, 16, v37
    v_and_b32 v167, 0xffff0000, v37
    v_mul_f32 v164, s70, v164
    v_mul_f32 v165, s70, v165
    v_mul_f32 v166, s70, v166
    v_mul_f32 v167, s70, v167
    v_cvt_pk_bf16_f32 v36, v164, v165
    v_cvt_pk_bf16_f32 v37, v166, v167
    v_lshlrev_b32 v164, 16, v36
    v_and_b32 v165, 0xffff0000, v36
    v_lshlrev_b32 v166, 16, v37
    v_and_b32 v167, 0xffff0000, v37
    v_max3_f32 v33, v33, v164, v165
    v_max3_f32 v33, v33, v166, v167
    s_waitcnt lgkmcnt(0)
    v_mfma_f32_16x16x32_bf16 v[168:171], v[40:43], v[112:115], 0
    v_mfma_f32_16x16x32_bf16 v[168:171], v[44:47], v[116:119], v[168:171]
    v_mfma_f32_16x16x32_bf16 v[168:171], v[48:51], v[120:123], v[168:171]
    v_mfma_f32_16x16x32_bf16 v[168:171], v[52:55], v[124:127], v[168:171]
    v_mfma_f32_16x16x32_bf16 v[168:171], v[56:59], v[128:131], v[168:171]
    v_mfma_f32_16x16x32_bf16 v[168:171], v[60:63], v[132:135], v[168:171]
    s_waitcnt vmcnt(10)
    s_add_u32 s55, s58, 56
    s_and_b32 s55, s55, 63
    s_mul_i32 s55, s55, 6144
    s_add_u32 m0, s54, 24576
    s_nop 0
    buffer_load_dwordx4 v2, s[20:23], s55 offen nt lds
    s_waitcnt vmcnt(10)
    s_add_u32 m0, s54, 25600
    s_nop 0
    buffer_load_dwordx4 v3, s[20:23], s55 offen nt lds
    s_waitcnt vmcnt(10)
    s_add_u32 m0, s54, 26624
    s_nop 0
    buffer_load_dwordx4 v4, s[20:23], s55 offen nt lds
    ds_write_b128 v235, a[96:99] offset:30720
    ds_write_b128 v235, a[100:103] offset:31744
    ds_write_b128 v235, a[104:107] offset:32768
    ds_write_b128 v235, a[108:111] offset:33792
    ds_write_b128 v235, a[112:115] offset:34816
    ds_write_b128 v235, a[116:119] offset:35840
    ds_read_b128 v[40:43], v19 offset:30720
    ds_read_b128 v[44:47], v20 offset:30720
    ds_read_b128 v[48:51], v19 offset:30848
    ds_read_b128 v[52:55], v20 offset:30848
    ds_read_b128 v[56:59], v19 offset:30976
    ds_read_b128 v[60:63], v20 offset:30976
    s_nop 1
    v_cvt_pk_bf16_f32 v36, v168, v169
    v_cvt_pk_bf16_f32 v37, v170, v171
    v_lshlrev_b32 v168, 16, v36
    v_and_b32 v169, 0xffff0000, v36
    v_lshlrev_b32 v170, 16, v37
    v_and_b32 v171, 0xffff0000, v37
    v_mul_f32 v168, s70, v168
    v_mul_f32 v169, s70, v169
    v_mul_f32 v170, s70, v170
    v_mul_f32 v171, s70, v171
    v_cvt_pk_bf16_f32 v36, v168, v169
    v_cvt_pk_bf16_f32 v37, v170, v171
    v_lshlrev_b32 v168, 16, v36
    v_and_b32 v169, 0xffff0000, v36
    v_lshlrev_b32 v170, 16, v37
    v_and_b32 v171, 0xffff0000, v37
    v_max3_f32 v33, v33, v168, v169
    v_max3_f32 v33, v33, v170, v171
    s_waitcnt lgkmcnt(0)
    v_mfma_f32_16x16x32_bf16 v[172:175], v[40:43], v[112:115], 0
    v_mfma_f32_16x16x32_bf16 v[172:175], v[44:47], v[116:119], v[172:175]
    v_mfma_f32_16x16x32_bf16 v[172:175], v[48:51], v[120:123], v[172:175]
    v_mfma_f32_16x16x32_bf16 v[172:175], v[52:55], v[124:127], v[172:175]
    v_mfma_f32_16x16x32_bf16 v[172:175], v[56:59], v[128:131], v[172:175]
    v_mfma_f32_16x16x32_bf16 v[172:175], v[60:63], v[132:135], v[172:175]
    s_waitcnt vmcnt(10)
    s_add_u32 m0, s54, 27648
    s_nop 0
    buffer_load_dwordx4 v5, s[20:23], s55 offen nt lds
    s_waitcnt vmcnt(10)
    s_add_u32 m0, s54, 28672
    s_nop 0
    buffer_load_dwordx4 v6, s[20:23], s55 offen nt lds
    s_waitcnt vmcnt(10)
    s_add_u32 m0, s54, 29696
    s_nop 0
    buffer_load_dwordx4 v7, s[20:23], s55 offen nt lds
    ds_write_b128 v235, a[72:75] offset:30720
    ds_write_b128 v235, a[76:79] offset:31744
    ds_write_b128 v235, a[80:83] offset:32768
    ds_write_b128 v235, a[84:87] offset:33792
    ds_write_b128 v235, a[88:91] offset:34816
    ds_write_b128 v235, a[92:95] offset:35840
    ds_read_b128 v[40:43], v19 offset:30720
    ds_read_b128 v[44:47], v20 offset:30720
    ds_read_b128 v[48:51], v19 offset:30848
    ds_read_b128 v[52:55], v20 offset:30848
    ds_read_b128 v[56:59], v19 offset:30976
    ds_read_b128 v[60:63], v20 offset:30976
    s_nop 1
    v_cvt_pk_bf16_f32 v36, v172, v173
    v_cvt_pk_bf16_f32 v37, v174, v175
    v_lshlrev_b32 v172, 16, v36
    v_and_b32 v173, 0xffff0000, v36
    v_lshlrev_b32 v174, 16, v37
    v_and_b32 v175, 0xffff0000, v37
    v_mul_f32 v172, s70, v172
    v_mul_f32 v173, s70, v173
    v_mul_f32 v174, s70, v174
    v_mul_f32 v175, s70, v175
    v_cvt_pk_bf16_f32 v36, v172, v173
    v_cvt_pk_bf16_f32 v37, v174, v175
    v_lshlrev_b32 v172, 16, v36
    v_and_b32 v173, 0xffff0000, v36
    v_lshlrev_b32 v174, 16, v37
    v_and_b32 v175, 0xffff0000, v37
    v_max3_f32 v33, v33, v172, v173
    v_max3_f32 v33, v33, v174, v175
    s_waitcnt lgkmcnt(0)
    v_mfma_f32_16x16x32_bf16 v[176:179], v[40:43], v[112:115], 0
    v_mfma_f32_16x16x32_bf16 v[176:179], v[44:47], v[116:119], v[176:179]
    v_mfma_f32_16x16x32_bf16 v[176:179], v[48:51], v[120:123], v[176:179]
    v_mfma_f32_16x16x32_bf16 v[176:179], v[52:55], v[124:127], v[176:179]
    v_mfma_f32_16x16x32_bf16 v[176:179], v[56:59], v[128:131], v[176:179]
    v_mfma_f32_16x16x32_bf16 v[176:179], v[60:63], v[132:135], v[176:179]
    ds_write_b128 v235, a[48:51] offset:30720
    ds_write_b128 v235, a[52:55] offset:31744
    ds_write_b128 v235, a[56:59] offset:32768
    ds_write_b128 v235, a[60:63] offset:33792
    ds_write_b128 v235, a[64:67] offset:34816
    ds_write_b128 v235, a[68:71] offset:35840
    ds_read_b128 v[40:43], v19 offset:30720
    ds_read_b128 v[44:47], v20 offset:30720
    ds_read_b128 v[48:51], v19 offset:30848
    ds_read_b128 v[52:55], v20 offset:30848
    ds_read_b128 v[56:59], v19 offset:30976
    ds_read_b128 v[60:63], v20 offset:30976
    s_nop 1
    v_cvt_pk_bf16_f32 v36, v176, v177
    v_cvt_pk_bf16_f32 v37, v178, v179
    v_lshlrev_b32 v176, 16, v36
    v_and_b32 v177, 0xffff0000, v36
    v_lshlrev_b32 v178, 16, v37
    v_and_b32 v179, 0xffff0000, v37
    v_mul_f32 v176, s70, v176
    v_mul_f32 v177, s70, v177
    v_mul_f32 v178, s70, v178
    v_mul_f32 v179, s70, v179
    v_cvt_pk_bf16_f32 v36, v176, v177
    v_cvt_pk_bf16_f32 v37, v178, v179
    v_lshlrev_b32 v176, 16, v36
    v_and_b32 v177, 0xffff0000, v36
    v_lshlrev_b32 v178, 16, v37
    v_and_b32 v179, 0xffff0000, v37
    v_max3_f32 v33, v33, v176, v177
    v_max3_f32 v33, v33, v178, v179
    s_waitcnt lgkmcnt(0)
    v_mfma_f32_16x16x32_bf16 v[180:183], v[40:43], v[112:115], 0
    v_mfma_f32_16x16x32_bf16 v[180:183], v[44:47], v[116:119], v[180:183]
    v_mfma_f32_16x16x32_bf16 v[180:183], v[48:51], v[120:123], v[180:183]
    v_mfma_f32_16x16x32_bf16 v[180:183], v[52:55], v[124:127], v[180:183]
    v_mfma_f32_16x16x32_bf16 v[180:183], v[56:59], v[128:131], v[180:183]
    v_mfma_f32_16x16x32_bf16 v[180:183], v[60:63], v[132:135], v[180:183]
    s_waitcnt vmcnt(10)
    s_add_u32 s55, s58, 60
    s_and_b32 s55, s55, 63
    s_mul_i32 s55, s55, 6144
    s_add_u32 m0, s54, 30720
    s_nop 0
    buffer_load_dwordx4 v2, s[20:23], s55 offen nt lds
    s_waitcnt vmcnt(10)
    s_add_u32 m0, s54, 31744
    s_nop 0
    buffer_load_dwordx4 v3, s[20:23], s55 offen nt lds
    s_waitcnt vmcnt(10)
    s_add_u32 m0, s54, 32768
    s_nop 0
    buffer_load_dwordx4 v4, s[20:23], s55 offen nt lds
    s_waitcnt vmcnt(10)
    s_add_u32 m0, s54, 33792
    s_nop 0
    buffer_load_dwordx4 v5, s[20:23], s55 offen nt lds
    s_waitcnt vmcnt(10)
    s_add_u32 m0, s54, 34816
    s_nop 0
    buffer_load_dwordx4 v6, s[20:23], s55 offen nt lds
    s_waitcnt vmcnt(10)
    s_add_u32 m0, s54, 35840
    s_nop 0
    buffer_load_dwordx4 v7, s[20:23], s55 offen nt lds
    s_waitcnt vmcnt(10)
    s_add_u32 s55, s58, 0
    s_and_b32 s55, s55, 63
    s_mul_i32 s55, s55, 6144
    s_add_u32 m0, s54, 0
    s_nop 0
    buffer_load_dwordx4 v2, s[24:27], s55 offen nt lds
    ds_read_b128 v[40:43], v19 offset:12288
    ds_read_b128 v[44:47], v20 offset:12288
    ds_read_b128 v[48:51], v19 offset:12416
    ds_read_b128 v[52:55], v20 offset:12416
    ds_read_b128 v[56:59], v19 offset:12544
    ds_read_b128 v[60:63], v20 offset:12544
    s_nop 1
    v_cvt_pk_bf16_f32 v36, v180, v181
    v_cvt_pk_bf16_f32 v37, v182, v183
    v_lshlrev_b32 v180, 16, v36
    v_and_b32 v181, 0xffff0000, v36
    v_lshlrev_b32 v182, 16, v37
    v_and_b32 v183, 0xffff0000, v37
    v_mul_f32 v180, s70, v180
    v_mul_f32 v181, s70, v181
    v_mul_f32 v182, s70, v182
    v_mul_f32 v183, s70, v183
    v_cvt_pk_bf16_f32 v36, v180, v181
    v_cvt_pk_bf16_f32 v37, v182, v183
    v_lshlrev_b32 v180, 16, v36
    v_and_b32 v181, 0xffff0000, v36
    v_lshlrev_b32 v182, 16, v37
    v_and_b32 v183, 0xffff0000, v37
    v_max3_f32 v33, v33, v180, v181
    v_max3_f32 v33, v33, v182, v183
    s_waitcnt lgkmcnt(0)
    v_mfma_f32_16x16x32_bf16 v[184:187], v[40:43], v[112:115], 0
    v_mfma_f32_16x16x32_bf16 v[184:187], v[44:47], v[116:119], v[184:187]
    v_mfma_f32_16x16x32_bf16 v[184:187], v[48:51], v[120:123], v[184:187]
    v_mfma_f32_16x16x32_bf16 v[184:187], v[52:55], v[124:127], v[184:187]
    v_mfma_f32_16x16x32_bf16 v[184:187], v[56:59], v[128:131], v[184:187]
    v_mfma_f32_16x16x32_bf16 v[184:187], v[60:63], v[132:135], v[184:187]
    s_waitcnt vmcnt(10)
    s_add_u32 m0, s54, 1024
    s_nop 0
    buffer_load_dwordx4 v3, s[24:27], s55 offen nt lds
    s_waitcnt vmcnt(10)
    s_add_u32 m0, s54, 2048
    s_nop 0
    buffer_load_dwordx4 v4, s[24:27], s55 offen nt lds
    ds_read_b128 v[40:43], v19 offset:18432
    ds_read_b128 v[44:47], v20 offset:18432
    ds_read_b128 v[48:51], v19 offset:18560
    ds_read_b128 v[52:55], v20 offset:18560
    ds_read_b128 v[56:59], v19 offset:18688
    ds_read_b128 v[60:63], v20 offset:18688
    s_nop 1
    v_cvt_pk_bf16_f32 v36, v184, v185
    v_cvt_pk_bf16_f32 v37, v186, v187
    v_lshlrev_b32 v184, 16, v36
    v_and_b32 v185, 0xffff0000, v36
    v_lshlrev_b32 v186, 16, v37
    v_and_b32 v187, 0xffff0000, v37
    v_mul_f32 v184, s70, v184
    v_mul_f32 v185, s70, v185
    v_mul_f32 v186, s70, v186
    v_mul_f32 v187, s70, v187
    v_cvt_pk_bf16_f32 v36, v184, v185
    v_cvt_pk_bf16_f32 v37, v186, v187
    v_lshlrev_b32 v184, 16, v36
    v_and_b32 v185, 0xffff0000, v36
    v_lshlrev_b32 v186, 16, v37
    v_and_b32 v187, 0xffff0000, v37
    v_max3_f32 v33, v33, v184, v185
    v_max3_f32 v33, v33, v186, v187
    s_waitcnt lgkmcnt(0)
    v_mfma_f32_16x16x32_bf16 v[188:191], v[40:43], v[112:115], 0
    v_mfma_f32_16x16x32_bf16 v[188:191], v[44:47], v[116:119], v[188:191]
    v_mfma_f32_16x16x32_bf16 v[188:191], v[48:51], v[120:123], v[188:191]
    v_mfma_f32_16x16x32_bf16 v[188:191], v[52:55], v[124:127], v[188:191]
    v_mfma_f32_16x16x32_bf16 v[188:191], v[56:59], v[128:131], v[188:191]
    v_mfma_f32_16x16x32_bf16 v[188:191], v[60:63], v[132:135], v[188:191]
    s_waitcnt vmcnt(10)
    s_add_u32 m0, s54, 3072
    s_nop 0
    buffer_load_dwordx4 v5, s[24:27], s55 offen nt lds
    s_waitcnt vmcnt(10)
    s_add_u32 m0, s54, 4096
    s_nop 0
    buffer_load_dwordx4 v6, s[24:27], s55 offen nt lds
    ds_read_b128 v[40:43], v19 offset:24576
    ds_read_b128 v[44:47], v20 offset:24576
    ds_read_b128 v[48:51], v19 offset:24704
    ds_read_b128 v[52:55], v20 offset:24704
    ds_read_b128 v[56:59], v19 offset:24832
    ds_read_b128 v[60:63], v20 offset:24832
    s_nop 1
    v_cvt_pk_bf16_f32 v36, v188, v189
    v_cvt_pk_bf16_f32 v37, v190, v191
    v_lshlrev_b32 v188, 16, v36
    v_and_b32 v189, 0xffff0000, v36
    v_lshlrev_b32 v190, 16, v37
    v_and_b32 v191, 0xffff0000, v37
    v_mul_f32 v188, s70, v188
    v_mul_f32 v189, s70, v189
    v_mul_f32 v190, s70, v190
    v_mul_f32 v191, s70, v191
    v_cvt_pk_bf16_f32 v36, v188, v189
    v_cvt_pk_bf16_f32 v37, v190, v191
    v_lshlrev_b32 v188, 16, v36
    v_and_b32 v189, 0xffff0000, v36
    v_lshlrev_b32 v190, 16, v37
    v_and_b32 v191, 0xffff0000, v37
    v_max3_f32 v33, v33, v188, v189
    v_max3_f32 v33, v33, v190, v191
    s_waitcnt lgkmcnt(0)
    v_mfma_f32_16x16x32_bf16 v[192:195], v[40:43], v[112:115], 0
    v_mfma_f32_16x16x32_bf16 v[192:195], v[44:47], v[116:119], v[192:195]
    v_mfma_f32_16x16x32_bf16 v[192:195], v[48:51], v[120:123], v[192:195]
    v_mfma_f32_16x16x32_bf16 v[192:195], v[52:55], v[124:127], v[192:195]
    v_mfma_f32_16x16x32_bf16 v[192:195], v[56:59], v[128:131], v[192:195]
    v_mfma_f32_16x16x32_bf16 v[192:195], v[60:63], v[132:135], v[192:195]
    s_waitcnt vmcnt(10)
    s_add_u32 m0, s54, 5120
    s_nop 0
    buffer_load_dwordx4 v7, s[24:27], s55 offen nt lds
    s_waitcnt vmcnt(10)
    s_add_u32 s55, s58, 4
    s_and_b32 s55, s55, 63
    s_mul_i32 s55, s55, 6144
    s_add_u32 m0, s54, 6144
    s_nop 0
    buffer_load_dwordx4 v2, s[24:27], s55 offen nt lds
    s_waitcnt vmcnt(10)
    s_add_u32 m0, s54, 7168
    s_nop 0
    buffer_load_dwordx4 v3, s[24:27], s55 offen nt lds
    s_waitcnt vmcnt(10)
    s_add_u32 m0, s54, 8192
    s_nop 0
    buffer_load_dwordx4 v4, s[24:27], s55 offen nt lds
    s_waitcnt vmcnt(10)
    s_add_u32 m0, s54, 9216
    s_nop 0
    buffer_load_dwordx4 v5, s[24:27], s55 offen nt lds
    s_waitcnt vmcnt(10)
    s_add_u32 m0, s54, 10240
    s_nop 0
    buffer_load_dwordx4 v6, s[24:27], s55 offen nt lds
    ds_read_b128 v[40:43], v19 offset:30720
    ds_read_b128 v[44:47], v20 offset:30720
    ds_read_b128 v[48:51], v19 offset:30848
    ds_read_b128 v[52:55], v20 offset:30848
    ds_read_b128 v[56:59], v19 offset:30976
    ds_read_b128 v[60:63], v20 offset:30976
    s_nop 1
    v_cvt_pk_bf16_f32 v36, v192, v193
    v_cvt_pk_bf16_f32 v37, v194, v195
    v_lshlrev_b32 v192, 16, v36
    v_and_b32 v193, 0xffff0000, v36
    v_lshlrev_b32 v194, 16, v37
    v_and_b32 v195, 0xffff0000, v37
    v_mul_f32 v192, s70, v192
    v_mul_f32 v193, s70, v193
    v_mul_f32 v194, s70, v194
    v_mul_f32 v195, s70, v195
    v_cvt_pk_bf16_f32 v36, v192, v193
    v_cvt_pk_bf16_f32 v37, v194, v195
    v_lshlrev_b32 v192, 16, v36
    v_and_b32 v193, 0xffff0000, v36
    v_lshlrev_b32 v194, 16, v37
    v_and_b32 v195, 0xffff0000, v37
    v_max3_f32 v33, v33, v192, v193
    v_max3_f32 v33, v33, v194, v195
    s_waitcnt lgkmcnt(0)
    v_mfma_f32_16x16x32_bf16 v[196:199], v[40:43], v[112:115], 0
    v_mfma_f32_16x16x32_bf16 v[196:199], v[44:47], v[116:119], v[196:199]
    v_mfma_f32_16x16x32_bf16 v[196:199], v[48:51], v[120:123], v[196:199]
    v_mfma_f32_16x16x32_bf16 v[196:199], v[52:55], v[124:127], v[196:199]
    v_mfma_f32_16x16x32_bf16 v[196:199], v[56:59], v[128:131], v[196:199]
    v_mfma_f32_16x16x32_bf16 v[196:199], v[60:63], v[132:135], v[196:199]
    s_waitcnt vmcnt(10)
    s_add_u32 m0, s54, 11264
    s_nop 0
    buffer_load_dwordx4 v7, s[24:27], s55 offen nt lds
    s_waitcnt vmcnt(10)
    s_add_u32 s55, s58, 8
    s_and_b32 s55, s55, 63
    s_mul_i32 s55, s55, 6144
    s_add_u32 m0, s54, 12288
    s_nop 0
    buffer_load_dwordx4 v2, s[24:27], s55 offen nt lds
    s_nop 7
    v_cvt_pk_bf16_f32 v36, v196, v197
    v_cvt_pk_bf16_f32 v37, v198, v199
    v_lshlrev_b32 v196, 16, v36
    v_and_b32 v197, 0xffff0000, v36
    v_lshlrev_b32 v198, 16, v37
    v_and_b32 v199, 0xffff0000, v37
    v_mul_f32 v196, s70, v196
    v_mul_f32 v197, s70, v197
    v_mul_f32 v198, s70, v198
    v_mul_f32 v199, s70, v199
    v_cvt_pk_bf16_f32 v36, v196, v197
    v_cvt_pk_bf16_f32 v37, v198, v199
    v_lshlrev_b32 v196, 16, v36
    v_and_b32 v197, 0xffff0000, v36
    v_lshlrev_b32 v198, 16, v37
    v_and_b32 v199, 0xffff0000, v37
    v_max3_f32 v33, v33, v196, v197
    v_max3_f32 v33, v33, v198, v199
    s_add_u32 m0, s54, 13312
    s_nop 0
    buffer_load_dwordx4 v3, s[24:27], s55 offen nt lds
    s_add_u32 m0, s54, 14336
    s_nop 0
    buffer_load_dwordx4 v4, s[24:27], s55 offen nt lds
    ds_write_b32 v31, v33
    s_waitcnt lgkmcnt(0)
    s_barrier
    ds_read_b128 v[40:43], v32 offset:0
    ds_read_b128 v[44:47], v32 offset:16
    ds_read_b128 v[48:51], v32 offset:32
    ds_read_b128 v[52:55], v32 offset:48
    s_waitcnt lgkmcnt(0)
    v_max3_f32 v33, v33, v40, v41
    v_max3_f32 v33, v33, v42, v43
    v_max3_f32 v33, v33, v44, v45
    v_max3_f32 v33, v33, v46, v47
    v_max3_f32 v33, v33, v48, v49
    v_max3_f32 v33, v33, v50, v51
    v_max3_f32 v33, v33, v52, v53
    v_max3_f32 v33, v33, v54, v55
    v_mul_f32 v33, s71, v33
    s_add_u32 m0, s54, 15360
    s_nop 0
    buffer_load_dwordx4 v5, s[24:27], s55 offen nt lds
    s_add_u32 m0, s54, 16384
    s_nop 0
    buffer_load_dwordx4 v6, s[24:27], s55 offen nt lds
    v_fma_f32 v136, v136, s71, -v33
    v_fma_f32 v137, v137, s71, -v33
    v_fma_f32 v138, v138, s71, -v33
    v_fma_f32 v139, v139, s71, -v33
    v_fma_f32 v140, v140, s71, -v33
    v_fma_f32 v141, v141, s71, -v33
    v_fma_f32 v142, v142, s71, -v33
    v_fma_f32 v143, v143, s71, -v33
    v_fma_f32 v144, v144, s71, -v33
    v_fma_f32 v145, v145, s71, -v33
    v_fma_f32 v146, v146, s71, -v33
    v_fma_f32 v147, v147, s71, -v33
    v_fma_f32 v148, v148, s71, -v33
    v_fma_f32 v149, v149, s71, -v33
    v_fma_f32 v150, v150, s71, -v33
    v_fma_f32 v151, v151, s71, -v33
    v_fma_f32 v152, v152, s71, -v33
    v_fma_f32 v153, v153, s71, -v33
    v_fma_f32 v154, v154, s71, -v33
    v_fma_f32 v155, v155, s71, -v33
    v_fma_f32 v156, v156, s71, -v33
    v_fma_f32 v157, v157, s71, -v33
    v_fma_f32 v158, v158, s71, -v33
    v_fma_f32 v159, v159, s71, -v33
    v_fma_f32 v160, v160, s71, -v33
    v_fma_f32 v161, v161, s71, -v33
    v_fma_f32 v162, v162, s71, -v33
    v_fma_f32 v163, v163, s71, -v33
    v_fma_f32 v164, v164, s71, -v33
    v_fma_f32 v165, v165, s71, -v33
    v_fma_f32 v166, v166, s71, -v33
    v_fma_f32 v167, v167, s71, -v33
    v_fma_f32 v168, v168, s71, -v33
    v_fma_f32 v169, v169, s71, -v33
    v_fma_f32 v170, v170, s71, -v33
    v_fma_f32 v171, v171, s71, -v33
    v_fma_f32 v172, v172, s71, -v33
    v_fma_f32 v173, v173, s71, -v33
    v_fma_f32 v174, v174, s71, -v33
    v_fma_f32 v175, v175, s71, -v33
    v_fma_f32 v176, v176, s71, -v33
    v_fma_f32 v177, v177, s71, -v33
    v_fma_f32 v178, v178, s71, -v33
    v_fma_f32 v179, v179, s71, -v33
    v_fma_f32 v180, v180, s71, -v33
    v_fma_f32 v181, v181, s71, -v33
    v_fma_f32 v182, v182, s71, -v33
    v_fma_f32 v183, v183, s71, -v33
    v_fma_f32 v184, v184, s71, -v33
    v_fma_f32 v185, v185, s71, -v33
    v_fma_f32 v186, v186, s71, -v33
    v_fma_f32 v187, v187, s71, -v33
    v_fma_f32 v188, v188, s71, -v33
    v_fma_f32 v189, v189, s71, -v33
    v_fma_f32 v190, v190, s71, -v33
    v_fma_f32 v191, v191, s71, -v33
    v_fma_f32 v192, v192, s71, -v33
    v_fma_f32 v193, v193, s71, -v33
    v_fma_f32 v194, v194, s71, -v33
    v_fma_f32 v195, v195, s71, -v33
    v_fma_f32 v196, v196, s71, -v33
    v_fma_f32 v197, v197, s71, -v33
    v_fma_f32 v198, v198, s71, -v33
    v_fma_f32 v199, v199, s71, -v33
    s_add_u32 m0, s54, 17408
    s_nop 0
    buffer_load_dwordx4 v7, s[24:27], s55 offen nt lds
    s_add_u32 s55, s58, 12
    s_and_b32 s55, s55, 63
    s_mul_i32 s55, s55, 6144
    s_add_u32 m0, s54, 18432
    s_nop 0
    buffer_load_dwordx4 v2, s[24:27], s55 offen nt lds
    v_exp_f32 v136, v136
    v_exp_f32 v137, v137
    v_exp_f32 v138, v138
    v_exp_f32 v139, v139
    v_exp_f32 v140, v140
    v_exp_f32 v141, v141
    v_exp_f32 v142, v142
    v_exp_f32 v143, v143
    v_exp_f32 v144, v144
    v_exp_f32 v145, v145
    v_exp_f32 v146, v146
    v_exp_f32 v147, v147
    v_exp_f32 v148, v148
    v_exp_f32 v149, v149
    v_exp_f32 v150, v150
    v_exp_f32 v151, v151
    v_exp_f32 v152, v152
    v_exp_f32 v153, v153
    v_exp_f32 v154, v154
    v_exp_f32 v155, v155
    v_exp_f32 v156, v156
    v_exp_f32 v157, v157
    v_exp_f32 v158, v158
    v_exp_f32 v159, v159
    v_exp_f32 v160, v160
    v_exp_f32 v161, v161
    v_exp_f32 v162, v162
    v_exp_f32 v163, v163
    v_exp_f32 v164, v164
    v_exp_f32 v165, v165
    v_exp_f32 v166, v166
    v_exp_f32 v167, v167
    s_add_u32 m0, s54, 19456
    s_nop 0
    buffer_load_dwordx4 v3, s[24:27], s55 offen nt lds
    s_add_u32 m0, s54, 20480
    s_nop 0
    buffer_load_dwordx4 v4, s[24:27], s55 offen nt lds
    v_exp_f32 v168, v168
    v_exp_f32 v169, v169
    v_exp_f32 v170, v170
    v_exp_f32 v171, v171
    v_exp_f32 v172, v172
    v_exp_f32 v173, v173
    v_exp_f32 v174, v174
    v_exp_f32 v175, v175
    v_exp_f32 v176, v176
    v_exp_f32 v177, v177
    v_exp_f32 v178, v178
    v_exp_f32 v179, v179
    v_exp_f32 v180, v180
    v_exp_f32 v181, v181
    v_exp_f32 v182, v182
    v_exp_f32 v183, v183
    v_exp_f32 v184, v184
    v_exp_f32 v185, v185
    v_exp_f32 v186, v186
    v_exp_f32 v187, v187
    v_exp_f32 v188, v188
    v_exp_f32 v189, v189
    v_exp_f32 v190, v190
    v_exp_f32 v191, v191
    v_exp_f32 v192, v192
    v_exp_f32 v193, v193
    v_exp_f32 v194, v194
    v_exp_f32 v195, v195
    v_exp_f32 v196, v196
    v_exp_f32 v197, v197
    v_exp_f32 v198, v198
    v_exp_f32 v199, v199
    s_add_u32 m0, s54, 21504
    s_nop 0
    buffer_load_dwordx4 v5, s[24:27], s55 offen nt lds
    s_add_u32 m0, s54, 22528
    s_nop 0
    buffer_load_dwordx4 v6, s[24:27], s55 offen nt lds
    v_add_f32 v36, v136, v137
    v_add_f32 v37, v138, v139
    v_add_f32 v36, v36, v140
    v_add_f32 v37, v37, v141
    v_add_f32 v36, v36, v142
    v_add_f32 v37, v37, v143
    v_add_f32 v36, v36, v144
    v_add_f32 v37, v37, v145
    v_add_f32 v36, v36, v146
    v_add_f32 v37, v37, v147
    v_add_f32 v36, v36, v148
    v_add_f32 v37, v37, v149
    v_add_f32 v36, v36, v150
    v_add_f32 v37, v37, v151
    v_add_f32 v36, v36, v152
    v_add_f32 v37, v37, v153
    v_add_f32 v36, v36, v154
    v_add_f32 v37, v37, v155
    v_add_f32 v36, v36, v156
    v_add_f32 v37, v37, v157
    v_add_f32 v36, v36, v158
    v_add_f32 v37, v37, v159
    v_add_f32 v36, v36, v160
    v_add_f32 v37, v37, v161
    v_add_f32 v36, v36, v162
    v_add_f32 v37, v37, v163
    v_add_f32 v36, v36, v164
    v_add_f32 v37, v37, v165
    v_add_f32 v36, v36, v166
    v_add_f32 v37, v37, v167
    v_add_f32 v36, v36, v168
    v_add_f32 v37, v37, v169
    v_add_f32 v36, v36, v170
    v_add_f32 v37, v37, v171
    v_add_f32 v36, v36, v172
    v_add_f32 v37, v37, v173
    v_add_f32 v36, v36, v174
    v_add_f32 v37, v37, v175
    v_add_f32 v36, v36, v176
    v_add_f32 v37, v37, v177
    v_add_f32 v36, v36, v178
    v_add_f32 v37, v37, v179
    v_add_f32 v36, v36, v180
    v_add_f32 v37, v37, v181
    v_add_f32 v36, v36, v182
    v_add_f32 v37, v37, v183
    v_add_f32 v36, v36, v184
    v_add_f32 v37, v37, v185
    v_add_f32 v36, v36, v186
    v_add_f32 v37, v37, v187
    v_add_f32 v36, v36, v188
    v_add_f32 v37, v37, v189
    v_add_f32 v36, v36, v190
    v_add_f32 v37, v37, v191
    v_add_f32 v36, v36, v192
    v_add_f32 v37, v37, v193
    v_add_f32 v36, v36, v194
    v_add_f32 v37, v37, v195
    v_add_f32 v36, v36, v196
    v_add_f32 v37, v37, v197
    v_add_f32 v36, v36, v198
    v_add_f32 v37, v37, v199
    v_add_f32 v36, v36, v37
    ds_write_b32 v31, v36 offset:256
    s_waitcnt lgkmcnt(0)
    s_barrier
    ds_read_b128 v[40:43], v32 offset:256
    ds_read_b128 v[44:47], v32 offset:272
    ds_read_b128 v[48:51], v32 offset:288
    ds_read_b128 v[52:55], v32 offset:304
    s_add_u32 m0, s54, 23552
    s_nop 0
    buffer_load_dwordx4 v7, s[24:27], s55 offen nt lds
    s_add_u32 s55, s58, 16
    s_and_b32 s55, s55, 63
    s_mul_i32 s55, s55, 6144
    s_add_u32 m0, s54, 24576
    s_nop 0
    buffer_load_dwordx4 v2, s[24:27], s55 offen nt lds
    s_waitcnt lgkmcnt(0)
    v_add_f32 v40, v40, v48
    v_add_f32 v41, v41, v49
    v_add_f32 v42, v42, v50
    v_add_f32 v43, v43, v51
    v_add_f32 v44, v44, v52
    v_add_f32 v45, v45, v53
    v_add_f32 v46, v46, v54
    v_add_f32 v47, v47, v55
    v_add_f32 v40, v40, v44
    v_add_f32 v41, v41, v45
    v_add_f32 v42, v42, v46
    v_add_f32 v43, v43, v47
    v_add_f32 v40, v40, v41
    v_add_f32 v42, v42, v43
    v_add_f32 v40, v40, v42
    v_rcp_f32 v36, v40
    s_nop 0
    v_mul_f32 v136, v36, v136
    v_mul_f32 v137, v36, v137
    v_mul_f32 v138, v36, v138
    v_mul_f32 v139, v36, v139
    v_mul_f32 v140, v36, v140
    v_mul_f32 v141, v36, v141
    v_mul_f32 v142, v36, v142
    v_mul_f32 v143, v36, v143
    v_mul_f32 v144, v36, v144
    v_mul_f32 v145, v36, v145
    v_mul_f32 v146, v36, v146
    v_mul_f32 v147, v36, v147
    v_mul_f32 v148, v36, v148
    v_mul_f32 v149, v36, v149
    v_mul_f32 v150, v36, v150
    v_mul_f32 v151, v36, v151
    v_mul_f32 v152, v36, v152
    v_mul_f32 v153, v36, v153
    v_mul_f32 v154, v36, v154
    v_mul_f32 v155, v36, v155
    v_mul_f32 v156, v36, v156
    v_mul_f32 v157, v36, v157
    v_mul_f32 v158, v36, v158
    v_mul_f32 v159, v36, v159
    v_mul_f32 v160, v36, v160
    v_mul_f32 v161, v36, v161
    v_mul_f32 v162, v36, v162
    v_mul_f32 v163, v36, v163
    v_mul_f32 v164, v36, v164
    v_mul_f32 v165, v36, v165
    v_mul_f32 v166, v36, v166
    v_mul_f32 v167, v36, v167
    v_mul_f32 v168, v36, v168
    v_mul_f32 v169, v36, v169
    v_mul_f32 v170, v36, v170
    v_mul_f32 v171, v36, v171
    v_mul_f32 v172, v36, v172
    v_mul_f32 v173, v36, v173
    v_mul_f32 v174, v36, v174
    v_mul_f32 v175, v36, v175
    v_mul_f32 v176, v36, v176
    v_mul_f32 v177, v36, v177
    v_mul_f32 v178, v36, v178
    v_mul_f32 v179, v36, v179
    v_mul_f32 v180, v36, v180
    v_mul_f32 v181, v36, v181
    v_mul_f32 v182, v36, v182
    v_mul_f32 v183, v36, v183
    v_mul_f32 v184, v36, v184
    v_mul_f32 v185, v36, v185
    v_mul_f32 v186, v36, v186
    v_mul_f32 v187, v36, v187
    v_mul_f32 v188, v36, v188
    v_mul_f32 v189, v36, v189
    v_mul_f32 v190, v36, v190
    v_mul_f32 v191, v36, v191
    v_mul_f32 v192, v36, v192
    v_mul_f32 v193, v36, v193
    v_mul_f32 v194, v36, v194
    v_mul_f32 v195, v36, v195
    v_mul_f32 v196, v36, v196
    v_mul_f32 v197, v36, v197
    v_mul_f32 v198, v36, v198
    v_mul_f32 v199, v36, v199
    s_add_u32 m0, s54, 25600
    s_nop 0
    buffer_load_dwordx4 v3, s[24:27], s55 offen nt lds
    s_add_u32 m0, s54, 26624
    s_nop 0
    buffer_load_dwordx4 v4, s[24:27], s55 offen nt lds
    v_cvt_pk_bf16_f32 v200, v136, v137
    v_cvt_pk_bf16_f32 v201, v138, v139
    v_cvt_pk_bf16_f32 v202, v140, v141
    v_cvt_pk_bf16_f32 v203, v142, v143
    v_cvt_pk_bf16_f32 v204, v144, v145
    v_cvt_pk_bf16_f32 v205, v146, v147
    v_cvt_pk_bf16_f32 v206, v148, v149
    v_cvt_pk_bf16_f32 v207, v150, v151
    v_cvt_pk_bf16_f32 v208, v152, v153
    v_cvt_pk_bf16_f32 v209, v154, v155
    v_cvt_pk_bf16_f32 v210, v156, v157
    v_cvt_pk_bf16_f32 v211, v158, v159
    v_cvt_pk_bf16_f32 v212, v160, v161
    v_cvt_pk_bf16_f32 v213, v162, v163
    v_cvt_pk_bf16_f32 v214, v164, v165
    v_cvt_pk_bf16_f32 v215, v166, v167
    v_cvt_pk_bf16_f32 v216, v168, v169
    v_cvt_pk_bf16_f32 v217, v170, v171
    v_cvt_pk_bf16_f32 v218, v172, v173
    v_cvt_pk_bf16_f32 v219, v174, v175
    v_cvt_pk_bf16_f32 v220, v176, v177
    v_cvt_pk_bf16_f32 v221, v178, v179
    v_cvt_pk_bf16_f32 v222, v180, v181
    v_cvt_pk_bf16_f32 v223, v182, v183
    v_cvt_pk_bf16_f32 v224, v184, v185
    v_cvt_pk_bf16_f32 v225, v186, v187
    v_cvt_pk_bf16_f32 v226, v188, v189
    v_cvt_pk_bf16_f32 v227, v190, v191
    v_cvt_pk_bf16_f32 v228, v192, v193
    v_cvt_pk_bf16_f32 v229, v194, v195
    v_cvt_pk_bf16_f32 v230, v196, v197
    v_cvt_pk_bf16_f32 v231, v198, v199
    v_mov_b32 v33, 0xffffff00
    s_nop 0
    s_waitcnt vmcnt(21)
    ds_read_b64_tr_b16 v[40:41], v21 offset:0
    ds_read_b64_tr_b16 v[42:43], v22 offset:0
    ds_read_b64_tr_b16 v[44:45], v23 offset:0
    ds_read_b64_tr_b16 v[46:47], v24 offset:0
    ds_read_b64_tr_b16 v[48:49], v21 offset:128
    ds_read_b64_tr_b16 v[50:51], v22 offset:128
    ds_read_b64_tr_b16 v[52:53], v23 offset:128
    ds_read_b64_tr_b16 v[54:55], v24 offset:128
    ds_read_b64_tr_b16 v[56:57], v21 offset:256
    ds_read_b64_tr_b16 v[58:59], v22 offset:256
    ds_read_b64_tr_b16 v[60:61], v23 offset:256
    ds_read_b64_tr_b16 v[62:63], v24 offset:256
    s_waitcnt lgkmcnt(0)
    v_mfma_f32_16x16x16_bf16 v[64:67], v[40:41], v[200:201], 0
    v_mfma_f32_16x16x16_bf16 v[68:71], v[42:43], v[200:201], 0
    v_mfma_f32_16x16x16_bf16 v[72:75], v[44:45], v[200:201], 0
    v_mfma_f32_16x16x16_bf16 v[76:79], v[46:47], v[200:201], 0
    v_mfma_f32_16x16x16_bf16 v[80:83], v[48:49], v[200:201], 0
    v_mfma_f32_16x16x16_bf16 v[84:87], v[50:51], v[200:201], 0
    v_mfma_f32_16x16x16_bf16 v[88:91], v[52:53], v[200:201], 0
    v_mfma_f32_16x16x16_bf16 v[92:95], v[54:55], v[200:201], 0
    v_mfma_f32_16x16x16_bf16 v[96:99], v[56:57], v[200:201], 0
    v_mfma_f32_16x16x16_bf16 v[100:103], v[58:59], v[200:201], 0
    v_mfma_f32_16x16x16_bf16 v[104:107], v[60:61], v[200:201], 0
    v_mfma_f32_16x16x16_bf16 v[108:111], v[62:63], v[200:201], 0
    s_waitcnt vmcnt(10)
    s_add_u32 m0, s54, 27648
    s_nop 0
    buffer_load_dwordx4 v5, s[24:27], s55 offen nt lds
    s_waitcnt vmcnt(10)
    s_add_u32 m0, s54, 28672
    s_nop 0
    buffer_load_dwordx4 v6, s[24:27], s55 offen nt lds
    ds_read_b64_tr_b16 v[40:41], v21 offset:6144
    ds_read_b64_tr_b16 v[42:43], v22 offset:6144
    ds_read_b64_tr_b16 v[44:45], v23 offset:6144
    ds_read_b64_tr_b16 v[46:47], v24 offset:6144
    ds_read_b64_tr_b16 v[48:49], v21 offset:6272
    ds_read_b64_tr_b16 v[50:51], v22 offset:6272
    ds_read_b64_tr_b16 v[52:53], v23 offset:6272
    ds_read_b64_tr_b16 v[54:55], v24 offset:6272
    ds_read_b64_tr_b16 v[56:57], v21 offset:6400
    ds_read_b64_tr_b16 v[58:59], v22 offset:6400
    ds_read_b64_tr_b16 v[60:61], v23 offset:6400
    ds_read_b64_tr_b16 v[62:63], v24 offset:6400
    s_waitcnt lgkmcnt(0)
    v_mfma_f32_16x16x16_bf16 v[64:67], v[40:41], v[202:203], v[64:67]
    v_mfma_f32_16x16x16_bf16 v[68:71], v[42:43], v[202:203], v[68:71]
    v_mfma_f32_16x16x16_bf16 v[72:75], v[44:45], v[202:203], v[72:75]
    v_mfma_f32_16x16x16_bf16 v[76:79], v[46:47], v[202:203], v[76:79]
    v_mfma_f32_16x16x16_bf16 v[80:83], v[48:49], v[202:203], v[80:83]
    v_mfma_f32_16x16x16_bf16 v[84:87], v[50:51], v[202:203], v[84:87]
    v_mfma_f32_16x16x16_bf16 v[88:91], v[52:53], v[202:203], v[88:91]
    v_mfma_f32_16x16x16_bf16 v[92:95], v[54:55], v[202:203], v[92:95]
    v_mfma_f32_16x16x16_bf16 v[96:99], v[56:57], v[202:203], v[96:99]
    v_mfma_f32_16x16x16_bf16 v[100:103], v[58:59], v[202:203], v[100:103]
    v_mfma_f32_16x16x16_bf16 v[104:107], v[60:61], v[202:203], v[104:107]
    v_mfma_f32_16x16x16_bf16 v[108:111], v[62:63], v[202:203], v[108:111]
    s_waitcnt vmcnt(10)
    s_add_u32 m0, s54, 29696
    s_nop 0
    buffer_load_dwordx4 v7, s[24:27], s55 offen nt lds
    s_waitcnt vmcnt(10)
    s_add_u32 s55, s58, 20
    s_and_b32 s55, s55, 63
    s_mul_i32 s55, s55, 6144
    s_add_u32 m0, s54, 30720
    s_nop 0
    buffer_load_dwordx4 v2, s[24:27], s55 offen nt lds
    ds_read_b64_tr_b16 v[40:41], v21 offset:12288
    ds_read_b64_tr_b16 v[42:43], v22 offset:12288
    ds_read_b64_tr_b16 v[44:45], v23 offset:12288
    ds_read_b64_tr_b16 v[46:47], v24 offset:12288
    ds_read_b64_tr_b16 v[48:49], v21 offset:12416
    ds_read_b64_tr_b16 v[50:51], v22 offset:12416
    ds_read_b64_tr_b16 v[52:53], v23 offset:12416
    ds_read_b64_tr_b16 v[54:55], v24 offset:12416
    ds_read_b64_tr_b16 v[56:57], v21 offset:12544
    ds_read_b64_tr_b16 v[58:59], v22 offset:12544
    ds_read_b64_tr_b16 v[60:61], v23 offset:12544
    ds_read_b64_tr_b16 v[62:63], v24 offset:12544
    s_waitcnt lgkmcnt(0)
    v_mfma_f32_16x16x16_bf16 v[64:67], v[40:41], v[204:205], v[64:67]
    v_mfma_f32_16x16x16_bf16 v[68:71], v[42:43], v[204:205], v[68:71]
    v_mfma_f32_16x16x16_bf16 v[72:75], v[44:45], v[204:205], v[72:75]
    v_mfma_f32_16x16x16_bf16 v[76:79], v[46:47], v[204:205], v[76:79]
    v_mfma_f32_16x16x16_bf16 v[80:83], v[48:49], v[204:205], v[80:83]
    v_mfma_f32_16x16x16_bf16 v[84:87], v[50:51], v[204:205], v[84:87]
    v_mfma_f32_16x16x16_bf16 v[88:91], v[52:53], v[204:205], v[88:91]
    v_mfma_f32_16x16x16_bf16 v[92:95], v[54:55], v[204:205], v[92:95]
    v_mfma_f32_16x16x16_bf16 v[96:99], v[56:57], v[204:205], v[96:99]
    v_mfma_f32_16x16x16_bf16 v[100:103], v[58:59], v[204:205], v[100:103]
    v_mfma_f32_16x16x16_bf16 v[104:107], v[60:61], v[204:205], v[104:107]
    v_mfma_f32_16x16x16_bf16 v[108:111], v[62:63], v[204:205], v[108:111]
    s_waitcnt vmcnt(10)
    s_add_u32 m0, s54, 31744
    s_nop 0
    buffer_load_dwordx4 v3, s[24:27], s55 offen nt lds
    s_waitcnt vmcnt(10)
    s_add_u32 m0, s54, 32768
    s_nop 0
    buffer_load_dwordx4 v4, s[24:27], s55 offen nt lds
    s_waitcnt vmcnt(10)
    s_add_u32 m0, s54, 33792
    s_nop 0
    buffer_load_dwordx4 v5, s[24:27], s55 offen nt lds
    s_waitcnt vmcnt(10)
    s_add_u32 m0, s54, 34816
    s_nop 0
    buffer_load_dwordx4 v6, s[24:27], s55 offen nt lds
    ds_read_b64_tr_b16 v[40:41], v21 offset:18432
    ds_read_b64_tr_b16 v[42:43], v22 offset:18432
    ds_read_b64_tr_b16 v[44:45], v23 offset:18432
    ds_read_b64_tr_b16 v[46:47], v24 offset:18432
    ds_read_b64_tr_b16 v[48:49], v21 offset:18560
    ds_read_b64_tr_b16 v[50:51], v22 offset:18560
    ds_read_b64_tr_b16 v[52:53], v23 offset:18560
    ds_read_b64_tr_b16 v[54:55], v24 offset:18560
    ds_read_b64_tr_b16 v[56:57], v21 offset:18688
    ds_read_b64_tr_b16 v[58:59], v22 offset:18688
    ds_read_b64_tr_b16 v[60:61], v23 offset:18688
    ds_read_b64_tr_b16 v[62:63], v24 offset:18688
    s_waitcnt lgkmcnt(0)
    v_mfma_f32_16x16x16_bf16 v[64:67], v[40:41], v[206:207], v[64:67]
    v_mfma_f32_16x16x16_bf16 v[68:71], v[42:43], v[206:207], v[68:71]
    v_mfma_f32_16x16x16_bf16 v[72:75], v[44:45], v[206:207], v[72:75]
    v_mfma_f32_16x16x16_bf16 v[76:79], v[46:47], v[206:207], v[76:79]
    v_mfma_f32_16x16x16_bf16 v[80:83], v[48:49], v[206:207], v[80:83]
    v_mfma_f32_16x16x16_bf16 v[84:87], v[50:51], v[206:207], v[84:87]
    v_mfma_f32_16x16x16_bf16 v[88:91], v[52:53], v[206:207], v[88:91]
    v_mfma_f32_16x16x16_bf16 v[92:95], v[54:55], v[206:207], v[92:95]
    v_mfma_f32_16x16x16_bf16 v[96:99], v[56:57], v[206:207], v[96:99]
    v_mfma_f32_16x16x16_bf16 v[100:103], v[58:59], v[206:207], v[100:103]
    v_mfma_f32_16x16x16_bf16 v[104:107], v[60:61], v[206:207], v[104:107]
    v_mfma_f32_16x16x16_bf16 v[108:111], v[62:63], v[206:207], v[108:111]
    s_waitcnt vmcnt(10)
    s_add_u32 m0, s54, 35840
    s_nop 0
    buffer_load_dwordx4 v7, s[24:27], s55 offen nt lds
    s_waitcnt vmcnt(10)
    s_add_u32 s55, s58, 24
    s_and_b32 s55, s55, 63
    s_mul_i32 s55, s55, 6144
    s_add_u32 m0, s54, 0
    s_nop 0
    buffer_load_dwordx4 v2, s[24:27], s55 offen nt lds
    s_waitcnt vmcnt(10)
    s_add_u32 m0, s54, 1024
    s_nop 0
    buffer_load_dwordx4 v3, s[24:27], s55 offen nt lds
    s_waitcnt vmcnt(10)
    s_add_u32 m0, s54, 2048
    s_nop 0
    buffer_load_dwordx4 v4, s[24:27], s55 offen nt lds
    s_waitcnt vmcnt(10)
    s_add_u32 m0, s54, 3072
    s_nop 0
    buffer_load_dwordx4 v5, s[24:27], s55 offen nt lds
    s_waitcnt vmcnt(10)
    s_add_u32 m0, s54, 4096
    s_nop 0
    buffer_load_dwordx4 v6, s[24:27], s55 offen nt lds
    ds_read_b64_tr_b16 v[40:41], v21 offset:24576
    ds_read_b64_tr_b16 v[42:43], v22 offset:24576
    ds_read_b64_tr_b16 v[44:45], v23 offset:24576
    ds_read_b64_tr_b16 v[46:47], v24 offset:24576
    ds_read_b64_tr_b16 v[48:49], v21 offset:24704
    ds_read_b64_tr_b16 v[50:51], v22 offset:24704
    ds_read_b64_tr_b16 v[52:53], v23 offset:24704
    ds_read_b64_tr_b16 v[54:55], v24 offset:24704
    ds_read_b64_tr_b16 v[56:57], v21 offset:24832
    ds_read_b64_tr_b16 v[58:59], v22 offset:24832
    ds_read_b64_tr_b16 v[60:61], v23 offset:24832
    ds_read_b64_tr_b16 v[62:63], v24 offset:24832
    s_waitcnt lgkmcnt(0)
    v_mfma_f32_16x16x16_bf16 v[64:67], v[40:41], v[208:209], v[64:67]
    v_mfma_f32_16x16x16_bf16 v[68:71], v[42:43], v[208:209], v[68:71]
    v_mfma_f32_16x16x16_bf16 v[72:75], v[44:45], v[208:209], v[72:75]
    v_mfma_f32_16x16x16_bf16 v[76:79], v[46:47], v[208:209], v[76:79]
    v_mfma_f32_16x16x16_bf16 v[80:83], v[48:49], v[208:209], v[80:83]
    v_mfma_f32_16x16x16_bf16 v[84:87], v[50:51], v[208:209], v[84:87]
    v_mfma_f32_16x16x16_bf16 v[88:91], v[52:53], v[208:209], v[88:91]
    v_mfma_f32_16x16x16_bf16 v[92:95], v[54:55], v[208:209], v[92:95]
    v_mfma_f32_16x16x16_bf16 v[96:99], v[56:57], v[208:209], v[96:99]
    v_mfma_f32_16x16x16_bf16 v[100:103], v[58:59], v[208:209], v[100:103]
    v_mfma_f32_16x16x16_bf16 v[104:107], v[60:61], v[208:209], v[104:107]
    v_mfma_f32_16x16x16_bf16 v[108:111], v[62:63], v[208:209], v[108:111]
    s_waitcnt vmcnt(10)
    s_add_u32 m0, s54, 5120
    s_nop 0
    buffer_load_dwordx4 v7, s[24:27], s55 offen nt lds
    s_waitcnt vmcnt(10)
    s_add_u32 s55, s58, 28
    s_and_b32 s55, s55, 63
    s_mul_i32 s55, s55, 6144
    s_add_u32 m0, s54, 6144
    s_nop 0
    buffer_load_dwordx4 v2, s[24:27], s55 offen nt lds
    s_waitcnt vmcnt(10)
    s_add_u32 m0, s54, 7168
    s_nop 0
    buffer_load_dwordx4 v3, s[24:27], s55 offen nt lds
    s_waitcnt vmcnt(10)
    s_add_u32 m0, s54, 8192
    s_nop 0
    buffer_load_dwordx4 v4, s[24:27], s55 offen nt lds
    s_waitcnt vmcnt(10)
    s_add_u32 m0, s54, 9216
    s_nop 0
    buffer_load_dwordx4 v5, s[24:27], s55 offen nt lds
    s_waitcnt vmcnt(10)
    s_add_u32 m0, s54, 10240
    s_nop 0
    buffer_load_dwordx4 v6, s[24:27], s55 offen nt lds
    ds_read_b64_tr_b16 v[40:41], v21 offset:30720
    ds_read_b64_tr_b16 v[42:43], v22 offset:30720
    ds_read_b64_tr_b16 v[44:45], v23 offset:30720
    ds_read_b64_tr_b16 v[46:47], v24 offset:30720
    ds_read_b64_tr_b16 v[48:49], v21 offset:30848
    ds_read_b64_tr_b16 v[50:51], v22 offset:30848
    ds_read_b64_tr_b16 v[52:53], v23 offset:30848
    ds_read_b64_tr_b16 v[54:55], v24 offset:30848
    ds_read_b64_tr_b16 v[56:57], v21 offset:30976
    ds_read_b64_tr_b16 v[58:59], v22 offset:30976
    ds_read_b64_tr_b16 v[60:61], v23 offset:30976
    ds_read_b64_tr_b16 v[62:63], v24 offset:30976
    s_waitcnt lgkmcnt(0)
    v_mfma_f32_16x16x16_bf16 v[64:67], v[40:41], v[210:211], v[64:67]
    v_mfma_f32_16x16x16_bf16 v[68:71], v[42:43], v[210:211], v[68:71]
    v_mfma_f32_16x16x16_bf16 v[72:75], v[44:45], v[210:211], v[72:75]
    v_mfma_f32_16x16x16_bf16 v[76:79], v[46:47], v[210:211], v[76:79]
    v_mfma_f32_16x16x16_bf16 v[80:83], v[48:49], v[210:211], v[80:83]
    v_mfma_f32_16x16x16_bf16 v[84:87], v[50:51], v[210:211], v[84:87]
    v_mfma_f32_16x16x16_bf16 v[88:91], v[52:53], v[210:211], v[88:91]
    v_mfma_f32_16x16x16_bf16 v[92:95], v[54:55], v[210:211], v[92:95]
    v_mfma_f32_16x16x16_bf16 v[96:99], v[56:57], v[210:211], v[96:99]
    v_mfma_f32_16x16x16_bf16 v[100:103], v[58:59], v[210:211], v[100:103]
    v_mfma_f32_16x16x16_bf16 v[104:107], v[60:61], v[210:211], v[104:107]
    v_mfma_f32_16x16x16_bf16 v[108:111], v[62:63], v[210:211], v[108:111]
    s_waitcnt vmcnt(10)
    s_add_u32 m0, s54, 11264
    s_nop 0
    buffer_load_dwordx4 v7, s[24:27], s55 offen nt lds
    s_waitcnt vmcnt(10)
    s_add_u32 s55, s58, 32
    s_and_b32 s55, s55, 63
    s_mul_i32 s55, s55, 6144
    s_add_u32 m0, s54, 12288
    s_nop 0
    buffer_load_dwordx4 v2, s[24:27], s55 offen nt lds
    s_waitcnt vmcnt(10)
    s_add_u32 m0, s54, 13312
    s_nop 0
    buffer_load_dwordx4 v3, s[24:27], s55 offen nt lds
    s_waitcnt vmcnt(10)
    s_add_u32 m0, s54, 14336
    s_nop 0
    buffer_load_dwordx4 v4, s[24:27], s55 offen nt lds
    s_waitcnt vmcnt(10)
    s_add_u32 m0, s54, 15360
    s_nop 0
    buffer_load_dwordx4 v5, s[24:27], s55 offen nt lds
    s_waitcnt vmcnt(10)
    s_add_u32 m0, s54, 16384
    s_nop 0
    buffer_load_dwordx4 v6, s[24:27], s55 offen nt lds
    ds_read_b64_tr_b16 v[40:41], v21 offset:0
    ds_read_b64_tr_b16 v[42:43], v22 offset:0
    ds_read_b64_tr_b16 v[44:45], v23 offset:0
    ds_read_b64_tr_b16 v[46:47], v24 offset:0
    ds_read_b64_tr_b16 v[48:49], v21 offset:128
    ds_read_b64_tr_b16 v[50:51], v22 offset:128
    ds_read_b64_tr_b16 v[52:53], v23 offset:128
    ds_read_b64_tr_b16 v[54:55], v24 offset:128
    ds_read_b64_tr_b16 v[56:57], v21 offset:256
    ds_read_b64_tr_b16 v[58:59], v22 offset:256
    ds_read_b64_tr_b16 v[60:61], v23 offset:256
    ds_read_b64_tr_b16 v[62:63], v24 offset:256
    s_waitcnt lgkmcnt(0)
    v_mfma_f32_16x16x16_bf16 v[64:67], v[40:41], v[212:213], v[64:67]
    v_mfma_f32_16x16x16_bf16 v[68:71], v[42:43], v[212:213], v[68:71]
    v_mfma_f32_16x16x16_bf16 v[72:75], v[44:45], v[212:213], v[72:75]
    v_mfma_f32_16x16x16_bf16 v[76:79], v[46:47], v[212:213], v[76:79]
    v_mfma_f32_16x16x16_bf16 v[80:83], v[48:49], v[212:213], v[80:83]
    v_mfma_f32_16x16x16_bf16 v[84:87], v[50:51], v[212:213], v[84:87]
    v_mfma_f32_16x16x16_bf16 v[88:91], v[52:53], v[212:213], v[88:91]
    v_mfma_f32_16x16x16_bf16 v[92:95], v[54:55], v[212:213], v[92:95]
    v_mfma_f32_16x16x16_bf16 v[96:99], v[56:57], v[212:213], v[96:99]
    v_mfma_f32_16x16x16_bf16 v[100:103], v[58:59], v[212:213], v[100:103]
    v_mfma_f32_16x16x16_bf16 v[104:107], v[60:61], v[212:213], v[104:107]
    v_mfma_f32_16x16x16_bf16 v[108:111], v[62:63], v[212:213], v[108:111]
    s_waitcnt vmcnt(10)
    s_add_u32 m0, s54, 17408
    s_nop 0
    buffer_load_dwordx4 v7, s[24:27], s55 offen nt lds
    s_waitcnt vmcnt(10)
    s_branch L_page_7
    .p2align 12
L_page_7:
    s_add_u32 s55, s58, 36
    s_and_b32 s55, s55, 63
    s_mul_i32 s55, s55, 6144
    s_add_u32 m0, s54, 18432
    s_nop 0
    buffer_load_dwordx4 v2, s[24:27], s55 offen nt lds
    s_waitcnt vmcnt(10)
    s_add_u32 m0, s54, 19456
    s_nop 0
    buffer_load_dwordx4 v3, s[24:27], s55 offen nt lds
    s_waitcnt vmcnt(10)
    s_add_u32 m0, s54, 20480
    s_nop 0
    buffer_load_dwordx4 v4, s[24:27], s55 offen nt lds
    s_waitcnt vmcnt(10)
    s_add_u32 m0, s54, 21504
    s_nop 0
    buffer_load_dwordx4 v5, s[24:27], s55 offen nt lds
    s_waitcnt vmcnt(10)
    s_add_u32 m0, s54, 22528
    s_nop 0
    buffer_load_dwordx4 v6, s[24:27], s55 offen nt lds
    ds_read_b64_tr_b16 v[40:41], v21 offset:6144
    ds_read_b64_tr_b16 v[42:43], v22 offset:6144
    ds_read_b64_tr_b16 v[44:45], v23 offset:6144
    ds_read_b64_tr_b16 v[46:47], v24 offset:6144
    ds_read_b64_tr_b16 v[48:49], v21 offset:6272
    ds_read_b64_tr_b16 v[50:51], v22 offset:6272
    ds_read_b64_tr_b16 v[52:53], v23 offset:6272
    ds_read_b64_tr_b16 v[54:55], v24 offset:6272
    ds_read_b64_tr_b16 v[56:57], v21 offset:6400
    ds_read_b64_tr_b16 v[58:59], v22 offset:6400
    ds_read_b64_tr_b16 v[60:61], v23 offset:6400
    ds_read_b64_tr_b16 v[62:63], v24 offset:6400
    s_waitcnt lgkmcnt(0)
    v_mfma_f32_16x16x16_bf16 v[64:67], v[40:41], v[214:215], v[64:67]
    v_mfma_f32_16x16x16_bf16 v[68:71], v[42:43], v[214:215], v[68:71]
    v_mfma_f32_16x16x16_bf16 v[72:75], v[44:45], v[214:215], v[72:75]
    v_mfma_f32_16x16x16_bf16 v[76:79], v[46:47], v[214:215], v[76:79]
    v_mfma_f32_16x16x16_bf16 v[80:83], v[48:49], v[214:215], v[80:83]
    v_mfma_f32_16x16x16_bf16 v[84:87], v[50:51], v[214:215], v[84:87]
    v_mfma_f32_16x16x16_bf16 v[88:91], v[52:53], v[214:215], v[88:91]
    v_mfma_f32_16x16x16_bf16 v[92:95], v[54:55], v[214:215], v[92:95]
    v_mfma_f32_16x16x16_bf16 v[96:99], v[56:57], v[214:215], v[96:99]
    v_mfma_f32_16x16x16_bf16 v[100:103], v[58:59], v[214:215], v[100:103]
    v_mfma_f32_16x16x16_bf16 v[104:107], v[60:61], v[214:215], v[104:107]
    v_mfma_f32_16x16x16_bf16 v[108:111], v[62:63], v[214:215], v[108:111]
    s_waitcnt vmcnt(10)
    s_add_u32 m0, s54, 23552
    s_nop 0
    buffer_load_dwordx4 v7, s[24:27], s55 offen nt lds
    s_waitcnt vmcnt(10)
    s_mov_b32 s55, 0
    s_add_u32 m0, s54, 24576
    s_nop 0
    buffer_load_dwordx4 v14, s[32:35], s55 offen  lds
    s_waitcnt vmcnt(10)
    s_add_u32 m0, s54, 25600
    s_nop 0
    buffer_load_dwordx4 v15, s[32:35], s55 offen  lds
    s_waitcnt vmcnt(10)
    s_add_u32 m0, s54, 26624
    s_nop 0
    buffer_load_dwordx4 v16, s[32:35], s55 offen  lds
    s_waitcnt vmcnt(10)
    s_add_u32 m0, s54, 27648
    s_nop 0
    buffer_load_dwordx4 v17, s[32:35], s55 offen  lds
    s_waitcnt vmcnt(10)
    s_add_u32 m0, s54, 28672
    s_nop 0
    buffer_load_dwordx4 v18, s[32:35], s55 offen  lds
    ds_read_b64_tr_b16 v[40:41], v21 offset:12288
    ds_read_b64_tr_b16 v[42:43], v22 offset:12288
    ds_read_b64_tr_b16 v[44:45], v23 offset:12288
    ds_read_b64_tr_b16 v[46:47], v24 offset:12288
    ds_read_b64_tr_b16 v[48:49], v21 offset:12416
    ds_read_b64_tr_b16 v[50:51], v22 offset:12416
    ds_read_b64_tr_b16 v[52:53], v23 offset:12416
    ds_read_b64_tr_b16 v[54:55], v24 offset:12416
    ds_read_b64_tr_b16 v[56:57], v21 offset:12544
    ds_read_b64_tr_b16 v[58:59], v22 offset:12544
    ds_read_b64_tr_b16 v[60:61], v23 offset:12544
    ds_read_b64_tr_b16 v[62:63], v24 offset:12544
    s_waitcnt lgkmcnt(0)
    v_mfma_f32_16x16x16_bf16 v[64:67], v[40:41], v[216:217], v[64:67]
    v_mfma_f32_16x16x16_bf16 v[68:71], v[42:43], v[216:217], v[68:71]
    v_mfma_f32_16x16x16_bf16 v[72:75], v[44:45], v[216:217], v[72:75]
    v_mfma_f32_16x16x16_bf16 v[76:79], v[46:47], v[216:217], v[76:79]
    v_mfma_f32_16x16x16_bf16 v[80:83], v[48:49], v[216:217], v[80:83]
    v_mfma_f32_16x16x16_bf16 v[84:87], v[50:51], v[216:217], v[84:87]
    v_mfma_f32_16x16x16_bf16 v[88:91], v[52:53], v[216:217], v[88:91]
    v_mfma_f32_16x16x16_bf16 v[92:95], v[54:55], v[216:217], v[92:95]
    v_mfma_f32_16x16x16_bf16 v[96:99], v[56:57], v[216:217], v[96:99]
    v_mfma_f32_16x16x16_bf16 v[100:103], v[58:59], v[216:217], v[100:103]
    v_mfma_f32_16x16x16_bf16 v[104:107], v[60:61], v[216:217], v[104:107]
    v_mfma_f32_16x16x16_bf16 v[108:111], v[62:63], v[216:217], v[108:111]
    s_waitcnt vmcnt(10)
    s_mov_b32 s55, 20480
    s_add_u32 m0, s54, 30720
    s_nop 0
    buffer_load_dwordx4 v14, s[32:35], s55 offen  lds
    s_waitcnt vmcnt(10)
    s_add_u32 m0, s54, 31744
    s_nop 0
    buffer_load_dwordx4 v15, s[32:35], s55 offen  lds
    s_waitcnt vmcnt(10)
    s_add_u32 m0, s54, 32768
    s_nop 0
    buffer_load_dwordx4 v16, s[32:35], s55 offen  lds
    s_waitcnt vmcnt(10)
    s_add_u32 m0, s54, 33792
    s_nop 0
    buffer_load_dwordx4 v17, s[32:35], s55 offen  lds
    s_waitcnt vmcnt(10)
    s_add_u32 m0, s54, 34816
    s_nop 0
    buffer_load_dwordx4 v18, s[32:35], s55 offen  lds
    s_waitcnt vmcnt(10)
    s_mov_b32 s55, 40960
    s_add_u32 m0, s54, 0
    s_nop 0
    buffer_load_dwordx4 v14, s[32:35], s55 offen  lds
    ds_read_b64_tr_b16 v[40:41], v21 offset:18432
    ds_read_b64_tr_b16 v[42:43], v22 offset:18432
    ds_read_b64_tr_b16 v[44:45], v23 offset:18432
    ds_read_b64_tr_b16 v[46:47], v24 offset:18432
    ds_read_b64_tr_b16 v[48:49], v21 offset:18560
    ds_read_b64_tr_b16 v[50:51], v22 offset:18560
    ds_read_b64_tr_b16 v[52:53], v23 offset:18560
    ds_read_b64_tr_b16 v[54:55], v24 offset:18560
    ds_read_b64_tr_b16 v[56:57], v21 offset:18688
    ds_read_b64_tr_b16 v[58:59], v22 offset:18688
    ds_read_b64_tr_b16 v[60:61], v23 offset:18688
    ds_read_b64_tr_b16 v[62:63], v24 offset:18688
    s_waitcnt lgkmcnt(0)
    v_mfma_f32_16x16x16_bf16 v[64:67], v[40:41], v[218:219], v[64:67]
    v_mfma_f32_16x16x16_bf16 v[68:71], v[42:43], v[218:219], v[68:71]
    v_mfma_f32_16x16x16_bf16 v[72:75], v[44:45], v[218:219], v[72:75]
    v_mfma_f32_16x16x16_bf16 v[76:79], v[46:47], v[218:219], v[76:79]
    v_mfma_f32_16x16x16_bf16 v[80:83], v[48:49], v[218:219], v[80:83]
    v_mfma_f32_16x16x16_bf16 v[84:87], v[50:51], v[218:219], v[84:87]
    v_mfma_f32_16x16x16_bf16 v[88:91], v[52:53], v[218:219], v[88:91]
    v_mfma_f32_16x16x16_bf16 v[92:95], v[54:55], v[218:219], v[92:95]
    v_mfma_f32_16x16x16_bf16 v[96:99], v[56:57], v[218:219], v[96:99]
    v_mfma_f32_16x16x16_bf16 v[100:103], v[58:59], v[218:219], v[100:103]
    v_mfma_f32_16x16x16_bf16 v[104:107], v[60:61], v[218:219], v[104:107]
    v_mfma_f32_16x16x16_bf16 v[108:111], v[62:63], v[218:219], v[108:111]
    s_waitcnt vmcnt(10)
    s_add_u32 m0, s54, 1024
    s_nop 0
    buffer_load_dwordx4 v15, s[32:35], s55 offen  lds
    s_waitcnt vmcnt(10)
    s_add_u32 m0, s54, 2048
    s_nop 0
    buffer_load_dwordx4 v16, s[32:35], s55 offen  lds
    s_waitcnt vmcnt(10)
    s_add_u32 m0, s54, 3072
    s_nop 0
    buffer_load_dwordx4 v17, s[32:35], s55 offen  lds
    s_waitcnt vmcnt(10)
    s_add_u32 m0, s54, 4096
    s_nop 0
    buffer_load_dwordx4 v18, s[32:35], s55 offen  lds
    s_waitcnt vmcnt(10)
    s_mov_b32 s55, 61440
    s_add_u32 m0, s54, 6144
    s_nop 0
    buffer_load_dwordx4 v14, s[32:35], s55 offen  lds
    ds_read_b64_tr_b16 a[0:1], v25 offset:24576
    ds_read_b64_tr_b16 a[4:5], v25 offset:24608
    ds_read_b64_tr_b16 a[8:9], v25 offset:24640
    ds_read_b64_tr_b16 a[12:13], v25 offset:24672
    ds_read_b64_tr_b16 a[16:17], v25 offset:24704
    ds_read_b64_tr_b16 a[20:21], v25 offset:24736
    ds_read_b64_tr_b16 a[24:25], v25 offset:24768
    ds_read_b64_tr_b16 a[28:29], v25 offset:24800
    ds_read_b64_tr_b16 a[32:33], v25 offset:24832
    ds_read_b64_tr_b16 a[36:37], v25 offset:24864
    s_waitcnt lgkmcnt(0)
    s_waitcnt vmcnt(10)
    s_add_u32 m0, s54, 7168
    s_nop 0
    buffer_load_dwordx4 v15, s[32:35], s55 offen  lds
    s_waitcnt vmcnt(10)
    s_add_u32 m0, s54, 8192
    s_nop 0
    buffer_load_dwordx4 v16, s[32:35], s55 offen  lds
    s_waitcnt vmcnt(10)
    s_add_u32 m0, s54, 9216
    s_nop 0
    buffer_load_dwordx4 v17, s[32:35], s55 offen  lds
    s_waitcnt vmcnt(10)
    s_add_u32 m0, s54, 10240
    s_nop 0
    buffer_load_dwordx4 v18, s[32:35], s55 offen  lds
    s_waitcnt vmcnt(10)
    s_mov_b32 s55, 81920
    s_add_u32 m0, s54, 12288
    s_nop 0
    buffer_load_dwordx4 v14, s[32:35], s55 offen  lds
    ds_read_b64_tr_b16 a[2:3], v25 offset:30720
    ds_read_b64_tr_b16 a[6:7], v25 offset:30752
    ds_read_b64_tr_b16 a[10:11], v25 offset:30784
    ds_read_b64_tr_b16 a[14:15], v25 offset:30816
    ds_read_b64_tr_b16 a[18:19], v25 offset:30848
    ds_read_b64_tr_b16 a[22:23], v25 offset:30880
    ds_read_b64_tr_b16 a[26:27], v25 offset:30912
    ds_read_b64_tr_b16 a[30:31], v25 offset:30944
    ds_read_b64_tr_b16 a[34:35], v25 offset:30976
    ds_read_b64_tr_b16 a[38:39], v25 offset:31008
    s_waitcnt lgkmcnt(0)
    s_waitcnt vmcnt(10)
    s_add_u32 m0, s54, 13312
    s_nop 0
    buffer_load_dwordx4 v15, s[32:35], s55 offen  lds
    s_waitcnt vmcnt(10)
    s_add_u32 m0, s54, 14336
    s_nop 0
    buffer_load_dwordx4 v16, s[32:35], s55 offen  lds
    s_waitcnt vmcnt(10)
    s_add_u32 m0, s54, 15360
    s_nop 0
    buffer_load_dwordx4 v17, s[32:35], s55 offen  lds
    s_waitcnt vmcnt(10)
    s_add_u32 m0, s54, 16384
    s_nop 0
    buffer_load_dwordx4 v18, s[32:35], s55 offen  lds
    s_waitcnt vmcnt(10)
    s_mov_b32 s55, 102400
    s_add_u32 m0, s54, 18432
    s_nop 0
    buffer_load_dwordx4 v14, s[32:35], s55 offen  lds
    ds_read_b64_tr_b16 a[40:41], v25 offset:0
    ds_read_b64_tr_b16 a[44:45], v25 offset:32
    ds_read_b64_tr_b16 a[48:49], v25 offset:64
    ds_read_b64_tr_b16 a[52:53], v25 offset:96
    ds_read_b64_tr_b16 a[56:57], v25 offset:128
    ds_read_b64_tr_b16 a[60:61], v25 offset:160
    ds_read_b64_tr_b16 a[64:65], v25 offset:192
    ds_read_b64_tr_b16 a[68:69], v25 offset:224
    ds_read_b64_tr_b16 a[72:73], v25 offset:256
    ds_read_b64_tr_b16 a[76:77], v25 offset:288
    s_waitcnt lgkmcnt(0)
    s_waitcnt vmcnt(10)
    s_add_u32 m0, s54, 19456
    s_nop 0
    buffer_load_dwordx4 v15, s[32:35], s55 offen  lds
    s_waitcnt vmcnt(10)
    s_add_u32 m0, s54, 20480
    s_nop 0
    buffer_load_dwordx4 v16, s[32:35], s55 offen  lds
    s_waitcnt vmcnt(10)
    s_add_u32 m0, s54, 21504
    s_nop 0
    buffer_load_dwordx4 v17, s[32:35], s55 offen  lds
    s_waitcnt vmcnt(10)
    s_add_u32 m0, s54, 22528
    s_nop 0
    buffer_load_dwordx4 v18, s[32:35], s55 offen  lds
    s_waitcnt vmcnt(10)
    s_mov_b32 s55, 122880
    s_add_u32 m0, s54, 24576
    s_nop 0
    buffer_load_dwordx4 v14, s[32:35], s55 offen  lds
    ds_read_b64_tr_b16 a[42:43], v25 offset:6144
    ds_read_b64_tr_b16 a[46:47], v25 offset:6176
    ds_read_b64_tr_b16 a[50:51], v25 offset:6208
    ds_read_b64_tr_b16 a[54:55], v25 offset:6240
    ds_read_b64_tr_b16 a[58:59], v25 offset:6272
    ds_read_b64_tr_b16 a[62:63], v25 offset:6304
    ds_read_b64_tr_b16 a[66:67], v25 offset:6336
    ds_read_b64_tr_b16 a[70:71], v25 offset:6368
    ds_read_b64_tr_b16 a[74:75], v25 offset:6400
    ds_read_b64_tr_b16 a[78:79], v25 offset:6432
    s_waitcnt lgkmcnt(0)
    s_waitcnt vmcnt(10)
    s_add_u32 m0, s54, 25600
    s_nop 0
    buffer_load_dwordx4 v15, s[32:35], s55 offen  lds
    s_waitcnt vmcnt(10)
    s_add_u32 m0, s54, 26624
    s_nop 0
    buffer_load_dwordx4 v16, s[32:35], s55 offen  lds
    s_waitcnt vmcnt(10)
    s_add_u32 m0, s54, 27648
    s_nop 0
    buffer_load_dwordx4 v17, s[32:35], s55 offen  lds
    s_waitcnt vmcnt(10)
    s_add_u32 m0, s54, 28672
    s_nop 0
    buffer_load_dwordx4 v18, s[32:35], s55 offen  lds
    s_waitcnt vmcnt(10)
    s_mov_b32 s55, 143360
    s_add_u32 m0, s54, 30720
    s_nop 0
    buffer_load_dwordx4 v14, s[32:35], s55 offen  lds
    ds_read_b64_tr_b16 a[80:81], v25 offset:12288
    ds_read_b64_tr_b16 a[84:85], v25 offset:12320
    ds_read_b64_tr_b16 a[88:89], v25 offset:12352
    ds_read_b64_tr_b16 a[92:93], v25 offset:12384
    ds_read_b64_tr_b16 a[96:97], v25 offset:12416
    ds_read_b64_tr_b16 a[100:101], v25 offset:12448
    ds_read_b64_tr_b16 a[104:105], v25 offset:12480
    ds_read_b64_tr_b16 a[108:109], v25 offset:12512
    ds_read_b64_tr_b16 a[112:113], v25 offset:12544
    ds_read_b64_tr_b16 a[116:117], v25 offset:12576
    s_waitcnt lgkmcnt(0)
    s_waitcnt vmcnt(10)
    s_add_u32 m0, s54, 31744
    s_nop 0
    buffer_load_dwordx4 v15, s[32:35], s55 offen  lds
    s_waitcnt vmcnt(10)
    s_add_u32 m0, s54, 32768
    s_nop 0
    buffer_load_dwordx4 v16, s[32:35], s55 offen  lds
    s_waitcnt vmcnt(10)
    s_add_u32 m0, s54, 33792
    s_nop 0
    buffer_load_dwordx4 v17, s[32:35], s55 offen  lds
    s_waitcnt vmcnt(10)
    s_add_u32 m0, s54, 34816
    s_nop 0
    buffer_load_dwordx4 v18, s[32:35], s55 offen  lds
    s_waitcnt vmcnt(10)
    s_mov_b32 s55, 163840
    s_add_u32 m0, s54, 0
    s_nop 0
    buffer_load_dwordx4 v14, s[32:35], s55 offen  lds
    ds_read_b64_tr_b16 a[82:83], v25 offset:18432
    ds_read_b64_tr_b16 a[86:87], v25 offset:18464
    ds_read_b64_tr_b16 a[90:91], v25 offset:18496
    ds_read_b64_tr_b16 a[94:95], v25 offset:18528
    ds_read_b64_tr_b16 a[98:99], v25 offset:18560
    ds_read_b64_tr_b16 a[102:103], v25 offset:18592
    ds_read_b64_tr_b16 a[106:107], v25 offset:18624
    ds_read_b64_tr_b16 a[110:111], v25 offset:18656
    ds_read_b64_tr_b16 a[114:115], v25 offset:18688
    ds_read_b64_tr_b16 a[118:119], v25 offset:18720
    s_waitcnt lgkmcnt(0)
    s_waitcnt vmcnt(10)
    s_add_u32 m0, s54, 1024
    s_nop 0
    buffer_load_dwordx4 v15, s[32:35], s55 offen  lds
    s_waitcnt vmcnt(10)
    s_add_u32 m0, s54, 2048
    s_nop 0
    buffer_load_dwordx4 v16, s[32:35], s55 offen  lds
    s_waitcnt vmcnt(10)
    s_add_u32 m0, s54, 3072
    s_nop 0
    buffer_load_dwordx4 v17, s[32:35], s55 offen  lds
    s_waitcnt vmcnt(10)
    s_add_u32 m0, s54, 4096
    s_nop 0
    buffer_load_dwordx4 v18, s[32:35], s55 offen  lds
    s_waitcnt vmcnt(10)
    s_mov_b32 s55, 184320
    s_add_u32 m0, s54, 6144
    s_nop 0
    buffer_load_dwordx4 v14, s[32:35], s55 offen  lds
    ds_read_b64_tr_b16 a[120:121], v25 offset:24576
    ds_read_b64_tr_b16 a[124:125], v25 offset:24608
    ds_read_b64_tr_b16 a[128:129], v25 offset:24640
    ds_read_b64_tr_b16 a[132:133], v25 offset:24672
    ds_read_b64_tr_b16 a[136:137], v25 offset:24704
    ds_read_b64_tr_b16 a[140:141], v25 offset:24736
    ds_read_b64_tr_b16 a[144:145], v25 offset:24768
    ds_read_b64_tr_b16 a[148:149], v25 offset:24800
    ds_read_b64_tr_b16 a[152:153], v25 offset:24832
    ds_read_b64_tr_b16 a[156:157], v25 offset:24864
    s_waitcnt lgkmcnt(0)
    s_waitcnt vmcnt(10)
    s_add_u32 m0, s54, 7168
    s_nop 0
    buffer_load_dwordx4 v15, s[32:35], s55 offen  lds
    s_waitcnt vmcnt(10)
    s_add_u32 m0, s54, 8192
    s_nop 0
    buffer_load_dwordx4 v16, s[32:35], s55 offen  lds
    s_waitcnt vmcnt(10)
    s_add_u32 m0, s54, 9216
    s_nop 0
    buffer_load_dwordx4 v17, s[32:35], s55 offen  lds
    s_waitcnt vmcnt(10)
    s_add_u32 m0, s54, 10240
    s_nop 0
    buffer_load_dwordx4 v18, s[32:35], s55 offen  lds
    s_waitcnt vmcnt(10)
    s_mov_b32 s55, 204800
    s_add_u32 m0, s54, 12288
    s_nop 0
    buffer_load_dwordx4 v14, s[32:35], s55 offen  lds
    ds_read_b64_tr_b16 a[122:123], v25 offset:30720
    ds_read_b64_tr_b16 a[126:127], v25 offset:30752
    ds_read_b64_tr_b16 a[130:131], v25 offset:30784
    ds_read_b64_tr_b16 a[134:135], v25 offset:30816
    ds_read_b64_tr_b16 a[138:139], v25 offset:30848
    ds_read_b64_tr_b16 a[142:143], v25 offset:30880
    ds_read_b64_tr_b16 a[146:147], v25 offset:30912
    ds_read_b64_tr_b16 a[150:151], v25 offset:30944
    ds_read_b64_tr_b16 a[154:155], v25 offset:30976
    ds_read_b64_tr_b16 a[158:159], v25 offset:31008
    s_waitcnt lgkmcnt(0)
    s_waitcnt vmcnt(10)
    s_add_u32 m0, s54, 13312
    s_nop 0
    buffer_load_dwordx4 v15, s[32:35], s55 offen  lds
    s_waitcnt vmcnt(10)
    s_add_u32 m0, s54, 14336
    s_nop 0
    buffer_load_dwordx4 v16, s[32:35], s55 offen  lds
    s_waitcnt vmcnt(10)
    s_add_u32 m0, s54, 15360
    s_nop 0
    buffer_load_dwordx4 v17, s[32:35], s55 offen  lds
    s_waitcnt vmcnt(10)
    s_add_u32 m0, s54, 16384
    s_nop 0
    buffer_load_dwordx4 v18, s[32:35], s55 offen  lds
    s_waitcnt vmcnt(10)
    s_mov_b32 s55, 225280
    s_add_u32 m0, s54, 18432
    s_nop 0
    buffer_load_dwordx4 v14, s[32:35], s55 offen  lds
    ds_read_b64_tr_b16 a[160:161], v25 offset:0
    ds_read_b64_tr_b16 a[164:165], v25 offset:32
    ds_read_b64_tr_b16 a[168:169], v25 offset:64
    ds_read_b64_tr_b16 a[172:173], v25 offset:96
    ds_read_b64_tr_b16 a[176:177], v25 offset:128
    ds_read_b64_tr_b16 a[180:181], v25 offset:160
    ds_read_b64_tr_b16 a[184:185], v25 offset:192
    ds_read_b64_tr_b16 a[188:189], v25 offset:224
    ds_read_b64_tr_b16 a[192:193], v25 offset:256
    ds_read_b64_tr_b16 a[196:197], v25 offset:288
    s_waitcnt lgkmcnt(0)
    s_waitcnt vmcnt(10)
    s_add_u32 m0, s54, 19456
    s_nop 0
    buffer_load_dwordx4 v15, s[32:35], s55 offen  lds
    s_waitcnt vmcnt(10)
    s_add_u32 m0, s54, 20480
    s_nop 0
    buffer_load_dwordx4 v16, s[32:35], s55 offen  lds
    s_waitcnt vmcnt(10)
    s_add_u32 m0, s54, 21504
    s_nop 0
    buffer_load_dwordx4 v17, s[32:35], s55 offen  lds
    s_waitcnt vmcnt(10)
    s_add_u32 m0, s54, 22528
    s_nop 0
    buffer_load_dwordx4 v18, s[32:35], s55 offen  lds
    s_waitcnt vmcnt(10)
    s_add_u32 s55, s58, 40
    s_and_b32 s55, s55, 63
    s_mul_i32 s55, s55, 6144
    s_add_u32 m0, s54, 24576
    s_nop 0
    buffer_load_dwordx4 v236, s[24:27], s55 offen nt lds
    ds_read_b64_tr_b16 a[162:163], v25 offset:6144
    ds_read_b64_tr_b16 a[166:167], v25 offset:6176
    ds_read_b64_tr_b16 a[170:171], v25 offset:6208
    ds_read_b64_tr_b16 a[174:175], v25 offset:6240
    ds_read_b64_tr_b16 a[178:179], v25 offset:6272
    ds_read_b64_tr_b16 a[182:183], v25 offset:6304
    ds_read_b64_tr_b16 a[186:187], v25 offset:6336
    ds_read_b64_tr_b16 a[190:191], v25 offset:6368
    ds_read_b64_tr_b16 a[194:195], v25 offset:6400
    ds_read_b64_tr_b16 a[198:199], v25 offset:6432
    s_waitcnt lgkmcnt(0)
    s_waitcnt vmcnt(10)
    s_add_u32 m0, s54, 25600
    s_nop 0
    buffer_load_dwordx4 v237, s[24:27], s55 offen nt lds
    s_waitcnt vmcnt(10)
    s_add_u32 s55, s58, 44
    s_and_b32 s55, s55, 63
    s_mul_i32 s55, s55, 6144
    s_add_u32 m0, s54, 26624
    s_nop 0
    buffer_load_dwordx4 v236, s[24:27], s55 offen nt lds
    s_waitcnt vmcnt(10)
    s_add_u32 m0, s54, 27648
    s_nop 0
    buffer_load_dwordx4 v237, s[24:27], s55 offen nt lds
    s_waitcnt vmcnt(10)
    s_add_u32 s55, s58, 48
    s_and_b32 s55, s55, 63
    s_mul_i32 s55, s55, 6144
    s_add_u32 m0, s54, 28672
    s_nop 0
    buffer_load_dwordx4 v236, s[24:27], s55 offen nt lds
    s_waitcnt vmcnt(10)
    s_add_u32 m0, s54, 29696
    s_nop 0
    buffer_load_dwordx4 v237, s[24:27], s55 offen nt lds
    ds_read_b64_tr_b16 a[200:201], v25 offset:12288
    ds_read_b64_tr_b16 a[204:205], v25 offset:12320
    ds_read_b64_tr_b16 a[208:209], v25 offset:12352
    ds_read_b64_tr_b16 a[212:213], v25 offset:12384
    ds_read_b64_tr_b16 a[216:217], v25 offset:12416
    ds_read_b64_tr_b16 a[220:221], v25 offset:12448
    ds_read_b64_tr_b16 a[224:225], v25 offset:12480
    ds_read_b64_tr_b16 a[228:229], v25 offset:12512
    ds_read_b64_tr_b16 a[232:233], v25 offset:12544
    ds_read_b64_tr_b16 a[236:237], v25 offset:12576
    s_waitcnt lgkmcnt(0)
    s_waitcnt vmcnt(10)
    s_add_u32 s55, s58, 52
    s_and_b32 s55, s55, 63
    s_mul_i32 s55, s55, 6144
    s_add_u32 m0, s54, 30720
    s_nop 0
    buffer_load_dwordx4 v236, s[24:27], s55 offen nt lds
    s_waitcnt vmcnt(10)
    s_add_u32 m0, s54, 31744
    s_nop 0
    buffer_load_dwordx4 v237, s[24:27], s55 offen nt lds
    s_waitcnt vmcnt(10)
    s_add_u32 s55, s58, 56
    s_and_b32 s55, s55, 63
    s_mul_i32 s55, s55, 6144
    s_add_u32 m0, s54, 32768
    s_nop 0
    buffer_load_dwordx4 v236, s[24:27], s55 offen nt lds
    s_waitcnt vmcnt(10)
    s_add_u32 m0, s54, 33792
    s_nop 0
    buffer_load_dwordx4 v237, s[24:27], s55 offen nt lds
    s_waitcnt vmcnt(10)
    s_add_u32 s55, s58, 60
    s_and_b32 s55, s55, 63
    s_mul_i32 s55, s55, 6144
    s_add_u32 m0, s54, 34816
    s_nop 0
    buffer_load_dwordx4 v236, s[24:27], s55 offen nt lds
    ds_read_b64_tr_b16 a[202:203], v25 offset:18432
    ds_read_b64_tr_b16 a[206:207], v25 offset:18464
    ds_read_b64_tr_b16 a[210:211], v25 offset:18496
    ds_read_b64_tr_b16 a[214:215], v25 offset:18528
    ds_read_b64_tr_b16 a[218:219], v25 offset:18560
    ds_read_b64_tr_b16 a[222:223], v25 offset:18592
    ds_read_b64_tr_b16 a[226:227], v25 offset:18624
    ds_read_b64_tr_b16 a[230:231], v25 offset:18656
    ds_read_b64_tr_b16 a[234:235], v25 offset:18688
    ds_read_b64_tr_b16 a[238:239], v25 offset:18720
    s_waitcnt lgkmcnt(0)
    s_waitcnt vmcnt(10)
    s_add_u32 m0, s54, 35840
    s_nop 0
    buffer_load_dwordx4 v237, s[24:27], s55 offen nt lds
    s_waitcnt vmcnt(10)
    s_add_u32 s55, s58, 40
    s_and_b32 s55, s55, 63
    s_mul_i32 s55, s55, 6144
    s_add_u32 s55, s55, 128
    s_add_u32 m0, s54, 0
    s_nop 0
    buffer_load_dwordx4 v236, s[24:27], s55 offen nt lds
    s_waitcnt vmcnt(10)
    s_add_u32 m0, s54, 1024
    s_nop 0
    buffer_load_dwordx4 v237, s[24:27], s55 offen nt lds
    s_waitcnt vmcnt(10)
    s_add_u32 s55, s58, 44
    s_and_b32 s55, s55, 63
    s_mul_i32 s55, s55, 6144
    s_add_u32 s55, s55, 128
    s_add_u32 m0, s54, 2048
    s_nop 0
    buffer_load_dwordx4 v236, s[24:27], s55 offen nt lds
    s_waitcnt vmcnt(10)
    s_add_u32 m0, s54, 3072
    s_nop 0
    buffer_load_dwordx4 v237, s[24:27], s55 offen nt lds
    s_waitcnt vmcnt(10)
    s_add_u32 s55, s58, 48
    s_and_b32 s55, s55, 63
    s_mul_i32 s55, s55, 6144
    s_add_u32 s55, s55, 128
    s_add_u32 m0, s54, 4096
    s_nop 0
    buffer_load_dwordx4 v236, s[24:27], s55 offen nt lds
    ds_read_b64_tr_b16 v[40:41], v238 offset:24576
    ds_read_b64_tr_b16 v[42:43], v238 offset:26624
    ds_read_b64_tr_b16 v[44:45], v239 offset:24576
    ds_read_b64_tr_b16 v[46:47], v239 offset:26624
    ds_read_b64_tr_b16 v[48:49], v240 offset:24576
    ds_read_b64_tr_b16 v[50:51], v240 offset:26624
    ds_read_b64_tr_b16 v[52:53], v241 offset:24576
    ds_read_b64_tr_b16 v[54:55], v241 offset:26624
    ds_read_b64_tr_b16 v[56:57], v238 offset:28672
    ds_read_b64_tr_b16 v[58:59], v239 offset:28672
    ds_read_b64_tr_b16 v[60:61], v240 offset:28672
    ds_read_b64_tr_b16 v[62:63], v241 offset:28672
    s_waitcnt lgkmcnt(0)
    s_waitcnt vmcnt(10)
    s_add_u32 m0, s54, 5120
    s_nop 0
    buffer_load_dwordx4 v237, s[24:27], s55 offen nt lds
    s_waitcnt vmcnt(10)
    s_add_u32 s55, s58, 52
    s_and_b32 s55, s55, 63
    s_mul_i32 s55, s55, 6144
    s_add_u32 s55, s55, 128
    s_add_u32 m0, s54, 6144
    s_nop 0
    buffer_load_dwordx4 v236, s[24:27], s55 offen nt lds
    v_mfma_f32_16x16x32_bf16 v[64:67], v[40:43], v[220:223], v[64:67]
    v_mfma_f32_16x16x32_bf16 v[68:71], v[44:47], v[220:223], v[68:71]
    v_mfma_f32_16x16x32_bf16 v[72:75], v[48:51], v[220:223], v[72:75]
    v_mfma_f32_16x16x32_bf16 v[76:79], v[52:55], v[220:223], v[76:79]
    s_nop 2
    v_mfma_f32_16x16x16_bf16 v[64:67], v[56:57], v[224:225], v[64:67]
    v_mfma_f32_16x16x16_bf16 v[68:71], v[58:59], v[224:225], v[68:71]
    v_mfma_f32_16x16x16_bf16 v[72:75], v[60:61], v[224:225], v[72:75]
    v_mfma_f32_16x16x16_bf16 v[76:79], v[62:63], v[224:225], v[76:79]
L_merge:
    s_waitcnt vmcnt(10)
    s_add_u32 m0, s54, 7168
    s_nop 0
    buffer_load_dwordx4 v237, s[24:27], s55 offen nt lds
    s_waitcnt vmcnt(10)
    s_add_u32 s55, s58, 56
    s_and_b32 s55, s55, 63
    s_mul_i32 s55, s55, 6144
    s_add_u32 s55, s55, 128
    s_add_u32 m0, s54, 8192
    s_nop 0
    buffer_load_dwordx4 v236, s[24:27], s55 offen nt lds
    s_waitcnt vmcnt(10)
    s_add_u32 m0, s54, 9216
    s_nop 0
    buffer_load_dwordx4 v237, s[24:27], s55 offen nt lds
    s_waitcnt vmcnt(10)
    s_add_u32 s55, s58, 60
    s_and_b32 s55, s55, 63
    s_mul_i32 s55, s55, 6144
    s_add_u32 s55, s55, 128
    s_add_u32 m0, s54, 10240
    s_nop 0
    buffer_load_dwordx4 v236, s[24:27], s55 offen nt lds
    buffer_load_dword v252, off, s[48:51], s78 sc1
    ds_read_b64_tr_b16 v[40:41], v238 offset:30720
    ds_read_b64_tr_b16 v[42:43], v238 offset:32768
    ds_read_b64_tr_b16 v[44:45], v239 offset:30720
    ds_read_b64_tr_b16 v[46:47], v239 offset:32768
    ds_read_b64_tr_b16 v[48:49], v240 offset:30720
    ds_read_b64_tr_b16 v[50:51], v240 offset:32768
    ds_read_b64_tr_b16 v[52:53], v241 offset:30720
    ds_read_b64_tr_b16 v[54:55], v241 offset:32768
    ds_read_b64_tr_b16 v[56:57], v238 offset:34816
    ds_read_b64_tr_b16 v[58:59], v239 offset:34816
    ds_read_b64_tr_b16 v[60:61], v240 offset:34816
    ds_read_b64_tr_b16 v[62:63], v241 offset:34816
    s_waitcnt lgkmcnt(0)
    s_waitcnt vmcnt(11)
    s_add_u32 m0, s54, 11264
    s_nop 0
    buffer_load_dwordx4 v237, s[24:27], s55 offen nt lds
    s_waitcnt vmcnt(11)
    s_add_u32 s55, s58, 40
    s_and_b32 s55, s55, 63
    s_mul_i32 s55, s55, 6144
    s_add_u32 s55, s55, 256
    s_add_u32 m0, s54, 12288
    s_nop 0
    buffer_load_dwordx4 v236, s[24:27], s55 offen nt lds
    v_mfma_f32_16x16x32_bf16 v[64:67], v[40:43], v[226:229], v[64:67]
    v_mfma_f32_16x16x32_bf16 v[68:71], v[44:47], v[226:229], v[68:71]
    v_mfma_f32_16x16x32_bf16 v[72:75], v[48:51], v[226:229], v[72:75]
    v_mfma_f32_16x16x32_bf16 v[76:79], v[52:55], v[226:229], v[76:79]
    s_nop 2
    v_mfma_f32_16x16x16_bf16 v[64:67], v[56:57], v[230:231], v[64:67]
    v_mfma_f32_16x16x16_bf16 v[68:71], v[58:59], v[230:231], v[68:71]
    v_mfma_f32_16x16x16_bf16 v[72:75], v[60:61], v[230:231], v[72:75]
    v_mfma_f32_16x16x16_bf16 v[76:79], v[62:63], v[230:231], v[76:79]
    s_mov_b32 exec_lo, 0x000f000f
    s_mov_b32 exec_hi, 0x000f000f
    s_nop 2
    ds_write_b128 v242, v[64:67] offset:0
    ds_write_b128 v242, v[68:71] offset:1024
    ds_write_b128 v242, v[72:75] offset:2048
    ds_write_b128 v242, v[76:79] offset:3072
    s_mov_b64 exec, -1
    s_add_u32 m0, s54, 13312
    s_nop 0
    buffer_load_dwordx4 v237, s[24:27], s55 offen nt lds
    s_waitcnt lgkmcnt(0)
    s_barrier
    ds_read_b128 v[40:43], v243 offset:0
    ds_read_b128 v[44:47], v243 offset:1024
    ds_read_b128 v[48:51], v243 offset:2048
    ds_read_b128 v[52:55], v243 offset:3072
    s_waitcnt lgkmcnt(3)
    v_add_f32_dpp v40, v40, v40 row_ror:8 row_mask:0xf bank_mask:0xf
    v_add_f32_dpp v41, v41, v41 row_ror:8 row_mask:0xf bank_mask:0xf
    v_add_f32_dpp v42, v42, v42 row_ror:8 row_mask:0xf bank_mask:0xf
    v_add_f32_dpp v43, v43, v43 row_ror:8 row_mask:0xf bank_mask:0xf
    s_waitcnt lgkmcnt(2)
    v_add_f32_dpp v44, v44, v44 row_ror:8 row_mask:0xf bank_mask:0xf
    v_add_f32_dpp v45, v45, v45 row_ror:8 row_mask:0xf bank_mask:0xf
    v_add_f32_dpp v46, v46, v46 row_ror:8 row_mask:0xf bank_mask:0xf
    v_add_f32_dpp v47, v47, v47 row_ror:8 row_mask:0xf bank_mask:0xf
    s_waitcnt lgkmcnt(1)
    v_add_f32_dpp v48, v48, v48 row_ror:8 row_mask:0xf bank_mask:0xf
    v_add_f32_dpp v49, v49, v49 row_ror:8 row_mask:0xf bank_mask:0xf
    v_add_f32_dpp v50, v50, v50 row_ror:8 row_mask:0xf bank_mask:0xf
    v_add_f32_dpp v51, v51, v51 row_ror:8 row_mask:0xf bank_mask:0xf
    s_waitcnt lgkmcnt(0)
    v_add_f32_dpp v52, v52, v52 row_ror:8 row_mask:0xf bank_mask:0xf
    v_add_f32_dpp v53, v53, v53 row_ror:8 row_mask:0xf bank_mask:0xf
    v_add_f32_dpp v54, v54, v54 row_ror:8 row_mask:0xf bank_mask:0xf
    v_add_f32_dpp v55, v55, v55 row_ror:8 row_mask:0xf bank_mask:0xf
    v_add_f32_dpp v40, v40, v40 row_ror:4 row_mask:0xf bank_mask:0xf
    v_add_f32_dpp v41, v41, v41 row_ror:4 row_mask:0xf bank_mask:0xf
    v_add_f32_dpp v42, v42, v42 row_ror:4 row_mask:0xf bank_mask:0xf
    v_add_f32_dpp v43, v43, v43 row_ror:4 row_mask:0xf bank_mask:0xf
    v_add_f32_dpp v44, v44, v44 row_ror:4 row_mask:0xf bank_mask:0xf
    v_add_f32_dpp v45, v45, v45 row_ror:4 row_mask:0xf bank_mask:0xf
    v_add_f32_dpp v46, v46, v46 row_ror:4 row_mask:0xf bank_mask:0xf
    v_add_f32_dpp v47, v47, v47 row_ror:4 row_mask:0xf bank_mask:0xf
    v_add_f32_dpp v48, v48, v48 row_ror:4 row_mask:0xf bank_mask:0xf
    v_add_f32_dpp v49, v49, v49 row_ror:4 row_mask:0xf bank_mask:0xf
    v_add_f32_dpp v50, v50, v50 row_ror:4 row_mask:0xf bank_mask:0xf
    v_add_f32_dpp v51, v51, v51 row_ror:4 row_mask:0xf bank_mask:0xf
    v_add_f32_dpp v52, v52, v52 row_ror:4 row_mask:0xf bank_mask:0xf
    v_add_f32_dpp v53, v53, v53 row_ror:4 row_mask:0xf bank_mask:0xf
    v_add_f32_dpp v54, v54, v54 row_ror:4 row_mask:0xf bank_mask:0xf
    v_add_f32_dpp v55, v55, v55 row_ror:4 row_mask:0xf bank_mask:0xf
    v_cvt_pk_bf16_f32 v112, v40, v41
    v_cvt_pk_bf16_f32 v113, v42, v43
    v_cvt_pk_bf16_f32 v114, v44, v45
    v_cvt_pk_bf16_f32 v115, v46, v47
    v_cvt_pk_bf16_f32 v116, v48, v49
    v_cvt_pk_bf16_f32 v117, v50, v51
    v_cvt_pk_bf16_f32 v118, v52, v53
    v_cvt_pk_bf16_f32 v119, v54, v55
    s_add_u32 s55, s58, 44
    s_and_b32 s55, s55, 63
    s_mul_i32 s55, s55, 6144
    s_add_u32 s55, s55, 256
    s_add_u32 m0, s54, 14336
    s_nop 0
    buffer_load_dwordx4 v236, s[24:27], s55 offen nt lds
    s_nop 0
    v_mfma_f32_16x16x32_bf16 v[136:139], a[0:3], v[112:115], 0
    v_mfma_f32_16x16x32_bf16 v[140:143], a[4:7], v[112:115], 0
    v_mfma_f32_16x16x32_bf16 v[144:147], a[8:11], v[112:115], 0
    v_mfma_f32_16x16x32_bf16 v[148:151], a[12:15], v[112:115], 0
    v_mfma_f32_16x16x32_bf16 v[152:155], a[16:19], v[112:115], 0
    v_mfma_f32_16x16x32_bf16 v[156:159], a[20:23], v[112:115], 0
    v_mfma_f32_16x16x32_bf16 v[160:163], a[24:27], v[112:115], 0
    v_mfma_f32_16x16x32_bf16 v[164:167], a[28:31], v[112:115], 0
    v_mfma_f32_16x16x32_bf16 v[168:171], a[32:35], v[112:115], 0
    v_mfma_f32_16x16x32_bf16 v[172:175], a[36:39], v[112:115], 0
    v_mfma_f32_16x16x32_bf16 v[136:139], a[40:43], v[116:119], v[136:139]
    v_mfma_f32_16x16x32_bf16 v[140:143], a[44:47], v[116:119], v[140:143]
    v_mfma_f32_16x16x32_bf16 v[144:147], a[48:51], v[116:119], v[144:147]
    v_mfma_f32_16x16x32_bf16 v[148:151], a[52:55], v[116:119], v[148:151]
    v_mfma_f32_16x16x32_bf16 v[152:155], a[56:59], v[116:119], v[152:155]
    v_mfma_f32_16x16x32_bf16 v[156:159], a[60:63], v[116:119], v[156:159]
    v_mfma_f32_16x16x32_bf16 v[160:163], a[64:67], v[116:119], v[160:163]
    v_mfma_f32_16x16x32_bf16 v[164:167], a[68:71], v[116:119], v[164:167]
    v_mfma_f32_16x16x32_bf16 v[168:171], a[72:75], v[116:119], v[168:171]
    v_mfma_f32_16x16x32_bf16 v[172:175], a[76:79], v[116:119], v[172:175]
    s_waitcnt vmcnt(11)
    s_add_u32 m0, s54, 15360
    s_nop 0
    buffer_load_dwordx4 v237, s[24:27], s55 offen nt lds
    s_waitcnt vmcnt(11)
    s_add_u32 s55, s58, 48
    s_and_b32 s55, s55, 63
    s_mul_i32 s55, s55, 6144
    s_add_u32 s55, s55, 256
    s_add_u32 m0, s54, 16384
    s_nop 0
    buffer_load_dwordx4 v236, s[24:27], s55 offen nt lds
    ds_read_b64_tr_b16 v[40:41], v238 offset:0
    ds_read_b64_tr_b16 v[42:43], v238 offset:2048
    ds_read_b64_tr_b16 v[44:45], v239 offset:0
    ds_read_b64_tr_b16 v[46:47], v239 offset:2048
    ds_read_b64_tr_b16 v[48:49], v240 offset:0
    ds_read_b64_tr_b16 v[50:51], v240 offset:2048
    ds_read_b64_tr_b16 v[52:53], v241 offset:0
    ds_read_b64_tr_b16 v[54:55], v241 offset:2048
    ds_read_b64_tr_b16 v[56:57], v238 offset:4096
    ds_read_b64_tr_b16 v[58:59], v239 offset:4096
    ds_read_b64_tr_b16 v[60:61], v240 offset:4096
    ds_read_b64_tr_b16 v[62:63], v241 offset:4096
    s_waitcnt lgkmcnt(0)
    s_waitcnt vmcnt(11)
    s_add_u32 m0, s54, 17408
    s_nop 0
    buffer_load_dwordx4 v237, s[24:27], s55 offen nt lds
    s_waitcnt vmcnt(11)
    s_add_u32 s55, s58, 52
    s_and_b32 s55, s55, 63
    s_mul_i32 s55, s55, 6144
    s_add_u32 s55, s55, 256
    s_add_u32 m0, s54, 18432
    s_nop 0
    buffer_load_dwordx4 v236, s[24:27], s55 offen nt lds
    v_mfma_f32_16x16x32_bf16 v[80:83], v[40:43], v[220:223], v[80:83]
    v_mfma_f32_16x16x32_bf16 v[84:87], v[44:47], v[220:223], v[84:87]
    v_mfma_f32_16x16x32_bf16 v[88:91], v[48:51], v[220:223], v[88:91]
    v_mfma_f32_16x16x32_bf16 v[92:95], v[52:55], v[220:223], v[92:95]
    s_nop 2
    v_mfma_f32_16x16x16_bf16 v[80:83], v[56:57], v[224:225], v[80:83]
    v_mfma_f32_16x16x16_bf16 v[84:87], v[58:59], v[224:225], v[84:87]
    v_mfma_f32_16x16x16_bf16 v[88:91], v[60:61], v[224:225], v[88:91]
    v_mfma_f32_16x16x16_bf16 v[92:95], v[62:63], v[224:225], v[92:95]
    s_waitcnt vmcnt(11)
    s_add_u32 m0, s54, 19456
    s_nop 0
    buffer_load_dwordx4 v237, s[24:27], s55 offen nt lds
    s_waitcnt vmcnt(11)
    s_add_u32 s55, s58, 56
    s_and_b32 s55, s55, 63
    s_mul_i32 s55, s55, 6144
    s_add_u32 s55, s55, 256
    s_add_u32 m0, s54, 20480
    s_nop 0
    buffer_load_dwordx4 v236, s[24:27], s55 offen nt lds
    s_waitcnt vmcnt(11)
    s_add_u32 m0, s54, 21504
    s_nop 0
    buffer_load_dwordx4 v237, s[24:27], s55 offen nt lds
    s_waitcnt vmcnt(10)
    s_add_u32 s55, s58, 60
    s_and_b32 s55, s55, 63
    s_mul_i32 s55, s55, 6144
    s_add_u32 s55, s55, 256
    s_add_u32 m0, s54, 22528
    s_nop 0
    buffer_load_dwordx4 v236, s[24:27], s55 offen nt lds
    ds_read_b64_tr_b16 v[40:41], v238 offset:6144
    ds_read_b64_tr_b16 v[42:43], v238 offset:8192
    ds_read_b64_tr_b16 v[44:45], v239 offset:6144
    ds_read_b64_tr_b16 v[46:47], v239 offset:8192
    ds_read_b64_tr_b16 v[48:49], v240 offset:6144
    ds_read_b64_tr_b16 v[50:51], v240 offset:8192
    ds_read_b64_tr_b16 v[52:53], v241 offset:6144
    ds_read_b64_tr_b16 v[54:55], v241 offset:8192
    ds_read_b64_tr_b16 v[56:57], v238 offset:10240
    ds_read_b64_tr_b16 v[58:59], v239 offset:10240
    ds_read_b64_tr_b16 v[60:61], v240 offset:10240
    ds_read_b64_tr_b16 v[62:63], v241 offset:10240
    s_waitcnt lgkmcnt(0)
    s_waitcnt vmcnt(10)
    s_add_u32 m0, s54, 23552
    s_nop 0
    buffer_load_dwordx4 v237, s[24:27], s55 offen nt lds
    v_mfma_f32_16x16x32_bf16 v[80:83], v[40:43], v[226:229], v[80:83]
    v_mfma_f32_16x16x32_bf16 v[84:87], v[44:47], v[226:229], v[84:87]
    v_mfma_f32_16x16x32_bf16 v[88:91], v[48:51], v[226:229], v[88:91]
    v_mfma_f32_16x16x32_bf16 v[92:95], v[52:55], v[226:229], v[92:95]
    s_nop 2
    v_mfma_f32_16x16x16_bf16 v[80:83], v[56:57], v[230:231], v[80:83]
    v_mfma_f32_16x16x16_bf16 v[84:87], v[58:59], v[230:231], v[84:87]
    v_mfma_f32_16x16x16_bf16 v[88:91], v[60:61], v[230:231], v[88:91]
    v_mfma_f32_16x16x16_bf16 v[92:95], v[62:63], v[230:231], v[92:95]
    s_mov_b32 exec_lo, 0x000f000f
    s_mov_b32 exec_hi, 0x000f000f
    s_nop 2
    ds_write_b128 v242, v[80:83] offset:4096
    ds_write_b128 v242, v[84:87] offset:5120
    ds_write_b128 v242, v[88:91] offset:6144
    ds_write_b128 v242, v[92:95] offset:7168
    s_mov_b64 exec, -1
    s_waitcnt lgkmcnt(0)
    s_barrier
    ds_read_b128 v[40:43], v243 offset:4096
    ds_read_b128 v[44:47], v243 offset:5120
    ds_read_b128 v[48:51], v243 offset:6144
    ds_read_b128 v[52:55], v243 offset:7168
    s_waitcnt lgkmcnt(3)
    v_add_f32_dpp v40, v40, v40 row_ror:8 row_mask:0xf bank_mask:0xf
    v_add_f32_dpp v41, v41, v41 row_ror:8 row_mask:0xf bank_mask:0xf
    v_add_f32_dpp v42, v42, v42 row_ror:8 row_mask:0xf bank_mask:0xf
    v_add_f32_dpp v43, v43, v43 row_ror:8 row_mask:0xf bank_mask:0xf
    s_waitcnt lgkmcnt(2)
    v_add_f32_dpp v44, v44, v44 row_ror:8 row_mask:0xf bank_mask:0xf
    v_add_f32_dpp v45, v45, v45 row_ror:8 row_mask:0xf bank_mask:0xf
    v_add_f32_dpp v46, v46, v46 row_ror:8 row_mask:0xf bank_mask:0xf
    v_add_f32_dpp v47, v47, v47 row_ror:8 row_mask:0xf bank_mask:0xf
    s_waitcnt lgkmcnt(1)
    v_add_f32_dpp v48, v48, v48 row_ror:8 row_mask:0xf bank_mask:0xf
    v_add_f32_dpp v49, v49, v49 row_ror:8 row_mask:0xf bank_mask:0xf
    v_add_f32_dpp v50, v50, v50 row_ror:8 row_mask:0xf bank_mask:0xf
    v_add_f32_dpp v51, v51, v51 row_ror:8 row_mask:0xf bank_mask:0xf
    s_waitcnt lgkmcnt(0)
    v_add_f32_dpp v52, v52, v52 row_ror:8 row_mask:0xf bank_mask:0xf
    v_add_f32_dpp v53, v53, v53 row_ror:8 row_mask:0xf bank_mask:0xf
    v_add_f32_dpp v54, v54, v54 row_ror:8 row_mask:0xf bank_mask:0xf
    v_add_f32_dpp v55, v55, v55 row_ror:8 row_mask:0xf bank_mask:0xf
    v_add_f32_dpp v40, v40, v40 row_ror:4 row_mask:0xf bank_mask:0xf
    v_add_f32_dpp v41, v41, v41 row_ror:4 row_mask:0xf bank_mask:0xf
    v_add_f32_dpp v42, v42, v42 row_ror:4 row_mask:0xf bank_mask:0xf
    v_add_f32_dpp v43, v43, v43 row_ror:4 row_mask:0xf bank_mask:0xf
    v_add_f32_dpp v44, v44, v44 row_ror:4 row_mask:0xf bank_mask:0xf
    v_add_f32_dpp v45, v45, v45 row_ror:4 row_mask:0xf bank_mask:0xf
    v_add_f32_dpp v46, v46, v46 row_ror:4 row_mask:0xf bank_mask:0xf
    v_add_f32_dpp v47, v47, v47 row_ror:4 row_mask:0xf bank_mask:0xf
    v_add_f32_dpp v48, v48, v48 row_ror:4 row_mask:0xf bank_mask:0xf
    v_add_f32_dpp v49, v49, v49 row_ror:4 row_mask:0xf bank_mask:0xf
    v_add_f32_dpp v50, v50, v50 row_ror:4 row_mask:0xf bank_mask:0xf
    v_add_f32_dpp v51, v51, v51 row_ror:4 row_mask:0xf bank_mask:0xf
    v_add_f32_dpp v52, v52, v52 row_ror:4 row_mask:0xf bank_mask:0xf
    v_add_f32_dpp v53, v53, v53 row_ror:4 row_mask:0xf bank_mask:0xf
    v_add_f32_dpp v54, v54, v54 row_ror:4 row_mask:0xf bank_mask:0xf
    v_add_f32_dpp v55, v55, v55 row_ror:4 row_mask:0xf bank_mask:0xf
    v_cvt_pk_bf16_f32 v112, v40, v41
    v_cvt_pk_bf16_f32 v113, v42, v43
    v_cvt_pk_bf16_f32 v114, v44, v45
    v_cvt_pk_bf16_f32 v115, v46, v47
    v_cvt_pk_bf16_f32 v116, v48, v49
    v_cvt_pk_bf16_f32 v117, v50, v51
    v_cvt_pk_bf16_f32 v118, v52, v53
    v_cvt_pk_bf16_f32 v119, v54, v55
    s_nop 0
    v_mfma_f32_16x16x32_bf16 v[136:139], a[80:83], v[112:115], v[136:139]
    v_mfma_f32_16x16x32_bf16 v[140:143], a[84:87], v[112:115], v[140:143]
    v_mfma_f32_16x16x32_bf16 v[144:147], a[88:91], v[112:115], v[144:147]
    v_mfma_f32_16x16x32_bf16 v[148:151], a[92:95], v[112:115], v[148:151]
    v_mfma_f32_16x16x32_bf16 v[152:155], a[96:99], v[112:115], v[152:155]
    v_mfma_f32_16x16x32_bf16 v[156:159], a[100:103], v[112:115], v[156:159]
    v_mfma_f32_16x16x32_bf16 v[160:163], a[104:107], v[112:115], v[160:163]
    v_mfma_f32_16x16x32_bf16 v[164:167], a[108:111], v[112:115], v[164:167]
    v_mfma_f32_16x16x32_bf16 v[168:171], a[112:115], v[112:115], v[168:171]
    v_mfma_f32_16x16x32_bf16 v[172:175], a[116:119], v[112:115], v[172:175]
    v_mfma_f32_16x16x32_bf16 v[136:139], a[120:123], v[116:119], v[136:139]
    v_mfma_f32_16x16x32_bf16 v[140:143], a[124:127], v[116:119], v[140:143]
    v_mfma_f32_16x16x32_bf16 v[144:147], a[128:131], v[116:119], v[144:147]
    v_mfma_f32_16x16x32_bf16 v[148:151], a[132:135], v[116:119], v[148:151]
    v_mfma_f32_16x16x32_bf16 v[152:155], a[136:139], v[116:119], v[152:155]
    v_mfma_f32_16x16x32_bf16 v[156:159], a[140:143], v[116:119], v[156:159]
    v_mfma_f32_16x16x32_bf16 v[160:163], a[144:147], v[116:119], v[160:163]
    v_mfma_f32_16x16x32_bf16 v[164:167], a[148:151], v[116:119], v[164:167]
    v_mfma_f32_16x16x32_bf16 v[168:171], a[152:155], v[116:119], v[168:171]
    v_mfma_f32_16x16x32_bf16 v[172:175], a[156:159], v[116:119], v[172:175]
    s_branch L_tailpage
    .p2align 12
L_tailpage:
    s_waitcnt vmcnt(6)
    s_mov_b32 s73, 100000
L_spin:
    v_readfirstlane_b32 s56, v252
    s_sub_u32 s73, s73, 1
    s_cbranch_scc1 L_spin_done
    s_cmp_lg_u32 s56, 0
    s_cbranch_scc1 L_spin_done
    buffer_load_dword v252, off, s[48:51], s78 sc1
    s_waitcnt vmcnt(0)
    s_branch L_spin
L_spin_done:
    s_bfe_u32 s64, s56, 0x80000
    s_bfe_u32 s65, s56, 0x80008
    s_bfe_u32 s66, s56, 0x80010
    s_bfe_u32 s67, s56, 0x80018
    ds_read_b64_tr_b16 v[40:41], v238 offset:12288
    ds_read_b64_tr_b16 v[42:43], v238 offset:14336
    ds_read_b64_tr_b16 v[44:45], v239 offset:12288
    ds_read_b64_tr_b16 v[46:47], v239 offset:14336
    ds_read_b64_tr_b16 v[48:49], v240 offset:12288
    ds_read_b64_tr_b16 v[50:51], v240 offset:14336
    ds_read_b64_tr_b16 v[52:53], v241 offset:12288
    ds_read_b64_tr_b16 v[54:55], v241 offset:14336
    ds_read_b64_tr_b16 v[56:57], v238 offset:16384
    ds_read_b64_tr_b16 v[58:59], v239 offset:16384
    ds_read_b64_tr_b16 v[60:61], v240 offset:16384
    ds_read_b64_tr_b16 v[62:63], v241 offset:16384
    s_waitcnt lgkmcnt(0)
    v_mfma_f32_16x16x32_bf16 v[96:99], v[40:43], v[220:223], v[96:99]
    v_mfma_f32_16x16x32_bf16 v[100:103], v[44:47], v[220:223], v[100:103]
    v_mfma_f32_16x16x32_bf16 v[104:107], v[48:51], v[220:223], v[104:107]
    v_mfma_f32_16x16x32_bf16 v[108:111], v[52:55], v[220:223], v[108:111]
    s_nop 2
    v_mfma_f32_16x16x16_bf16 v[96:99], v[56:57], v[224:225], v[96:99]
    v_mfma_f32_16x16x16_bf16 v[100:103], v[58:59], v[224:225], v[100:103]
    v_mfma_f32_16x16x16_bf16 v[104:107], v[60:61], v[224:225], v[104:107]
    v_mfma_f32_16x16x16_bf16 v[108:111], v[62:63], v[224:225], v[108:111]
    s_waitcnt vmcnt(2)
    ds_read_b64_tr_b16 v[40:41], v238 offset:18432
    ds_read_b64_tr_b16 v[42:43], v238 offset:20480
    ds_read_b64_tr_b16 v[44:45], v239 offset:18432
    ds_read_b64_tr_b16 v[46:47], v239 offset:20480
    ds_read_b64_tr_b16 v[48:49], v240 offset:18432
    ds_read_b64_tr_b16 v[50:51], v240 offset:20480
    ds_read_b64_tr_b16 v[52:53], v241 offset:18432
    ds_read_b64_tr_b16 v[54:55], v241 offset:20480
    s_waitcnt lgkmcnt(0)
    v_mfma_f32_16x16x32_bf16 v[96:99], v[40:43], v[226:229], v[96:99]
    v_mfma_f32_16x16x32_bf16 v[100:103], v[44:47], v[226:229], v[100:103]
    v_mfma_f32_16x16x32_bf16 v[104:107], v[48:51], v[226:229], v[104:107]
    v_mfma_f32_16x16x32_bf16 v[108:111], v[52:55], v[226:229], v[108:111]
    s_waitcnt vmcnt(0)
    ds_read_b64_tr_b16 v[56:57], v238 offset:22528
    ds_read_b64_tr_b16 v[58:59], v239 offset:22528
    ds_read_b64_tr_b16 v[60:61], v240 offset:22528
    ds_read_b64_tr_b16 v[62:63], v241 offset:22528
    s_waitcnt lgkmcnt(3)
    v_mfma_f32_16x16x16_bf16 v[96:99], v[56:57], v[230:231], v[96:99]
    s_waitcnt lgkmcnt(2)
    v_mfma_f32_16x16x16_bf16 v[100:103], v[58:59], v[230:231], v[100:103]
    s_waitcnt lgkmcnt(1)
    v_mfma_f32_16x16x16_bf16 v[104:107], v[60:61], v[230:231], v[104:107]
    s_waitcnt lgkmcnt(0)
    v_mfma_f32_16x16x16_bf16 v[108:111], v[62:63], v[230:231], v[108:111]
    s_mov_b32 exec_lo, 0x000f000f
    s_mov_b32 exec_hi, 0x000f000f
    s_nop 2
    ds_write_b128 v242, v[96:99] offset:8192
    ds_write_b128 v242, v[100:103] offset:9216
    ds_write_b128 v242, v[104:107] offset:10240
    ds_write_b128 v242, v[108:111] offset:11264
    s_mov_b64 exec, -1
    s_waitcnt lgkmcnt(0)
    s_barrier
    ds_read_b128 v[40:43], v243 offset:8192
    ds_read_b128 v[44:47], v243 offset:9216
    ds_read_b128 v[48:51], v243 offset:10240
    ds_read_b128 v[52:55], v243 offset:11264
    s_waitcnt lgkmcnt(3)
    v_add_f32_dpp v40, v40, v40 row_ror:8 row_mask:0xf bank_mask:0xf
    v_add_f32_dpp v41, v41, v41 row_ror:8 row_mask:0xf bank_mask:0xf
    v_add_f32_dpp v42, v42, v42 row_ror:8 row_mask:0xf bank_mask:0xf
    v_add_f32_dpp v43, v43, v43 row_ror:8 row_mask:0xf bank_mask:0xf
    s_waitcnt lgkmcnt(2)
    v_add_f32_dpp v44, v44, v44 row_ror:8 row_mask:0xf bank_mask:0xf
    v_add_f32_dpp v45, v45, v45 row_ror:8 row_mask:0xf bank_mask:0xf
    v_add_f32_dpp v46, v46, v46 row_ror:8 row_mask:0xf bank_mask:0xf
    v_add_f32_dpp v47, v47, v47 row_ror:8 row_mask:0xf bank_mask:0xf
    s_waitcnt lgkmcnt(1)
    v_add_f32_dpp v48, v48, v48 row_ror:8 row_mask:0xf bank_mask:0xf
    v_add_f32_dpp v49, v49, v49 row_ror:8 row_mask:0xf bank_mask:0xf
    v_add_f32_dpp v50, v50, v50 row_ror:8 row_mask:0xf bank_mask:0xf
    v_add_f32_dpp v51, v51, v51 row_ror:8 row_mask:0xf bank_mask:0xf
    s_waitcnt lgkmcnt(0)
    v_add_f32_dpp v52, v52, v52 row_ror:8 row_mask:0xf bank_mask:0xf
    v_add_f32_dpp v53, v53, v53 row_ror:8 row_mask:0xf bank_mask:0xf
    v_add_f32_dpp v54, v54, v54 row_ror:8 row_mask:0xf bank_mask:0xf
    v_add_f32_dpp v55, v55, v55 row_ror:8 row_mask:0xf bank_mask:0xf
    v_add_f32_dpp v40, v40, v40 row_ror:4 row_mask:0xf bank_mask:0xf
    v_add_f32_dpp v41, v41, v41 row_ror:4 row_mask:0xf bank_mask:0xf
    v_add_f32_dpp v42, v42, v42 row_ror:4 row_mask:0xf bank_mask:0xf
    v_add_f32_dpp v43, v43, v43 row_ror:4 row_mask:0xf bank_mask:0xf
    v_add_f32_dpp v44, v44, v44 row_ror:4 row_mask:0xf bank_mask:0xf
    v_add_f32_dpp v45, v45, v45 row_ror:4 row_mask:0xf bank_mask:0xf
    v_add_f32_dpp v46, v46, v46 row_ror:4 row_mask:0xf bank_mask:0xf
    v_add_f32_dpp v47, v47, v47 row_ror:4 row_mask:0xf bank_mask:0xf
    v_add_f32_dpp v48, v48, v48 row_ror:4 row_mask:0xf bank_mask:0xf
    v_add_f32_dpp v49, v49, v49 row_ror:4 row_mask:0xf bank_mask:0xf
    v_add_f32_dpp v50, v50, v50 row_ror:4 row_mask:0xf bank_mask:0xf
    v_add_f32_dpp v51, v51, v51 row_ror:4 row_mask:0xf bank_mask:0xf
    v_add_f32_dpp v52, v52, v52 row_ror:4 row_mask:0xf bank_mask:0xf
    v_add_f32_dpp v53, v53, v53 row_ror:4 row_mask:0xf bank_mask:0xf
    v_add_f32_dpp v54, v54, v54 row_ror:4 row_mask:0xf bank_mask:0xf
    v_add_f32_dpp v55, v55, v55 row_ror:4 row_mask:0xf bank_mask:0xf
    v_cvt_pk_bf16_f32 v112, v40, v41
    v_cvt_pk_bf16_f32 v113, v42, v43
    v_cvt_pk_bf16_f32 v114, v44, v45
    v_cvt_pk_bf16_f32 v115, v46, v47
    v_cvt_pk_bf16_f32 v116, v48, v49
    v_cvt_pk_bf16_f32 v117, v50, v51
    v_cvt_pk_bf16_f32 v118, v52, v53
    v_cvt_pk_bf16_f32 v119, v54, v55
    s_nop 0
    v_mfma_f32_16x16x32_bf16 v[136:139], a[160:163], v[112:115], v[136:139]
    v_mfma_f32_16x16x32_bf16 v[136:139], a[200:203], v[116:119], v[136:139]
    v_mfma_f32_16x16x32_bf16 v[140:143], a[164:167], v[112:115], v[140:143]
    v_mfma_f32_16x16x32_bf16 v[140:143], a[204:207], v[116:119], v[140:143]
    v_mfma_f32_16x16x32_bf16 v[144:147], a[168:171], v[112:115], v[144:147]
    v_mfma_f32_16x16x32_bf16 v[144:147], a[208:211], v[116:119], v[144:147]
    v_mfma_f32_16x16x32_bf16 v[148:151], a[172:175], v[112:115], v[148:151]
    v_mfma_f32_16x16x32_bf16 v[148:151], a[212:215], v[116:119], v[148:151]
    v_mfma_f32_16x16x32_bf16 v[152:155], a[176:179], v[112:115], v[152:155]
    v_mfma_f32_16x16x32_bf16 v[152:155], a[216:219], v[116:119], v[152:155]
    v_mfma_f32_16x16x32_bf16 v[156:159], a[180:183], v[112:115], v[156:159]
    v_mfma_f32_16x16x32_bf16 v[156:159], a[220:223], v[116:119], v[156:159]
    v_mov_b32_dpp v136, v140 quad_perm:[0,1,2,3] row_mask:0xf bank_mask:0x2
    v_mov_b32_dpp v137, v141 quad_perm:[0,1,2,3] row_mask:0xf bank_mask:0x2
    v_mfma_f32_16x16x32_bf16 v[160:163], a[184:187], v[112:115], v[160:163]
    v_mov_b32_dpp v138, v142 quad_perm:[0,1,2,3] row_mask:0xf bank_mask:0x2
    v_mov_b32_dpp v139, v143 quad_perm:[0,1,2,3] row_mask:0xf bank_mask:0x2
    v_mfma_f32_16x16x32_bf16 v[160:163], a[224:227], v[116:119], v[160:163]
    v_mov_b32_dpp v136, v144 quad_perm:[0,1,2,3] row_mask:0xf bank_mask:0x4
    v_mov_b32_dpp v137, v145 quad_perm:[0,1,2,3] row_mask:0xf bank_mask:0x4
    v_mfma_f32_16x16x32_bf16 v[164:167], a[188:191], v[112:115], v[164:167]
    v_mov_b32_dpp v138, v146 quad_perm:[0,1,2,3] row_mask:0xf bank_mask:0x4
    v_mov_b32_dpp v139, v147 quad_perm:[0,1,2,3] row_mask:0xf bank_mask:0x4
    v_mfma_f32_16x16x32_bf16 v[164:167], a[228:231], v[116:119], v[164:167]
    v_mov_b32_dpp v136, v148 quad_perm:[0,1,2,3] row_mask:0xf bank_mask:0x8
    v_mov_b32_dpp v137, v149 quad_perm:[0,1,2,3] row_mask:0xf bank_mask:0x8
    v_mfma_f32_16x16x32_bf16 v[168:171], a[192:195], v[112:115], v[168:171]
    v_mov_b32_dpp v138, v150 quad_perm:[0,1,2,3] row_mask:0xf bank_mask:0x8
    v_mov_b32_dpp v139, v151 quad_perm:[0,1,2,3] row_mask:0xf bank_mask:0x8
    v_mfma_f32_16x16x32_bf16 v[168:171], a[232:235], v[116:119], v[168:171]
    v_and_or_b32 v136, v136, v33, s64
    v_and_or_b32 v137, v137, v33, s65
    v_mfma_f32_16x16x32_bf16 v[172:175], a[196:199], v[112:115], v[172:175]
    v_and_or_b32 v138, v138, v33, s66
    v_and_or_b32 v139, v139, v33, s67
    v_mfma_f32_16x16x32_bf16 v[172:175], a[236:239], v[116:119], v[172:175]
    buffer_store_dwordx4 v[136:139], v39, s[40:43], s60 offen sc1
    v_mov_b32_dpp v152, v156 quad_perm:[0,1,2,3] row_mask:0xf bank_mask:0x2
    v_mov_b32_dpp v153, v157 quad_perm:[0,1,2,3] row_mask:0xf bank_mask:0x2
    v_mov_b32_dpp v154, v158 quad_perm:[0,1,2,3] row_mask:0xf bank_mask:0x2
    v_mov_b32_dpp v155, v159 quad_perm:[0,1,2,3] row_mask:0xf bank_mask:0x2
    v_mov_b32_dpp v152, v160 quad_perm:[0,1,2,3] row_mask:0xf bank_mask:0x4
    v_mov_b32_dpp v153, v161 quad_perm:[0,1,2,3] row_mask:0xf bank_mask:0x4
    v_mov_b32_dpp v154, v162 quad_perm:[0,1,2,3] row_mask:0xf bank_mask:0x4
    v_mov_b32_dpp v155, v163 quad_perm:[0,1,2,3] row_mask:0xf bank_mask:0x4
    v_mov_b32_dpp v152, v164 quad_perm:[0,1,2,3] row_mask:0xf bank_mask:0x8
    v_mov_b32_dpp v153, v165 quad_perm:[0,1,2,3] row_mask:0xf bank_mask:0x8
    v_mov_b32_dpp v154, v166 quad_perm:[0,1,2,3] row_mask:0xf bank_mask:0x8
    v_mov_b32_dpp v155, v167 quad_perm:[0,1,2,3] row_mask:0xf bank_mask:0x8
    v_and_or_b32 v152, v152, v33, s64
    v_and_or_b32 v153, v153, v33, s65
    v_and_or_b32 v154, v154, v33, s66
    v_and_or_b32 v155, v155, v33, s67
    buffer_store_dwordx4 v[152:155], v39, s[40:43], s61 offen sc1
    v_mov_b32_dpp v168, v172 quad_perm:[0,1,2,3] row_mask:0xf bank_mask:0x2
    v_mov_b32_dpp v169, v173 quad_perm:[0,1,2,3] row_mask:0xf bank_mask:0x2
    v_mov_b32_dpp v170, v174 quad_perm:[0,1,2,3] row_mask:0xf bank_mask:0x2
    v_mov_b32_dpp v171, v175 quad_perm:[0,1,2,3] row_mask:0xf bank_mask:0x2
    v_and_or_b32 v168, v168, v33, s64
    v_and_or_b32 v169, v169, v33, s65
    v_and_or_b32 v170, v170, v33, s66
    v_and_or_b32 v171, v171, v33, s67
    buffer_store_dwordx4 v[168:171], v255, s[40:43], s62 offen sc1
    s_cmp_ge_u32 s72, 80
    s_cbranch_scc1 L_fin
    s_mov_b32 s73, 100000
    s_waitcnt vmcnt(0)
L_poll:
    buffer_load_dwordx4 v[136:139], v232, s[28:31], 0 offen offset:0 sc1
    buffer_load_dwordx4 v[140:143], v232, s[28:31], 0 offen offset:1024 sc1
    buffer_load_dwordx4 v[144:147], v232, s[28:31], 0 offen offset:2048 sc1
    buffer_load_dwordx4 v[148:151], v232, s[28:31], 0 offen offset:3072 sc1
    s_waitcnt vmcnt(3)
    v_xor_b32 v136, s64, v136
    v_xor_b32 v137, s65, v137
    v_xor_b32 v138, s66, v138
    v_xor_b32 v139, s67, v139
    v_or3_b32 v44, v136, v137, v138
    v_or_b32 v44, v44, v139
    s_waitcnt vmcnt(2)
    v_xor_b32 v140, s64, v140
    v_xor_b32 v141, s65, v141
    v_xor_b32 v142, s66, v142
    v_xor_b32 v143, s67, v143
    v_or3_b32 v44, v44, v140, v141
    v_or3_b32 v44, v44, v142, v143
    v_add_f32 v40, v136, v140
    v_add_f32 v41, v137, v141
    v_add_f32 v42, v138, v142
    v_add_f32 v43, v139, v143
    s_waitcnt vmcnt(1)
    v_xor_b32 v144, s64, v144
    v_xor_b32 v145, s65, v145
    v_xor_b32 v146, s66, v146
    v_xor_b32 v147, s67, v147
    v_or3_b32 v44, v44, v144, v145
    v_or3_b32 v44, v44, v146, v147
    v_add_f32 v40, v40, v144
    v_add_f32 v41, v41, v145
    v_add_f32 v42, v42, v146
    v_add_f32 v43, v43, v147
    s_waitcnt vmcnt(0)
    v_xor_b32 v148, s64, v148
    v_xor_b32 v149, s65, v149
    v_xor_b32 v150, s66, v150
    v_xor_b32 v151, s67, v151
    v_or3_b32 v44, v44, v148, v149
    v_or3_b32 v44, v44, v150, v151
    v_add_f32 v40, v40, v148
    v_add_f32 v41, v41, v149
    v_add_f32 v42, v42, v150
    v_add_f32 v43, v43, v151
    v_and_b32 v44, 0xff, v44
    v_cmp_ne_u32 vcc, 0, v44
    s_sub_u32 s73, s73, 1
    s_cbranch_scc1 L_ready
    s_cbranch_vccnz L_poll
L_ready:
    v_permlane32_swap_b32 v40, v41
    v_permlane32_swap_b32 v42, v43
    s_nop 0
    v_add_f32 v40, v40, v41
    v_add_f32 v42, v42, v43
    s_nop 1
    v_permlane16_swap_b32 v40, v42
    s_nop 0
    v_add_f32 v40, v40, v42
    s_nop 1
    v_add_f32_dpp v40, v40, v40 row_ror:8 row_mask:0xf bank_mask:0xf
    v_cvt_pk_bf16_f32 v40, v40, v40
    buffer_store_short v40, v234, s[44:47], 0 offen
L_fin:
L_end:
    s_endpgm

.section .rodata,"a"
.p2align 6
.amdhsa_kernel standalone__sliding_block_cached__sampling_kernel
  .amdhsa_next_free_vgpr 496
  .amdhsa_next_free_sgpr 102
  .amdhsa_accum_offset 256
  .amdhsa_group_segment_fixed_size 0
  .amdhsa_kernarg_size 64
  .amdhsa_user_sgpr_count 2
  .amdhsa_user_sgpr_kernarg_segment_ptr 1
  .amdhsa_system_sgpr_workgroup_id_x 1
  .amdhsa_float_denorm_mode_32 3
.end_amdhsa_kernel
```
